```python
import torch

def _softmax(x, axis=-1):
    return torch.softmax(x, dim=axis)

def _gelu(x):
    return torch.nn.functional.gelu(x, approximate='tanh')

def _silu(x):
    return torch.nn.functional.silu(x)

def _sigmoid(x):
    return torch.sigmoid(x)

def _layernorm(x, axis=-1, eps=1e-05):
    m = x.mean(dim=axis, keepdim=True)
    v = x.var(dim=axis, keepdim=True, unbiased=False)
    return (x - m) / torch.sqrt(v + eps)

def _scatter_add(tgt, idx, src, axis=0):
    return tgt.clone().index_add_(axis, idx, src)

def _segment_sum(src, seg, n):
    out = torch.zeros((n,) + src.shape[1:], dtype=src.dtype)
    return out.index_add_(0, seg, src)

def _pad(x, pw):
    flat = tuple((v for pair in reversed(pw) for v in pair))
    return torch.nn.functional.pad(x, flat)
kernel_name = 'gated_mix__memory_aug_recurrent_mem_tr__moe_arch_mod__prompt'

def setup_inputs():

    _w = lambda a: (lambda t: t.to(torch.bfloat16) if t.is_floating_point() else t)(torch.as_tensor(a))

    def _A_setup():
        B, S, Dm = (1, 2048, 1024)
        H, Dh = (32, 128)
        M, seg = (8, 32)
        seg = min(seg, S)
        S = S // seg * seg
        return {'x': _w((lambda *s: torch.randn(*s, dtype=torch.bfloat16) * 0.05)(B, S, Dm)), 'mem0': _w((lambda *s: torch.randn(*s, dtype=torch.bfloat16) * 0.8)(B, M, Dm)), 'Wq': _w((lambda *s: torch.randn(*s, dtype=torch.bfloat16) * 3.2)(Dm, H, Dh) * Dm ** (-0.5)), 'Wk': _w((lambda *s: torch.randn(*s, dtype=torch.bfloat16) * 3.2)(Dm, H, Dh) * Dm ** (-0.5)), 'Wv': _w((lambda *s: torch.randn(*s, dtype=torch.bfloat16) * 0.8)(Dm, H, Dh) * Dm ** (-0.5)), 'Wo': _w((lambda *s: torch.randn(*s, dtype=torch.bfloat16) * 0.8)(H, Dh, Dm) * (H * Dh) ** (-0.5)), 'seg_len': seg}
    _A_in = _A_setup()

    def _B_setup():
        B, S, D, F, C = (1, 2048, 1024, 3584, 8)
        return {'x': _w((lambda *s: torch.randn(*s, dtype=torch.bfloat16) * 0.05)(B, S, D)), 'w_r': _w((lambda *s: torch.randn(*s, dtype=torch.bfloat16) * 1.6)(D)), 'w_gate': _w((lambda *s: torch.randn(*s, dtype=torch.bfloat16) * 0.1)(D, F)), 'w_up': _w((lambda *s: torch.randn(*s, dtype=torch.bfloat16) * 0.1)(D, F)), 'w_down': _w((lambda *s: torch.randn(*s, dtype=torch.bfloat16) * 0.1)(F, D))}
    _B_in = _B_setup()
    return {'A_x': _A_in['x'], 'A_mem0': _A_in['mem0'], 'A_Wq': _A_in['Wq'], 'A_Wk': _A_in['Wk'], 'A_Wv': _A_in['Wv'], 'A_Wo': _A_in['Wo'], 'A_seg_len': _A_in['seg_len'], 'B_x': _B_in['x'], 'B_w_r': _B_in['w_r'], 'B_w_gate': _B_in['w_gate'], 'B_w_up': _B_in['w_up'], 'B_w_down': _B_in['w_down'], 'gate_w': _w((lambda *s: torch.randn(*s, dtype=torch.bfloat16) * 0.05)(1024) * 16.0)}

def reference(A_x, A_mem0, A_Wq, A_Wk, A_Wv, A_Wo, A_seg_len, B_x, B_w_r, B_w_gate, B_w_up, B_w_down, gate_w):

    def _A_ref(x, mem0, Wq, Wk, Wv, Wo, seg_len):
        B, S, Dm = x.shape
        H, Dh = (Wq.shape[1], Wq.shape[2])
        M = mem0.shape[1]
        scale = Dh ** (-0.5)
        n_seg = S // seg_len
        L = M + seg_len
        idx = torch.arange(L)
        mask = (idx[:, None] < M) | (idx[:, None] >= idx[None, :])
        mem = mem0
        outs = []
        for s in range(n_seg):
            xs = x[:, s * seg_len:(s + 1) * seg_len, :].clone()
            h = torch.concatenate([mem, xs], axis=1)
            q = torch.einsum('btd,dhe->bhte', h, Wq)
            k = torch.einsum('btd,dhe->bhte', h, Wk)
            v = torch.einsum('btd,dhe->bhte', h, Wv)
            scores = torch.einsum('bhqe,bhke->bhqk', q, k) * scale
            scores = torch.where(mask[None, None], scores, -1000000000.0)
            p = _softmax(scores, axis=-1)
            o = torch.einsum('bhqk,bhke->bhqe', p, v)
            o = torch.einsum('bhte,hed->btd', o, Wo)
            mem = o[:, :M, :].clone()
            outs.append(o[:, M:, :])
        return torch.concatenate(outs, axis=1)

    def _B_ref(x, w_r, w_gate, w_up, w_down):
        B, S, D = x.shape
        C = 8
        r = x @ w_r
        idx = torch.argsort(-r, axis=-1)[:, :C]
        idx_e = (lambda x, n, axis: torch.repeat_interleave(x, n, dim=axis))(idx.reshape(B, C, 1), D, axis=2)
        x_sel = (lambda x, i, axis: torch.take_along_dim(x, i, dim=axis))(x, idx_e, axis=1)
        g = _silu(x_sel @ w_gate)
        u = x_sel @ w_up
        y = g * u @ w_down
        r_sel = _sigmoid((lambda x, i, axis: torch.take_along_dim(x, i, dim=axis))(r, idx, axis=1))
        y = y * r_sel.reshape(B, C, 1)
        b_off = (torch.arange(B) * S).reshape(B, 1)
        flat_idx = (idx + b_off).reshape(B * C)
        zero = (x * 0.0).reshape(B * S, D)
        upd = _scatter_add(zero, flat_idx, y.reshape(B * C, D), axis=0)
        return x + upd.reshape(B, S, D)
    x = A_x
    g = _sigmoid((x * gate_w).sum(-1, keepdims=True))
    a = _A_ref(x, A_mem0, A_Wq, A_Wk, A_Wv, A_Wo, A_seg_len)
    b = _B_ref(x, B_w_r, B_w_gate, B_w_up, B_w_down)
    return g * a + (1 - g) * b
```

```asm
; @launch grid=(256,1,1) block=(256,1,1) lds=163840
.amdgcn_target "amdgcn-amd-amdhsa--gfx950"
.text
.globl gated_mix__memory_aug_recurrent_mem_tr__moe_arch_mod__prompt_kernel
.p2align 8
.type gated_mix__memory_aug_recurrent_mem_tr__moe_arch_mod__prompt_kernel,@function
gated_mix__memory_aug_recurrent_mem_tr__moe_arch_mod__prompt_kernel:
    s_cmp_ge_u32 s2, 256
    s_cbranch_scc1 L_exit
    s_load_dwordx16 s[16:31], s[0:1], 0
    s_load_dwordx16 s[32:47], s[0:1], 64
    s_getreg_b32 s12, hwreg(HW_REG_XCC_ID, 0, 4)
    v_lshrrev_b32 v1, 6, v0
    v_and_b32 v0, 63, v0
    v_readfirstlane_b32 s14, v1
    s_mov_b32 s15, 131072
    s_mov_b32 s3, 64
    s_lshr_b32 s13, s12, 1
    s_and_b32 s13, s13, 2
    s_xor_b32 s12, s12, s13
    s_and_b32 s12, s12, 7
    s_lshr_b32 s13, s2, 3
    s_waitcnt lgkmcnt(0)
    s_mov_b32 s4, s46
    s_and_b32 s5, s47, 0xffff
    s_mov_b32 s6, 268435456
    s_mov_b32 s7, 0x20000
L_roles:
    s_cmp_lt_u32 s12, 4
    s_cbranch_scc1 L_rec
    s_cmp_lt_u32 s12, 6
    s_cbranch_scc1 L_kv
    s_cmp_eq_u32 s12, 6
    s_cbranch_scc1 L_q
    s_cmp_eq_u32 s12, 7
    s_cbranch_scc1 L_kv
    s_barrier
    s_cmp_lg_u32 s14, 3
    s_cbranch_scc1 L_arr_1
    s_mov_b32 s91, 0x100
    s_bfm_b32 s90, 1, s13
    s_lshl_b32 s92, s12, 3
    s_add_u32 s92, s92, s3
    s_atomic_add_x2 s[90:91], s[44:45], s92
L_arr_1:
    v_and_b32 v254, 7, v0
    v_lshl_add_u32 v254, v254, 3, s3
L_wall_2:
    global_load_dwordx2 v[250:251], v254, s[44:45] sc1
    s_waitcnt vmcnt(0)
    v_lshrrev_b32 v255, 8, v251
    s_nop 1
    v_add_u32_dpp v255, v255, v255 row_ror:1 row_mask:0xf bank_mask:0xf
    s_nop 1
    v_add_u32_dpp v255, v255, v255 row_ror:2 row_mask:0xf bank_mask:0xf
    s_nop 1
    v_add_u32_dpp v255, v255, v255 row_ror:4 row_mask:0xf bank_mask:0xf
    s_nop 0
    v_readfirstlane_b32 s100, v255
    s_nop 0
    s_and_b32 s64, s100, 0x1ff
    s_cmp_eq_u32 s64, 256
    s_cbranch_scc1 L_walld_3
    s_sleep 4
    s_sub_u32 s15, s15, 1
    s_cbranch_scc0 L_wall_2
    s_branch L_abort
L_walld_3:
    v_cmp_ne_u32 vcc, -1, v250
    s_cbranch_vccnz L_restart
    s_bfe_u32 s64, s100, 0x80009
    s_lshr_b32 s100, s100, 17
    s_cmp_gt_u32 s100, s64
    s_cselect_b32 s100, 0x2000, 0
    s_branch L_drain
L_kv:
    s_cmp_eq_u32 s12, 5
    s_cselect_b32 s73, 1, 0
    s_lshl_b32 s69, s13, 8
    s_lshl_b32 s64, s14, 6
    s_add_u32 s69, s69, s64
    s_cmp_eq_u32 s12, 4
    s_cselect_b32 s20, s22, s20
    s_cselect_b32 s21, s23, s21
    s_cmp_eq_u32 s12, 5
    s_cselect_b32 s20, s24, s20
    s_cselect_b32 s21, s25, s21
    s_mov_b32 s48, s20
    s_and_b32 s49, s21, 0xffff
    s_mov_b32 s50, 8388608
    s_mov_b32 s51, 0x20000
    v_lshrrev_b32 v3, 2, v0
    v_and_b32 v1, 3, v0
    v_lshlrev_b32 v1, 4, v1
    v_lshl_add_u32 v1, v3, 13, v1
    s_mul_i32 s64, s14, 24576
    s_add_u32 m0, s64, 65536
    s_xor_b32 s65, s69, 0
    buffer_load_dwordx4 v1, s[48:51], s65 offen  lds
    s_add_u32 m0, m0, 1024
    s_xor_b32 s65, s69, 131072
    buffer_load_dwordx4 v1, s[48:51], s65 offen  lds
    s_add_u32 m0, m0, 1024
    s_xor_b32 s65, s69, 262144
    buffer_load_dwordx4 v1, s[48:51], s65 offen  lds
    s_add_u32 m0, m0, 1024
    s_xor_b32 s65, s69, 393216
    buffer_load_dwordx4 v1, s[48:51], s65 offen  lds
    s_add_u32 m0, m0, 1024
    s_xor_b32 s65, s69, 524288
    buffer_load_dwordx4 v1, s[48:51], s65 offen  lds
    s_add_u32 m0, m0, 1024
    s_xor_b32 s65, s69, 655360
    buffer_load_dwordx4 v1, s[48:51], s65 offen  lds
    s_add_u32 m0, m0, 1024
    s_xor_b32 s65, s69, 786432
    buffer_load_dwordx4 v1, s[48:51], s65 offen  lds
    s_add_u32 m0, m0, 1024
    s_xor_b32 s65, s69, 917504
    buffer_load_dwordx4 v1, s[48:51], s65 offen  lds
    s_mov_b32 s68, 0
    s_mov_b32 s71, 0
    s_lshl_b32 s64, s13, 7
    s_lshl_b32 s65, s14, 3
    s_add_u32 s64, s64, s65
    s_mul_i32 s65, s73, 20
    s_xor_b32 s64, s64, s65
    s_add_u32 s64, s64, 85131264
    s_cmp_eq_u32 s12, 7
    s_cselect_b32 s65, 4096, 0
    s_add_u32 s64, s64, s65
    v_mov_b32 v69, s64
    v_cmp_eq_u32 vcc, 0, v0
    v_mov_b32 v3, 2147483648
    s_nop 0
    v_cndmask_b32 v69, v3, v69, vcc
    s_mov_b32 s87, s64
    s_mul_i32 s74, s73, 28
    s_add_u32 s74, s74, s13
    s_lshl_b32 s64, s74, 2
    s_lshl_b32 s65, s14, 8
    s_add_u32 s64, s64, s65
    s_add_u32 s64, s64, 85997568
    s_cmp_lt_u32 s13, 28
    s_cselect_b32 s64, s64, 2147483648
    v_mov_b32 v71, s64
    v_cmp_eq_u32 vcc, 0, v0
    v_mov_b32 v3, 2147483648
    s_nop 0
    v_cndmask_b32 v71, v3, v71, vcc
    s_lshl_b32 s64, s73, 5
    s_add_u32 s64, s64, s13
    s_lshl_b32 s64, s64, 2
    s_add_u32 s64, s64, s14
    s_lshl_b32 s64, s64, 2
    s_add_u32 s64, s64, 85996544
    v_mov_b32 v72, s64
    v_cmp_eq_u32 vcc, 0, v0
    v_mov_b32 v3, 2147483648
    s_nop 0
    v_cndmask_b32 v72, v3, v72, vcc
    s_cmp_lg_u32 s12, 7
    s_cbranch_scc1 L_d7_4
    s_lshl_b32 s64, s13, 2
    s_add_u32 s64, s64, 85995520
    v_mov_b32 v71, s64
    v_cmp_eq_u32 vcc, 0, v0
    v_mov_b32 v3, 2147483648
    s_nop 0
    v_cndmask_b32 v71, v3, v71, vcc
    v_and_b32 v72, 7, v0
    v_lshlrev_b32 v72, 2, v72
    v_add_u32 v72, 85995648, v72
L_d7_4:
    v_mov_b32 v70, 0
    buffer_store_dword v70, v69, s[4:7], 0 offen sc1
    buffer_store_dword v70, v71, s[4:7], 0 offen sc1
    buffer_store_dword v70, v72, s[4:7], 0 offen sc1
    s_movk_i32 s64, 0x2000
    buffer_store_dword v70, v69, s[4:7], s64 offen sc1
    s_lshl_b32 s64, s13, 14
    s_lshl_b32 s65, s14, 11
    s_add_u32 s64, s64, s65
    s_lshl_b32 s65, s73, 25
    s_add_u32 s64, s64, s65
    s_cmp_eq_u32 s12, 7
    s_cselect_b32 s65, 134217728, 0
    s_add_u32 s64, s64, s65
    v_and_b32 v68, 7, v0
    v_lshlrev_b32 v68, 4, v68
    v_lshrrev_b32 v3, 3, v0
    v_lshl_add_u32 v68, v3, 8, v68
    v_add_u32 v68, s64, v68
    s_mov_b32 s8, s16
    s_and_b32 s9, s17, 0xffff
    s_mov_b32 s10, 4194304
    s_mov_b32 s11, 0x20000
    s_lshr_b32 s64, s13, 1
    s_lshl_b32 s64, s64, 14
    s_and_b32 s65, s13, 1
    s_lshl_b32 s65, s65, 12
    s_add_u32 s64, s64, s65
    s_lshl_b32 s65, s14, 10
    s_add_u32 s64, s64, s65
    s_lshl_b32 s65, s73, 9
    s_add_u32 s64, s64, s65
    s_add_u32 s64, s64, 67108864
    s_cmp_eq_u32 s12, 7
    s_cselect_b32 s64, 2147483648, s64
    v_lshl_add_u32 v73, v0, 4, s64
    s_lshr_b32 s76, s13, 3
    s_and_b32 s77, s13, 7
    s_lshl_b32 s77, s77, 2
    s_add_u32 s77, s77, s14
    s_lshr_b32 s64, s77, 2
    s_lshl_b32 s64, s64, 14
    s_and_b32 s65, s77, 3
    s_lshl_b32 s65, s65, 11
    s_add_u32 s64, s64, s65
    s_lshl_b32 s65, s76, 9
    s_add_u32 s64, s64, s65
    s_add_u32 s64, s64, 167772160
    s_sub_u32 s64, s64, 512
    s_cmp_eq_u32 s12, 4
    s_cselect_b32 s64, s64, 2147483648
    v_lshl_add_u32 v88, v0, 4, s64
    v_cmp_gt_u32 vcc, 32, v0
    s_nop 1
    v_cndmask_b32 v73, v88, v73, vcc
    v_mov_b32 v76, -1
    v_mov_b32 v77, -1
    v_mov_b32 v78, -1
    v_mov_b32 v79, -1
    s_and_b32 s64, s13, 7
    s_lshl_b32 s64, s64, 16
    s_lshl_b32 s65, s14, 14
    s_add_u32 s64, s64, s65
    s_lshr_b32 s65, s13, 3
    s_lshl_b32 s65, s65, 12
    s_add_u32 s64, s64, s65
    s_and_b32 s65, s12, 3
    s_lshl_b32 s65, s65, 20
    s_add_u32 s64, s64, s65
    s_add_u32 s64, s64, 88080384
    v_lshlrev_b32 v88, 4, v0
    v_add_u32 v88, s64, v88
    v_mov_b32 v60, -1
    v_mov_b32 v61, -1
    v_mov_b32 v62, -1
    v_mov_b32 v63, -1
    s_mov_b32 s64, 0x80000
    buffer_store_dwordx4 v[60:63], v88, s[4:7], 0 offen offset:1024
    buffer_store_dwordx4 v[60:63], v88, s[4:7], s64 offen offset:1024
    buffer_store_dwordx4 v[60:63], v88, s[4:7], 0 offen offset:2048
    buffer_store_dwordx4 v[60:63], v88, s[4:7], s64 offen offset:2048
    buffer_store_dwordx4 v[60:63], v88, s[4:7], 0 offen offset:3072
    buffer_store_dwordx4 v[60:63], v88, s[4:7], s64 offen offset:3072
    v_lshrrev_b32 v88, 5, v0
    v_lshlrev_b32 v88, 4, v88
    v_bfe_u32 v89, v0, 3, 1
    v_lshl_add_u32 v88, v89, 3, v88
    v_mov_b32 v90, 0x4444
    v_mul_u32_u24 v89, 0xaaaa, v89
    v_add_u32 v90, v90, v89
    v_bfe_u32 v89, v0, 4, 1
    v_lshl_add_u32 v88, v89, 2, v88
    v_bfe_u32 v89, v0, 2, 1
    v_add_u32 v88, v88, v89
    v_lshlrev_b32 v88, 7, v88
    v_and_b32 v89, 3, v0
    v_lshl_add_u32 v88, v89, 3, v88
    s_lshl_b32 s75, s14, 13
    s_add_u32 s75, s75, 131072
    v_bfe_u32 v89, v88, 9, 2
    v_lshl_add_u32 v88, v89, 5, v88
    v_add_u32 v84, s75, v88
    v_xor_b32 v85, 32, v84
    v_xor_b32 v86, 64, v84
    v_xor_b32 v87, 96, v84
    v_lshlrev_b32 v91, 4, v0
    v_mov_b32 v80, 0
    v_mov_b32 v81, 0
    v_and_b32 v82, 0x70, v91
    v_and_b32 v88, 32, v0
    v_xor_b32 v82, v82, v88
    v_lshrrev_b32 v88, 5, v0
    v_and_b32 v89, 15, v0
    v_lshl_add_u32 v88, v88, 4, v89
    v_lshlrev_b32 v88, 5, v88
    v_bfe_u32 v89, v0, 4, 1
    v_lshl_add_u32 v92, v89, 4, v88
    s_lshl_b32 s88, s74, 15
    s_lshl_b32 s64, s14, 13
    s_add_u32 s88, s88, s64
    s_add_u32 s88, s88, 93323264
    s_cmp_lt_u32 s13, 28
    s_cselect_b32 s80, 1623195648, 0
    s_cselect_b32 s81, 6125344, 0
    s_cselect_b32 s82, 126873600, 0
    s_mov_b32 s83, 0
    s_mov_b32 s76, 2147483648
    s_mov_b32 s77, 0
    s_mov_b32 s78, 0
    s_cmp_lg_u32 s12, 7
    s_cbranch_scc1 L_d7_5
    s_mov_b64 s[80:81], 0
    s_mov_b32 s82, 0
    s_mov_b32 s68, 56
    s_mov_b32 s71, 3670016
L_d7_5:
    v_lshrrev_b32 v3, 3, v0
    s_lshl_b32 s64, s14, 3
    v_add_u32 v3, s64, v3
    s_lshr_b32 s64, s14, 1
    s_lshl_b32 s64, s64, 2
    v_lshrrev_b32 v4, 4, v0
    v_or_b32 v4, s64, v4
    v_xor_b32 v4, v4, v0
    v_and_b32 v4, 7, v4
    v_lshlrev_b32 v4, 4, v4
    v_lshl_add_u32 v2, v3, 11, v4
    v_bfe_u32 v3, v0, 1, 3
    v_lshrrev_b32 v4, 4, v0
    v_xor_b32 v3, v3, v4
    v_lshlrev_b32 v3, 4, v3
    v_and_b32 v4, 7, v0
    v_lshl_add_u32 v3, v4, 7, v3
    v_bfe_u32 v4, v0, 3, 1
    v_lshl_add_u32 v7, v4, 11, v3
    v_xor_b32 v8, 64, v7
    s_lshl_b32 s64, s13, 11
    s_lshl_b32 s65, s14, 9
    s_add_u32 s64, s64, s65
    s_add_u32 s64, s64, 0x20000
    v_and_b32 v4, 7, v0
    v_lshlrev_b32 v4, 6, v4
    v_add_u32 v5, s64, v4
    s_lshl_b32 s70, s14, 10
    v_bfe_u32 v4, v0, 2, 2
    s_mul_i32 s64, s14, 24576
    s_add_u32 s64, s64, 65536
    v_lshrrev_b32 v3, 4, v0
    v_lshl_add_u32 v4, v3, 3, v4
    v_lshlrev_b32 v4, 6, v4
    v_bfe_u32 v3, v0, 1, 1
    v_lshl_add_u32 v4, v3, 5, v4
    v_and_b32 v3, 1, v0
    v_lshl_add_u32 v4, v3, 3, v4
    v_add_u32 v12, s64, v4
    v_add_u32 v13, 16, v12
    s_mul_i32 s64, s14, 24576
    s_add_u32 m0, s64, 73728
    s_xor_b32 s65, s69, 1048576
    buffer_load_dwordx4 v1, s[48:51], s65 offen  lds
    s_add_u32 m0, m0, 1024
    s_xor_b32 s65, s69, 1179648
    buffer_load_dwordx4 v1, s[48:51], s65 offen  lds
    s_add_u32 m0, m0, 1024
    s_xor_b32 s65, s69, 1310720
    buffer_load_dwordx4 v1, s[48:51], s65 offen  lds
    s_add_u32 m0, m0, 1024
    s_xor_b32 s65, s69, 1441792
    buffer_load_dwordx4 v1, s[48:51], s65 offen  lds
    s_add_u32 m0, m0, 1024
    s_xor_b32 s65, s69, 1572864
    buffer_load_dwordx4 v1, s[48:51], s65 offen  lds
    s_add_u32 m0, m0, 1024
    s_xor_b32 s65, s69, 1703936
    buffer_load_dwordx4 v1, s[48:51], s65 offen  lds
    s_add_u32 m0, m0, 1024
    s_xor_b32 s65, s69, 1835008
    buffer_load_dwordx4 v1, s[48:51], s65 offen  lds
    s_add_u32 m0, m0, 1024
    s_xor_b32 s65, s69, 1966080
    buffer_load_dwordx4 v1, s[48:51], s65 offen  lds
    s_waitcnt vmcnt(8)
    s_barrier
    s_cmp_lg_u32 s14, 3
    s_cbranch_scc1 L_arr_6
    s_mov_b32 s91, 0x100
    s_bfm_b32 s90, 1, s13
    s_lshl_b32 s92, s12, 3
    s_add_u32 s92, s92, s3
    s_atomic_add_x2 s[90:91], s[44:45], s92
L_arr_6:
    s_mul_i32 s64, s14, 24576
    s_add_u32 m0, s64, 81920
    s_xor_b32 s65, s69, 2097152
    buffer_load_dwordx4 v1, s[48:51], s65 offen  lds
    s_add_u32 m0, m0, 1024
    s_xor_b32 s65, s69, 2228224
    buffer_load_dwordx4 v1, s[48:51], s65 offen  lds
    s_add_u32 m0, m0, 1024
    s_xor_b32 s65, s69, 2359296
    buffer_load_dwordx4 v1, s[48:51], s65 offen  lds
    s_add_u32 m0, m0, 1024
    s_xor_b32 s65, s69, 2490368
    buffer_load_dwordx4 v1, s[48:51], s65 offen  lds
    s_add_u32 m0, m0, 1024
    s_xor_b32 s65, s69, 2621440
    buffer_load_dwordx4 v1, s[48:51], s65 offen  lds
    s_add_u32 m0, m0, 1024
    s_xor_b32 s65, s69, 2752512
    buffer_load_dwordx4 v1, s[48:51], s65 offen  lds
    s_add_u32 m0, m0, 1024
    s_xor_b32 s65, s69, 2883584
    buffer_load_dwordx4 v1, s[48:51], s65 offen  lds
    s_add_u32 m0, m0, 1024
    s_xor_b32 s65, s69, 3014656
    buffer_load_dwordx4 v1, s[48:51], s65 offen  lds
    s_waitcnt vmcnt(16)
    ds_read_b64_tr_b16 a[0:1], v12 offset:0
    ds_read_b64_tr_b16 a[2:3], v12 offset:256
    ds_read_b64_tr_b16 a[4:5], v13 offset:0
    ds_read_b64_tr_b16 a[6:7], v13 offset:256
    ds_read_b64_tr_b16 a[8:9], v12 offset:2048
    ds_read_b64_tr_b16 a[10:11], v12 offset:2304
    ds_read_b64_tr_b16 a[12:13], v13 offset:2048
    ds_read_b64_tr_b16 a[14:15], v13 offset:2304
    ds_read_b64_tr_b16 a[16:17], v12 offset:4096
    ds_read_b64_tr_b16 a[18:19], v12 offset:4352
    ds_read_b64_tr_b16 a[20:21], v13 offset:4096
    ds_read_b64_tr_b16 a[22:23], v13 offset:4352
    ds_read_b64_tr_b16 a[24:25], v12 offset:6144
    ds_read_b64_tr_b16 a[26:27], v12 offset:6400
    ds_read_b64_tr_b16 a[28:29], v13 offset:6144
    ds_read_b64_tr_b16 a[30:31], v13 offset:6400
    s_waitcnt lgkmcnt(0)
    s_mov_b32 m0, s70
    s_nop 0
    buffer_load_dwordx4 v2, s[8:11], s71 offen offset:0 lds
    s_add_u32 m0, m0, 3968
    s_nop 0
    buffer_load_dwordx4 v2, s[8:11], s71 offen offset:128 lds
    s_add_u32 m0, m0, 3968
    s_nop 0
    buffer_load_dwordx4 v2, s[8:11], s71 offen offset:256 lds
    s_add_u32 m0, m0, 3968
    s_nop 0
    buffer_load_dwordx4 v2, s[8:11], s71 offen offset:384 lds
    s_add_u32 m0, m0, 3968
    s_nop 0
    buffer_load_dwordx4 v2, s[8:11], s71 offen offset:512 lds
    s_add_u32 m0, m0, 3968
    s_nop 0
    buffer_load_dwordx4 v2, s[8:11], s71 offen offset:640 lds
    s_add_u32 m0, m0, 3968
    s_nop 0
    buffer_load_dwordx4 v2, s[8:11], s71 offen offset:768 lds
    s_add_u32 m0, m0, 3968
    s_nop 0
    buffer_load_dwordx4 v2, s[8:11], s71 offen offset:896 lds
    s_add_u32 m0, m0, 3968
    s_nop 0
    buffer_load_dwordx4 v2, s[8:11], s71 offen offset:1024 lds
    s_add_u32 m0, m0, 3968
    s_nop 0
    buffer_load_dwordx4 v2, s[8:11], s71 offen offset:1152 lds
    s_add_u32 m0, m0, 3968
    s_nop 0
    buffer_load_dwordx4 v2, s[8:11], s71 offen offset:1280 lds
    s_add_u32 m0, m0, 3968
    s_nop 0
    buffer_load_dwordx4 v2, s[8:11], s71 offen offset:1408 lds
    s_add_u32 m0, m0, 3968
    s_nop 0
    buffer_load_dwordx4 v2, s[8:11], s71 offen offset:1536 lds
    s_add_u32 m0, m0, 3968
    s_nop 0
    buffer_load_dwordx4 v2, s[8:11], s71 offen offset:1664 lds
    s_add_u32 m0, m0, 3968
    s_nop 0
    buffer_load_dwordx4 v2, s[8:11], s71 offen offset:1792 lds
    s_add_u32 m0, m0, 3968
    s_nop 0
    buffer_load_dwordx4 v2, s[8:11], s71 offen offset:1920 lds
    s_mul_i32 s64, s14, 24576
    s_add_u32 m0, s64, 65536
    s_xor_b32 s65, s69, 3145728
    buffer_load_dwordx4 v1, s[48:51], s65 offen  lds
    s_add_u32 m0, m0, 1024
    s_xor_b32 s65, s69, 3276800
    buffer_load_dwordx4 v1, s[48:51], s65 offen  lds
    s_add_u32 m0, m0, 1024
    s_xor_b32 s65, s69, 3407872
    buffer_load_dwordx4 v1, s[48:51], s65 offen  lds
    s_add_u32 m0, m0, 1024
    s_xor_b32 s65, s69, 3538944
    buffer_load_dwordx4 v1, s[48:51], s65 offen  lds
    s_add_u32 m0, m0, 1024
    s_xor_b32 s65, s69, 3670016
    buffer_load_dwordx4 v1, s[48:51], s65 offen  lds
    s_add_u32 m0, m0, 1024
    s_xor_b32 s65, s69, 3801088
    buffer_load_dwordx4 v1, s[48:51], s65 offen  lds
    s_add_u32 m0, m0, 1024
    s_xor_b32 s65, s69, 3932160
    buffer_load_dwordx4 v1, s[48:51], s65 offen  lds
    s_add_u32 m0, m0, 1024
    s_xor_b32 s65, s69, 4063232
    buffer_load_dwordx4 v1, s[48:51], s65 offen  lds
    s_waitcnt vmcnt(16)
    ds_read_b64_tr_b16 a[32:33], v12 offset:8192
    ds_read_b64_tr_b16 a[34:35], v12 offset:8448
    ds_read_b64_tr_b16 a[36:37], v13 offset:8192
    ds_read_b64_tr_b16 a[38:39], v13 offset:8448
    ds_read_b64_tr_b16 a[40:41], v12 offset:10240
    ds_read_b64_tr_b16 a[42:43], v12 offset:10496
    ds_read_b64_tr_b16 a[44:45], v13 offset:10240
    ds_read_b64_tr_b16 a[46:47], v13 offset:10496
    ds_read_b64_tr_b16 a[48:49], v12 offset:12288
    ds_read_b64_tr_b16 a[50:51], v12 offset:12544
    ds_read_b64_tr_b16 a[52:53], v13 offset:12288
    ds_read_b64_tr_b16 a[54:55], v13 offset:12544
    ds_read_b64_tr_b16 a[56:57], v12 offset:14336
    ds_read_b64_tr_b16 a[58:59], v12 offset:14592
    ds_read_b64_tr_b16 a[60:61], v13 offset:14336
    ds_read_b64_tr_b16 a[62:63], v13 offset:14592
    s_waitcnt lgkmcnt(0)
    s_mul_i32 s64, s14, 24576
    s_add_u32 m0, s64, 73728
    s_xor_b32 s65, s69, 4194304
    buffer_load_dwordx4 v1, s[48:51], s65 offen  lds
    s_add_u32 m0, m0, 1024
    s_xor_b32 s65, s69, 4325376
    buffer_load_dwordx4 v1, s[48:51], s65 offen  lds
    s_add_u32 m0, m0, 1024
    s_xor_b32 s65, s69, 4456448
    buffer_load_dwordx4 v1, s[48:51], s65 offen  lds
    s_add_u32 m0, m0, 1024
    s_xor_b32 s65, s69, 4587520
    buffer_load_dwordx4 v1, s[48:51], s65 offen  lds
    s_add_u32 m0, m0, 1024
    s_xor_b32 s65, s69, 4718592
    buffer_load_dwordx4 v1, s[48:51], s65 offen  lds
    s_add_u32 m0, m0, 1024
    s_xor_b32 s65, s69, 4849664
    buffer_load_dwordx4 v1, s[48:51], s65 offen  lds
    s_add_u32 m0, m0, 1024
    s_xor_b32 s65, s69, 4980736
    buffer_load_dwordx4 v1, s[48:51], s65 offen  lds
    s_add_u32 m0, m0, 1024
    s_xor_b32 s65, s69, 5111808
    buffer_load_dwordx4 v1, s[48:51], s65 offen  lds
    s_waitcnt vmcnt(16)
    ds_read_b64_tr_b16 a[64:65], v12 offset:16384
    ds_read_b64_tr_b16 a[66:67], v12 offset:16640
    ds_read_b64_tr_b16 a[68:69], v13 offset:16384
    ds_read_b64_tr_b16 a[70:71], v13 offset:16640
    ds_read_b64_tr_b16 a[72:73], v12 offset:18432
    ds_read_b64_tr_b16 a[74:75], v12 offset:18688
    ds_read_b64_tr_b16 a[76:77], v13 offset:18432
    ds_read_b64_tr_b16 a[78:79], v13 offset:18688
    ds_read_b64_tr_b16 a[80:81], v12 offset:20480
    ds_read_b64_tr_b16 a[82:83], v12 offset:20736
    ds_read_b64_tr_b16 a[84:85], v13 offset:20480
    ds_read_b64_tr_b16 a[86:87], v13 offset:20736
    ds_read_b64_tr_b16 a[88:89], v12 offset:22528
    ds_read_b64_tr_b16 a[90:91], v12 offset:22784
    ds_read_b64_tr_b16 a[92:93], v13 offset:22528
    ds_read_b64_tr_b16 a[94:95], v13 offset:22784
    s_waitcnt lgkmcnt(0)
    s_mul_i32 s64, s14, 24576
    s_add_u32 m0, s64, 81920
    s_xor_b32 s65, s69, 5242880
    buffer_load_dwordx4 v1, s[48:51], s65 offen  lds
    s_add_u32 m0, m0, 1024
    s_xor_b32 s65, s69, 5373952
    buffer_load_dwordx4 v1, s[48:51], s65 offen  lds
    s_add_u32 m0, m0, 1024
    s_xor_b32 s65, s69, 5505024
    buffer_load_dwordx4 v1, s[48:51], s65 offen  lds
    s_add_u32 m0, m0, 1024
    s_xor_b32 s65, s69, 5636096
    buffer_load_dwordx4 v1, s[48:51], s65 offen  lds
    s_add_u32 m0, m0, 1024
    s_xor_b32 s65, s69, 5767168
    buffer_load_dwordx4 v1, s[48:51], s65 offen  lds
    s_add_u32 m0, m0, 1024
    s_xor_b32 s65, s69, 5898240
    buffer_load_dwordx4 v1, s[48:51], s65 offen  lds
    s_add_u32 m0, m0, 1024
    s_xor_b32 s65, s69, 6029312
    buffer_load_dwordx4 v1, s[48:51], s65 offen  lds
    s_add_u32 m0, m0, 1024
    s_xor_b32 s65, s69, 6160384
    buffer_load_dwordx4 v1, s[48:51], s65 offen  lds
    s_waitcnt vmcnt(16)
    ds_read_b64_tr_b16 a[96:97], v12 offset:0
    ds_read_b64_tr_b16 a[98:99], v12 offset:256
    ds_read_b64_tr_b16 a[100:101], v13 offset:0
    ds_read_b64_tr_b16 a[102:103], v13 offset:256
    ds_read_b64_tr_b16 a[104:105], v12 offset:2048
    ds_read_b64_tr_b16 a[106:107], v12 offset:2304
    ds_read_b64_tr_b16 a[108:109], v13 offset:2048
    ds_read_b64_tr_b16 a[110:111], v13 offset:2304
    ds_read_b64_tr_b16 a[112:113], v12 offset:4096
    ds_read_b64_tr_b16 a[114:115], v12 offset:4352
    ds_read_b64_tr_b16 a[116:117], v13 offset:4096
    ds_read_b64_tr_b16 a[118:119], v13 offset:4352
    ds_read_b64_tr_b16 a[120:121], v12 offset:6144
    ds_read_b64_tr_b16 a[122:123], v12 offset:6400
    ds_read_b64_tr_b16 a[124:125], v13 offset:6144
    ds_read_b64_tr_b16 a[126:127], v13 offset:6400
    s_waitcnt lgkmcnt(0)
    s_mul_i32 s64, s14, 24576
    s_add_u32 m0, s64, 65536
    s_xor_b32 s65, s69, 6291456
    buffer_load_dwordx4 v1, s[48:51], s65 offen  lds
    s_add_u32 m0, m0, 1024
    s_xor_b32 s65, s69, 6422528
    buffer_load_dwordx4 v1, s[48:51], s65 offen  lds
    s_add_u32 m0, m0, 1024
    s_xor_b32 s65, s69, 6553600
    buffer_load_dwordx4 v1, s[48:51], s65 offen  lds
    s_add_u32 m0, m0, 1024
    s_xor_b32 s65, s69, 6684672
    buffer_load_dwordx4 v1, s[48:51], s65 offen  lds
    s_add_u32 m0, m0, 1024
    s_xor_b32 s65, s69, 6815744
    buffer_load_dwordx4 v1, s[48:51], s65 offen  lds
    s_add_u32 m0, m0, 1024
    s_xor_b32 s65, s69, 6946816
    buffer_load_dwordx4 v1, s[48:51], s65 offen  lds
    s_add_u32 m0, m0, 1024
    s_xor_b32 s65, s69, 7077888
    buffer_load_dwordx4 v1, s[48:51], s65 offen  lds
    s_add_u32 m0, m0, 1024
    s_xor_b32 s65, s69, 7208960
    buffer_load_dwordx4 v1, s[48:51], s65 offen  lds
    s_waitcnt vmcnt(16)
    ds_read_b64_tr_b16 a[128:129], v12 offset:8192
    ds_read_b64_tr_b16 a[130:131], v12 offset:8448
    ds_read_b64_tr_b16 a[132:133], v13 offset:8192
    ds_read_b64_tr_b16 a[134:135], v13 offset:8448
    ds_read_b64_tr_b16 a[136:137], v12 offset:10240
    ds_read_b64_tr_b16 a[138:139], v12 offset:10496
    ds_read_b64_tr_b16 a[140:141], v13 offset:10240
    ds_read_b64_tr_b16 a[142:143], v13 offset:10496
    ds_read_b64_tr_b16 a[144:145], v12 offset:12288
    ds_read_b64_tr_b16 a[146:147], v12 offset:12544
    ds_read_b64_tr_b16 a[148:149], v13 offset:12288
    ds_read_b64_tr_b16 a[150:151], v13 offset:12544
    ds_read_b64_tr_b16 a[152:153], v12 offset:14336
    ds_read_b64_tr_b16 a[154:155], v12 offset:14592
    ds_read_b64_tr_b16 a[156:157], v13 offset:14336
    ds_read_b64_tr_b16 a[158:159], v13 offset:14592
    s_waitcnt lgkmcnt(0)
    s_mul_i32 s64, s14, 24576
    s_add_u32 m0, s64, 73728
    s_xor_b32 s65, s69, 7340032
    buffer_load_dwordx4 v1, s[48:51], s65 offen  lds
    s_add_u32 m0, m0, 1024
    s_xor_b32 s65, s69, 7471104
    buffer_load_dwordx4 v1, s[48:51], s65 offen  lds
    s_add_u32 m0, m0, 1024
    s_xor_b32 s65, s69, 7602176
    buffer_load_dwordx4 v1, s[48:51], s65 offen  lds
    s_add_u32 m0, m0, 1024
    s_xor_b32 s65, s69, 7733248
    buffer_load_dwordx4 v1, s[48:51], s65 offen  lds
    s_add_u32 m0, m0, 1024
    s_xor_b32 s65, s69, 7864320
    buffer_load_dwordx4 v1, s[48:51], s65 offen  lds
    s_add_u32 m0, m0, 1024
    s_xor_b32 s65, s69, 7995392
    buffer_load_dwordx4 v1, s[48:51], s65 offen  lds
    s_add_u32 m0, m0, 1024
    s_xor_b32 s65, s69, 8126464
    buffer_load_dwordx4 v1, s[48:51], s65 offen  lds
    s_add_u32 m0, m0, 1024
    s_xor_b32 s65, s69, 8257536
    buffer_load_dwordx4 v1, s[48:51], s65 offen  lds
    s_waitcnt vmcnt(16)
    ds_read_b64_tr_b16 a[160:161], v12 offset:16384
    ds_read_b64_tr_b16 a[162:163], v12 offset:16640
    ds_read_b64_tr_b16 a[164:165], v13 offset:16384
    ds_read_b64_tr_b16 a[166:167], v13 offset:16640
    ds_read_b64_tr_b16 a[168:169], v12 offset:18432
    ds_read_b64_tr_b16 a[170:171], v12 offset:18688
    ds_read_b64_tr_b16 a[172:173], v13 offset:18432
    ds_read_b64_tr_b16 a[174:175], v13 offset:18688
    ds_read_b64_tr_b16 a[176:177], v12 offset:20480
    ds_read_b64_tr_b16 a[178:179], v12 offset:20736
    ds_read_b64_tr_b16 a[180:181], v13 offset:20480
    ds_read_b64_tr_b16 a[182:183], v13 offset:20736
    ds_read_b64_tr_b16 a[184:185], v12 offset:22528
    ds_read_b64_tr_b16 a[186:187], v12 offset:22784
    ds_read_b64_tr_b16 a[188:189], v13 offset:22528
    ds_read_b64_tr_b16 a[190:191], v13 offset:22784
    s_waitcnt lgkmcnt(0)
    s_waitcnt vmcnt(8)
    ds_read_b64_tr_b16 a[192:193], v12 offset:0
    ds_read_b64_tr_b16 a[194:195], v12 offset:256
    ds_read_b64_tr_b16 a[196:197], v13 offset:0
    ds_read_b64_tr_b16 a[198:199], v13 offset:256
    ds_read_b64_tr_b16 a[200:201], v12 offset:2048
    ds_read_b64_tr_b16 a[202:203], v12 offset:2304
    ds_read_b64_tr_b16 a[204:205], v13 offset:2048
    ds_read_b64_tr_b16 a[206:207], v13 offset:2304
    ds_read_b64_tr_b16 a[208:209], v12 offset:4096
    ds_read_b64_tr_b16 a[210:211], v12 offset:4352
    ds_read_b64_tr_b16 a[212:213], v13 offset:4096
    ds_read_b64_tr_b16 a[214:215], v13 offset:4352
    ds_read_b64_tr_b16 a[216:217], v12 offset:6144
    ds_read_b64_tr_b16 a[218:219], v12 offset:6400
    ds_read_b64_tr_b16 a[220:221], v13 offset:6144
    ds_read_b64_tr_b16 a[222:223], v13 offset:6400
    s_waitcnt lgkmcnt(0)
    s_waitcnt vmcnt(0)
    ds_read_b64_tr_b16 a[224:225], v12 offset:8192
    ds_read_b64_tr_b16 a[226:227], v12 offset:8448
    ds_read_b64_tr_b16 a[228:229], v13 offset:8192
    ds_read_b64_tr_b16 a[230:231], v13 offset:8448
    ds_read_b64_tr_b16 a[232:233], v12 offset:10240
    ds_read_b64_tr_b16 a[234:235], v12 offset:10496
    ds_read_b64_tr_b16 a[236:237], v13 offset:10240
    ds_read_b64_tr_b16 a[238:239], v13 offset:10496
    ds_read_b64_tr_b16 a[240:241], v12 offset:12288
    ds_read_b64_tr_b16 a[242:243], v12 offset:12544
    ds_read_b64_tr_b16 a[244:245], v13 offset:12288
    ds_read_b64_tr_b16 a[246:247], v13 offset:12544
    ds_read_b64_tr_b16 a[248:249], v12 offset:14336
    ds_read_b64_tr_b16 a[250:251], v12 offset:14592
    ds_read_b64_tr_b16 a[252:253], v13 offset:14336
    ds_read_b64_tr_b16 a[254:255], v13 offset:14592
    s_waitcnt lgkmcnt(0)
    v_and_b32 v254, 7, v0
    v_lshl_add_u32 v254, v254, 3, s3
L_wall_7:
    global_load_dwordx2 v[250:251], v254, s[44:45] sc1
    s_waitcnt vmcnt(0)
    v_lshrrev_b32 v255, 8, v251
    s_nop 1
    v_add_u32_dpp v255, v255, v255 row_ror:1 row_mask:0xf bank_mask:0xf
    s_nop 1
    v_add_u32_dpp v255, v255, v255 row_ror:2 row_mask:0xf bank_mask:0xf
    s_nop 1
    v_add_u32_dpp v255, v255, v255 row_ror:4 row_mask:0xf bank_mask:0xf
    s_nop 0
    v_readfirstlane_b32 s100, v255
    s_nop 0
    s_and_b32 s64, s100, 0x1ff
    s_cmp_eq_u32 s64, 256
    s_cbranch_scc1 L_walld_8
    s_sleep 4
    s_sub_u32 s15, s15, 1
    s_cbranch_scc0 L_wall_7
    s_branch L_abort
L_walld_8:
    v_cmp_ne_u32 vcc, -1, v250
    s_cbranch_vccnz L_restart
    s_bfe_u32 s64, s100, 0x80009
    s_lshr_b32 s100, s100, 17
    s_cmp_gt_u32 s100, s64
    s_cselect_b32 s100, 0x2000, 0
    s_add_u32 s87, s87, s100
    s_mov_b32 s72, 2147483648
    s_mov_b32 s84, 2147483648
    s_mov_b32 s86, 0
    s_barrier
    s_xor_b32 s70, s70, 0x10000
    s_add_u32 s71, s71, 0x10000
    ds_read_b128 v[28:31], v7 offset:0
    ds_read_b128 v[32:35], v7 offset:1024
    ds_read_b128 v[36:39], v8 offset:0
    ds_read_b128 v[40:43], v8 offset:1024
    ds_read_b128 v[44:47], v7 offset:4096
    ds_read_b128 v[48:51], v7 offset:5120
    s_cmp_eq_u32 s73, 0
    s_cbranch_scc0 L_v_loop
L_k_loop:
    s_waitcnt lgkmcnt(4)
    v_mfma_f32_16x16x32_bf16 v[12:15], a[0:3], v[28:31], 0
    ds_read_b128 v[52:55], v8 offset:4096
    v_mfma_f32_16x16x32_bf16 v[16:19], a[4:7], v[28:31], 0
    v_mfma_f32_16x16x32_bf16 v[24:27], a[4:7], v[32:35], 0
    ds_read_b128 v[56:59], v8 offset:5120
    v_mfma_f32_16x16x32_bf16 v[20:23], a[0:3], v[32:35], 0
    buffer_store_dwordx4 v[76:79], v73, s[4:7], s84 offen sc1
    s_waitcnt lgkmcnt(4)
    v_mfma_f32_16x16x32_bf16 v[12:15], a[8:11], v[36:39], v[12:15]
    ds_read_b128 v[28:31], v7 offset:8192
    v_mfma_f32_16x16x32_bf16 v[16:19], a[12:15], v[36:39], v[16:19]
    v_cvt_pk_bf16_f32 v180, v180, v181
    v_cvt_pk_bf16_f32 v181, v182, v183
    v_mfma_f32_16x16x32_bf16 v[24:27], a[12:15], v[40:43], v[24:27]
    ds_read_b128 v[32:35], v7 offset:9216
    v_mfma_f32_16x16x32_bf16 v[20:23], a[8:11], v[40:43], v[20:23]
    v_cvt_pk_bf16_f32 v182, v184, v185
    v_cvt_pk_bf16_f32 v183, v186, v187
    s_waitcnt lgkmcnt(4)
    v_mfma_f32_16x16x32_bf16 v[12:15], a[16:19], v[44:47], v[12:15]
    ds_read_b128 v[36:39], v8 offset:8192
    v_mfma_f32_16x16x32_bf16 v[16:19], a[20:23], v[44:47], v[16:19]
    v_cvt_pk_bf16_f32 v184, v188, v189
    v_cvt_pk_bf16_f32 v185, v190, v191
    v_mfma_f32_16x16x32_bf16 v[24:27], a[20:23], v[48:51], v[24:27]
    ds_read_b128 v[40:43], v8 offset:9216
    v_mfma_f32_16x16x32_bf16 v[20:23], a[16:19], v[48:51], v[20:23]
    v_cvt_pk_bf16_f32 v186, v192, v193
    v_cvt_pk_bf16_f32 v187, v194, v195
    s_waitcnt lgkmcnt(4)
    v_mfma_f32_16x16x32_bf16 v[12:15], a[24:27], v[52:55], v[12:15]
    ds_read_b128 v[44:47], v7 offset:12288
    v_mfma_f32_16x16x32_bf16 v[16:19], a[28:31], v[52:55], v[16:19]
    buffer_store_dwordx4 v[180:183], v68, s[4:7], s72 offen offset:0 sc1
    v_mfma_f32_16x16x32_bf16 v[24:27], a[28:31], v[56:59], v[24:27]
    ds_read_b128 v[48:51], v7 offset:13312
    v_mfma_f32_16x16x32_bf16 v[20:23], a[24:27], v[56:59], v[20:23]
    buffer_store_dwordx4 v[184:187], v68, s[4:7], s72 offen offset:128 sc1
    s_waitcnt lgkmcnt(4)
    v_mfma_f32_16x16x32_bf16 v[12:15], a[32:35], v[28:31], v[12:15]
    ds_read_b128 v[52:55], v8 offset:12288
    v_mfma_f32_16x16x32_bf16 v[16:19], a[36:39], v[28:31], v[16:19]
    v_mfma_f32_16x16x32_bf16 v[24:27], a[36:39], v[32:35], v[24:27]
    ds_read_b128 v[56:59], v8 offset:13312
    v_mfma_f32_16x16x32_bf16 v[20:23], a[32:35], v[32:35], v[20:23]
    s_lshl_b32 s84, s68, 10
    s_and_b32 s84, s84, 0x2000
    s_waitcnt lgkmcnt(4)
    v_mfma_f32_16x16x32_bf16 v[12:15], a[40:43], v[36:39], v[12:15]
    ds_read_b128 v[28:31], v7 offset:16384
    v_mfma_f32_16x16x32_bf16 v[16:19], a[44:47], v[36:39], v[16:19]
    s_xor_b32 s84, s84, s100
    s_lshl_b32 s67, s68, 18
    v_mfma_f32_16x16x32_bf16 v[24:27], a[44:47], v[40:43], v[24:27]
    ds_read_b128 v[32:35], v7 offset:17408
    v_mfma_f32_16x16x32_bf16 v[20:23], a[40:43], v[40:43], v[20:23]
    s_or_b32 s84, s84, s67
    s_lshl_b32 s72, s68, 11
    s_waitcnt lgkmcnt(4)
    v_mfma_f32_16x16x32_bf16 v[12:15], a[48:51], v[44:47], v[12:15]
    ds_read_b128 v[36:39], v8 offset:16384
    v_mfma_f32_16x16x32_bf16 v[16:19], a[52:55], v[44:47], v[16:19]
    s_and_b32 s72, s72, 0x2000
    s_xor_b32 s72, s72, s100
    v_mfma_f32_16x16x32_bf16 v[24:27], a[52:55], v[48:51], v[24:27]
    ds_read_b128 v[40:43], v8 offset:17408
    v_mfma_f32_16x16x32_bf16 v[20:23], a[48:51], v[48:51], v[20:23]
    s_lshl_b32 s67, s68, 19
    s_or_b32 s72, s72, s67
    s_waitcnt lgkmcnt(4)
    v_mfma_f32_16x16x32_bf16 v[12:15], a[56:59], v[52:55], v[12:15]
    ds_read_b128 v[44:47], v7 offset:20480
    v_mfma_f32_16x16x32_bf16 v[16:19], a[60:63], v[52:55], v[16:19]
    s_sub_u32 s79, s68, 22
    s_mov_b32 s85, 0
    v_mfma_f32_16x16x32_bf16 v[24:27], a[60:63], v[56:59], v[24:27]
    ds_read_b128 v[48:51], v7 offset:21504
    v_mfma_f32_16x16x32_bf16 v[20:23], a[56:59], v[56:59], v[20:23]
    s_waitcnt lgkmcnt(4)
    v_mfma_f32_16x16x32_bf16 v[12:15], a[64:67], v[28:31], v[12:15]
    ds_read_b128 v[52:55], v8 offset:20480
    v_mfma_f32_16x16x32_bf16 v[16:19], a[68:71], v[28:31], v[16:19]
    s_mov_b32 m0, s70
    v_mfma_f32_16x16x32_bf16 v[24:27], a[68:71], v[32:35], v[24:27]
    ds_read_b128 v[56:59], v8 offset:21504
    v_mfma_f32_16x16x32_bf16 v[20:23], a[64:67], v[32:35], v[20:23]
    buffer_load_dwordx4 v2, s[8:11], s71 offen offset:0 lds
    s_waitcnt lgkmcnt(4)
    v_mfma_f32_16x16x32_bf16 v[12:15], a[72:75], v[36:39], v[12:15]
    ds_read_b128 v[28:31], v7 offset:24576
    v_mfma_f32_16x16x32_bf16 v[16:19], a[76:79], v[36:39], v[16:19]
    s_add_u32 m0, m0, 3968
    v_mfma_f32_16x16x32_bf16 v[24:27], a[76:79], v[40:43], v[24:27]
    ds_read_b128 v[32:35], v7 offset:25600
    v_mfma_f32_16x16x32_bf16 v[20:23], a[72:75], v[40:43], v[20:23]
    buffer_load_dwordx4 v2, s[8:11], s71 offen offset:128 lds
    s_waitcnt lgkmcnt(4)
    v_mfma_f32_16x16x32_bf16 v[12:15], a[80:83], v[44:47], v[12:15]
    ds_read_b128 v[36:39], v8 offset:24576
    v_mfma_f32_16x16x32_bf16 v[16:19], a[84:87], v[44:47], v[16:19]
    s_add_u32 m0, m0, 3968
    v_mfma_f32_16x16x32_bf16 v[24:27], a[84:87], v[48:51], v[24:27]
    ds_read_b128 v[40:43], v8 offset:25600
    v_mfma_f32_16x16x32_bf16 v[20:23], a[80:83], v[48:51], v[20:23]
    buffer_load_dwordx4 v2, s[8:11], s71 offen offset:256 lds
    s_waitcnt lgkmcnt(4)
    v_mfma_f32_16x16x32_bf16 v[12:15], a[88:91], v[52:55], v[12:15]
    ds_read_b128 v[44:47], v7 offset:28672
    v_mfma_f32_16x16x32_bf16 v[16:19], a[92:95], v[52:55], v[16:19]
    s_add_u32 m0, m0, 3968
    v_mfma_f32_16x16x32_bf16 v[24:27], a[92:95], v[56:59], v[24:27]
    ds_read_b128 v[48:51], v7 offset:29696
    v_mfma_f32_16x16x32_bf16 v[20:23], a[88:91], v[56:59], v[20:23]
    buffer_load_dwordx4 v2, s[8:11], s71 offen offset:384 lds
    s_waitcnt lgkmcnt(4)
    v_mfma_f32_16x16x32_bf16 v[12:15], a[96:99], v[28:31], v[12:15]
    ds_read_b128 v[52:55], v8 offset:28672
    v_mfma_f32_16x16x32_bf16 v[16:19], a[100:103], v[28:31], v[16:19]
    s_add_u32 m0, m0, 3968
    v_mfma_f32_16x16x32_bf16 v[24:27], a[100:103], v[32:35], v[24:27]
    ds_read_b128 v[56:59], v8 offset:29696
    v_mfma_f32_16x16x32_bf16 v[20:23], a[96:99], v[32:35], v[20:23]
    buffer_load_dwordx4 v2, s[8:11], s71 offen offset:512 lds
    s_waitcnt lgkmcnt(4)
    v_mfma_f32_16x16x32_bf16 v[12:15], a[104:107], v[36:39], v[12:15]
    ds_read_b128 v[28:31], v7 offset:32768
    v_mfma_f32_16x16x32_bf16 v[16:19], a[108:111], v[36:39], v[16:19]
    s_add_u32 m0, m0, 3968
    v_mfma_f32_16x16x32_bf16 v[24:27], a[108:111], v[40:43], v[24:27]
    ds_read_b128 v[32:35], v7 offset:33792
    v_mfma_f32_16x16x32_bf16 v[20:23], a[104:107], v[40:43], v[20:23]
    buffer_load_dwordx4 v2, s[8:11], s71 offen offset:640 lds
    s_waitcnt lgkmcnt(4)
    v_mfma_f32_16x16x32_bf16 v[12:15], a[112:115], v[44:47], v[12:15]
    ds_read_b128 v[36:39], v8 offset:32768
    v_mfma_f32_16x16x32_bf16 v[16:19], a[116:119], v[44:47], v[16:19]
    s_add_u32 m0, m0, 3968
    v_mfma_f32_16x16x32_bf16 v[24:27], a[116:119], v[48:51], v[24:27]
    ds_read_b128 v[40:43], v8 offset:33792
    v_mfma_f32_16x16x32_bf16 v[20:23], a[112:115], v[48:51], v[20:23]
    buffer_load_dwordx4 v2, s[8:11], s71 offen offset:768 lds
    s_waitcnt lgkmcnt(4)
    v_mfma_f32_16x16x32_bf16 v[12:15], a[120:123], v[52:55], v[12:15]
    ds_read_b128 v[44:47], v7 offset:36864
    v_mfma_f32_16x16x32_bf16 v[16:19], a[124:127], v[52:55], v[16:19]
    s_add_u32 m0, m0, 3968
    v_mfma_f32_16x16x32_bf16 v[24:27], a[124:127], v[56:59], v[24:27]
    ds_read_b128 v[48:51], v7 offset:37888
    v_mfma_f32_16x16x32_bf16 v[20:23], a[120:123], v[56:59], v[20:23]
    buffer_load_dwordx4 v2, s[8:11], s71 offen offset:896 lds
    s_waitcnt lgkmcnt(4)
    v_mfma_f32_16x16x32_bf16 v[12:15], a[128:131], v[28:31], v[12:15]
    ds_read_b128 v[52:55], v8 offset:36864
    v_mfma_f32_16x16x32_bf16 v[16:19], a[132:135], v[28:31], v[16:19]
    s_add_u32 m0, m0, 3968
    s_waitcnt vmcnt(8)
    s_atomic_umax s86, s[46:47], s87
    v_mfma_f32_16x16x32_bf16 v[24:27], a[132:135], v[32:35], v[24:27]
    ds_read_b128 v[56:59], v8 offset:37888
    v_mfma_f32_16x16x32_bf16 v[20:23], a[128:131], v[32:35], v[20:23]
    buffer_load_dwordx4 v2, s[8:11], s71 offen offset:1024 lds
    s_waitcnt lgkmcnt(4)
    v_mfma_f32_16x16x32_bf16 v[12:15], a[136:139], v[36:39], v[12:15]
    ds_read_b128 v[28:31], v7 offset:40960
    v_mfma_f32_16x16x32_bf16 v[16:19], a[140:143], v[36:39], v[16:19]
    s_add_u32 m0, m0, 3968
    v_mfma_f32_16x16x32_bf16 v[24:27], a[140:143], v[40:43], v[24:27]
    ds_read_b128 v[32:35], v7 offset:41984
    v_mfma_f32_16x16x32_bf16 v[20:23], a[136:139], v[40:43], v[20:23]
    buffer_load_dwordx4 v2, s[8:11], s71 offen offset:1152 lds
    s_waitcnt lgkmcnt(4)
    v_mfma_f32_16x16x32_bf16 v[12:15], a[144:147], v[44:47], v[12:15]
    ds_read_b128 v[36:39], v8 offset:40960
    v_mfma_f32_16x16x32_bf16 v[16:19], a[148:151], v[44:47], v[16:19]
    s_add_u32 m0, m0, 3968
    v_mfma_f32_16x16x32_bf16 v[24:27], a[148:151], v[48:51], v[24:27]
    ds_read_b128 v[40:43], v8 offset:41984
    v_mfma_f32_16x16x32_bf16 v[20:23], a[144:147], v[48:51], v[20:23]
    buffer_load_dwordx4 v2, s[8:11], s71 offen offset:1280 lds
    s_waitcnt lgkmcnt(4)
    v_mfma_f32_16x16x32_bf16 v[12:15], a[152:155], v[52:55], v[12:15]
    ds_read_b128 v[44:47], v7 offset:45056
    v_mfma_f32_16x16x32_bf16 v[16:19], a[156:159], v[52:55], v[16:19]
    s_add_u32 m0, m0, 3968
    v_mfma_f32_16x16x32_bf16 v[24:27], a[156:159], v[56:59], v[24:27]
    ds_read_b128 v[48:51], v7 offset:46080
    v_mfma_f32_16x16x32_bf16 v[20:23], a[152:155], v[56:59], v[20:23]
    buffer_load_dwordx4 v2, s[8:11], s71 offen offset:1408 lds
    s_waitcnt lgkmcnt(4)
    v_mfma_f32_16x16x32_bf16 v[12:15], a[160:163], v[28:31], v[12:15]
    ds_read_b128 v[52:55], v8 offset:45056
    v_mfma_f32_16x16x32_bf16 v[16:19], a[164:167], v[28:31], v[16:19]
    s_add_u32 m0, m0, 3968
    v_mfma_f32_16x16x32_bf16 v[24:27], a[164:167], v[32:35], v[24:27]
    ds_read_b128 v[56:59], v8 offset:46080
    v_mfma_f32_16x16x32_bf16 v[20:23], a[160:163], v[32:35], v[20:23]
    buffer_load_dwordx4 v2, s[8:11], s71 offen offset:1536 lds
    s_waitcnt lgkmcnt(4)
    v_mfma_f32_16x16x32_bf16 v[12:15], a[168:171], v[36:39], v[12:15]
    ds_read_b128 v[28:31], v7 offset:49152
    v_mfma_f32_16x16x32_bf16 v[16:19], a[172:175], v[36:39], v[16:19]
    s_add_u32 m0, m0, 3968
    v_mfma_f32_16x16x32_bf16 v[24:27], a[172:175], v[40:43], v[24:27]
    ds_read_b128 v[32:35], v7 offset:50176
    v_mfma_f32_16x16x32_bf16 v[20:23], a[168:171], v[40:43], v[20:23]
    buffer_load_dwordx4 v2, s[8:11], s71 offen offset:1664 lds
    s_waitcnt lgkmcnt(4)
    v_mfma_f32_16x16x32_bf16 v[12:15], a[176:179], v[44:47], v[12:15]
    ds_read_b128 v[36:39], v8 offset:49152
    v_mfma_f32_16x16x32_bf16 v[16:19], a[180:183], v[44:47], v[16:19]
    s_add_u32 m0, m0, 3968
    v_mfma_f32_16x16x32_bf16 v[24:27], a[180:183], v[48:51], v[24:27]
    ds_read_b128 v[40:43], v8 offset:50176
    v_mfma_f32_16x16x32_bf16 v[20:23], a[176:179], v[48:51], v[20:23]
    buffer_load_dwordx4 v2, s[8:11], s71 offen offset:1792 lds
    s_waitcnt lgkmcnt(4)
    v_mfma_f32_16x16x32_bf16 v[12:15], a[184:187], v[52:55], v[12:15]
    ds_read_b128 v[44:47], v7 offset:53248
    v_mfma_f32_16x16x32_bf16 v[16:19], a[188:191], v[52:55], v[16:19]
    s_add_u32 m0, m0, 3968
    v_mfma_f32_16x16x32_bf16 v[24:27], a[188:191], v[56:59], v[24:27]
    ds_read_b128 v[48:51], v7 offset:54272
    v_mfma_f32_16x16x32_bf16 v[20:23], a[184:187], v[56:59], v[20:23]
    buffer_load_dwordx4 v2, s[8:11], s71 offen offset:1920 lds
    s_waitcnt lgkmcnt(4)
    v_mfma_f32_16x16x32_bf16 v[12:15], a[192:195], v[28:31], v[12:15]
    ds_read_b128 v[52:55], v8 offset:53248
    v_mfma_f32_16x16x32_bf16 v[16:19], a[196:199], v[28:31], v[16:19]
    v_mfma_f32_16x16x32_bf16 v[24:27], a[196:199], v[32:35], v[24:27]
    ds_read_b128 v[56:59], v8 offset:54272
    v_mfma_f32_16x16x32_bf16 v[20:23], a[192:195], v[32:35], v[20:23]
    s_waitcnt lgkmcnt(4)
    v_mfma_f32_16x16x32_bf16 v[12:15], a[200:203], v[36:39], v[12:15]
    ds_read_b128 v[28:31], v7 offset:57344
    v_mfma_f32_16x16x32_bf16 v[16:19], a[204:207], v[36:39], v[16:19]
    v_mfma_f32_16x16x32_bf16 v[24:27], a[204:207], v[40:43], v[24:27]
    ds_read_b128 v[32:35], v7 offset:58368
    v_mfma_f32_16x16x32_bf16 v[20:23], a[200:203], v[40:43], v[20:23]
    s_waitcnt lgkmcnt(4)
    v_mfma_f32_16x16x32_bf16 v[12:15], a[208:211], v[44:47], v[12:15]
    ds_read_b128 v[36:39], v8 offset:57344
    v_mfma_f32_16x16x32_bf16 v[16:19], a[212:215], v[44:47], v[16:19]
    v_mfma_f32_16x16x32_bf16 v[24:27], a[212:215], v[48:51], v[24:27]
    ds_read_b128 v[40:43], v8 offset:58368
    v_mfma_f32_16x16x32_bf16 v[20:23], a[208:211], v[48:51], v[20:23]
    s_waitcnt lgkmcnt(4)
    v_mfma_f32_16x16x32_bf16 v[12:15], a[216:219], v[52:55], v[12:15]
    ds_read_b128 v[44:47], v7 offset:61440
    v_mfma_f32_16x16x32_bf16 v[16:19], a[220:223], v[52:55], v[16:19]
    v_mfma_f32_16x16x32_bf16 v[24:27], a[220:223], v[56:59], v[24:27]
    ds_read_b128 v[48:51], v7 offset:62464
    v_mfma_f32_16x16x32_bf16 v[20:23], a[216:219], v[56:59], v[20:23]
    s_waitcnt lgkmcnt(4)
    v_mfma_f32_16x16x32_bf16 v[12:15], a[224:227], v[28:31], v[12:15]
    ds_read_b128 v[52:55], v8 offset:61440
    v_mfma_f32_16x16x32_bf16 v[16:19], a[228:231], v[28:31], v[16:19]
    v_mfma_f32_16x16x32_bf16 v[24:27], a[228:231], v[32:35], v[24:27]
    ds_read_b128 v[56:59], v8 offset:62464
    v_xor_b32 v7, 0x10000, v7
    v_xor_b32 v8, 0x10000, v8
    v_mfma_f32_16x16x32_bf16 v[20:23], a[224:227], v[32:35], v[20:23]
    s_bitcmp1_b64 s[80:81], s68
    s_waitcnt vmcnt(0)
    s_barrier
    s_waitcnt lgkmcnt(4)
    v_mfma_f32_16x16x32_bf16 v[12:15], a[232:235], v[36:39], v[12:15]
    ds_read_b128 v[28:31], v7 offset:0
    v_mfma_f32_16x16x32_bf16 v[16:19], a[236:239], v[36:39], v[16:19]
    buffer_load_dword v6, v5, s[8:11], s71 offen
    s_cbranch_scc1 L_moe
L_moe_ret0:
    v_mfma_f32_16x16x32_bf16 v[24:27], a[236:239], v[40:43], v[24:27]
    ds_read_b128 v[32:35], v7 offset:1024
    v_mfma_f32_16x16x32_bf16 v[20:23], a[232:235], v[40:43], v[20:23]
    s_xor_b32 s70, s70, 0x10000
    s_add_u32 s71, s71, 0x10000
    s_waitcnt lgkmcnt(4)
    v_mfma_f32_16x16x32_bf16 v[12:15], a[240:243], v[44:47], v[12:15]
    ds_read_b128 v[36:39], v8 offset:0
    v_mfma_f32_16x16x32_bf16 v[16:19], a[244:247], v[44:47], v[16:19]
    v_mfma_f32_16x16x32_bf16 v[24:27], a[244:247], v[48:51], v[24:27]
    ds_read_b128 v[40:43], v8 offset:1024
    v_mfma_f32_16x16x32_bf16 v[20:23], a[240:243], v[48:51], v[20:23]
    s_waitcnt lgkmcnt(4)
    v_mfma_f32_16x16x32_bf16 v[12:15], a[248:251], v[52:55], v[12:15]
    ds_read_b128 v[44:47], v7 offset:4096
    v_mfma_f32_16x16x32_bf16 v[16:19], a[252:255], v[52:55], v[16:19]
    s_add_u32 s68, s68, 1
    s_mov_b32 s86, s68
    v_mfma_f32_16x16x32_bf16 v[24:27], a[252:255], v[56:59], v[24:27]
    ds_read_b128 v[48:51], v7 offset:5120
    v_mfma_f32_16x16x32_bf16 v[20:23], a[248:251], v[56:59], v[20:23]
    s_waitcnt lgkmcnt(4)
    v_mfma_f32_16x16x32_bf16 v[180:183], a[0:3], v[28:31], 0
    ds_read_b128 v[52:55], v8 offset:4096
    v_mfma_f32_16x16x32_bf16 v[184:187], a[4:7], v[28:31], 0
    v_mfma_f32_16x16x32_bf16 v[192:195], a[4:7], v[32:35], 0
    ds_read_b128 v[56:59], v8 offset:5120
    v_mfma_f32_16x16x32_bf16 v[188:191], a[0:3], v[32:35], 0
    buffer_store_dwordx4 v[76:79], v73, s[4:7], s84 offen sc1
    s_waitcnt lgkmcnt(4)
    v_mfma_f32_16x16x32_bf16 v[180:183], a[8:11], v[36:39], v[180:183]
    ds_read_b128 v[28:31], v7 offset:8192
    v_mfma_f32_16x16x32_bf16 v[184:187], a[12:15], v[36:39], v[184:187]
    v_cvt_pk_bf16_f32 v12, v12, v13
    v_cvt_pk_bf16_f32 v13, v14, v15
    v_mfma_f32_16x16x32_bf16 v[192:195], a[12:15], v[40:43], v[192:195]
    ds_read_b128 v[32:35], v7 offset:9216
    v_mfma_f32_16x16x32_bf16 v[188:191], a[8:11], v[40:43], v[188:191]
    v_cvt_pk_bf16_f32 v14, v16, v17
    v_cvt_pk_bf16_f32 v15, v18, v19
    s_waitcnt lgkmcnt(4)
    v_mfma_f32_16x16x32_bf16 v[180:183], a[16:19], v[44:47], v[180:183]
    ds_read_b128 v[36:39], v8 offset:8192
    v_mfma_f32_16x16x32_bf16 v[184:187], a[20:23], v[44:47], v[184:187]
    v_cvt_pk_bf16_f32 v16, v20, v21
    v_cvt_pk_bf16_f32 v17, v22, v23
    v_mfma_f32_16x16x32_bf16 v[192:195], a[20:23], v[48:51], v[192:195]
    ds_read_b128 v[40:43], v8 offset:9216
    v_mfma_f32_16x16x32_bf16 v[188:191], a[16:19], v[48:51], v[188:191]
    v_cvt_pk_bf16_f32 v18, v24, v25
    v_cvt_pk_bf16_f32 v19, v26, v27
    s_waitcnt lgkmcnt(4)
    v_mfma_f32_16x16x32_bf16 v[180:183], a[24:27], v[52:55], v[180:183]
    ds_read_b128 v[44:47], v7 offset:12288
    v_mfma_f32_16x16x32_bf16 v[184:187], a[28:31], v[52:55], v[184:187]
    buffer_store_dwordx4 v[12:15], v68, s[4:7], s72 offen offset:0 sc1
    v_mfma_f32_16x16x32_bf16 v[192:195], a[28:31], v[56:59], v[192:195]
    ds_read_b128 v[48:51], v7 offset:13312
    v_mfma_f32_16x16x32_bf16 v[188:191], a[24:27], v[56:59], v[188:191]
    buffer_store_dwordx4 v[16:19], v68, s[4:7], s72 offen offset:128 sc1
    s_waitcnt lgkmcnt(4)
    v_mfma_f32_16x16x32_bf16 v[180:183], a[32:35], v[28:31], v[180:183]
    ds_read_b128 v[52:55], v8 offset:12288
    v_mfma_f32_16x16x32_bf16 v[184:187], a[36:39], v[28:31], v[184:187]
    v_mfma_f32_16x16x32_bf16 v[192:195], a[36:39], v[32:35], v[192:195]
    ds_read_b128 v[56:59], v8 offset:13312
    v_mfma_f32_16x16x32_bf16 v[188:191], a[32:35], v[32:35], v[188:191]
    s_lshl_b32 s84, s68, 10
    s_and_b32 s84, s84, 0x2000
    s_waitcnt lgkmcnt(4)
    v_mfma_f32_16x16x32_bf16 v[180:183], a[40:43], v[36:39], v[180:183]
    ds_read_b128 v[28:31], v7 offset:16384
    v_mfma_f32_16x16x32_bf16 v[184:187], a[44:47], v[36:39], v[184:187]
    s_xor_b32 s84, s84, s100
    s_lshl_b32 s67, s68, 18
    v_mfma_f32_16x16x32_bf16 v[192:195], a[44:47], v[40:43], v[192:195]
    ds_read_b128 v[32:35], v7 offset:17408
    v_mfma_f32_16x16x32_bf16 v[188:191], a[40:43], v[40:43], v[188:191]
    s_or_b32 s84, s84, s67
    s_lshl_b32 s72, s68, 11
    s_waitcnt lgkmcnt(4)
    v_mfma_f32_16x16x32_bf16 v[180:183], a[48:51], v[44:47], v[180:183]
    ds_read_b128 v[36:39], v8 offset:16384
    v_mfma_f32_16x16x32_bf16 v[184:187], a[52:55], v[44:47], v[184:187]
    s_and_b32 s72, s72, 0x2000
    s_xor_b32 s72, s72, s100
    v_mfma_f32_16x16x32_bf16 v[192:195], a[52:55], v[48:51], v[192:195]
    ds_read_b128 v[40:43], v8 offset:17408
    v_mfma_f32_16x16x32_bf16 v[188:191], a[48:51], v[48:51], v[188:191]
    s_lshl_b32 s67, s68, 19
    s_or_b32 s72, s72, s67
    s_waitcnt lgkmcnt(4)
    v_mfma_f32_16x16x32_bf16 v[180:183], a[56:59], v[52:55], v[180:183]
    ds_read_b128 v[44:47], v7 offset:20480
    v_mfma_f32_16x16x32_bf16 v[184:187], a[60:63], v[52:55], v[184:187]
    s_sub_u32 s79, s68, 22
    s_mov_b32 s85, 1
    v_mfma_f32_16x16x32_bf16 v[192:195], a[60:63], v[56:59], v[192:195]
    ds_read_b128 v[48:51], v7 offset:21504
    v_mfma_f32_16x16x32_bf16 v[188:191], a[56:59], v[56:59], v[188:191]
    s_waitcnt lgkmcnt(4)
    v_mfma_f32_16x16x32_bf16 v[180:183], a[64:67], v[28:31], v[180:183]
    ds_read_b128 v[52:55], v8 offset:20480
    v_mfma_f32_16x16x32_bf16 v[184:187], a[68:71], v[28:31], v[184:187]
    s_mov_b32 m0, s70
    v_mfma_f32_16x16x32_bf16 v[192:195], a[68:71], v[32:35], v[192:195]
    ds_read_b128 v[56:59], v8 offset:21504
    v_mfma_f32_16x16x32_bf16 v[188:191], a[64:67], v[32:35], v[188:191]
    buffer_load_dwordx4 v2, s[8:11], s71 offen offset:0 lds
    s_waitcnt lgkmcnt(4)
    v_mfma_f32_16x16x32_bf16 v[180:183], a[72:75], v[36:39], v[180:183]
    ds_read_b128 v[28:31], v7 offset:24576
    v_mfma_f32_16x16x32_bf16 v[184:187], a[76:79], v[36:39], v[184:187]
    s_add_u32 m0, m0, 3968
    v_mfma_f32_16x16x32_bf16 v[192:195], a[76:79], v[40:43], v[192:195]
    ds_read_b128 v[32:35], v7 offset:25600
    v_mfma_f32_16x16x32_bf16 v[188:191], a[72:75], v[40:43], v[188:191]
    buffer_load_dwordx4 v2, s[8:11], s71 offen offset:128 lds
    s_waitcnt lgkmcnt(4)
    v_mfma_f32_16x16x32_bf16 v[180:183], a[80:83], v[44:47], v[180:183]
    ds_read_b128 v[36:39], v8 offset:24576
    v_mfma_f32_16x16x32_bf16 v[184:187], a[84:87], v[44:47], v[184:187]
    s_add_u32 m0, m0, 3968
    v_mfma_f32_16x16x32_bf16 v[192:195], a[84:87], v[48:51], v[192:195]
    ds_read_b128 v[40:43], v8 offset:25600
    v_mfma_f32_16x16x32_bf16 v[188:191], a[80:83], v[48:51], v[188:191]
    buffer_load_dwordx4 v2, s[8:11], s71 offen offset:256 lds
    s_waitcnt lgkmcnt(4)
    v_mfma_f32_16x16x32_bf16 v[180:183], a[88:91], v[52:55], v[180:183]
    ds_read_b128 v[44:47], v7 offset:28672
    v_mfma_f32_16x16x32_bf16 v[184:187], a[92:95], v[52:55], v[184:187]
    s_add_u32 m0, m0, 3968
    v_mfma_f32_16x16x32_bf16 v[192:195], a[92:95], v[56:59], v[192:195]
    ds_read_b128 v[48:51], v7 offset:29696
    v_mfma_f32_16x16x32_bf16 v[188:191], a[88:91], v[56:59], v[188:191]
    buffer_load_dwordx4 v2, s[8:11], s71 offen offset:384 lds
    s_waitcnt lgkmcnt(4)
    v_mfma_f32_16x16x32_bf16 v[180:183], a[96:99], v[28:31], v[180:183]
    ds_read_b128 v[52:55], v8 offset:28672
    v_mfma_f32_16x16x32_bf16 v[184:187], a[100:103], v[28:31], v[184:187]
    s_add_u32 m0, m0, 3968
    v_mfma_f32_16x16x32_bf16 v[192:195], a[100:103], v[32:35], v[192:195]
    ds_read_b128 v[56:59], v8 offset:29696
    v_mfma_f32_16x16x32_bf16 v[188:191], a[96:99], v[32:35], v[188:191]
    buffer_load_dwordx4 v2, s[8:11], s71 offen offset:512 lds
    s_waitcnt lgkmcnt(4)
    v_mfma_f32_16x16x32_bf16 v[180:183], a[104:107], v[36:39], v[180:183]
    ds_read_b128 v[28:31], v7 offset:32768
    v_mfma_f32_16x16x32_bf16 v[184:187], a[108:111], v[36:39], v[184:187]
    s_add_u32 m0, m0, 3968
    v_mfma_f32_16x16x32_bf16 v[192:195], a[108:111], v[40:43], v[192:195]
    ds_read_b128 v[32:35], v7 offset:33792
    v_mfma_f32_16x16x32_bf16 v[188:191], a[104:107], v[40:43], v[188:191]
    buffer_load_dwordx4 v2, s[8:11], s71 offen offset:640 lds
    s_waitcnt lgkmcnt(4)
    v_mfma_f32_16x16x32_bf16 v[180:183], a[112:115], v[44:47], v[180:183]
    ds_read_b128 v[36:39], v8 offset:32768
    v_mfma_f32_16x16x32_bf16 v[184:187], a[116:119], v[44:47], v[184:187]
    s_add_u32 m0, m0, 3968
    v_mfma_f32_16x16x32_bf16 v[192:195], a[116:119], v[48:51], v[192:195]
    ds_read_b128 v[40:43], v8 offset:33792
    v_mfma_f32_16x16x32_bf16 v[188:191], a[112:115], v[48:51], v[188:191]
    buffer_load_dwordx4 v2, s[8:11], s71 offen offset:768 lds
    s_waitcnt lgkmcnt(4)
    v_mfma_f32_16x16x32_bf16 v[180:183], a[120:123], v[52:55], v[180:183]
    ds_read_b128 v[44:47], v7 offset:36864
    v_mfma_f32_16x16x32_bf16 v[184:187], a[124:127], v[52:55], v[184:187]
    s_add_u32 m0, m0, 3968
    v_mfma_f32_16x16x32_bf16 v[192:195], a[124:127], v[56:59], v[192:195]
    ds_read_b128 v[48:51], v7 offset:37888
    v_mfma_f32_16x16x32_bf16 v[188:191], a[120:123], v[56:59], v[188:191]
    buffer_load_dwordx4 v2, s[8:11], s71 offen offset:896 lds
    s_waitcnt lgkmcnt(4)
    v_mfma_f32_16x16x32_bf16 v[180:183], a[128:131], v[28:31], v[180:183]
    ds_read_b128 v[52:55], v8 offset:36864
    v_mfma_f32_16x16x32_bf16 v[184:187], a[132:135], v[28:31], v[184:187]
    s_add_u32 m0, m0, 3968
    s_waitcnt vmcnt(8)
    s_atomic_umax s86, s[46:47], s87
    v_mfma_f32_16x16x32_bf16 v[192:195], a[132:135], v[32:35], v[192:195]
    ds_read_b128 v[56:59], v8 offset:37888
    v_mfma_f32_16x16x32_bf16 v[188:191], a[128:131], v[32:35], v[188:191]
    buffer_load_dwordx4 v2, s[8:11], s71 offen offset:1024 lds
    s_waitcnt lgkmcnt(4)
    v_mfma_f32_16x16x32_bf16 v[180:183], a[136:139], v[36:39], v[180:183]
    ds_read_b128 v[28:31], v7 offset:40960
    v_mfma_f32_16x16x32_bf16 v[184:187], a[140:143], v[36:39], v[184:187]
    s_add_u32 m0, m0, 3968
    v_mfma_f32_16x16x32_bf16 v[192:195], a[140:143], v[40:43], v[192:195]
    ds_read_b128 v[32:35], v7 offset:41984
    v_mfma_f32_16x16x32_bf16 v[188:191], a[136:139], v[40:43], v[188:191]
    buffer_load_dwordx4 v2, s[8:11], s71 offen offset:1152 lds
    s_waitcnt lgkmcnt(4)
    v_mfma_f32_16x16x32_bf16 v[180:183], a[144:147], v[44:47], v[180:183]
    ds_read_b128 v[36:39], v8 offset:40960
    v_mfma_f32_16x16x32_bf16 v[184:187], a[148:151], v[44:47], v[184:187]
    s_add_u32 m0, m0, 3968
    v_mfma_f32_16x16x32_bf16 v[192:195], a[148:151], v[48:51], v[192:195]
    ds_read_b128 v[40:43], v8 offset:41984
    v_mfma_f32_16x16x32_bf16 v[188:191], a[144:147], v[48:51], v[188:191]
    buffer_load_dwordx4 v2, s[8:11], s71 offen offset:1280 lds
    s_waitcnt lgkmcnt(4)
    v_mfma_f32_16x16x32_bf16 v[180:183], a[152:155], v[52:55], v[180:183]
    ds_read_b128 v[44:47], v7 offset:45056
    v_mfma_f32_16x16x32_bf16 v[184:187], a[156:159], v[52:55], v[184:187]
    s_add_u32 m0, m0, 3968
    v_mfma_f32_16x16x32_bf16 v[192:195], a[156:159], v[56:59], v[192:195]
    ds_read_b128 v[48:51], v7 offset:46080
    v_mfma_f32_16x16x32_bf16 v[188:191], a[152:155], v[56:59], v[188:191]
    buffer_load_dwordx4 v2, s[8:11], s71 offen offset:1408 lds
    s_waitcnt lgkmcnt(4)
    v_mfma_f32_16x16x32_bf16 v[180:183], a[160:163], v[28:31], v[180:183]
    ds_read_b128 v[52:55], v8 offset:45056
    v_mfma_f32_16x16x32_bf16 v[184:187], a[164:167], v[28:31], v[184:187]
    s_add_u32 m0, m0, 3968
    v_mfma_f32_16x16x32_bf16 v[192:195], a[164:167], v[32:35], v[192:195]
    ds_read_b128 v[56:59], v8 offset:46080
    v_mfma_f32_16x16x32_bf16 v[188:191], a[160:163], v[32:35], v[188:191]
    buffer_load_dwordx4 v2, s[8:11], s71 offen offset:1536 lds
    s_waitcnt lgkmcnt(4)
    v_mfma_f32_16x16x32_bf16 v[180:183], a[168:171], v[36:39], v[180:183]
    ds_read_b128 v[28:31], v7 offset:49152
    v_mfma_f32_16x16x32_bf16 v[184:187], a[172:175], v[36:39], v[184:187]
    s_add_u32 m0, m0, 3968
    v_mfma_f32_16x16x32_bf16 v[192:195], a[172:175], v[40:43], v[192:195]
    ds_read_b128 v[32:35], v7 offset:50176
    v_mfma_f32_16x16x32_bf16 v[188:191], a[168:171], v[40:43], v[188:191]
    buffer_load_dwordx4 v2, s[8:11], s71 offen offset:1664 lds
    s_waitcnt lgkmcnt(4)
    v_mfma_f32_16x16x32_bf16 v[180:183], a[176:179], v[44:47], v[180:183]
    ds_read_b128 v[36:39], v8 offset:49152
    v_mfma_f32_16x16x32_bf16 v[184:187], a[180:183], v[44:47], v[184:187]
    s_add_u32 m0, m0, 3968
    v_mfma_f32_16x16x32_bf16 v[192:195], a[180:183], v[48:51], v[192:195]
    ds_read_b128 v[40:43], v8 offset:50176
    v_mfma_f32_16x16x32_bf16 v[188:191], a[176:179], v[48:51], v[188:191]
    buffer_load_dwordx4 v2, s[8:11], s71 offen offset:1792 lds
    s_waitcnt lgkmcnt(4)
    v_mfma_f32_16x16x32_bf16 v[180:183], a[184:187], v[52:55], v[180:183]
    ds_read_b128 v[44:47], v7 offset:53248
    v_mfma_f32_16x16x32_bf16 v[184:187], a[188:191], v[52:55], v[184:187]
    s_add_u32 m0, m0, 3968
    v_mfma_f32_16x16x32_bf16 v[192:195], a[188:191], v[56:59], v[192:195]
    ds_read_b128 v[48:51], v7 offset:54272
    v_mfma_f32_16x16x32_bf16 v[188:191], a[184:187], v[56:59], v[188:191]
    buffer_load_dwordx4 v2, s[8:11], s71 offen offset:1920 lds
    s_waitcnt lgkmcnt(4)
    v_mfma_f32_16x16x32_bf16 v[180:183], a[192:195], v[28:31], v[180:183]
    ds_read_b128 v[52:55], v8 offset:53248
    v_mfma_f32_16x16x32_bf16 v[184:187], a[196:199], v[28:31], v[184:187]
    v_mfma_f32_16x16x32_bf16 v[192:195], a[196:199], v[32:35], v[192:195]
    ds_read_b128 v[56:59], v8 offset:54272
    v_mfma_f32_16x16x32_bf16 v[188:191], a[192:195], v[32:35], v[188:191]
    s_waitcnt lgkmcnt(4)
    v_mfma_f32_16x16x32_bf16 v[180:183], a[200:203], v[36:39], v[180:183]
    ds_read_b128 v[28:31], v7 offset:57344
    v_mfma_f32_16x16x32_bf16 v[184:187], a[204:207], v[36:39], v[184:187]
    v_mfma_f32_16x16x32_bf16 v[192:195], a[204:207], v[40:43], v[192:195]
    ds_read_b128 v[32:35], v7 offset:58368
    v_mfma_f32_16x16x32_bf16 v[188:191], a[200:203], v[40:43], v[188:191]
    s_waitcnt lgkmcnt(4)
    v_mfma_f32_16x16x32_bf16 v[180:183], a[208:211], v[44:47], v[180:183]
    ds_read_b128 v[36:39], v8 offset:57344
    v_mfma_f32_16x16x32_bf16 v[184:187], a[212:215], v[44:47], v[184:187]
    v_mfma_f32_16x16x32_bf16 v[192:195], a[212:215], v[48:51], v[192:195]
    ds_read_b128 v[40:43], v8 offset:58368
    v_mfma_f32_16x16x32_bf16 v[188:191], a[208:211], v[48:51], v[188:191]
    s_waitcnt lgkmcnt(4)
    v_mfma_f32_16x16x32_bf16 v[180:183], a[216:219], v[52:55], v[180:183]
    ds_read_b128 v[44:47], v7 offset:61440
    v_mfma_f32_16x16x32_bf16 v[184:187], a[220:223], v[52:55], v[184:187]
    v_mfma_f32_16x16x32_bf16 v[192:195], a[220:223], v[56:59], v[192:195]
    ds_read_b128 v[48:51], v7 offset:62464
    v_mfma_f32_16x16x32_bf16 v[188:191], a[216:219], v[56:59], v[188:191]
    s_waitcnt lgkmcnt(4)
    v_mfma_f32_16x16x32_bf16 v[180:183], a[224:227], v[28:31], v[180:183]
    ds_read_b128 v[52:55], v8 offset:61440
    v_mfma_f32_16x16x32_bf16 v[184:187], a[228:231], v[28:31], v[184:187]
    v_mfma_f32_16x16x32_bf16 v[192:195], a[228:231], v[32:35], v[192:195]
    ds_read_b128 v[56:59], v8 offset:62464
    v_xor_b32 v7, 0x10000, v7
    v_xor_b32 v8, 0x10000, v8
    v_mfma_f32_16x16x32_bf16 v[188:191], a[224:227], v[32:35], v[188:191]
    s_bitcmp1_b64 s[80:81], s68
    s_waitcnt vmcnt(0)
    s_barrier
    s_waitcnt lgkmcnt(4)
    v_mfma_f32_16x16x32_bf16 v[180:183], a[232:235], v[36:39], v[180:183]
    ds_read_b128 v[28:31], v7 offset:0
    v_mfma_f32_16x16x32_bf16 v[184:187], a[236:239], v[36:39], v[184:187]
    buffer_load_dword v6, v5, s[8:11], s71 offen
    s_cbranch_scc1 L_moe
L_moe_ret1:
    v_mfma_f32_16x16x32_bf16 v[192:195], a[236:239], v[40:43], v[192:195]
    ds_read_b128 v[32:35], v7 offset:1024
    v_mfma_f32_16x16x32_bf16 v[188:191], a[232:235], v[40:43], v[188:191]
    s_xor_b32 s70, s70, 0x10000
    s_add_u32 s71, s71, 0x10000
    s_waitcnt lgkmcnt(4)
    v_mfma_f32_16x16x32_bf16 v[180:183], a[240:243], v[44:47], v[180:183]
    ds_read_b128 v[36:39], v8 offset:0
    v_mfma_f32_16x16x32_bf16 v[184:187], a[244:247], v[44:47], v[184:187]
    v_mfma_f32_16x16x32_bf16 v[192:195], a[244:247], v[48:51], v[192:195]
    ds_read_b128 v[40:43], v8 offset:1024
    v_mfma_f32_16x16x32_bf16 v[188:191], a[240:243], v[48:51], v[188:191]
    s_waitcnt lgkmcnt(4)
    v_mfma_f32_16x16x32_bf16 v[180:183], a[248:251], v[52:55], v[180:183]
    ds_read_b128 v[44:47], v7 offset:4096
    v_mfma_f32_16x16x32_bf16 v[184:187], a[252:255], v[52:55], v[184:187]
    s_add_u32 s68, s68, 1
    s_mov_b32 s86, s68
    v_mfma_f32_16x16x32_bf16 v[192:195], a[252:255], v[56:59], v[192:195]
    ds_read_b128 v[48:51], v7 offset:5120
    v_mfma_f32_16x16x32_bf16 v[188:191], a[248:251], v[56:59], v[188:191]
    s_lshr_b32 s64, s68, 1
    s_bitcmp1_b64 s[82:83], s64
    s_cbranch_scc1 L_k_loopm
    s_cmp_lt_u32 s68, 64
    s_cbranch_scc1 L_k_loop
    s_branch L_kv_done
L_k_loopm:
    s_waitcnt lgkmcnt(4)
    v_mfma_f32_16x16x32_bf16 v[12:15], a[0:3], v[28:31], 0
    ds_read_b128 v[52:55], v8 offset:4096
    v_mfma_f32_16x16x32_bf16 v[16:19], a[4:7], v[28:31], 0
    v_mfma_f32_16x16x32_bf16 v[24:27], a[4:7], v[32:35], 0
    ds_read_b128 v[56:59], v8 offset:5120
    v_mfma_f32_16x16x32_bf16 v[20:23], a[0:3], v[32:35], 0
    buffer_store_dwordx4 v[76:79], v73, s[4:7], s84 offen sc1
    s_waitcnt lgkmcnt(4)
    v_mfma_f32_16x16x32_bf16 v[12:15], a[8:11], v[36:39], v[12:15]
    ds_read_b128 v[28:31], v7 offset:8192
    v_mfma_f32_16x16x32_bf16 v[16:19], a[12:15], v[36:39], v[16:19]
    v_cvt_pk_bf16_f32 v180, v180, v181
    v_cvt_pk_bf16_f32 v181, v182, v183
    v_mfma_f32_16x16x32_bf16 v[24:27], a[12:15], v[40:43], v[24:27]
    ds_read_b128 v[32:35], v7 offset:9216
    v_mfma_f32_16x16x32_bf16 v[20:23], a[8:11], v[40:43], v[20:23]
    v_cvt_pk_bf16_f32 v182, v184, v185
    v_cvt_pk_bf16_f32 v183, v186, v187
    s_waitcnt lgkmcnt(4)
    v_mfma_f32_16x16x32_bf16 v[12:15], a[16:19], v[44:47], v[12:15]
    ds_read_b128 v[36:39], v8 offset:8192
    v_mfma_f32_16x16x32_bf16 v[16:19], a[20:23], v[44:47], v[16:19]
    v_cvt_pk_bf16_f32 v184, v188, v189
    v_cvt_pk_bf16_f32 v185, v190, v191
    v_mfma_f32_16x16x32_bf16 v[24:27], a[20:23], v[48:51], v[24:27]
    ds_read_b128 v[40:43], v8 offset:9216
    v_mfma_f32_16x16x32_bf16 v[20:23], a[16:19], v[48:51], v[20:23]
    v_cvt_pk_bf16_f32 v186, v192, v193
    v_cvt_pk_bf16_f32 v187, v194, v195
    s_waitcnt lgkmcnt(4)
    v_mfma_f32_16x16x32_bf16 v[12:15], a[24:27], v[52:55], v[12:15]
    ds_read_b128 v[44:47], v7 offset:12288
    v_mfma_f32_16x16x32_bf16 v[16:19], a[28:31], v[52:55], v[16:19]
    buffer_store_dwordx4 v[180:183], v68, s[4:7], s72 offen offset:0 sc1
    v_mfma_f32_16x16x32_bf16 v[24:27], a[28:31], v[56:59], v[24:27]
    ds_read_b128 v[48:51], v7 offset:13312
    v_mfma_f32_16x16x32_bf16 v[20:23], a[24:27], v[56:59], v[20:23]
    buffer_store_dwordx4 v[184:187], v68, s[4:7], s72 offen offset:128 sc1
    s_waitcnt lgkmcnt(4)
    v_mfma_f32_16x16x32_bf16 v[12:15], a[32:35], v[28:31], v[12:15]
    ds_read_b128 v[52:55], v8 offset:12288
    v_mfma_f32_16x16x32_bf16 v[16:19], a[36:39], v[28:31], v[16:19]
    v_mfma_f32_16x16x32_bf16 v[24:27], a[36:39], v[32:35], v[24:27]
    ds_read_b128 v[56:59], v8 offset:13312
    v_mfma_f32_16x16x32_bf16 v[20:23], a[32:35], v[32:35], v[20:23]
    s_lshl_b32 s84, s68, 10
    s_and_b32 s84, s84, 0x2000
    s_waitcnt lgkmcnt(4)
    v_mfma_f32_16x16x32_bf16 v[12:15], a[40:43], v[36:39], v[12:15]
    ds_read_b128 v[28:31], v7 offset:16384
    v_mfma_f32_16x16x32_bf16 v[16:19], a[44:47], v[36:39], v[16:19]
    s_xor_b32 s84, s84, s100
    s_lshl_b32 s67, s68, 18
    v_mfma_f32_16x16x32_bf16 v[24:27], a[44:47], v[40:43], v[24:27]
    ds_read_b128 v[32:35], v7 offset:17408
    v_mfma_f32_16x16x32_bf16 v[20:23], a[40:43], v[40:43], v[20:23]
    s_or_b32 s84, s84, s67
    s_lshl_b32 s72, s68, 11
    s_waitcnt lgkmcnt(4)
    v_mfma_f32_16x16x32_bf16 v[12:15], a[48:51], v[44:47], v[12:15]
    ds_read_b128 v[36:39], v8 offset:16384
    v_mfma_f32_16x16x32_bf16 v[16:19], a[52:55], v[44:47], v[16:19]
    s_and_b32 s72, s72, 0x2000
    s_xor_b32 s72, s72, s100
    v_mfma_f32_16x16x32_bf16 v[24:27], a[52:55], v[48:51], v[24:27]
    ds_read_b128 v[40:43], v8 offset:17408
    v_mfma_f32_16x16x32_bf16 v[20:23], a[48:51], v[48:51], v[20:23]
    s_lshl_b32 s67, s68, 19
    s_or_b32 s72, s72, s67
    s_waitcnt lgkmcnt(4)
    v_mfma_f32_16x16x32_bf16 v[12:15], a[56:59], v[52:55], v[12:15]
    ds_read_b128 v[44:47], v7 offset:20480
    v_mfma_f32_16x16x32_bf16 v[16:19], a[60:63], v[52:55], v[16:19]
    s_sub_u32 s79, s68, 22
    s_mov_b32 s85, 2
    v_mfma_f32_16x16x32_bf16 v[24:27], a[60:63], v[56:59], v[24:27]
    ds_read_b128 v[48:51], v7 offset:21504
    v_mfma_f32_16x16x32_bf16 v[20:23], a[56:59], v[56:59], v[20:23]
    s_waitcnt lgkmcnt(4)
    v_mfma_f32_16x16x32_bf16 v[12:15], a[64:67], v[28:31], v[12:15]
    ds_read_b128 v[52:55], v8 offset:20480
    v_mfma_f32_16x16x32_bf16 v[16:19], a[68:71], v[28:31], v[16:19]
    s_mov_b32 m0, s70
    v_mfma_f32_16x16x32_bf16 v[24:27], a[68:71], v[32:35], v[24:27]
    ds_read_b128 v[56:59], v8 offset:21504
    v_mfma_f32_16x16x32_bf16 v[20:23], a[64:67], v[32:35], v[20:23]
    buffer_load_dwordx4 v2, s[8:11], s71 offen offset:0 lds
    s_waitcnt lgkmcnt(4)
    v_mfma_f32_16x16x32_bf16 v[12:15], a[72:75], v[36:39], v[12:15]
    ds_read_b128 v[28:31], v7 offset:24576
    v_mfma_f32_16x16x32_bf16 v[16:19], a[76:79], v[36:39], v[16:19]
    s_add_u32 m0, m0, 3968
    v_mfma_f32_16x16x32_bf16 v[24:27], a[76:79], v[40:43], v[24:27]
    ds_read_b128 v[32:35], v7 offset:25600
    v_mfma_f32_16x16x32_bf16 v[20:23], a[72:75], v[40:43], v[20:23]
    buffer_load_dwordx4 v2, s[8:11], s71 offen offset:128 lds
    s_waitcnt lgkmcnt(4)
    v_mfma_f32_16x16x32_bf16 v[12:15], a[80:83], v[44:47], v[12:15]
    ds_read_b128 v[36:39], v8 offset:24576
    v_mfma_f32_16x16x32_bf16 v[16:19], a[84:87], v[44:47], v[16:19]
    s_add_u32 m0, m0, 3968
    v_mfma_f32_16x16x32_bf16 v[24:27], a[84:87], v[48:51], v[24:27]
    ds_read_b128 v[40:43], v8 offset:25600
    v_mfma_f32_16x16x32_bf16 v[20:23], a[80:83], v[48:51], v[20:23]
    buffer_load_dwordx4 v2, s[8:11], s71 offen offset:256 lds
    s_waitcnt lgkmcnt(4)
    v_mfma_f32_16x16x32_bf16 v[12:15], a[88:91], v[52:55], v[12:15]
    ds_read_b128 v[44:47], v7 offset:28672
    v_mfma_f32_16x16x32_bf16 v[16:19], a[92:95], v[52:55], v[16:19]
    s_add_u32 m0, m0, 3968
    v_mfma_f32_16x16x32_bf16 v[24:27], a[92:95], v[56:59], v[24:27]
    ds_read_b128 v[48:51], v7 offset:29696
    v_mfma_f32_16x16x32_bf16 v[20:23], a[88:91], v[56:59], v[20:23]
    buffer_load_dwordx4 v2, s[8:11], s71 offen offset:384 lds
    s_waitcnt lgkmcnt(4)
    v_mfma_f32_16x16x32_bf16 v[12:15], a[96:99], v[28:31], v[12:15]
    ds_read_b128 v[52:55], v8 offset:28672
    v_mfma_f32_16x16x32_bf16 v[16:19], a[100:103], v[28:31], v[16:19]
    s_add_u32 m0, m0, 3968
    v_mfma_f32_16x16x32_bf16 v[24:27], a[100:103], v[32:35], v[24:27]
    ds_read_b128 v[56:59], v8 offset:29696
    v_mfma_f32_16x16x32_bf16 v[20:23], a[96:99], v[32:35], v[20:23]
    buffer_load_dwordx4 v2, s[8:11], s71 offen offset:512 lds
    s_waitcnt lgkmcnt(4)
    v_mfma_f32_16x16x32_bf16 v[12:15], a[104:107], v[36:39], v[12:15]
    ds_read_b128 v[28:31], v7 offset:32768
    v_mfma_f32_16x16x32_bf16 v[16:19], a[108:111], v[36:39], v[16:19]
    s_add_u32 m0, m0, 3968
    v_mfma_f32_16x16x32_bf16 v[24:27], a[108:111], v[40:43], v[24:27]
    ds_read_b128 v[32:35], v7 offset:33792
    v_mfma_f32_16x16x32_bf16 v[20:23], a[104:107], v[40:43], v[20:23]
    buffer_load_dwordx4 v2, s[8:11], s71 offen offset:640 lds
    s_waitcnt lgkmcnt(4)
    v_mfma_f32_16x16x32_bf16 v[12:15], a[112:115], v[44:47], v[12:15]
    ds_read_b128 v[36:39], v8 offset:32768
    v_mfma_f32_16x16x32_bf16 v[16:19], a[116:119], v[44:47], v[16:19]
    s_add_u32 m0, m0, 3968
    v_mfma_f32_16x16x32_bf16 v[24:27], a[116:119], v[48:51], v[24:27]
    ds_read_b128 v[40:43], v8 offset:33792
    v_mfma_f32_16x16x32_bf16 v[20:23], a[112:115], v[48:51], v[20:23]
    buffer_load_dwordx4 v2, s[8:11], s71 offen offset:768 lds
    s_waitcnt lgkmcnt(4)
    v_mfma_f32_16x16x32_bf16 v[12:15], a[120:123], v[52:55], v[12:15]
    ds_read_b128 v[44:47], v7 offset:36864
    v_mfma_f32_16x16x32_bf16 v[16:19], a[124:127], v[52:55], v[16:19]
    s_add_u32 m0, m0, 3968
    v_mfma_f32_16x16x32_bf16 v[24:27], a[124:127], v[56:59], v[24:27]
    ds_read_b128 v[48:51], v7 offset:37888
    v_mfma_f32_16x16x32_bf16 v[20:23], a[120:123], v[56:59], v[20:23]
    buffer_load_dwordx4 v2, s[8:11], s71 offen offset:896 lds
    s_waitcnt lgkmcnt(4)
    v_mfma_f32_16x16x32_bf16 v[12:15], a[128:131], v[28:31], v[12:15]
    ds_read_b128 v[52:55], v8 offset:36864
    v_mfma_f32_16x16x32_bf16 v[16:19], a[132:135], v[28:31], v[16:19]
    s_add_u32 m0, m0, 3968
    s_waitcnt vmcnt(8)
    s_atomic_umax s86, s[46:47], s87
    v_mfma_f32_16x16x32_bf16 v[24:27], a[132:135], v[32:35], v[24:27]
    ds_read_b128 v[56:59], v8 offset:37888
    v_mfma_f32_16x16x32_bf16 v[20:23], a[128:131], v[32:35], v[20:23]
    buffer_load_dwordx4 v2, s[8:11], s71 offen offset:1024 lds
    ds_read_b64_tr_b16 v[148:149], v84 offset:0
    ds_read_b64_tr_b16 v[150:151], v84 offset:256
    s_waitcnt lgkmcnt(6)
    v_mfma_f32_16x16x32_bf16 v[12:15], a[136:139], v[36:39], v[12:15]
    ds_read_b128 v[28:31], v7 offset:40960
    v_mfma_f32_16x16x32_bf16 v[16:19], a[140:143], v[36:39], v[16:19]
    s_add_u32 m0, m0, 3968
    ds_read_b64_tr_b16 v[152:153], v84 offset:4096
    ds_read_b64_tr_b16 v[154:155], v84 offset:4352
    v_mfma_f32_16x16x32_bf16 v[24:27], a[140:143], v[40:43], v[24:27]
    ds_read_b128 v[32:35], v7 offset:41984
    v_mfma_f32_16x16x32_bf16 v[20:23], a[136:139], v[40:43], v[20:23]
    buffer_load_dwordx4 v2, s[8:11], s71 offen offset:1152 lds
    ds_read_b64_tr_b16 v[156:157], v85 offset:0
    ds_read_b64_tr_b16 v[158:159], v85 offset:256
    s_waitcnt lgkmcnt(10)
    v_mfma_f32_16x16x32_bf16 v[12:15], a[144:147], v[44:47], v[12:15]
    ds_read_b128 v[36:39], v8 offset:40960
    v_mfma_f32_16x16x32_bf16 v[16:19], a[148:151], v[44:47], v[16:19]
    s_add_u32 m0, m0, 3968
    ds_read_b64_tr_b16 v[160:161], v85 offset:4096
    ds_read_b64_tr_b16 v[162:163], v85 offset:4352
    v_mfma_f32_16x16x32_bf16 v[24:27], a[148:151], v[48:51], v[24:27]
    ds_read_b128 v[40:43], v8 offset:41984
    v_mfma_f32_16x16x32_bf16 v[20:23], a[144:147], v[48:51], v[20:23]
    buffer_load_dwordx4 v2, s[8:11], s71 offen offset:1280 lds
    ds_read_b64_tr_b16 v[164:165], v86 offset:0
    ds_read_b64_tr_b16 v[166:167], v86 offset:256
    s_waitcnt lgkmcnt(14)
    v_mfma_f32_16x16x32_bf16 v[12:15], a[152:155], v[52:55], v[12:15]
    ds_read_b128 v[44:47], v7 offset:45056
    v_mfma_f32_16x16x32_bf16 v[16:19], a[156:159], v[52:55], v[16:19]
    s_add_u32 m0, m0, 3968
    ds_read_b64_tr_b16 v[168:169], v86 offset:4096
    ds_read_b64_tr_b16 v[170:171], v86 offset:4352
    v_mfma_f32_16x16x32_bf16 v[24:27], a[156:159], v[56:59], v[24:27]
    ds_read_b128 v[48:51], v7 offset:46080
    v_mfma_f32_16x16x32_bf16 v[20:23], a[152:155], v[56:59], v[20:23]
    buffer_load_dwordx4 v2, s[8:11], s71 offen offset:1408 lds
    ds_read_b64_tr_b16 v[172:173], v87 offset:0
    ds_read_b64_tr_b16 v[174:175], v87 offset:256
    s_waitcnt lgkmcnt(14)
    v_mfma_f32_16x16x32_bf16 v[12:15], a[160:163], v[28:31], v[12:15]
    ds_read_b128 v[52:55], v8 offset:45056
    v_mfma_f32_16x16x32_bf16 v[16:19], a[164:167], v[28:31], v[16:19]
    s_add_u32 m0, m0, 3968
    ds_read_b64_tr_b16 v[176:177], v87 offset:4096
    ds_read_b64_tr_b16 v[178:179], v87 offset:4352
    v_mfma_f32_16x16x32_bf16 v[24:27], a[164:167], v[32:35], v[24:27]
    ds_read_b128 v[56:59], v8 offset:46080
    v_mfma_f32_16x16x32_bf16 v[20:23], a[160:163], v[32:35], v[20:23]
    buffer_load_dwordx4 v2, s[8:11], s71 offen offset:1536 lds
    s_waitcnt lgkmcnt(12)
    v_mfma_f32_16x16x32_bf16 v[12:15], a[168:171], v[36:39], v[12:15]
    ds_read_b128 v[28:31], v7 offset:49152
    v_mfma_f32_16x16x32_bf16 v[16:19], a[172:175], v[36:39], v[16:19]
    s_add_u32 m0, m0, 3968
    v_mfma_f32_16x16x32_bf16 v[24:27], a[172:175], v[40:43], v[24:27]
    ds_read_b128 v[32:35], v7 offset:50176
    v_mfma_f32_16x16x32_bf16 v[20:23], a[168:171], v[40:43], v[20:23]
    buffer_load_dwordx4 v2, s[8:11], s71 offen offset:1664 lds
    s_waitcnt lgkmcnt(8)
    v_mfma_f32_16x16x32_bf16 v[12:15], a[176:179], v[44:47], v[12:15]
    ds_read_b128 v[36:39], v8 offset:49152
    v_mfma_f32_16x16x32_bf16 v[16:19], a[180:183], v[44:47], v[16:19]
    s_add_u32 m0, m0, 3968
    s_waitcnt lgkmcnt(4)
    v_smfmac_f32_16x16x64_bf16 v[116:119], v[96:99], v[148:155], v90
    v_mfma_f32_16x16x32_bf16 v[24:27], a[180:183], v[48:51], v[24:27]
    ds_read_b128 v[40:43], v8 offset:50176
    v_mfma_f32_16x16x32_bf16 v[20:23], a[176:179], v[48:51], v[20:23]
    buffer_load_dwordx4 v2, s[8:11], s71 offen offset:1792 lds
    v_smfmac_f32_16x16x64_bf16 v[120:123], v[96:99], v[156:163], v90
    s_waitcnt lgkmcnt(4)
    v_mfma_f32_16x16x32_bf16 v[12:15], a[184:187], v[52:55], v[12:15]
    ds_read_b128 v[44:47], v7 offset:53248
    v_mfma_f32_16x16x32_bf16 v[16:19], a[188:191], v[52:55], v[16:19]
    s_add_u32 m0, m0, 3968
    v_smfmac_f32_16x16x64_bf16 v[124:127], v[96:99], v[164:171], v90
    v_mfma_f32_16x16x32_bf16 v[24:27], a[188:191], v[56:59], v[24:27]
    ds_read_b128 v[48:51], v7 offset:54272
    v_mfma_f32_16x16x32_bf16 v[20:23], a[184:187], v[56:59], v[20:23]
    buffer_load_dwordx4 v2, s[8:11], s71 offen offset:1920 lds
    v_smfmac_f32_16x16x64_bf16 v[128:131], v[96:99], v[172:179], v90
    s_waitcnt lgkmcnt(4)
    v_mfma_f32_16x16x32_bf16 v[12:15], a[192:195], v[28:31], v[12:15]
    ds_read_b128 v[52:55], v8 offset:53248
    v_mfma_f32_16x16x32_bf16 v[16:19], a[196:199], v[28:31], v[16:19]
    s_add_u32 m0, s75, 0
    s_add_u32 s76, s76, s78
    v_mfma_f32_16x16x32_bf16 v[24:27], a[196:199], v[32:35], v[24:27]
    ds_read_b128 v[56:59], v8 offset:54272
    v_mfma_f32_16x16x32_bf16 v[20:23], a[192:195], v[32:35], v[20:23]
    buffer_load_dwordx4 v80, s[48:51], s76 offen nt lds
    s_waitcnt lgkmcnt(4)
    v_mfma_f32_16x16x32_bf16 v[12:15], a[200:203], v[36:39], v[12:15]
    ds_read_b128 v[28:31], v7 offset:57344
    v_mfma_f32_16x16x32_bf16 v[16:19], a[204:207], v[36:39], v[16:19]
    s_add_u32 m0, m0, 1024
    s_add_u32 s76, s76, s77
    v_mfma_f32_16x16x32_bf16 v[24:27], a[204:207], v[40:43], v[24:27]
    ds_read_b128 v[32:35], v7 offset:58368
    v_mfma_f32_16x16x32_bf16 v[20:23], a[200:203], v[40:43], v[20:23]
    buffer_load_dwordx4 v81, s[48:51], s76 offen nt lds
    s_waitcnt lgkmcnt(4)
    v_mfma_f32_16x16x32_bf16 v[12:15], a[208:211], v[44:47], v[12:15]
    ds_read_b128 v[36:39], v8 offset:57344
    v_mfma_f32_16x16x32_bf16 v[16:19], a[212:215], v[44:47], v[16:19]
    s_add_u32 m0, m0, 1024
    s_add_u32 s76, s76, s77
    v_mfma_f32_16x16x32_bf16 v[24:27], a[212:215], v[48:51], v[24:27]
    ds_read_b128 v[40:43], v8 offset:58368
    v_mfma_f32_16x16x32_bf16 v[20:23], a[208:211], v[48:51], v[20:23]
    buffer_load_dwordx4 v80, s[48:51], s76 offen nt lds
    s_waitcnt lgkmcnt(4)
    v_mfma_f32_16x16x32_bf16 v[12:15], a[216:219], v[52:55], v[12:15]
    ds_read_b128 v[44:47], v7 offset:61440
    v_mfma_f32_16x16x32_bf16 v[16:19], a[220:223], v[52:55], v[16:19]
    s_add_u32 m0, m0, 1024
    s_add_u32 s76, s76, s77
    v_mfma_f32_16x16x32_bf16 v[24:27], a[220:223], v[56:59], v[24:27]
    ds_read_b128 v[48:51], v7 offset:62464
    v_mfma_f32_16x16x32_bf16 v[20:23], a[216:219], v[56:59], v[20:23]
    buffer_load_dwordx4 v81, s[48:51], s76 offen nt lds
    s_waitcnt lgkmcnt(4)
    v_mfma_f32_16x16x32_bf16 v[12:15], a[224:227], v[28:31], v[12:15]
    ds_read_b128 v[52:55], v8 offset:61440
    v_mfma_f32_16x16x32_bf16 v[16:19], a[228:231], v[28:31], v[16:19]
    s_add_u32 m0, m0, 1024
    s_add_u32 s76, s76, s77
    v_mfma_f32_16x16x32_bf16 v[24:27], a[228:231], v[32:35], v[24:27]
    ds_read_b128 v[56:59], v8 offset:62464
    v_xor_b32 v7, 0x10000, v7
    v_xor_b32 v8, 0x10000, v8
    v_mfma_f32_16x16x32_bf16 v[20:23], a[224:227], v[32:35], v[20:23]
    s_bitcmp1_b64 s[80:81], s68
    s_waitcnt vmcnt(4)
    s_barrier
    s_waitcnt lgkmcnt(4)
    v_mfma_f32_16x16x32_bf16 v[12:15], a[232:235], v[36:39], v[12:15]
    ds_read_b128 v[28:31], v7 offset:0
    v_mfma_f32_16x16x32_bf16 v[16:19], a[236:239], v[36:39], v[16:19]
    buffer_load_dword v6, v5, s[8:11], s71 offen
    s_cbranch_scc1 L_moe
L_moe_ret2:
    v_mfma_f32_16x16x32_bf16 v[24:27], a[236:239], v[40:43], v[24:27]
    ds_read_b128 v[32:35], v7 offset:1024
    v_mfma_f32_16x16x32_bf16 v[20:23], a[232:235], v[40:43], v[20:23]
    s_xor_b32 s70, s70, 0x10000
    s_add_u32 s71, s71, 0x10000
    s_waitcnt lgkmcnt(4)
    v_mfma_f32_16x16x32_bf16 v[12:15], a[240:243], v[44:47], v[12:15]
    ds_read_b128 v[36:39], v8 offset:0
    v_mfma_f32_16x16x32_bf16 v[16:19], a[244:247], v[44:47], v[16:19]
    v_mfma_f32_16x16x32_bf16 v[24:27], a[244:247], v[48:51], v[24:27]
    ds_read_b128 v[40:43], v8 offset:1024
    v_mfma_f32_16x16x32_bf16 v[20:23], a[240:243], v[48:51], v[20:23]
    s_waitcnt lgkmcnt(4)
    v_mfma_f32_16x16x32_bf16 v[12:15], a[248:251], v[52:55], v[12:15]
    ds_read_b128 v[44:47], v7 offset:4096
    v_mfma_f32_16x16x32_bf16 v[16:19], a[252:255], v[52:55], v[16:19]
    s_add_u32 s68, s68, 1
    s_mov_b32 s86, s68
    v_mfma_f32_16x16x32_bf16 v[24:27], a[252:255], v[56:59], v[24:27]
    ds_read_b128 v[48:51], v7 offset:5120
    v_mfma_f32_16x16x32_bf16 v[20:23], a[248:251], v[56:59], v[20:23]
    s_waitcnt lgkmcnt(4)
    v_mfma_f32_16x16x32_bf16 v[180:183], a[0:3], v[28:31], 0
    ds_read_b128 v[52:55], v8 offset:4096
    v_mfma_f32_16x16x32_bf16 v[184:187], a[4:7], v[28:31], 0
    v_mfma_f32_16x16x32_bf16 v[192:195], a[4:7], v[32:35], 0
    ds_read_b128 v[56:59], v8 offset:5120
    v_mfma_f32_16x16x32_bf16 v[188:191], a[0:3], v[32:35], 0
    buffer_store_dwordx4 v[76:79], v73, s[4:7], s84 offen sc1
    s_waitcnt lgkmcnt(4)
    v_mfma_f32_16x16x32_bf16 v[180:183], a[8:11], v[36:39], v[180:183]
    ds_read_b128 v[28:31], v7 offset:8192
    v_mfma_f32_16x16x32_bf16 v[184:187], a[12:15], v[36:39], v[184:187]
    v_cvt_pk_bf16_f32 v12, v12, v13
    v_cvt_pk_bf16_f32 v13, v14, v15
    v_mfma_f32_16x16x32_bf16 v[192:195], a[12:15], v[40:43], v[192:195]
    ds_read_b128 v[32:35], v7 offset:9216
    v_mfma_f32_16x16x32_bf16 v[188:191], a[8:11], v[40:43], v[188:191]
    v_cvt_pk_bf16_f32 v14, v16, v17
    v_cvt_pk_bf16_f32 v15, v18, v19
    s_waitcnt lgkmcnt(4)
    v_mfma_f32_16x16x32_bf16 v[180:183], a[16:19], v[44:47], v[180:183]
    ds_read_b128 v[36:39], v8 offset:8192
    v_mfma_f32_16x16x32_bf16 v[184:187], a[20:23], v[44:47], v[184:187]
    v_cvt_pk_bf16_f32 v16, v20, v21
    v_cvt_pk_bf16_f32 v17, v22, v23
    v_mfma_f32_16x16x32_bf16 v[192:195], a[20:23], v[48:51], v[192:195]
    ds_read_b128 v[40:43], v8 offset:9216
    v_mfma_f32_16x16x32_bf16 v[188:191], a[16:19], v[48:51], v[188:191]
    v_cvt_pk_bf16_f32 v18, v24, v25
    v_cvt_pk_bf16_f32 v19, v26, v27
    s_waitcnt lgkmcnt(4)
    v_mfma_f32_16x16x32_bf16 v[180:183], a[24:27], v[52:55], v[180:183]
    ds_read_b128 v[44:47], v7 offset:12288
    v_mfma_f32_16x16x32_bf16 v[184:187], a[28:31], v[52:55], v[184:187]
    buffer_store_dwordx4 v[12:15], v68, s[4:7], s72 offen offset:0 sc1
    v_mfma_f32_16x16x32_bf16 v[192:195], a[28:31], v[56:59], v[192:195]
    ds_read_b128 v[48:51], v7 offset:13312
    v_mfma_f32_16x16x32_bf16 v[188:191], a[24:27], v[56:59], v[188:191]
    buffer_store_dwordx4 v[16:19], v68, s[4:7], s72 offen offset:128 sc1
    s_waitcnt lgkmcnt(4)
    v_mfma_f32_16x16x32_bf16 v[180:183], a[32:35], v[28:31], v[180:183]
    ds_read_b128 v[52:55], v8 offset:12288
    v_mfma_f32_16x16x32_bf16 v[184:187], a[36:39], v[28:31], v[184:187]
    v_mfma_f32_16x16x32_bf16 v[192:195], a[36:39], v[32:35], v[192:195]
    ds_read_b128 v[56:59], v8 offset:13312
    v_mfma_f32_16x16x32_bf16 v[188:191], a[32:35], v[32:35], v[188:191]
    s_lshl_b32 s84, s68, 10
    s_and_b32 s84, s84, 0x2000
    s_waitcnt lgkmcnt(4)
    v_mfma_f32_16x16x32_bf16 v[180:183], a[40:43], v[36:39], v[180:183]
    ds_read_b128 v[28:31], v7 offset:16384
    v_mfma_f32_16x16x32_bf16 v[184:187], a[44:47], v[36:39], v[184:187]
    s_xor_b32 s84, s84, s100
    s_lshl_b32 s67, s68, 18
    v_mfma_f32_16x16x32_bf16 v[192:195], a[44:47], v[40:43], v[192:195]
    ds_read_b128 v[32:35], v7 offset:17408
    v_mfma_f32_16x16x32_bf16 v[188:191], a[40:43], v[40:43], v[188:191]
    s_or_b32 s84, s84, s67
    s_lshl_b32 s72, s68, 11
    s_waitcnt lgkmcnt(4)
    v_mfma_f32_16x16x32_bf16 v[180:183], a[48:51], v[44:47], v[180:183]
    ds_read_b128 v[36:39], v8 offset:16384
    v_mfma_f32_16x16x32_bf16 v[184:187], a[52:55], v[44:47], v[184:187]
    s_and_b32 s72, s72, 0x2000
    s_xor_b32 s72, s72, s100
    v_mfma_f32_16x16x32_bf16 v[192:195], a[52:55], v[48:51], v[192:195]
    ds_read_b128 v[40:43], v8 offset:17408
    v_mfma_f32_16x16x32_bf16 v[188:191], a[48:51], v[48:51], v[188:191]
    s_lshl_b32 s67, s68, 19
    s_or_b32 s72, s72, s67
    s_waitcnt lgkmcnt(4)
    v_mfma_f32_16x16x32_bf16 v[180:183], a[56:59], v[52:55], v[180:183]
    ds_read_b128 v[44:47], v7 offset:20480
    v_mfma_f32_16x16x32_bf16 v[184:187], a[60:63], v[52:55], v[184:187]
    s_sub_u32 s79, s68, 22
    s_mov_b32 s85, 3
    v_mfma_f32_16x16x32_bf16 v[192:195], a[60:63], v[56:59], v[192:195]
    ds_read_b128 v[48:51], v7 offset:21504
    v_mfma_f32_16x16x32_bf16 v[188:191], a[56:59], v[56:59], v[188:191]
    s_waitcnt lgkmcnt(4)
    v_mfma_f32_16x16x32_bf16 v[180:183], a[64:67], v[28:31], v[180:183]
    ds_read_b128 v[52:55], v8 offset:20480
    v_mfma_f32_16x16x32_bf16 v[184:187], a[68:71], v[28:31], v[184:187]
    s_mov_b32 m0, s70
    v_mov_b64 v[112:113], v[96:97]
    v_mfma_f32_16x16x32_bf16 v[192:195], a[68:71], v[32:35], v[192:195]
    ds_read_b128 v[56:59], v8 offset:21504
    v_mfma_f32_16x16x32_bf16 v[188:191], a[64:67], v[32:35], v[188:191]
    buffer_load_dwordx4 v2, s[8:11], s71 offen offset:0 lds
    s_waitcnt lgkmcnt(4)
    v_mfma_f32_16x16x32_bf16 v[180:183], a[72:75], v[36:39], v[180:183]
    ds_read_b128 v[28:31], v7 offset:24576
    v_mfma_f32_16x16x32_bf16 v[184:187], a[76:79], v[36:39], v[184:187]
    s_add_u32 m0, m0, 3968
    v_mov_b64 v[114:115], v[98:99]
    v_mfma_f32_16x16x32_bf16 v[192:195], a[76:79], v[40:43], v[192:195]
    ds_read_b128 v[32:35], v7 offset:25600
    v_mfma_f32_16x16x32_bf16 v[188:191], a[72:75], v[40:43], v[188:191]
    buffer_load_dwordx4 v2, s[8:11], s71 offen offset:128 lds
    s_waitcnt lgkmcnt(4)
    v_mfma_f32_16x16x32_bf16 v[180:183], a[80:83], v[44:47], v[180:183]
    ds_read_b128 v[36:39], v8 offset:24576
    v_mfma_f32_16x16x32_bf16 v[184:187], a[84:87], v[44:47], v[184:187]
    s_add_u32 m0, m0, 3968
    v_mov_b64 v[96:97], v[100:101]
    v_mfma_f32_16x16x32_bf16 v[192:195], a[84:87], v[48:51], v[192:195]
    ds_read_b128 v[40:43], v8 offset:25600
    v_mfma_f32_16x16x32_bf16 v[188:191], a[80:83], v[48:51], v[188:191]
    buffer_load_dwordx4 v2, s[8:11], s71 offen offset:256 lds
    s_waitcnt lgkmcnt(4)
    v_mfma_f32_16x16x32_bf16 v[180:183], a[88:91], v[52:55], v[180:183]
    ds_read_b128 v[44:47], v7 offset:28672
    v_mfma_f32_16x16x32_bf16 v[184:187], a[92:95], v[52:55], v[184:187]
    s_add_u32 m0, m0, 3968
    v_mov_b64 v[98:99], v[102:103]
    v_mfma_f32_16x16x32_bf16 v[192:195], a[92:95], v[56:59], v[192:195]
    ds_read_b128 v[48:51], v7 offset:29696
    v_mfma_f32_16x16x32_bf16 v[188:191], a[88:91], v[56:59], v[188:191]
    buffer_load_dwordx4 v2, s[8:11], s71 offen offset:384 lds
    s_waitcnt lgkmcnt(4)
    v_mfma_f32_16x16x32_bf16 v[180:183], a[96:99], v[28:31], v[180:183]
    ds_read_b128 v[52:55], v8 offset:28672
    v_mfma_f32_16x16x32_bf16 v[184:187], a[100:103], v[28:31], v[184:187]
    s_add_u32 m0, m0, 3968
    v_mov_b64 v[100:101], v[104:105]
    v_mfma_f32_16x16x32_bf16 v[192:195], a[100:103], v[32:35], v[192:195]
    ds_read_b128 v[56:59], v8 offset:29696
    v_mfma_f32_16x16x32_bf16 v[188:191], a[96:99], v[32:35], v[188:191]
    buffer_load_dwordx4 v2, s[8:11], s71 offen offset:512 lds
    s_waitcnt lgkmcnt(4)
    v_mfma_f32_16x16x32_bf16 v[180:183], a[104:107], v[36:39], v[180:183]
    ds_read_b128 v[28:31], v7 offset:32768
    v_mfma_f32_16x16x32_bf16 v[184:187], a[108:111], v[36:39], v[184:187]
    s_add_u32 m0, m0, 3968
    v_mov_b64 v[102:103], v[106:107]
    v_mfma_f32_16x16x32_bf16 v[192:195], a[108:111], v[40:43], v[192:195]
    ds_read_b128 v[32:35], v7 offset:33792
    v_mfma_f32_16x16x32_bf16 v[188:191], a[104:107], v[40:43], v[188:191]
    buffer_load_dwordx4 v2, s[8:11], s71 offen offset:640 lds
    s_waitcnt lgkmcnt(4)
    v_mfma_f32_16x16x32_bf16 v[180:183], a[112:115], v[44:47], v[180:183]
    ds_read_b128 v[36:39], v8 offset:32768
    v_mfma_f32_16x16x32_bf16 v[184:187], a[116:119], v[44:47], v[184:187]
    s_add_u32 m0, m0, 3968
    v_mov_b64 v[104:105], v[108:109]
    v_mfma_f32_16x16x32_bf16 v[192:195], a[116:119], v[48:51], v[192:195]
    ds_read_b128 v[40:43], v8 offset:33792
    v_mfma_f32_16x16x32_bf16 v[188:191], a[112:115], v[48:51], v[188:191]
    buffer_load_dwordx4 v2, s[8:11], s71 offen offset:768 lds
    s_waitcnt lgkmcnt(4)
    v_mfma_f32_16x16x32_bf16 v[180:183], a[120:123], v[52:55], v[180:183]
    ds_read_b128 v[44:47], v7 offset:36864
    v_mfma_f32_16x16x32_bf16 v[184:187], a[124:127], v[52:55], v[184:187]
    s_add_u32 m0, m0, 3968
    v_mov_b64 v[106:107], v[110:111]
    v_mfma_f32_16x16x32_bf16 v[192:195], a[124:127], v[56:59], v[192:195]
    ds_read_b128 v[48:51], v7 offset:37888
    v_mfma_f32_16x16x32_bf16 v[188:191], a[120:123], v[56:59], v[188:191]
    buffer_load_dwordx4 v2, s[8:11], s71 offen offset:896 lds
    s_waitcnt lgkmcnt(4)
    v_mfma_f32_16x16x32_bf16 v[180:183], a[128:131], v[28:31], v[180:183]
    ds_read_b128 v[52:55], v8 offset:36864
    v_mfma_f32_16x16x32_bf16 v[184:187], a[132:135], v[28:31], v[184:187]
    s_add_u32 m0, m0, 3968
    s_waitcnt vmcnt(8)
    s_atomic_umax s86, s[46:47], s87
    v_mov_b64 v[108:109], v[112:113]
    v_mfma_f32_16x16x32_bf16 v[192:195], a[132:135], v[32:35], v[192:195]
    ds_read_b128 v[56:59], v8 offset:37888
    v_mfma_f32_16x16x32_bf16 v[188:191], a[128:131], v[32:35], v[188:191]
    buffer_load_dwordx4 v2, s[8:11], s71 offen offset:1024 lds
    s_waitcnt lgkmcnt(4)
    v_mfma_f32_16x16x32_bf16 v[180:183], a[136:139], v[36:39], v[180:183]
    ds_read_b128 v[28:31], v7 offset:40960
    v_mfma_f32_16x16x32_bf16 v[184:187], a[140:143], v[36:39], v[184:187]
    s_add_u32 m0, m0, 3968
    v_mov_b64 v[110:111], v[114:115]
    v_mfma_f32_16x16x32_bf16 v[192:195], a[140:143], v[40:43], v[192:195]
    ds_read_b128 v[32:35], v7 offset:41984
    v_mfma_f32_16x16x32_bf16 v[188:191], a[136:139], v[40:43], v[188:191]
    buffer_load_dwordx4 v2, s[8:11], s71 offen offset:1152 lds
    s_waitcnt lgkmcnt(4)
    v_mfma_f32_16x16x32_bf16 v[180:183], a[144:147], v[44:47], v[180:183]
    ds_read_b128 v[36:39], v8 offset:40960
    v_mfma_f32_16x16x32_bf16 v[184:187], a[148:151], v[44:47], v[184:187]
    s_add_u32 m0, m0, 3968
    v_mfma_f32_16x16x32_bf16 v[192:195], a[148:151], v[48:51], v[192:195]
    ds_read_b128 v[40:43], v8 offset:41984
    v_mfma_f32_16x16x32_bf16 v[188:191], a[144:147], v[48:51], v[188:191]
    buffer_load_dwordx4 v2, s[8:11], s71 offen offset:1280 lds
    s_waitcnt lgkmcnt(4)
    v_mfma_f32_16x16x32_bf16 v[180:183], a[152:155], v[52:55], v[180:183]
    ds_read_b128 v[44:47], v7 offset:45056
    v_mfma_f32_16x16x32_bf16 v[184:187], a[156:159], v[52:55], v[184:187]
    s_add_u32 m0, m0, 3968
    v_mfma_f32_16x16x32_bf16 v[192:195], a[156:159], v[56:59], v[192:195]
    ds_read_b128 v[48:51], v7 offset:46080
    v_mfma_f32_16x16x32_bf16 v[188:191], a[152:155], v[56:59], v[188:191]
    buffer_load_dwordx4 v2, s[8:11], s71 offen offset:1408 lds
    s_waitcnt lgkmcnt(4)
    v_mfma_f32_16x16x32_bf16 v[180:183], a[160:163], v[28:31], v[180:183]
    ds_read_b128 v[52:55], v8 offset:45056
    v_mfma_f32_16x16x32_bf16 v[184:187], a[164:167], v[28:31], v[184:187]
    s_add_u32 m0, m0, 3968
    v_mfma_f32_16x16x32_bf16 v[192:195], a[164:167], v[32:35], v[192:195]
    ds_read_b128 v[56:59], v8 offset:46080
    v_mfma_f32_16x16x32_bf16 v[188:191], a[160:163], v[32:35], v[188:191]
    buffer_load_dwordx4 v2, s[8:11], s71 offen offset:1536 lds
    s_waitcnt lgkmcnt(4)
    v_mfma_f32_16x16x32_bf16 v[180:183], a[168:171], v[36:39], v[180:183]
    ds_read_b128 v[28:31], v7 offset:49152
    v_mfma_f32_16x16x32_bf16 v[184:187], a[172:175], v[36:39], v[184:187]
    s_add_u32 m0, m0, 3968
    v_mfma_f32_16x16x32_bf16 v[192:195], a[172:175], v[40:43], v[192:195]
    ds_read_b128 v[32:35], v7 offset:50176
    v_mfma_f32_16x16x32_bf16 v[188:191], a[168:171], v[40:43], v[188:191]
    buffer_load_dwordx4 v2, s[8:11], s71 offen offset:1664 lds
    s_waitcnt lgkmcnt(4)
    v_mfma_f32_16x16x32_bf16 v[180:183], a[176:179], v[44:47], v[180:183]
    ds_read_b128 v[36:39], v8 offset:49152
    v_mfma_f32_16x16x32_bf16 v[184:187], a[180:183], v[44:47], v[184:187]
    s_add_u32 m0, m0, 3968
    v_mfma_f32_16x16x32_bf16 v[192:195], a[180:183], v[48:51], v[192:195]
    ds_read_b128 v[40:43], v8 offset:50176
    v_mfma_f32_16x16x32_bf16 v[188:191], a[176:179], v[48:51], v[188:191]
    buffer_load_dwordx4 v2, s[8:11], s71 offen offset:1792 lds
    s_waitcnt lgkmcnt(4)
    v_mfma_f32_16x16x32_bf16 v[180:183], a[184:187], v[52:55], v[180:183]
    ds_read_b128 v[44:47], v7 offset:53248
    v_mfma_f32_16x16x32_bf16 v[184:187], a[188:191], v[52:55], v[184:187]
    s_add_u32 m0, m0, 3968
    v_mfma_f32_16x16x32_bf16 v[192:195], a[188:191], v[56:59], v[192:195]
    ds_read_b128 v[48:51], v7 offset:54272
    v_mfma_f32_16x16x32_bf16 v[188:191], a[184:187], v[56:59], v[188:191]
    buffer_load_dwordx4 v2, s[8:11], s71 offen offset:1920 lds
    s_waitcnt lgkmcnt(4)
    v_mfma_f32_16x16x32_bf16 v[180:183], a[192:195], v[28:31], v[180:183]
    ds_read_b128 v[52:55], v8 offset:53248
    v_mfma_f32_16x16x32_bf16 v[184:187], a[196:199], v[28:31], v[184:187]
    s_add_u32 m0, s75, 4096
    v_mfma_f32_16x16x32_bf16 v[192:195], a[196:199], v[32:35], v[192:195]
    ds_read_b128 v[56:59], v8 offset:54272
    v_mfma_f32_16x16x32_bf16 v[188:191], a[192:195], v[32:35], v[188:191]
    buffer_load_dwordx4 v80, s[48:51], s76 offen nt lds
    s_waitcnt lgkmcnt(4)
    v_mfma_f32_16x16x32_bf16 v[180:183], a[200:203], v[36:39], v[180:183]
    ds_read_b128 v[28:31], v7 offset:57344
    v_mfma_f32_16x16x32_bf16 v[184:187], a[204:207], v[36:39], v[184:187]
    s_add_u32 m0, m0, 1024
    s_add_u32 s76, s76, s77
    v_mfma_f32_16x16x32_bf16 v[192:195], a[204:207], v[40:43], v[192:195]
    ds_read_b128 v[32:35], v7 offset:58368
    v_mfma_f32_16x16x32_bf16 v[188:191], a[200:203], v[40:43], v[188:191]
    buffer_load_dwordx4 v81, s[48:51], s76 offen nt lds
    s_waitcnt lgkmcnt(4)
    v_mfma_f32_16x16x32_bf16 v[180:183], a[208:211], v[44:47], v[180:183]
    ds_read_b128 v[36:39], v8 offset:57344
    v_mfma_f32_16x16x32_bf16 v[184:187], a[212:215], v[44:47], v[184:187]
    s_add_u32 m0, m0, 1024
    s_add_u32 s76, s76, s77
    v_mfma_f32_16x16x32_bf16 v[192:195], a[212:215], v[48:51], v[192:195]
    ds_read_b128 v[40:43], v8 offset:58368
    v_mfma_f32_16x16x32_bf16 v[188:191], a[208:211], v[48:51], v[188:191]
    buffer_load_dwordx4 v80, s[48:51], s76 offen nt lds
    s_waitcnt lgkmcnt(4)
    v_mfma_f32_16x16x32_bf16 v[180:183], a[216:219], v[52:55], v[180:183]
    ds_read_b128 v[44:47], v7 offset:61440
    v_mfma_f32_16x16x32_bf16 v[184:187], a[220:223], v[52:55], v[184:187]
    s_add_u32 m0, m0, 1024
    s_add_u32 s76, s76, s77
    v_mfma_f32_16x16x32_bf16 v[192:195], a[220:223], v[56:59], v[192:195]
    ds_read_b128 v[48:51], v7 offset:62464
    v_mfma_f32_16x16x32_bf16 v[188:191], a[216:219], v[56:59], v[188:191]
    buffer_load_dwordx4 v81, s[48:51], s76 offen nt lds
    s_waitcnt lgkmcnt(4)
    v_mfma_f32_16x16x32_bf16 v[180:183], a[224:227], v[28:31], v[180:183]
    ds_read_b128 v[52:55], v8 offset:61440
    v_mfma_f32_16x16x32_bf16 v[184:187], a[228:231], v[28:31], v[184:187]
    s_add_u32 m0, m0, 1024
    s_add_u32 s76, s76, s77
    v_mfma_f32_16x16x32_bf16 v[192:195], a[228:231], v[32:35], v[192:195]
    ds_read_b128 v[56:59], v8 offset:62464
    v_xor_b32 v7, 0x10000, v7
    v_xor_b32 v8, 0x10000, v8
    v_mfma_f32_16x16x32_bf16 v[188:191], a[224:227], v[32:35], v[188:191]
    s_bitcmp1_b64 s[80:81], s68
    s_waitcnt vmcnt(4)
    s_barrier
    s_waitcnt lgkmcnt(4)
    v_mfma_f32_16x16x32_bf16 v[180:183], a[232:235], v[36:39], v[180:183]
    ds_read_b128 v[28:31], v7 offset:0
    v_mfma_f32_16x16x32_bf16 v[184:187], a[236:239], v[36:39], v[184:187]
    buffer_load_dword v6, v5, s[8:11], s71 offen
    s_cbranch_scc1 L_moe
L_moe_ret3:
    v_mfma_f32_16x16x32_bf16 v[192:195], a[236:239], v[40:43], v[192:195]
    ds_read_b128 v[32:35], v7 offset:1024
    v_mfma_f32_16x16x32_bf16 v[188:191], a[232:235], v[40:43], v[188:191]
    s_xor_b32 s70, s70, 0x10000
    s_add_u32 s71, s71, 0x10000
    s_waitcnt lgkmcnt(4)
    v_mfma_f32_16x16x32_bf16 v[180:183], a[240:243], v[44:47], v[180:183]
    ds_read_b128 v[36:39], v8 offset:0
    v_mfma_f32_16x16x32_bf16 v[184:187], a[244:247], v[44:47], v[184:187]
    v_mfma_f32_16x16x32_bf16 v[192:195], a[244:247], v[48:51], v[192:195]
    ds_read_b128 v[40:43], v8 offset:1024
    v_mfma_f32_16x16x32_bf16 v[188:191], a[240:243], v[48:51], v[188:191]
    s_waitcnt lgkmcnt(4)
    v_mfma_f32_16x16x32_bf16 v[180:183], a[248:251], v[52:55], v[180:183]
    ds_read_b128 v[44:47], v7 offset:4096
    v_mfma_f32_16x16x32_bf16 v[184:187], a[252:255], v[52:55], v[184:187]
    s_add_u32 s68, s68, 1
    s_mov_b32 s86, s68
    v_mfma_f32_16x16x32_bf16 v[192:195], a[252:255], v[56:59], v[192:195]
    ds_read_b128 v[48:51], v7 offset:5120
    v_mfma_f32_16x16x32_bf16 v[188:191], a[248:251], v[56:59], v[188:191]
    s_lshr_b32 s64, s68, 1
    s_bitcmp1_b64 s[82:83], s64
    s_cbranch_scc1 L_k_loopm
    s_cmp_lt_u32 s68, 64
    s_cbranch_scc1 L_k_loop
    s_branch L_kv_done
L_v_loop:
    s_waitcnt lgkmcnt(4)
    v_mfma_f32_16x16x32_bf16 v[12:15], v[28:31], a[0:3], 0
    ds_read_b128 v[52:55], v8 offset:4096
    v_mfma_f32_16x16x32_bf16 v[20:23], v[28:31], a[4:7], 0
    v_mfma_f32_16x16x32_bf16 v[24:27], v[32:35], a[4:7], 0
    ds_read_b128 v[56:59], v8 offset:5120
    v_mfma_f32_16x16x32_bf16 v[16:19], v[32:35], a[0:3], 0
    buffer_store_dwordx4 v[76:79], v73, s[4:7], s84 offen sc1
    s_waitcnt lgkmcnt(4)
    v_mfma_f32_16x16x32_bf16 v[12:15], v[36:39], a[8:11], v[12:15]
    ds_read_b128 v[28:31], v7 offset:8192
    v_mfma_f32_16x16x32_bf16 v[20:23], v[36:39], a[12:15], v[20:23]
    v_cvt_pk_bf16_f32 v180, v180, v181
    v_cvt_pk_bf16_f32 v181, v182, v183
    v_mfma_f32_16x16x32_bf16 v[24:27], v[40:43], a[12:15], v[24:27]
    ds_read_b128 v[32:35], v7 offset:9216
    v_mfma_f32_16x16x32_bf16 v[16:19], v[40:43], a[8:11], v[16:19]
    v_cvt_pk_bf16_f32 v182, v184, v185
    v_cvt_pk_bf16_f32 v183, v186, v187
    s_waitcnt lgkmcnt(4)
    v_mfma_f32_16x16x32_bf16 v[12:15], v[44:47], a[16:19], v[12:15]
    ds_read_b128 v[36:39], v8 offset:8192
    v_mfma_f32_16x16x32_bf16 v[20:23], v[44:47], a[20:23], v[20:23]
    v_cvt_pk_bf16_f32 v184, v188, v189
    v_cvt_pk_bf16_f32 v185, v190, v191
    v_mfma_f32_16x16x32_bf16 v[24:27], v[48:51], a[20:23], v[24:27]
    ds_read_b128 v[40:43], v8 offset:9216
    v_mfma_f32_16x16x32_bf16 v[16:19], v[48:51], a[16:19], v[16:19]
    v_cvt_pk_bf16_f32 v186, v192, v193
    v_cvt_pk_bf16_f32 v187, v194, v195
    s_waitcnt lgkmcnt(4)
    v_mfma_f32_16x16x32_bf16 v[12:15], v[52:55], a[24:27], v[12:15]
    ds_read_b128 v[44:47], v7 offset:12288
    v_mfma_f32_16x16x32_bf16 v[20:23], v[52:55], a[28:31], v[20:23]
    buffer_store_dwordx4 v[180:183], v68, s[4:7], s72 offen offset:0 sc1
    v_mfma_f32_16x16x32_bf16 v[24:27], v[56:59], a[28:31], v[24:27]
    ds_read_b128 v[48:51], v7 offset:13312
    v_mfma_f32_16x16x32_bf16 v[16:19], v[56:59], a[24:27], v[16:19]
    buffer_store_dwordx4 v[184:187], v68, s[4:7], s72 offen offset:128 sc1
    s_waitcnt lgkmcnt(4)
    v_mfma_f32_16x16x32_bf16 v[12:15], v[28:31], a[32:35], v[12:15]
    ds_read_b128 v[52:55], v8 offset:12288
    v_mfma_f32_16x16x32_bf16 v[20:23], v[28:31], a[36:39], v[20:23]
    v_mfma_f32_16x16x32_bf16 v[24:27], v[32:35], a[36:39], v[24:27]
    ds_read_b128 v[56:59], v8 offset:13312
    v_mfma_f32_16x16x32_bf16 v[16:19], v[32:35], a[32:35], v[16:19]
    s_lshl_b32 s84, s68, 10
    s_and_b32 s84, s84, 0x2000
    s_waitcnt lgkmcnt(4)
    v_mfma_f32_16x16x32_bf16 v[12:15], v[36:39], a[40:43], v[12:15]
    ds_read_b128 v[28:31], v7 offset:16384
    v_mfma_f32_16x16x32_bf16 v[20:23], v[36:39], a[44:47], v[20:23]
    s_xor_b32 s84, s84, s100
    s_lshl_b32 s67, s68, 18
    v_mfma_f32_16x16x32_bf16 v[24:27], v[40:43], a[44:47], v[24:27]
    ds_read_b128 v[32:35], v7 offset:17408
    v_mfma_f32_16x16x32_bf16 v[16:19], v[40:43], a[40:43], v[16:19]
    s_or_b32 s84, s84, s67
    s_lshl_b32 s72, s68, 11
    s_waitcnt lgkmcnt(4)
    v_mfma_f32_16x16x32_bf16 v[12:15], v[44:47], a[48:51], v[12:15]
    ds_read_b128 v[36:39], v8 offset:16384
    v_mfma_f32_16x16x32_bf16 v[20:23], v[44:47], a[52:55], v[20:23]
    s_and_b32 s72, s72, 0x2000
    s_xor_b32 s72, s72, s100
    v_mfma_f32_16x16x32_bf16 v[24:27], v[48:51], a[52:55], v[24:27]
    ds_read_b128 v[40:43], v8 offset:17408
    v_mfma_f32_16x16x32_bf16 v[16:19], v[48:51], a[48:51], v[16:19]
    s_lshl_b32 s67, s68, 19
    s_or_b32 s72, s72, s67
    s_waitcnt lgkmcnt(4)
    v_mfma_f32_16x16x32_bf16 v[12:15], v[52:55], a[56:59], v[12:15]
    ds_read_b128 v[44:47], v7 offset:20480
    v_mfma_f32_16x16x32_bf16 v[20:23], v[52:55], a[60:63], v[20:23]
    s_sub_u32 s79, s68, 22
    s_mov_b32 s85, 4
    v_mfma_f32_16x16x32_bf16 v[24:27], v[56:59], a[60:63], v[24:27]
    ds_read_b128 v[48:51], v7 offset:21504
    v_mfma_f32_16x16x32_bf16 v[16:19], v[56:59], a[56:59], v[16:19]
    s_waitcnt lgkmcnt(4)
    v_mfma_f32_16x16x32_bf16 v[12:15], v[28:31], a[64:67], v[12:15]
    ds_read_b128 v[52:55], v8 offset:20480
    v_mfma_f32_16x16x32_bf16 v[20:23], v[28:31], a[68:71], v[20:23]
    s_mov_b32 m0, s70
    v_mfma_f32_16x16x32_bf16 v[24:27], v[32:35], a[68:71], v[24:27]
    ds_read_b128 v[56:59], v8 offset:21504
    v_mfma_f32_16x16x32_bf16 v[16:19], v[32:35], a[64:67], v[16:19]
    buffer_load_dwordx4 v2, s[8:11], s71 offen offset:0 lds
    s_waitcnt lgkmcnt(4)
    v_mfma_f32_16x16x32_bf16 v[12:15], v[36:39], a[72:75], v[12:15]
    ds_read_b128 v[28:31], v7 offset:24576
    v_mfma_f32_16x16x32_bf16 v[20:23], v[36:39], a[76:79], v[20:23]
    s_add_u32 m0, m0, 3968
    v_mfma_f32_16x16x32_bf16 v[24:27], v[40:43], a[76:79], v[24:27]
    ds_read_b128 v[32:35], v7 offset:25600
    v_mfma_f32_16x16x32_bf16 v[16:19], v[40:43], a[72:75], v[16:19]
    buffer_load_dwordx4 v2, s[8:11], s71 offen offset:128 lds
    s_waitcnt lgkmcnt(4)
    v_mfma_f32_16x16x32_bf16 v[12:15], v[44:47], a[80:83], v[12:15]
    ds_read_b128 v[36:39], v8 offset:24576
    v_mfma_f32_16x16x32_bf16 v[20:23], v[44:47], a[84:87], v[20:23]
    s_add_u32 m0, m0, 3968
    v_mfma_f32_16x16x32_bf16 v[24:27], v[48:51], a[84:87], v[24:27]
    ds_read_b128 v[40:43], v8 offset:25600
    v_mfma_f32_16x16x32_bf16 v[16:19], v[48:51], a[80:83], v[16:19]
    buffer_load_dwordx4 v2, s[8:11], s71 offen offset:256 lds
    s_waitcnt lgkmcnt(4)
    v_mfma_f32_16x16x32_bf16 v[12:15], v[52:55], a[88:91], v[12:15]
    ds_read_b128 v[44:47], v7 offset:28672
    v_mfma_f32_16x16x32_bf16 v[20:23], v[52:55], a[92:95], v[20:23]
    s_add_u32 m0, m0, 3968
    v_mfma_f32_16x16x32_bf16 v[24:27], v[56:59], a[92:95], v[24:27]
    ds_read_b128 v[48:51], v7 offset:29696
    v_mfma_f32_16x16x32_bf16 v[16:19], v[56:59], a[88:91], v[16:19]
    buffer_load_dwordx4 v2, s[8:11], s71 offen offset:384 lds
    s_waitcnt lgkmcnt(4)
    v_mfma_f32_16x16x32_bf16 v[12:15], v[28:31], a[96:99], v[12:15]
    ds_read_b128 v[52:55], v8 offset:28672
    v_mfma_f32_16x16x32_bf16 v[20:23], v[28:31], a[100:103], v[20:23]
    s_add_u32 m0, m0, 3968
    v_mfma_f32_16x16x32_bf16 v[24:27], v[32:35], a[100:103], v[24:27]
    ds_read_b128 v[56:59], v8 offset:29696
    v_mfma_f32_16x16x32_bf16 v[16:19], v[32:35], a[96:99], v[16:19]
    buffer_load_dwordx4 v2, s[8:11], s71 offen offset:512 lds
    s_waitcnt lgkmcnt(4)
    v_mfma_f32_16x16x32_bf16 v[12:15], v[36:39], a[104:107], v[12:15]
    ds_read_b128 v[28:31], v7 offset:32768
    v_mfma_f32_16x16x32_bf16 v[20:23], v[36:39], a[108:111], v[20:23]
    s_add_u32 m0, m0, 3968
    v_mfma_f32_16x16x32_bf16 v[24:27], v[40:43], a[108:111], v[24:27]
    ds_read_b128 v[32:35], v7 offset:33792
    v_mfma_f32_16x16x32_bf16 v[16:19], v[40:43], a[104:107], v[16:19]
    buffer_load_dwordx4 v2, s[8:11], s71 offen offset:640 lds
    s_waitcnt lgkmcnt(4)
    v_mfma_f32_16x16x32_bf16 v[12:15], v[44:47], a[112:115], v[12:15]
    ds_read_b128 v[36:39], v8 offset:32768
    v_mfma_f32_16x16x32_bf16 v[20:23], v[44:47], a[116:119], v[20:23]
    s_add_u32 m0, m0, 3968
    v_mfma_f32_16x16x32_bf16 v[24:27], v[48:51], a[116:119], v[24:27]
    ds_read_b128 v[40:43], v8 offset:33792
    v_mfma_f32_16x16x32_bf16 v[16:19], v[48:51], a[112:115], v[16:19]
    buffer_load_dwordx4 v2, s[8:11], s71 offen offset:768 lds
    s_waitcnt lgkmcnt(4)
    v_mfma_f32_16x16x32_bf16 v[12:15], v[52:55], a[120:123], v[12:15]
    ds_read_b128 v[44:47], v7 offset:36864
    v_mfma_f32_16x16x32_bf16 v[20:23], v[52:55], a[124:127], v[20:23]
    s_add_u32 m0, m0, 3968
    v_mfma_f32_16x16x32_bf16 v[24:27], v[56:59], a[124:127], v[24:27]
    ds_read_b128 v[48:51], v7 offset:37888
    v_mfma_f32_16x16x32_bf16 v[16:19], v[56:59], a[120:123], v[16:19]
    buffer_load_dwordx4 v2, s[8:11], s71 offen offset:896 lds
    s_waitcnt lgkmcnt(4)
    v_mfma_f32_16x16x32_bf16 v[12:15], v[28:31], a[128:131], v[12:15]
    ds_read_b128 v[52:55], v8 offset:36864
    v_mfma_f32_16x16x32_bf16 v[20:23], v[28:31], a[132:135], v[20:23]
    s_add_u32 m0, m0, 3968
    s_waitcnt vmcnt(8)
    s_atomic_umax s86, s[46:47], s87
    v_mfma_f32_16x16x32_bf16 v[24:27], v[32:35], a[132:135], v[24:27]
    ds_read_b128 v[56:59], v8 offset:37888
    v_mfma_f32_16x16x32_bf16 v[16:19], v[32:35], a[128:131], v[16:19]
    buffer_load_dwordx4 v2, s[8:11], s71 offen offset:1024 lds
    s_waitcnt lgkmcnt(4)
    v_mfma_f32_16x16x32_bf16 v[12:15], v[36:39], a[136:139], v[12:15]
    ds_read_b128 v[28:31], v7 offset:40960
    v_mfma_f32_16x16x32_bf16 v[20:23], v[36:39], a[140:143], v[20:23]
    s_add_u32 m0, m0, 3968
    v_mfma_f32_16x16x32_bf16 v[24:27], v[40:43], a[140:143], v[24:27]
    ds_read_b128 v[32:35], v7 offset:41984
    v_mfma_f32_16x16x32_bf16 v[16:19], v[40:43], a[136:139], v[16:19]
    buffer_load_dwordx4 v2, s[8:11], s71 offen offset:1152 lds
    s_waitcnt lgkmcnt(4)
    v_mfma_f32_16x16x32_bf16 v[12:15], v[44:47], a[144:147], v[12:15]
    ds_read_b128 v[36:39], v8 offset:40960
    v_mfma_f32_16x16x32_bf16 v[20:23], v[44:47], a[148:151], v[20:23]
    s_add_u32 m0, m0, 3968
    v_mfma_f32_16x16x32_bf16 v[24:27], v[48:51], a[148:151], v[24:27]
    ds_read_b128 v[40:43], v8 offset:41984
    v_mfma_f32_16x16x32_bf16 v[16:19], v[48:51], a[144:147], v[16:19]
    buffer_load_dwordx4 v2, s[8:11], s71 offen offset:1280 lds
    s_waitcnt lgkmcnt(4)
    v_mfma_f32_16x16x32_bf16 v[12:15], v[52:55], a[152:155], v[12:15]
    ds_read_b128 v[44:47], v7 offset:45056
    v_mfma_f32_16x16x32_bf16 v[20:23], v[52:55], a[156:159], v[20:23]
    s_add_u32 m0, m0, 3968
    v_mfma_f32_16x16x32_bf16 v[24:27], v[56:59], a[156:159], v[24:27]
    ds_read_b128 v[48:51], v7 offset:46080
    v_mfma_f32_16x16x32_bf16 v[16:19], v[56:59], a[152:155], v[16:19]
    buffer_load_dwordx4 v2, s[8:11], s71 offen offset:1408 lds
    s_waitcnt lgkmcnt(4)
    v_mfma_f32_16x16x32_bf16 v[12:15], v[28:31], a[160:163], v[12:15]
    ds_read_b128 v[52:55], v8 offset:45056
    v_mfma_f32_16x16x32_bf16 v[20:23], v[28:31], a[164:167], v[20:23]
    s_add_u32 m0, m0, 3968
    v_mfma_f32_16x16x32_bf16 v[24:27], v[32:35], a[164:167], v[24:27]
    ds_read_b128 v[56:59], v8 offset:46080
    v_mfma_f32_16x16x32_bf16 v[16:19], v[32:35], a[160:163], v[16:19]
    buffer_load_dwordx4 v2, s[8:11], s71 offen offset:1536 lds
    s_waitcnt lgkmcnt(4)
    v_mfma_f32_16x16x32_bf16 v[12:15], v[36:39], a[168:171], v[12:15]
    ds_read_b128 v[28:31], v7 offset:49152
    v_mfma_f32_16x16x32_bf16 v[20:23], v[36:39], a[172:175], v[20:23]
    s_add_u32 m0, m0, 3968
    v_mfma_f32_16x16x32_bf16 v[24:27], v[40:43], a[172:175], v[24:27]
    ds_read_b128 v[32:35], v7 offset:50176
    v_mfma_f32_16x16x32_bf16 v[16:19], v[40:43], a[168:171], v[16:19]
    buffer_load_dwordx4 v2, s[8:11], s71 offen offset:1664 lds
    s_waitcnt lgkmcnt(4)
    v_mfma_f32_16x16x32_bf16 v[12:15], v[44:47], a[176:179], v[12:15]
    ds_read_b128 v[36:39], v8 offset:49152
    v_mfma_f32_16x16x32_bf16 v[20:23], v[44:47], a[180:183], v[20:23]
    s_add_u32 m0, m0, 3968
    v_mfma_f32_16x16x32_bf16 v[24:27], v[48:51], a[180:183], v[24:27]
    ds_read_b128 v[40:43], v8 offset:50176
    v_mfma_f32_16x16x32_bf16 v[16:19], v[48:51], a[176:179], v[16:19]
    buffer_load_dwordx4 v2, s[8:11], s71 offen offset:1792 lds
    s_waitcnt lgkmcnt(4)
    v_mfma_f32_16x16x32_bf16 v[12:15], v[52:55], a[184:187], v[12:15]
    ds_read_b128 v[44:47], v7 offset:53248
    v_mfma_f32_16x16x32_bf16 v[20:23], v[52:55], a[188:191], v[20:23]
    s_add_u32 m0, m0, 3968
    v_mfma_f32_16x16x32_bf16 v[24:27], v[56:59], a[188:191], v[24:27]
    ds_read_b128 v[48:51], v7 offset:54272
    v_mfma_f32_16x16x32_bf16 v[16:19], v[56:59], a[184:187], v[16:19]
    buffer_load_dwordx4 v2, s[8:11], s71 offen offset:1920 lds
    s_waitcnt lgkmcnt(4)
    v_mfma_f32_16x16x32_bf16 v[12:15], v[28:31], a[192:195], v[12:15]
    ds_read_b128 v[52:55], v8 offset:53248
    v_mfma_f32_16x16x32_bf16 v[20:23], v[28:31], a[196:199], v[20:23]
    v_mfma_f32_16x16x32_bf16 v[24:27], v[32:35], a[196:199], v[24:27]
    ds_read_b128 v[56:59], v8 offset:54272
    v_mfma_f32_16x16x32_bf16 v[16:19], v[32:35], a[192:195], v[16:19]
    s_waitcnt lgkmcnt(4)
    v_mfma_f32_16x16x32_bf16 v[12:15], v[36:39], a[200:203], v[12:15]
    ds_read_b128 v[28:31], v7 offset:57344
    v_mfma_f32_16x16x32_bf16 v[20:23], v[36:39], a[204:207], v[20:23]
    v_mfma_f32_16x16x32_bf16 v[24:27], v[40:43], a[204:207], v[24:27]
    ds_read_b128 v[32:35], v7 offset:58368
    v_mfma_f32_16x16x32_bf16 v[16:19], v[40:43], a[200:203], v[16:19]
    s_waitcnt lgkmcnt(4)
    v_mfma_f32_16x16x32_bf16 v[12:15], v[44:47], a[208:211], v[12:15]
    ds_read_b128 v[36:39], v8 offset:57344
    v_mfma_f32_16x16x32_bf16 v[20:23], v[44:47], a[212:215], v[20:23]
    v_mfma_f32_16x16x32_bf16 v[24:27], v[48:51], a[212:215], v[24:27]
    ds_read_b128 v[40:43], v8 offset:58368
    v_mfma_f32_16x16x32_bf16 v[16:19], v[48:51], a[208:211], v[16:19]
    s_waitcnt lgkmcnt(4)
    v_mfma_f32_16x16x32_bf16 v[12:15], v[52:55], a[216:219], v[12:15]
    ds_read_b128 v[44:47], v7 offset:61440
    v_mfma_f32_16x16x32_bf16 v[20:23], v[52:55], a[220:223], v[20:23]
    v_mfma_f32_16x16x32_bf16 v[24:27], v[56:59], a[220:223], v[24:27]
    ds_read_b128 v[48:51], v7 offset:62464
    v_mfma_f32_16x16x32_bf16 v[16:19], v[56:59], a[216:219], v[16:19]
    s_waitcnt lgkmcnt(4)
    v_mfma_f32_16x16x32_bf16 v[12:15], v[28:31], a[224:227], v[12:15]
    ds_read_b128 v[52:55], v8 offset:61440
    v_mfma_f32_16x16x32_bf16 v[20:23], v[28:31], a[228:231], v[20:23]
    v_mfma_f32_16x16x32_bf16 v[24:27], v[32:35], a[228:231], v[24:27]
    ds_read_b128 v[56:59], v8 offset:62464
    v_xor_b32 v7, 0x10000, v7
    v_xor_b32 v8, 0x10000, v8
    v_mfma_f32_16x16x32_bf16 v[16:19], v[32:35], a[224:227], v[16:19]
    s_bitcmp1_b64 s[80:81], s68
    s_waitcnt vmcnt(0)
    s_barrier
    s_waitcnt lgkmcnt(4)
    v_mfma_f32_16x16x32_bf16 v[12:15], v[36:39], a[232:235], v[12:15]
    ds_read_b128 v[28:31], v7 offset:0
    v_mfma_f32_16x16x32_bf16 v[20:23], v[36:39], a[236:239], v[20:23]
    buffer_load_dword v6, v5, s[8:11], s71 offen
    s_cbranch_scc1 L_moe
L_moe_ret4:
    v_mfma_f32_16x16x32_bf16 v[24:27], v[40:43], a[236:239], v[24:27]
    ds_read_b128 v[32:35], v7 offset:1024
    v_mfma_f32_16x16x32_bf16 v[16:19], v[40:43], a[232:235], v[16:19]
    s_xor_b32 s70, s70, 0x10000
    s_add_u32 s71, s71, 0x10000
    s_waitcnt lgkmcnt(4)
    v_mfma_f32_16x16x32_bf16 v[12:15], v[44:47], a[240:243], v[12:15]
    ds_read_b128 v[36:39], v8 offset:0
    v_mfma_f32_16x16x32_bf16 v[20:23], v[44:47], a[244:247], v[20:23]
    v_mfma_f32_16x16x32_bf16 v[24:27], v[48:51], a[244:247], v[24:27]
    ds_read_b128 v[40:43], v8 offset:1024
    v_mfma_f32_16x16x32_bf16 v[16:19], v[48:51], a[240:243], v[16:19]
    s_waitcnt lgkmcnt(4)
    v_mfma_f32_16x16x32_bf16 v[12:15], v[52:55], a[248:251], v[12:15]
    ds_read_b128 v[44:47], v7 offset:4096
    v_mfma_f32_16x16x32_bf16 v[20:23], v[52:55], a[252:255], v[20:23]
    s_add_u32 s68, s68, 1
    s_mov_b32 s86, s68
    v_mfma_f32_16x16x32_bf16 v[24:27], v[56:59], a[252:255], v[24:27]
    ds_read_b128 v[48:51], v7 offset:5120
    v_mfma_f32_16x16x32_bf16 v[16:19], v[56:59], a[248:251], v[16:19]
    s_waitcnt lgkmcnt(4)
    v_mfma_f32_16x16x32_bf16 v[180:183], v[28:31], a[0:3], 0
    ds_read_b128 v[52:55], v8 offset:4096
    v_mfma_f32_16x16x32_bf16 v[188:191], v[28:31], a[4:7], 0
    v_mfma_f32_16x16x32_bf16 v[192:195], v[32:35], a[4:7], 0
    ds_read_b128 v[56:59], v8 offset:5120
    v_mfma_f32_16x16x32_bf16 v[184:187], v[32:35], a[0:3], 0
    buffer_store_dwordx4 v[76:79], v73, s[4:7], s84 offen sc1
    s_waitcnt lgkmcnt(4)
    v_mfma_f32_16x16x32_bf16 v[180:183], v[36:39], a[8:11], v[180:183]
    ds_read_b128 v[28:31], v7 offset:8192
    v_mfma_f32_16x16x32_bf16 v[188:191], v[36:39], a[12:15], v[188:191]
    v_cvt_pk_bf16_f32 v12, v12, v13
    v_cvt_pk_bf16_f32 v13, v14, v15
    v_mfma_f32_16x16x32_bf16 v[192:195], v[40:43], a[12:15], v[192:195]
    ds_read_b128 v[32:35], v7 offset:9216
    v_mfma_f32_16x16x32_bf16 v[184:187], v[40:43], a[8:11], v[184:187]
    v_cvt_pk_bf16_f32 v14, v16, v17
    v_cvt_pk_bf16_f32 v15, v18, v19
    s_waitcnt lgkmcnt(4)
    v_mfma_f32_16x16x32_bf16 v[180:183], v[44:47], a[16:19], v[180:183]
    ds_read_b128 v[36:39], v8 offset:8192
    v_mfma_f32_16x16x32_bf16 v[188:191], v[44:47], a[20:23], v[188:191]
    v_cvt_pk_bf16_f32 v16, v20, v21
    v_cvt_pk_bf16_f32 v17, v22, v23
    v_mfma_f32_16x16x32_bf16 v[192:195], v[48:51], a[20:23], v[192:195]
    ds_read_b128 v[40:43], v8 offset:9216
    v_mfma_f32_16x16x32_bf16 v[184:187], v[48:51], a[16:19], v[184:187]
    v_cvt_pk_bf16_f32 v18, v24, v25
    v_cvt_pk_bf16_f32 v19, v26, v27
    s_waitcnt lgkmcnt(4)
    v_mfma_f32_16x16x32_bf16 v[180:183], v[52:55], a[24:27], v[180:183]
    ds_read_b128 v[44:47], v7 offset:12288
    v_mfma_f32_16x16x32_bf16 v[188:191], v[52:55], a[28:31], v[188:191]
    buffer_store_dwordx4 v[12:15], v68, s[4:7], s72 offen offset:0 sc1
    v_mfma_f32_16x16x32_bf16 v[192:195], v[56:59], a[28:31], v[192:195]
    ds_read_b128 v[48:51], v7 offset:13312
    v_mfma_f32_16x16x32_bf16 v[184:187], v[56:59], a[24:27], v[184:187]
    buffer_store_dwordx4 v[16:19], v68, s[4:7], s72 offen offset:128 sc1
    s_waitcnt lgkmcnt(4)
    v_mfma_f32_16x16x32_bf16 v[180:183], v[28:31], a[32:35], v[180:183]
    ds_read_b128 v[52:55], v8 offset:12288
    v_mfma_f32_16x16x32_bf16 v[188:191], v[28:31], a[36:39], v[188:191]
    v_mfma_f32_16x16x32_bf16 v[192:195], v[32:35], a[36:39], v[192:195]
    ds_read_b128 v[56:59], v8 offset:13312
    v_mfma_f32_16x16x32_bf16 v[184:187], v[32:35], a[32:35], v[184:187]
    s_lshl_b32 s84, s68, 10
    s_and_b32 s84, s84, 0x2000
    s_waitcnt lgkmcnt(4)
    v_mfma_f32_16x16x32_bf16 v[180:183], v[36:39], a[40:43], v[180:183]
    ds_read_b128 v[28:31], v7 offset:16384
    v_mfma_f32_16x16x32_bf16 v[188:191], v[36:39], a[44:47], v[188:191]
    s_xor_b32 s84, s84, s100
    s_lshl_b32 s67, s68, 18
    v_mfma_f32_16x16x32_bf16 v[192:195], v[40:43], a[44:47], v[192:195]
    ds_read_b128 v[32:35], v7 offset:17408
    v_mfma_f32_16x16x32_bf16 v[184:187], v[40:43], a[40:43], v[184:187]
    s_or_b32 s84, s84, s67
    s_lshl_b32 s72, s68, 11
    s_waitcnt lgkmcnt(4)
    v_mfma_f32_16x16x32_bf16 v[180:183], v[44:47], a[48:51], v[180:183]
    ds_read_b128 v[36:39], v8 offset:16384
    v_mfma_f32_16x16x32_bf16 v[188:191], v[44:47], a[52:55], v[188:191]
    s_and_b32 s72, s72, 0x2000
    s_xor_b32 s72, s72, s100
    v_mfma_f32_16x16x32_bf16 v[192:195], v[48:51], a[52:55], v[192:195]
    ds_read_b128 v[40:43], v8 offset:17408
    v_mfma_f32_16x16x32_bf16 v[184:187], v[48:51], a[48:51], v[184:187]
    s_lshl_b32 s67, s68, 19
    s_or_b32 s72, s72, s67
    s_waitcnt lgkmcnt(4)
    v_mfma_f32_16x16x32_bf16 v[180:183], v[52:55], a[56:59], v[180:183]
    ds_read_b128 v[44:47], v7 offset:20480
    v_mfma_f32_16x16x32_bf16 v[188:191], v[52:55], a[60:63], v[188:191]
    s_sub_u32 s79, s68, 22
    s_mov_b32 s85, 5
    v_mfma_f32_16x16x32_bf16 v[192:195], v[56:59], a[60:63], v[192:195]
    ds_read_b128 v[48:51], v7 offset:21504
    v_mfma_f32_16x16x32_bf16 v[184:187], v[56:59], a[56:59], v[184:187]
    s_waitcnt lgkmcnt(4)
    v_mfma_f32_16x16x32_bf16 v[180:183], v[28:31], a[64:67], v[180:183]
    ds_read_b128 v[52:55], v8 offset:20480
    v_mfma_f32_16x16x32_bf16 v[188:191], v[28:31], a[68:71], v[188:191]
    s_mov_b32 m0, s70
    v_mfma_f32_16x16x32_bf16 v[192:195], v[32:35], a[68:71], v[192:195]
    ds_read_b128 v[56:59], v8 offset:21504
    v_mfma_f32_16x16x32_bf16 v[184:187], v[32:35], a[64:67], v[184:187]
    buffer_load_dwordx4 v2, s[8:11], s71 offen offset:0 lds
    s_waitcnt lgkmcnt(4)
    v_mfma_f32_16x16x32_bf16 v[180:183], v[36:39], a[72:75], v[180:183]
    ds_read_b128 v[28:31], v7 offset:24576
    v_mfma_f32_16x16x32_bf16 v[188:191], v[36:39], a[76:79], v[188:191]
    s_add_u32 m0, m0, 3968
    v_mfma_f32_16x16x32_bf16 v[192:195], v[40:43], a[76:79], v[192:195]
    ds_read_b128 v[32:35], v7 offset:25600
    v_mfma_f32_16x16x32_bf16 v[184:187], v[40:43], a[72:75], v[184:187]
    buffer_load_dwordx4 v2, s[8:11], s71 offen offset:128 lds
    s_waitcnt lgkmcnt(4)
    v_mfma_f32_16x16x32_bf16 v[180:183], v[44:47], a[80:83], v[180:183]
    ds_read_b128 v[36:39], v8 offset:24576
    v_mfma_f32_16x16x32_bf16 v[188:191], v[44:47], a[84:87], v[188:191]
    s_add_u32 m0, m0, 3968
    v_mfma_f32_16x16x32_bf16 v[192:195], v[48:51], a[84:87], v[192:195]
    ds_read_b128 v[40:43], v8 offset:25600
    v_mfma_f32_16x16x32_bf16 v[184:187], v[48:51], a[80:83], v[184:187]
    buffer_load_dwordx4 v2, s[8:11], s71 offen offset:256 lds
    s_waitcnt lgkmcnt(4)
    v_mfma_f32_16x16x32_bf16 v[180:183], v[52:55], a[88:91], v[180:183]
    ds_read_b128 v[44:47], v7 offset:28672
    v_mfma_f32_16x16x32_bf16 v[188:191], v[52:55], a[92:95], v[188:191]
    s_add_u32 m0, m0, 3968
    v_mfma_f32_16x16x32_bf16 v[192:195], v[56:59], a[92:95], v[192:195]
    ds_read_b128 v[48:51], v7 offset:29696
    v_mfma_f32_16x16x32_bf16 v[184:187], v[56:59], a[88:91], v[184:187]
    buffer_load_dwordx4 v2, s[8:11], s71 offen offset:384 lds
    s_waitcnt lgkmcnt(4)
    v_mfma_f32_16x16x32_bf16 v[180:183], v[28:31], a[96:99], v[180:183]
    ds_read_b128 v[52:55], v8 offset:28672
    v_mfma_f32_16x16x32_bf16 v[188:191], v[28:31], a[100:103], v[188:191]
    s_add_u32 m0, m0, 3968
    v_mfma_f32_16x16x32_bf16 v[192:195], v[32:35], a[100:103], v[192:195]
    ds_read_b128 v[56:59], v8 offset:29696
    v_mfma_f32_16x16x32_bf16 v[184:187], v[32:35], a[96:99], v[184:187]
    buffer_load_dwordx4 v2, s[8:11], s71 offen offset:512 lds
    s_waitcnt lgkmcnt(4)
    v_mfma_f32_16x16x32_bf16 v[180:183], v[36:39], a[104:107], v[180:183]
    ds_read_b128 v[28:31], v7 offset:32768
    v_mfma_f32_16x16x32_bf16 v[188:191], v[36:39], a[108:111], v[188:191]
    s_add_u32 m0, m0, 3968
    v_mfma_f32_16x16x32_bf16 v[192:195], v[40:43], a[108:111], v[192:195]
    ds_read_b128 v[32:35], v7 offset:33792
    v_mfma_f32_16x16x32_bf16 v[184:187], v[40:43], a[104:107], v[184:187]
    buffer_load_dwordx4 v2, s[8:11], s71 offen offset:640 lds
    s_waitcnt lgkmcnt(4)
    v_mfma_f32_16x16x32_bf16 v[180:183], v[44:47], a[112:115], v[180:183]
    ds_read_b128 v[36:39], v8 offset:32768
    v_mfma_f32_16x16x32_bf16 v[188:191], v[44:47], a[116:119], v[188:191]
    s_add_u32 m0, m0, 3968
    v_mfma_f32_16x16x32_bf16 v[192:195], v[48:51], a[116:119], v[192:195]
    ds_read_b128 v[40:43], v8 offset:33792
    v_mfma_f32_16x16x32_bf16 v[184:187], v[48:51], a[112:115], v[184:187]
    buffer_load_dwordx4 v2, s[8:11], s71 offen offset:768 lds
    s_waitcnt lgkmcnt(4)
    v_mfma_f32_16x16x32_bf16 v[180:183], v[52:55], a[120:123], v[180:183]
    ds_read_b128 v[44:47], v7 offset:36864
    v_mfma_f32_16x16x32_bf16 v[188:191], v[52:55], a[124:127], v[188:191]
    s_add_u32 m0, m0, 3968
    v_mfma_f32_16x16x32_bf16 v[192:195], v[56:59], a[124:127], v[192:195]
    ds_read_b128 v[48:51], v7 offset:37888
    v_mfma_f32_16x16x32_bf16 v[184:187], v[56:59], a[120:123], v[184:187]
    buffer_load_dwordx4 v2, s[8:11], s71 offen offset:896 lds
    s_waitcnt lgkmcnt(4)
    v_mfma_f32_16x16x32_bf16 v[180:183], v[28:31], a[128:131], v[180:183]
    ds_read_b128 v[52:55], v8 offset:36864
    v_mfma_f32_16x16x32_bf16 v[188:191], v[28:31], a[132:135], v[188:191]
    s_add_u32 m0, m0, 3968
    s_waitcnt vmcnt(8)
    s_atomic_umax s86, s[46:47], s87
    v_mfma_f32_16x16x32_bf16 v[192:195], v[32:35], a[132:135], v[192:195]
    ds_read_b128 v[56:59], v8 offset:37888
    v_mfma_f32_16x16x32_bf16 v[184:187], v[32:35], a[128:131], v[184:187]
    buffer_load_dwordx4 v2, s[8:11], s71 offen offset:1024 lds
    s_waitcnt lgkmcnt(4)
    v_mfma_f32_16x16x32_bf16 v[180:183], v[36:39], a[136:139], v[180:183]
    ds_read_b128 v[28:31], v7 offset:40960
    v_mfma_f32_16x16x32_bf16 v[188:191], v[36:39], a[140:143], v[188:191]
    s_add_u32 m0, m0, 3968
    v_mfma_f32_16x16x32_bf16 v[192:195], v[40:43], a[140:143], v[192:195]
    ds_read_b128 v[32:35], v7 offset:41984
    v_mfma_f32_16x16x32_bf16 v[184:187], v[40:43], a[136:139], v[184:187]
    buffer_load_dwordx4 v2, s[8:11], s71 offen offset:1152 lds
    s_waitcnt lgkmcnt(4)
    v_mfma_f32_16x16x32_bf16 v[180:183], v[44:47], a[144:147], v[180:183]
    ds_read_b128 v[36:39], v8 offset:40960
    v_mfma_f32_16x16x32_bf16 v[188:191], v[44:47], a[148:151], v[188:191]
    s_add_u32 m0, m0, 3968
    v_mfma_f32_16x16x32_bf16 v[192:195], v[48:51], a[148:151], v[192:195]
    ds_read_b128 v[40:43], v8 offset:41984
    v_mfma_f32_16x16x32_bf16 v[184:187], v[48:51], a[144:147], v[184:187]
    buffer_load_dwordx4 v2, s[8:11], s71 offen offset:1280 lds
    s_waitcnt lgkmcnt(4)
    v_mfma_f32_16x16x32_bf16 v[180:183], v[52:55], a[152:155], v[180:183]
    ds_read_b128 v[44:47], v7 offset:45056
    v_mfma_f32_16x16x32_bf16 v[188:191], v[52:55], a[156:159], v[188:191]
    s_add_u32 m0, m0, 3968
    v_mfma_f32_16x16x32_bf16 v[192:195], v[56:59], a[156:159], v[192:195]
    ds_read_b128 v[48:51], v7 offset:46080
    v_mfma_f32_16x16x32_bf16 v[184:187], v[56:59], a[152:155], v[184:187]
    buffer_load_dwordx4 v2, s[8:11], s71 offen offset:1408 lds
    s_waitcnt lgkmcnt(4)
    v_mfma_f32_16x16x32_bf16 v[180:183], v[28:31], a[160:163], v[180:183]
    ds_read_b128 v[52:55], v8 offset:45056
    v_mfma_f32_16x16x32_bf16 v[188:191], v[28:31], a[164:167], v[188:191]
    s_add_u32 m0, m0, 3968
    v_mfma_f32_16x16x32_bf16 v[192:195], v[32:35], a[164:167], v[192:195]
    ds_read_b128 v[56:59], v8 offset:46080
    v_mfma_f32_16x16x32_bf16 v[184:187], v[32:35], a[160:163], v[184:187]
    buffer_load_dwordx4 v2, s[8:11], s71 offen offset:1536 lds
    s_waitcnt lgkmcnt(4)
    v_mfma_f32_16x16x32_bf16 v[180:183], v[36:39], a[168:171], v[180:183]
    ds_read_b128 v[28:31], v7 offset:49152
    v_mfma_f32_16x16x32_bf16 v[188:191], v[36:39], a[172:175], v[188:191]
    s_add_u32 m0, m0, 3968
    v_mfma_f32_16x16x32_bf16 v[192:195], v[40:43], a[172:175], v[192:195]
    ds_read_b128 v[32:35], v7 offset:50176
    v_mfma_f32_16x16x32_bf16 v[184:187], v[40:43], a[168:171], v[184:187]
    buffer_load_dwordx4 v2, s[8:11], s71 offen offset:1664 lds
    s_waitcnt lgkmcnt(4)
    v_mfma_f32_16x16x32_bf16 v[180:183], v[44:47], a[176:179], v[180:183]
    ds_read_b128 v[36:39], v8 offset:49152
    v_mfma_f32_16x16x32_bf16 v[188:191], v[44:47], a[180:183], v[188:191]
    s_add_u32 m0, m0, 3968
    v_mfma_f32_16x16x32_bf16 v[192:195], v[48:51], a[180:183], v[192:195]
    ds_read_b128 v[40:43], v8 offset:50176
    v_mfma_f32_16x16x32_bf16 v[184:187], v[48:51], a[176:179], v[184:187]
    buffer_load_dwordx4 v2, s[8:11], s71 offen offset:1792 lds
    s_waitcnt lgkmcnt(4)
    v_mfma_f32_16x16x32_bf16 v[180:183], v[52:55], a[184:187], v[180:183]
    ds_read_b128 v[44:47], v7 offset:53248
    v_mfma_f32_16x16x32_bf16 v[188:191], v[52:55], a[188:191], v[188:191]
    s_add_u32 m0, m0, 3968
    v_mfma_f32_16x16x32_bf16 v[192:195], v[56:59], a[188:191], v[192:195]
    ds_read_b128 v[48:51], v7 offset:54272
    v_mfma_f32_16x16x32_bf16 v[184:187], v[56:59], a[184:187], v[184:187]
    buffer_load_dwordx4 v2, s[8:11], s71 offen offset:1920 lds
    s_waitcnt lgkmcnt(4)
    v_mfma_f32_16x16x32_bf16 v[180:183], v[28:31], a[192:195], v[180:183]
    ds_read_b128 v[52:55], v8 offset:53248
    v_mfma_f32_16x16x32_bf16 v[188:191], v[28:31], a[196:199], v[188:191]
    v_mfma_f32_16x16x32_bf16 v[192:195], v[32:35], a[196:199], v[192:195]
    ds_read_b128 v[56:59], v8 offset:54272
    v_mfma_f32_16x16x32_bf16 v[184:187], v[32:35], a[192:195], v[184:187]
    s_waitcnt lgkmcnt(4)
    v_mfma_f32_16x16x32_bf16 v[180:183], v[36:39], a[200:203], v[180:183]
    ds_read_b128 v[28:31], v7 offset:57344
    v_mfma_f32_16x16x32_bf16 v[188:191], v[36:39], a[204:207], v[188:191]
    v_mfma_f32_16x16x32_bf16 v[192:195], v[40:43], a[204:207], v[192:195]
    ds_read_b128 v[32:35], v7 offset:58368
    v_mfma_f32_16x16x32_bf16 v[184:187], v[40:43], a[200:203], v[184:187]
    s_waitcnt lgkmcnt(4)
    v_mfma_f32_16x16x32_bf16 v[180:183], v[44:47], a[208:211], v[180:183]
    ds_read_b128 v[36:39], v8 offset:57344
    v_mfma_f32_16x16x32_bf16 v[188:191], v[44:47], a[212:215], v[188:191]
    v_mfma_f32_16x16x32_bf16 v[192:195], v[48:51], a[212:215], v[192:195]
    ds_read_b128 v[40:43], v8 offset:58368
    v_mfma_f32_16x16x32_bf16 v[184:187], v[48:51], a[208:211], v[184:187]
    s_waitcnt lgkmcnt(4)
    v_mfma_f32_16x16x32_bf16 v[180:183], v[52:55], a[216:219], v[180:183]
    ds_read_b128 v[44:47], v7 offset:61440
    v_mfma_f32_16x16x32_bf16 v[188:191], v[52:55], a[220:223], v[188:191]
    v_mfma_f32_16x16x32_bf16 v[192:195], v[56:59], a[220:223], v[192:195]
    ds_read_b128 v[48:51], v7 offset:62464
    v_mfma_f32_16x16x32_bf16 v[184:187], v[56:59], a[216:219], v[184:187]
    s_waitcnt lgkmcnt(4)
    v_mfma_f32_16x16x32_bf16 v[180:183], v[28:31], a[224:227], v[180:183]
    ds_read_b128 v[52:55], v8 offset:61440
    v_mfma_f32_16x16x32_bf16 v[188:191], v[28:31], a[228:231], v[188:191]
    v_mfma_f32_16x16x32_bf16 v[192:195], v[32:35], a[228:231], v[192:195]
    ds_read_b128 v[56:59], v8 offset:62464
    v_xor_b32 v7, 0x10000, v7
    v_xor_b32 v8, 0x10000, v8
    v_mfma_f32_16x16x32_bf16 v[184:187], v[32:35], a[224:227], v[184:187]
    s_bitcmp1_b64 s[80:81], s68
    s_waitcnt vmcnt(0)
    s_barrier
    s_waitcnt lgkmcnt(4)
    v_mfma_f32_16x16x32_bf16 v[180:183], v[36:39], a[232:235], v[180:183]
    ds_read_b128 v[28:31], v7 offset:0
    v_mfma_f32_16x16x32_bf16 v[188:191], v[36:39], a[236:239], v[188:191]
    buffer_load_dword v6, v5, s[8:11], s71 offen
    s_cbranch_scc1 L_moe
L_moe_ret5:
    v_mfma_f32_16x16x32_bf16 v[192:195], v[40:43], a[236:239], v[192:195]
    ds_read_b128 v[32:35], v7 offset:1024
    v_mfma_f32_16x16x32_bf16 v[184:187], v[40:43], a[232:235], v[184:187]
    s_xor_b32 s70, s70, 0x10000
    s_add_u32 s71, s71, 0x10000
    s_waitcnt lgkmcnt(4)
    v_mfma_f32_16x16x32_bf16 v[180:183], v[44:47], a[240:243], v[180:183]
    ds_read_b128 v[36:39], v8 offset:0
    v_mfma_f32_16x16x32_bf16 v[188:191], v[44:47], a[244:247], v[188:191]
    v_mfma_f32_16x16x32_bf16 v[192:195], v[48:51], a[244:247], v[192:195]
    ds_read_b128 v[40:43], v8 offset:1024
    v_mfma_f32_16x16x32_bf16 v[184:187], v[48:51], a[240:243], v[184:187]
    s_waitcnt lgkmcnt(4)
    v_mfma_f32_16x16x32_bf16 v[180:183], v[52:55], a[248:251], v[180:183]
    ds_read_b128 v[44:47], v7 offset:4096
    v_mfma_f32_16x16x32_bf16 v[188:191], v[52:55], a[252:255], v[188:191]
    s_add_u32 s68, s68, 1
    s_mov_b32 s86, s68
    v_mfma_f32_16x16x32_bf16 v[192:195], v[56:59], a[252:255], v[192:195]
    ds_read_b128 v[48:51], v7 offset:5120
    v_mfma_f32_16x16x32_bf16 v[184:187], v[56:59], a[248:251], v[184:187]
    s_lshr_b32 s64, s68, 1
    s_bitcmp1_b64 s[82:83], s64
    s_cbranch_scc1 L_v_loopm
    s_cmp_lt_u32 s68, 64
    s_cbranch_scc1 L_v_loop
    s_branch L_kv_done
L_v_loopm:
    s_waitcnt lgkmcnt(4)
    v_mfma_f32_16x16x32_bf16 v[12:15], v[28:31], a[0:3], 0
    ds_read_b128 v[52:55], v8 offset:4096
    v_mfma_f32_16x16x32_bf16 v[20:23], v[28:31], a[4:7], 0
    v_mfma_f32_16x16x32_bf16 v[24:27], v[32:35], a[4:7], 0
    ds_read_b128 v[56:59], v8 offset:5120
    v_mfma_f32_16x16x32_bf16 v[16:19], v[32:35], a[0:3], 0
    buffer_store_dwordx4 v[76:79], v73, s[4:7], s84 offen sc1
    s_waitcnt lgkmcnt(4)
    v_mfma_f32_16x16x32_bf16 v[12:15], v[36:39], a[8:11], v[12:15]
    ds_read_b128 v[28:31], v7 offset:8192
    v_mfma_f32_16x16x32_bf16 v[20:23], v[36:39], a[12:15], v[20:23]
    v_cvt_pk_bf16_f32 v180, v180, v181
    v_cvt_pk_bf16_f32 v181, v182, v183
    v_mfma_f32_16x16x32_bf16 v[24:27], v[40:43], a[12:15], v[24:27]
    ds_read_b128 v[32:35], v7 offset:9216
    v_mfma_f32_16x16x32_bf16 v[16:19], v[40:43], a[8:11], v[16:19]
    v_cvt_pk_bf16_f32 v182, v184, v185
    v_cvt_pk_bf16_f32 v183, v186, v187
    s_waitcnt lgkmcnt(4)
    v_mfma_f32_16x16x32_bf16 v[12:15], v[44:47], a[16:19], v[12:15]
    ds_read_b128 v[36:39], v8 offset:8192
    v_mfma_f32_16x16x32_bf16 v[20:23], v[44:47], a[20:23], v[20:23]
    v_cvt_pk_bf16_f32 v184, v188, v189
    v_cvt_pk_bf16_f32 v185, v190, v191
    v_mfma_f32_16x16x32_bf16 v[24:27], v[48:51], a[20:23], v[24:27]
    ds_read_b128 v[40:43], v8 offset:9216
    v_mfma_f32_16x16x32_bf16 v[16:19], v[48:51], a[16:19], v[16:19]
    v_cvt_pk_bf16_f32 v186, v192, v193
    v_cvt_pk_bf16_f32 v187, v194, v195
    s_waitcnt lgkmcnt(4)
    v_mfma_f32_16x16x32_bf16 v[12:15], v[52:55], a[24:27], v[12:15]
    ds_read_b128 v[44:47], v7 offset:12288
    v_mfma_f32_16x16x32_bf16 v[20:23], v[52:55], a[28:31], v[20:23]
    buffer_store_dwordx4 v[180:183], v68, s[4:7], s72 offen offset:0 sc1
    v_mfma_f32_16x16x32_bf16 v[24:27], v[56:59], a[28:31], v[24:27]
    ds_read_b128 v[48:51], v7 offset:13312
    v_mfma_f32_16x16x32_bf16 v[16:19], v[56:59], a[24:27], v[16:19]
    buffer_store_dwordx4 v[184:187], v68, s[4:7], s72 offen offset:128 sc1
    s_waitcnt lgkmcnt(4)
    v_mfma_f32_16x16x32_bf16 v[12:15], v[28:31], a[32:35], v[12:15]
    ds_read_b128 v[52:55], v8 offset:12288
    v_mfma_f32_16x16x32_bf16 v[20:23], v[28:31], a[36:39], v[20:23]
    v_mfma_f32_16x16x32_bf16 v[24:27], v[32:35], a[36:39], v[24:27]
    ds_read_b128 v[56:59], v8 offset:13312
    v_mfma_f32_16x16x32_bf16 v[16:19], v[32:35], a[32:35], v[16:19]
    s_lshl_b32 s84, s68, 10
    s_and_b32 s84, s84, 0x2000
    s_waitcnt lgkmcnt(4)
    v_mfma_f32_16x16x32_bf16 v[12:15], v[36:39], a[40:43], v[12:15]
    ds_read_b128 v[28:31], v7 offset:16384
    v_mfma_f32_16x16x32_bf16 v[20:23], v[36:39], a[44:47], v[20:23]
    s_xor_b32 s84, s84, s100
    s_lshl_b32 s67, s68, 18
    v_mfma_f32_16x16x32_bf16 v[24:27], v[40:43], a[44:47], v[24:27]
    ds_read_b128 v[32:35], v7 offset:17408
    v_mfma_f32_16x16x32_bf16 v[16:19], v[40:43], a[40:43], v[16:19]
    s_or_b32 s84, s84, s67
    s_lshl_b32 s72, s68, 11
    s_waitcnt lgkmcnt(4)
    v_mfma_f32_16x16x32_bf16 v[12:15], v[44:47], a[48:51], v[12:15]
    ds_read_b128 v[36:39], v8 offset:16384
    v_mfma_f32_16x16x32_bf16 v[20:23], v[44:47], a[52:55], v[20:23]
    s_and_b32 s72, s72, 0x2000
    s_xor_b32 s72, s72, s100
    v_mfma_f32_16x16x32_bf16 v[24:27], v[48:51], a[52:55], v[24:27]
    ds_read_b128 v[40:43], v8 offset:17408
    v_mfma_f32_16x16x32_bf16 v[16:19], v[48:51], a[48:51], v[16:19]
    s_lshl_b32 s67, s68, 19
    s_or_b32 s72, s72, s67
    s_waitcnt lgkmcnt(4)
    v_mfma_f32_16x16x32_bf16 v[12:15], v[52:55], a[56:59], v[12:15]
    ds_read_b128 v[44:47], v7 offset:20480
    v_mfma_f32_16x16x32_bf16 v[20:23], v[52:55], a[60:63], v[20:23]
    s_sub_u32 s79, s68, 22
    s_mov_b32 s85, 6
    v_mfma_f32_16x16x32_bf16 v[24:27], v[56:59], a[60:63], v[24:27]
    ds_read_b128 v[48:51], v7 offset:21504
    v_mfma_f32_16x16x32_bf16 v[16:19], v[56:59], a[56:59], v[16:19]
    s_waitcnt lgkmcnt(4)
    v_mfma_f32_16x16x32_bf16 v[12:15], v[28:31], a[64:67], v[12:15]
    ds_read_b128 v[52:55], v8 offset:20480
    v_mfma_f32_16x16x32_bf16 v[20:23], v[28:31], a[68:71], v[20:23]
    s_mov_b32 m0, s70
    v_mfma_f32_16x16x32_bf16 v[24:27], v[32:35], a[68:71], v[24:27]
    ds_read_b128 v[56:59], v8 offset:21504
    v_mfma_f32_16x16x32_bf16 v[16:19], v[32:35], a[64:67], v[16:19]
    buffer_load_dwordx4 v2, s[8:11], s71 offen offset:0 lds
    s_waitcnt lgkmcnt(4)
    v_mfma_f32_16x16x32_bf16 v[12:15], v[36:39], a[72:75], v[12:15]
    ds_read_b128 v[28:31], v7 offset:24576
    v_mfma_f32_16x16x32_bf16 v[20:23], v[36:39], a[76:79], v[20:23]
    s_add_u32 m0, m0, 3968
    v_mfma_f32_16x16x32_bf16 v[24:27], v[40:43], a[76:79], v[24:27]
    ds_read_b128 v[32:35], v7 offset:25600
    v_mfma_f32_16x16x32_bf16 v[16:19], v[40:43], a[72:75], v[16:19]
    buffer_load_dwordx4 v2, s[8:11], s71 offen offset:128 lds
    s_waitcnt lgkmcnt(4)
    v_mfma_f32_16x16x32_bf16 v[12:15], v[44:47], a[80:83], v[12:15]
    ds_read_b128 v[36:39], v8 offset:24576
    v_mfma_f32_16x16x32_bf16 v[20:23], v[44:47], a[84:87], v[20:23]
    s_add_u32 m0, m0, 3968
    v_mfma_f32_16x16x32_bf16 v[24:27], v[48:51], a[84:87], v[24:27]
    ds_read_b128 v[40:43], v8 offset:25600
    v_mfma_f32_16x16x32_bf16 v[16:19], v[48:51], a[80:83], v[16:19]
    buffer_load_dwordx4 v2, s[8:11], s71 offen offset:256 lds
    s_waitcnt lgkmcnt(4)
    v_mfma_f32_16x16x32_bf16 v[12:15], v[52:55], a[88:91], v[12:15]
    ds_read_b128 v[44:47], v7 offset:28672
    v_mfma_f32_16x16x32_bf16 v[20:23], v[52:55], a[92:95], v[20:23]
    s_add_u32 m0, m0, 3968
    v_mfma_f32_16x16x32_bf16 v[24:27], v[56:59], a[92:95], v[24:27]
    ds_read_b128 v[48:51], v7 offset:29696
    v_mfma_f32_16x16x32_bf16 v[16:19], v[56:59], a[88:91], v[16:19]
    buffer_load_dwordx4 v2, s[8:11], s71 offen offset:384 lds
    s_waitcnt lgkmcnt(4)
    v_mfma_f32_16x16x32_bf16 v[12:15], v[28:31], a[96:99], v[12:15]
    ds_read_b128 v[52:55], v8 offset:28672
    v_mfma_f32_16x16x32_bf16 v[20:23], v[28:31], a[100:103], v[20:23]
    s_add_u32 m0, m0, 3968
    v_mfma_f32_16x16x32_bf16 v[24:27], v[32:35], a[100:103], v[24:27]
    ds_read_b128 v[56:59], v8 offset:29696
    v_mfma_f32_16x16x32_bf16 v[16:19], v[32:35], a[96:99], v[16:19]
    buffer_load_dwordx4 v2, s[8:11], s71 offen offset:512 lds
    s_waitcnt lgkmcnt(4)
    v_mfma_f32_16x16x32_bf16 v[12:15], v[36:39], a[104:107], v[12:15]
    ds_read_b128 v[28:31], v7 offset:32768
    v_mfma_f32_16x16x32_bf16 v[20:23], v[36:39], a[108:111], v[20:23]
    s_add_u32 m0, m0, 3968
    v_mfma_f32_16x16x32_bf16 v[24:27], v[40:43], a[108:111], v[24:27]
    ds_read_b128 v[32:35], v7 offset:33792
    v_mfma_f32_16x16x32_bf16 v[16:19], v[40:43], a[104:107], v[16:19]
    buffer_load_dwordx4 v2, s[8:11], s71 offen offset:640 lds
    s_waitcnt lgkmcnt(4)
    v_mfma_f32_16x16x32_bf16 v[12:15], v[44:47], a[112:115], v[12:15]
    ds_read_b128 v[36:39], v8 offset:32768
    v_mfma_f32_16x16x32_bf16 v[20:23], v[44:47], a[116:119], v[20:23]
    s_add_u32 m0, m0, 3968
    v_mfma_f32_16x16x32_bf16 v[24:27], v[48:51], a[116:119], v[24:27]
    ds_read_b128 v[40:43], v8 offset:33792
    v_mfma_f32_16x16x32_bf16 v[16:19], v[48:51], a[112:115], v[16:19]
    buffer_load_dwordx4 v2, s[8:11], s71 offen offset:768 lds
    s_waitcnt lgkmcnt(4)
    v_mfma_f32_16x16x32_bf16 v[12:15], v[52:55], a[120:123], v[12:15]
    ds_read_b128 v[44:47], v7 offset:36864
    v_mfma_f32_16x16x32_bf16 v[20:23], v[52:55], a[124:127], v[20:23]
    s_add_u32 m0, m0, 3968
    v_mfma_f32_16x16x32_bf16 v[24:27], v[56:59], a[124:127], v[24:27]
    ds_read_b128 v[48:51], v7 offset:37888
    v_mfma_f32_16x16x32_bf16 v[16:19], v[56:59], a[120:123], v[16:19]
    buffer_load_dwordx4 v2, s[8:11], s71 offen offset:896 lds
    s_waitcnt lgkmcnt(4)
    v_mfma_f32_16x16x32_bf16 v[12:15], v[28:31], a[128:131], v[12:15]
    ds_read_b128 v[52:55], v8 offset:36864
    v_mfma_f32_16x16x32_bf16 v[20:23], v[28:31], a[132:135], v[20:23]
    s_add_u32 m0, m0, 3968
    s_waitcnt vmcnt(8)
    s_atomic_umax s86, s[46:47], s87
    v_mfma_f32_16x16x32_bf16 v[24:27], v[32:35], a[132:135], v[24:27]
    ds_read_b128 v[56:59], v8 offset:37888
    v_mfma_f32_16x16x32_bf16 v[16:19], v[32:35], a[128:131], v[16:19]
    buffer_load_dwordx4 v2, s[8:11], s71 offen offset:1024 lds
    ds_read_b64_tr_b16 v[148:149], v84 offset:0
    ds_read_b64_tr_b16 v[150:151], v84 offset:256
    s_waitcnt lgkmcnt(6)
    v_mfma_f32_16x16x32_bf16 v[12:15], v[36:39], a[136:139], v[12:15]
    ds_read_b128 v[28:31], v7 offset:40960
    v_mfma_f32_16x16x32_bf16 v[20:23], v[36:39], a[140:143], v[20:23]
    s_add_u32 m0, m0, 3968
    ds_read_b64_tr_b16 v[152:153], v84 offset:4096
    ds_read_b64_tr_b16 v[154:155], v84 offset:4352
    v_mfma_f32_16x16x32_bf16 v[24:27], v[40:43], a[140:143], v[24:27]
    ds_read_b128 v[32:35], v7 offset:41984
    v_mfma_f32_16x16x32_bf16 v[16:19], v[40:43], a[136:139], v[16:19]
    buffer_load_dwordx4 v2, s[8:11], s71 offen offset:1152 lds
    ds_read_b64_tr_b16 v[156:157], v85 offset:0
    ds_read_b64_tr_b16 v[158:159], v85 offset:256
    s_waitcnt lgkmcnt(10)
    v_mfma_f32_16x16x32_bf16 v[12:15], v[44:47], a[144:147], v[12:15]
    ds_read_b128 v[36:39], v8 offset:40960
    v_mfma_f32_16x16x32_bf16 v[20:23], v[44:47], a[148:151], v[20:23]
    s_add_u32 m0, m0, 3968
    ds_read_b64_tr_b16 v[160:161], v85 offset:4096
    ds_read_b64_tr_b16 v[162:163], v85 offset:4352
    v_mfma_f32_16x16x32_bf16 v[24:27], v[48:51], a[148:151], v[24:27]
    ds_read_b128 v[40:43], v8 offset:41984
    v_mfma_f32_16x16x32_bf16 v[16:19], v[48:51], a[144:147], v[16:19]
    buffer_load_dwordx4 v2, s[8:11], s71 offen offset:1280 lds
    ds_read_b64_tr_b16 v[164:165], v86 offset:0
    ds_read_b64_tr_b16 v[166:167], v86 offset:256
    s_waitcnt lgkmcnt(14)
    v_mfma_f32_16x16x32_bf16 v[12:15], v[52:55], a[152:155], v[12:15]
    ds_read_b128 v[44:47], v7 offset:45056
    v_mfma_f32_16x16x32_bf16 v[20:23], v[52:55], a[156:159], v[20:23]
    s_add_u32 m0, m0, 3968
    ds_read_b64_tr_b16 v[168:169], v86 offset:4096
    ds_read_b64_tr_b16 v[170:171], v86 offset:4352
    v_mfma_f32_16x16x32_bf16 v[24:27], v[56:59], a[156:159], v[24:27]
    ds_read_b128 v[48:51], v7 offset:46080
    v_mfma_f32_16x16x32_bf16 v[16:19], v[56:59], a[152:155], v[16:19]
    buffer_load_dwordx4 v2, s[8:11], s71 offen offset:1408 lds
    ds_read_b64_tr_b16 v[172:173], v87 offset:0
    ds_read_b64_tr_b16 v[174:175], v87 offset:256
    s_waitcnt lgkmcnt(14)
    v_mfma_f32_16x16x32_bf16 v[12:15], v[28:31], a[160:163], v[12:15]
    ds_read_b128 v[52:55], v8 offset:45056
    v_mfma_f32_16x16x32_bf16 v[20:23], v[28:31], a[164:167], v[20:23]
    s_add_u32 m0, m0, 3968
    ds_read_b64_tr_b16 v[176:177], v87 offset:4096
    ds_read_b64_tr_b16 v[178:179], v87 offset:4352
    v_mfma_f32_16x16x32_bf16 v[24:27], v[32:35], a[164:167], v[24:27]
    ds_read_b128 v[56:59], v8 offset:46080
    v_mfma_f32_16x16x32_bf16 v[16:19], v[32:35], a[160:163], v[16:19]
    buffer_load_dwordx4 v2, s[8:11], s71 offen offset:1536 lds
    s_waitcnt lgkmcnt(12)
    v_mfma_f32_16x16x32_bf16 v[12:15], v[36:39], a[168:171], v[12:15]
    ds_read_b128 v[28:31], v7 offset:49152
    v_mfma_f32_16x16x32_bf16 v[20:23], v[36:39], a[172:175], v[20:23]
    s_add_u32 m0, m0, 3968
    v_mfma_f32_16x16x32_bf16 v[24:27], v[40:43], a[172:175], v[24:27]
    ds_read_b128 v[32:35], v7 offset:50176
    v_mfma_f32_16x16x32_bf16 v[16:19], v[40:43], a[168:171], v[16:19]
    buffer_load_dwordx4 v2, s[8:11], s71 offen offset:1664 lds
    s_waitcnt lgkmcnt(8)
    v_mfma_f32_16x16x32_bf16 v[12:15], v[44:47], a[176:179], v[12:15]
    ds_read_b128 v[36:39], v8 offset:49152
    v_mfma_f32_16x16x32_bf16 v[20:23], v[44:47], a[180:183], v[20:23]
    s_add_u32 m0, m0, 3968
    s_waitcnt lgkmcnt(4)
    v_smfmac_f32_16x16x64_bf16 v[116:119], v[96:99], v[148:155], v90
    v_mfma_f32_16x16x32_bf16 v[24:27], v[48:51], a[180:183], v[24:27]
    ds_read_b128 v[40:43], v8 offset:50176
    v_mfma_f32_16x16x32_bf16 v[16:19], v[48:51], a[176:179], v[16:19]
    buffer_load_dwordx4 v2, s[8:11], s71 offen offset:1792 lds
    v_smfmac_f32_16x16x64_bf16 v[120:123], v[96:99], v[156:163], v90
    s_waitcnt lgkmcnt(4)
    v_mfma_f32_16x16x32_bf16 v[12:15], v[52:55], a[184:187], v[12:15]
    ds_read_b128 v[44:47], v7 offset:53248
    v_mfma_f32_16x16x32_bf16 v[20:23], v[52:55], a[188:191], v[20:23]
    s_add_u32 m0, m0, 3968
    v_smfmac_f32_16x16x64_bf16 v[124:127], v[96:99], v[164:171], v90
    v_mfma_f32_16x16x32_bf16 v[24:27], v[56:59], a[188:191], v[24:27]
    ds_read_b128 v[48:51], v7 offset:54272
    v_mfma_f32_16x16x32_bf16 v[16:19], v[56:59], a[184:187], v[16:19]
    buffer_load_dwordx4 v2, s[8:11], s71 offen offset:1920 lds
    v_smfmac_f32_16x16x64_bf16 v[128:131], v[96:99], v[172:179], v90
    s_waitcnt lgkmcnt(4)
    v_mfma_f32_16x16x32_bf16 v[12:15], v[28:31], a[192:195], v[12:15]
    ds_read_b128 v[52:55], v8 offset:53248
    v_mfma_f32_16x16x32_bf16 v[20:23], v[28:31], a[196:199], v[20:23]
    s_add_u32 m0, s75, 0
    s_add_u32 s76, s76, s78
    v_mfma_f32_16x16x32_bf16 v[24:27], v[32:35], a[196:199], v[24:27]
    ds_read_b128 v[56:59], v8 offset:54272
    v_mfma_f32_16x16x32_bf16 v[16:19], v[32:35], a[192:195], v[16:19]
    buffer_load_dwordx4 v80, s[48:51], s76 offen nt lds
    s_waitcnt lgkmcnt(4)
    v_mfma_f32_16x16x32_bf16 v[12:15], v[36:39], a[200:203], v[12:15]
    ds_read_b128 v[28:31], v7 offset:57344
    v_mfma_f32_16x16x32_bf16 v[20:23], v[36:39], a[204:207], v[20:23]
    s_add_u32 m0, m0, 1024
    s_add_u32 s76, s76, s77
    v_mfma_f32_16x16x32_bf16 v[24:27], v[40:43], a[204:207], v[24:27]
    ds_read_b128 v[32:35], v7 offset:58368
    v_mfma_f32_16x16x32_bf16 v[16:19], v[40:43], a[200:203], v[16:19]
    buffer_load_dwordx4 v81, s[48:51], s76 offen nt lds
    s_waitcnt lgkmcnt(4)
    v_mfma_f32_16x16x32_bf16 v[12:15], v[44:47], a[208:211], v[12:15]
    ds_read_b128 v[36:39], v8 offset:57344
    v_mfma_f32_16x16x32_bf16 v[20:23], v[44:47], a[212:215], v[20:23]
    s_add_u32 m0, m0, 1024
    s_add_u32 s76, s76, s77
    v_mfma_f32_16x16x32_bf16 v[24:27], v[48:51], a[212:215], v[24:27]
    ds_read_b128 v[40:43], v8 offset:58368
    v_mfma_f32_16x16x32_bf16 v[16:19], v[48:51], a[208:211], v[16:19]
    buffer_load_dwordx4 v80, s[48:51], s76 offen nt lds
    s_waitcnt lgkmcnt(4)
    v_mfma_f32_16x16x32_bf16 v[12:15], v[52:55], a[216:219], v[12:15]
    ds_read_b128 v[44:47], v7 offset:61440
    v_mfma_f32_16x16x32_bf16 v[20:23], v[52:55], a[220:223], v[20:23]
    s_add_u32 m0, m0, 1024
    s_add_u32 s76, s76, s77
    v_mfma_f32_16x16x32_bf16 v[24:27], v[56:59], a[220:223], v[24:27]
    ds_read_b128 v[48:51], v7 offset:62464
    v_mfma_f32_16x16x32_bf16 v[16:19], v[56:59], a[216:219], v[16:19]
    buffer_load_dwordx4 v81, s[48:51], s76 offen nt lds
    s_waitcnt lgkmcnt(4)
    v_mfma_f32_16x16x32_bf16 v[12:15], v[28:31], a[224:227], v[12:15]
    ds_read_b128 v[52:55], v8 offset:61440
    v_mfma_f32_16x16x32_bf16 v[20:23], v[28:31], a[228:231], v[20:23]
    s_add_u32 m0, m0, 1024
    s_add_u32 s76, s76, s77
    v_mfma_f32_16x16x32_bf16 v[24:27], v[32:35], a[228:231], v[24:27]
    ds_read_b128 v[56:59], v8 offset:62464
    v_xor_b32 v7, 0x10000, v7
    v_xor_b32 v8, 0x10000, v8
    v_mfma_f32_16x16x32_bf16 v[16:19], v[32:35], a[224:227], v[16:19]
    s_bitcmp1_b64 s[80:81], s68
    s_waitcnt vmcnt(4)
    s_barrier
    s_waitcnt lgkmcnt(4)
    v_mfma_f32_16x16x32_bf16 v[12:15], v[36:39], a[232:235], v[12:15]
    ds_read_b128 v[28:31], v7 offset:0
    v_mfma_f32_16x16x32_bf16 v[20:23], v[36:39], a[236:239], v[20:23]
    buffer_load_dword v6, v5, s[8:11], s71 offen
    s_cbranch_scc1 L_moe
L_moe_ret6:
    v_mfma_f32_16x16x32_bf16 v[24:27], v[40:43], a[236:239], v[24:27]
    ds_read_b128 v[32:35], v7 offset:1024
    v_mfma_f32_16x16x32_bf16 v[16:19], v[40:43], a[232:235], v[16:19]
    s_xor_b32 s70, s70, 0x10000
    s_add_u32 s71, s71, 0x10000
    s_waitcnt lgkmcnt(4)
    v_mfma_f32_16x16x32_bf16 v[12:15], v[44:47], a[240:243], v[12:15]
    ds_read_b128 v[36:39], v8 offset:0
    v_mfma_f32_16x16x32_bf16 v[20:23], v[44:47], a[244:247], v[20:23]
    v_mfma_f32_16x16x32_bf16 v[24:27], v[48:51], a[244:247], v[24:27]
    ds_read_b128 v[40:43], v8 offset:1024
    v_mfma_f32_16x16x32_bf16 v[16:19], v[48:51], a[240:243], v[16:19]
    s_waitcnt lgkmcnt(4)
    v_mfma_f32_16x16x32_bf16 v[12:15], v[52:55], a[248:251], v[12:15]
    ds_read_b128 v[44:47], v7 offset:4096
    v_mfma_f32_16x16x32_bf16 v[20:23], v[52:55], a[252:255], v[20:23]
    s_add_u32 s68, s68, 1
    s_mov_b32 s86, s68
    v_mfma_f32_16x16x32_bf16 v[24:27], v[56:59], a[252:255], v[24:27]
    ds_read_b128 v[48:51], v7 offset:5120
    v_mfma_f32_16x16x32_bf16 v[16:19], v[56:59], a[248:251], v[16:19]
    s_waitcnt lgkmcnt(4)
    v_mfma_f32_16x16x32_bf16 v[180:183], v[28:31], a[0:3], 0
    ds_read_b128 v[52:55], v8 offset:4096
    v_mfma_f32_16x16x32_bf16 v[188:191], v[28:31], a[4:7], 0
    v_mfma_f32_16x16x32_bf16 v[192:195], v[32:35], a[4:7], 0
    ds_read_b128 v[56:59], v8 offset:5120
    v_mfma_f32_16x16x32_bf16 v[184:187], v[32:35], a[0:3], 0
    buffer_store_dwordx4 v[76:79], v73, s[4:7], s84 offen sc1
    s_waitcnt lgkmcnt(4)
    v_mfma_f32_16x16x32_bf16 v[180:183], v[36:39], a[8:11], v[180:183]
    ds_read_b128 v[28:31], v7 offset:8192
    v_mfma_f32_16x16x32_bf16 v[188:191], v[36:39], a[12:15], v[188:191]
    v_cvt_pk_bf16_f32 v12, v12, v13
    v_cvt_pk_bf16_f32 v13, v14, v15
    v_mfma_f32_16x16x32_bf16 v[192:195], v[40:43], a[12:15], v[192:195]
    ds_read_b128 v[32:35], v7 offset:9216
    v_mfma_f32_16x16x32_bf16 v[184:187], v[40:43], a[8:11], v[184:187]
    v_cvt_pk_bf16_f32 v14, v16, v17
    v_cvt_pk_bf16_f32 v15, v18, v19
    s_waitcnt lgkmcnt(4)
    v_mfma_f32_16x16x32_bf16 v[180:183], v[44:47], a[16:19], v[180:183]
    ds_read_b128 v[36:39], v8 offset:8192
    v_mfma_f32_16x16x32_bf16 v[188:191], v[44:47], a[20:23], v[188:191]
    v_cvt_pk_bf16_f32 v16, v20, v21
    v_cvt_pk_bf16_f32 v17, v22, v23
    v_mfma_f32_16x16x32_bf16 v[192:195], v[48:51], a[20:23], v[192:195]
    ds_read_b128 v[40:43], v8 offset:9216
    v_mfma_f32_16x16x32_bf16 v[184:187], v[48:51], a[16:19], v[184:187]
    v_cvt_pk_bf16_f32 v18, v24, v25
    v_cvt_pk_bf16_f32 v19, v26, v27
    s_waitcnt lgkmcnt(4)
    v_mfma_f32_16x16x32_bf16 v[180:183], v[52:55], a[24:27], v[180:183]
    ds_read_b128 v[44:47], v7 offset:12288
    v_mfma_f32_16x16x32_bf16 v[188:191], v[52:55], a[28:31], v[188:191]
    buffer_store_dwordx4 v[12:15], v68, s[4:7], s72 offen offset:0 sc1
    v_mfma_f32_16x16x32_bf16 v[192:195], v[56:59], a[28:31], v[192:195]
    ds_read_b128 v[48:51], v7 offset:13312
    v_mfma_f32_16x16x32_bf16 v[184:187], v[56:59], a[24:27], v[184:187]
    buffer_store_dwordx4 v[16:19], v68, s[4:7], s72 offen offset:128 sc1
    s_waitcnt lgkmcnt(4)
    v_mfma_f32_16x16x32_bf16 v[180:183], v[28:31], a[32:35], v[180:183]
    ds_read_b128 v[52:55], v8 offset:12288
    v_mfma_f32_16x16x32_bf16 v[188:191], v[28:31], a[36:39], v[188:191]
    v_mfma_f32_16x16x32_bf16 v[192:195], v[32:35], a[36:39], v[192:195]
    ds_read_b128 v[56:59], v8 offset:13312
    v_mfma_f32_16x16x32_bf16 v[184:187], v[32:35], a[32:35], v[184:187]
    s_lshl_b32 s84, s68, 10
    s_and_b32 s84, s84, 0x2000
    s_waitcnt lgkmcnt(4)
    v_mfma_f32_16x16x32_bf16 v[180:183], v[36:39], a[40:43], v[180:183]
    ds_read_b128 v[28:31], v7 offset:16384
    v_mfma_f32_16x16x32_bf16 v[188:191], v[36:39], a[44:47], v[188:191]
    s_xor_b32 s84, s84, s100
    s_lshl_b32 s67, s68, 18
    v_mfma_f32_16x16x32_bf16 v[192:195], v[40:43], a[44:47], v[192:195]
    ds_read_b128 v[32:35], v7 offset:17408
    v_mfma_f32_16x16x32_bf16 v[184:187], v[40:43], a[40:43], v[184:187]
    s_or_b32 s84, s84, s67
    s_lshl_b32 s72, s68, 11
    s_waitcnt lgkmcnt(4)
    v_mfma_f32_16x16x32_bf16 v[180:183], v[44:47], a[48:51], v[180:183]
    ds_read_b128 v[36:39], v8 offset:16384
    v_mfma_f32_16x16x32_bf16 v[188:191], v[44:47], a[52:55], v[188:191]
    s_and_b32 s72, s72, 0x2000
    s_xor_b32 s72, s72, s100
    v_mfma_f32_16x16x32_bf16 v[192:195], v[48:51], a[52:55], v[192:195]
    ds_read_b128 v[40:43], v8 offset:17408
    v_mfma_f32_16x16x32_bf16 v[184:187], v[48:51], a[48:51], v[184:187]
    s_lshl_b32 s67, s68, 19
    s_or_b32 s72, s72, s67
    s_waitcnt lgkmcnt(4)
    v_mfma_f32_16x16x32_bf16 v[180:183], v[52:55], a[56:59], v[180:183]
    ds_read_b128 v[44:47], v7 offset:20480
    v_mfma_f32_16x16x32_bf16 v[188:191], v[52:55], a[60:63], v[188:191]
    s_sub_u32 s79, s68, 22
    s_mov_b32 s85, 7
    v_mfma_f32_16x16x32_bf16 v[192:195], v[56:59], a[60:63], v[192:195]
    ds_read_b128 v[48:51], v7 offset:21504
    v_mfma_f32_16x16x32_bf16 v[184:187], v[56:59], a[56:59], v[184:187]
    s_waitcnt lgkmcnt(4)
    v_mfma_f32_16x16x32_bf16 v[180:183], v[28:31], a[64:67], v[180:183]
    ds_read_b128 v[52:55], v8 offset:20480
    v_mfma_f32_16x16x32_bf16 v[188:191], v[28:31], a[68:71], v[188:191]
    s_mov_b32 m0, s70
    v_mov_b64 v[112:113], v[96:97]
    v_mfma_f32_16x16x32_bf16 v[192:195], v[32:35], a[68:71], v[192:195]
    ds_read_b128 v[56:59], v8 offset:21504
    v_mfma_f32_16x16x32_bf16 v[184:187], v[32:35], a[64:67], v[184:187]
    buffer_load_dwordx4 v2, s[8:11], s71 offen offset:0 lds
    s_waitcnt lgkmcnt(4)
    v_mfma_f32_16x16x32_bf16 v[180:183], v[36:39], a[72:75], v[180:183]
    ds_read_b128 v[28:31], v7 offset:24576
    v_mfma_f32_16x16x32_bf16 v[188:191], v[36:39], a[76:79], v[188:191]
    s_add_u32 m0, m0, 3968
    v_mov_b64 v[114:115], v[98:99]
    v_mfma_f32_16x16x32_bf16 v[192:195], v[40:43], a[76:79], v[192:195]
    ds_read_b128 v[32:35], v7 offset:25600
    v_mfma_f32_16x16x32_bf16 v[184:187], v[40:43], a[72:75], v[184:187]
    buffer_load_dwordx4 v2, s[8:11], s71 offen offset:128 lds
    s_waitcnt lgkmcnt(4)
    v_mfma_f32_16x16x32_bf16 v[180:183], v[44:47], a[80:83], v[180:183]
    ds_read_b128 v[36:39], v8 offset:24576
    v_mfma_f32_16x16x32_bf16 v[188:191], v[44:47], a[84:87], v[188:191]
    s_add_u32 m0, m0, 3968
    v_mov_b64 v[96:97], v[100:101]
    v_mfma_f32_16x16x32_bf16 v[192:195], v[48:51], a[84:87], v[192:195]
    ds_read_b128 v[40:43], v8 offset:25600
    v_mfma_f32_16x16x32_bf16 v[184:187], v[48:51], a[80:83], v[184:187]
    buffer_load_dwordx4 v2, s[8:11], s71 offen offset:256 lds
    s_waitcnt lgkmcnt(4)
    v_mfma_f32_16x16x32_bf16 v[180:183], v[52:55], a[88:91], v[180:183]
    ds_read_b128 v[44:47], v7 offset:28672
    v_mfma_f32_16x16x32_bf16 v[188:191], v[52:55], a[92:95], v[188:191]
    s_add_u32 m0, m0, 3968
    v_mov_b64 v[98:99], v[102:103]
    v_mfma_f32_16x16x32_bf16 v[192:195], v[56:59], a[92:95], v[192:195]
    ds_read_b128 v[48:51], v7 offset:29696
    v_mfma_f32_16x16x32_bf16 v[184:187], v[56:59], a[88:91], v[184:187]
    buffer_load_dwordx4 v2, s[8:11], s71 offen offset:384 lds
    s_waitcnt lgkmcnt(4)
    v_mfma_f32_16x16x32_bf16 v[180:183], v[28:31], a[96:99], v[180:183]
    ds_read_b128 v[52:55], v8 offset:28672
    v_mfma_f32_16x16x32_bf16 v[188:191], v[28:31], a[100:103], v[188:191]
    s_add_u32 m0, m0, 3968
    v_mov_b64 v[100:101], v[104:105]
    v_mfma_f32_16x16x32_bf16 v[192:195], v[32:35], a[100:103], v[192:195]
    ds_read_b128 v[56:59], v8 offset:29696
    v_mfma_f32_16x16x32_bf16 v[184:187], v[32:35], a[96:99], v[184:187]
    buffer_load_dwordx4 v2, s[8:11], s71 offen offset:512 lds
    s_waitcnt lgkmcnt(4)
    v_mfma_f32_16x16x32_bf16 v[180:183], v[36:39], a[104:107], v[180:183]
    ds_read_b128 v[28:31], v7 offset:32768
    v_mfma_f32_16x16x32_bf16 v[188:191], v[36:39], a[108:111], v[188:191]
    s_add_u32 m0, m0, 3968
    v_mov_b64 v[102:103], v[106:107]
    v_mfma_f32_16x16x32_bf16 v[192:195], v[40:43], a[108:111], v[192:195]
    ds_read_b128 v[32:35], v7 offset:33792
    v_mfma_f32_16x16x32_bf16 v[184:187], v[40:43], a[104:107], v[184:187]
    buffer_load_dwordx4 v2, s[8:11], s71 offen offset:640 lds
    s_waitcnt lgkmcnt(4)
    v_mfma_f32_16x16x32_bf16 v[180:183], v[44:47], a[112:115], v[180:183]
    ds_read_b128 v[36:39], v8 offset:32768
    v_mfma_f32_16x16x32_bf16 v[188:191], v[44:47], a[116:119], v[188:191]
    s_add_u32 m0, m0, 3968
    v_mov_b64 v[104:105], v[108:109]
    v_mfma_f32_16x16x32_bf16 v[192:195], v[48:51], a[116:119], v[192:195]
    ds_read_b128 v[40:43], v8 offset:33792
    v_mfma_f32_16x16x32_bf16 v[184:187], v[48:51], a[112:115], v[184:187]
    buffer_load_dwordx4 v2, s[8:11], s71 offen offset:768 lds
    s_waitcnt lgkmcnt(4)
    v_mfma_f32_16x16x32_bf16 v[180:183], v[52:55], a[120:123], v[180:183]
    ds_read_b128 v[44:47], v7 offset:36864
    v_mfma_f32_16x16x32_bf16 v[188:191], v[52:55], a[124:127], v[188:191]
    s_add_u32 m0, m0, 3968
    v_mov_b64 v[106:107], v[110:111]
    v_mfma_f32_16x16x32_bf16 v[192:195], v[56:59], a[124:127], v[192:195]
    ds_read_b128 v[48:51], v7 offset:37888
    v_mfma_f32_16x16x32_bf16 v[184:187], v[56:59], a[120:123], v[184:187]
    buffer_load_dwordx4 v2, s[8:11], s71 offen offset:896 lds
    s_waitcnt lgkmcnt(4)
    v_mfma_f32_16x16x32_bf16 v[180:183], v[28:31], a[128:131], v[180:183]
    ds_read_b128 v[52:55], v8 offset:36864
    v_mfma_f32_16x16x32_bf16 v[188:191], v[28:31], a[132:135], v[188:191]
    s_add_u32 m0, m0, 3968
    s_waitcnt vmcnt(8)
    s_atomic_umax s86, s[46:47], s87
    v_mov_b64 v[108:109], v[112:113]
    v_mfma_f32_16x16x32_bf16 v[192:195], v[32:35], a[132:135], v[192:195]
    ds_read_b128 v[56:59], v8 offset:37888
    v_mfma_f32_16x16x32_bf16 v[184:187], v[32:35], a[128:131], v[184:187]
    buffer_load_dwordx4 v2, s[8:11], s71 offen offset:1024 lds
    s_waitcnt lgkmcnt(4)
    v_mfma_f32_16x16x32_bf16 v[180:183], v[36:39], a[136:139], v[180:183]
    ds_read_b128 v[28:31], v7 offset:40960
    v_mfma_f32_16x16x32_bf16 v[188:191], v[36:39], a[140:143], v[188:191]
    s_add_u32 m0, m0, 3968
    v_mov_b64 v[110:111], v[114:115]
    v_mfma_f32_16x16x32_bf16 v[192:195], v[40:43], a[140:143], v[192:195]
    ds_read_b128 v[32:35], v7 offset:41984
    v_mfma_f32_16x16x32_bf16 v[184:187], v[40:43], a[136:139], v[184:187]
    buffer_load_dwordx4 v2, s[8:11], s71 offen offset:1152 lds
    s_waitcnt lgkmcnt(4)
    v_mfma_f32_16x16x32_bf16 v[180:183], v[44:47], a[144:147], v[180:183]
    ds_read_b128 v[36:39], v8 offset:40960
    v_mfma_f32_16x16x32_bf16 v[188:191], v[44:47], a[148:151], v[188:191]
    s_add_u32 m0, m0, 3968
    v_mfma_f32_16x16x32_bf16 v[192:195], v[48:51], a[148:151], v[192:195]
    ds_read_b128 v[40:43], v8 offset:41984
    v_mfma_f32_16x16x32_bf16 v[184:187], v[48:51], a[144:147], v[184:187]
    buffer_load_dwordx4 v2, s[8:11], s71 offen offset:1280 lds
    s_waitcnt lgkmcnt(4)
    v_mfma_f32_16x16x32_bf16 v[180:183], v[52:55], a[152:155], v[180:183]
    ds_read_b128 v[44:47], v7 offset:45056
    v_mfma_f32_16x16x32_bf16 v[188:191], v[52:55], a[156:159], v[188:191]
    s_add_u32 m0, m0, 3968
    v_mfma_f32_16x16x32_bf16 v[192:195], v[56:59], a[156:159], v[192:195]
    ds_read_b128 v[48:51], v7 offset:46080
    v_mfma_f32_16x16x32_bf16 v[184:187], v[56:59], a[152:155], v[184:187]
    buffer_load_dwordx4 v2, s[8:11], s71 offen offset:1408 lds
    s_waitcnt lgkmcnt(4)
    v_mfma_f32_16x16x32_bf16 v[180:183], v[28:31], a[160:163], v[180:183]
    ds_read_b128 v[52:55], v8 offset:45056
    v_mfma_f32_16x16x32_bf16 v[188:191], v[28:31], a[164:167], v[188:191]
    s_add_u32 m0, m0, 3968
    v_mfma_f32_16x16x32_bf16 v[192:195], v[32:35], a[164:167], v[192:195]
    ds_read_b128 v[56:59], v8 offset:46080
    v_mfma_f32_16x16x32_bf16 v[184:187], v[32:35], a[160:163], v[184:187]
    buffer_load_dwordx4 v2, s[8:11], s71 offen offset:1536 lds
    s_waitcnt lgkmcnt(4)
    v_mfma_f32_16x16x32_bf16 v[180:183], v[36:39], a[168:171], v[180:183]
    ds_read_b128 v[28:31], v7 offset:49152
    v_mfma_f32_16x16x32_bf16 v[188:191], v[36:39], a[172:175], v[188:191]
    s_add_u32 m0, m0, 3968
    v_mfma_f32_16x16x32_bf16 v[192:195], v[40:43], a[172:175], v[192:195]
    ds_read_b128 v[32:35], v7 offset:50176
    v_mfma_f32_16x16x32_bf16 v[184:187], v[40:43], a[168:171], v[184:187]
    buffer_load_dwordx4 v2, s[8:11], s71 offen offset:1664 lds
    s_waitcnt lgkmcnt(4)
    v_mfma_f32_16x16x32_bf16 v[180:183], v[44:47], a[176:179], v[180:183]
    ds_read_b128 v[36:39], v8 offset:49152
    v_mfma_f32_16x16x32_bf16 v[188:191], v[44:47], a[180:183], v[188:191]
    s_add_u32 m0, m0, 3968
    v_mfma_f32_16x16x32_bf16 v[192:195], v[48:51], a[180:183], v[192:195]
    ds_read_b128 v[40:43], v8 offset:50176
    v_mfma_f32_16x16x32_bf16 v[184:187], v[48:51], a[176:179], v[184:187]
    buffer_load_dwordx4 v2, s[8:11], s71 offen offset:1792 lds
    s_waitcnt lgkmcnt(4)
    v_mfma_f32_16x16x32_bf16 v[180:183], v[52:55], a[184:187], v[180:183]
    ds_read_b128 v[44:47], v7 offset:53248
    v_mfma_f32_16x16x32_bf16 v[188:191], v[52:55], a[188:191], v[188:191]
    s_add_u32 m0, m0, 3968
    v_mfma_f32_16x16x32_bf16 v[192:195], v[56:59], a[188:191], v[192:195]
    ds_read_b128 v[48:51], v7 offset:54272
    v_mfma_f32_16x16x32_bf16 v[184:187], v[56:59], a[184:187], v[184:187]
    buffer_load_dwordx4 v2, s[8:11], s71 offen offset:1920 lds
    s_waitcnt lgkmcnt(4)
    v_mfma_f32_16x16x32_bf16 v[180:183], v[28:31], a[192:195], v[180:183]
    ds_read_b128 v[52:55], v8 offset:53248
    v_mfma_f32_16x16x32_bf16 v[188:191], v[28:31], a[196:199], v[188:191]
    s_add_u32 m0, s75, 4096
    v_mfma_f32_16x16x32_bf16 v[192:195], v[32:35], a[196:199], v[192:195]
    ds_read_b128 v[56:59], v8 offset:54272
    v_mfma_f32_16x16x32_bf16 v[184:187], v[32:35], a[192:195], v[184:187]
    buffer_load_dwordx4 v80, s[48:51], s76 offen nt lds
    s_waitcnt lgkmcnt(4)
    v_mfma_f32_16x16x32_bf16 v[180:183], v[36:39], a[200:203], v[180:183]
    ds_read_b128 v[28:31], v7 offset:57344
    v_mfma_f32_16x16x32_bf16 v[188:191], v[36:39], a[204:207], v[188:191]
    s_add_u32 m0, m0, 1024
    s_add_u32 s76, s76, s77
    v_mfma_f32_16x16x32_bf16 v[192:195], v[40:43], a[204:207], v[192:195]
    ds_read_b128 v[32:35], v7 offset:58368
    v_mfma_f32_16x16x32_bf16 v[184:187], v[40:43], a[200:203], v[184:187]
    buffer_load_dwordx4 v81, s[48:51], s76 offen nt lds
    s_waitcnt lgkmcnt(4)
    v_mfma_f32_16x16x32_bf16 v[180:183], v[44:47], a[208:211], v[180:183]
    ds_read_b128 v[36:39], v8 offset:57344
    v_mfma_f32_16x16x32_bf16 v[188:191], v[44:47], a[212:215], v[188:191]
    s_add_u32 m0, m0, 1024
    s_add_u32 s76, s76, s77
    v_mfma_f32_16x16x32_bf16 v[192:195], v[48:51], a[212:215], v[192:195]
    ds_read_b128 v[40:43], v8 offset:58368
    v_mfma_f32_16x16x32_bf16 v[184:187], v[48:51], a[208:211], v[184:187]
    buffer_load_dwordx4 v80, s[48:51], s76 offen nt lds
    s_waitcnt lgkmcnt(4)
    v_mfma_f32_16x16x32_bf16 v[180:183], v[52:55], a[216:219], v[180:183]
    ds_read_b128 v[44:47], v7 offset:61440
    v_mfma_f32_16x16x32_bf16 v[188:191], v[52:55], a[220:223], v[188:191]
    s_add_u32 m0, m0, 1024
    s_add_u32 s76, s76, s77
    v_mfma_f32_16x16x32_bf16 v[192:195], v[56:59], a[220:223], v[192:195]
    ds_read_b128 v[48:51], v7 offset:62464
    v_mfma_f32_16x16x32_bf16 v[184:187], v[56:59], a[216:219], v[184:187]
    buffer_load_dwordx4 v81, s[48:51], s76 offen nt lds
    s_waitcnt lgkmcnt(4)
    v_mfma_f32_16x16x32_bf16 v[180:183], v[28:31], a[224:227], v[180:183]
    ds_read_b128 v[52:55], v8 offset:61440
    v_mfma_f32_16x16x32_bf16 v[188:191], v[28:31], a[228:231], v[188:191]
    s_add_u32 m0, m0, 1024
    s_add_u32 s76, s76, s77
    v_mfma_f32_16x16x32_bf16 v[192:195], v[32:35], a[228:231], v[192:195]
    ds_read_b128 v[56:59], v8 offset:62464
    v_xor_b32 v7, 0x10000, v7
    v_xor_b32 v8, 0x10000, v8
    v_mfma_f32_16x16x32_bf16 v[184:187], v[32:35], a[224:227], v[184:187]
    s_bitcmp1_b64 s[80:81], s68
    s_waitcnt vmcnt(4)
    s_barrier
    s_waitcnt lgkmcnt(4)
    v_mfma_f32_16x16x32_bf16 v[180:183], v[36:39], a[232:235], v[180:183]
    ds_read_b128 v[28:31], v7 offset:0
    v_mfma_f32_16x16x32_bf16 v[188:191], v[36:39], a[236:239], v[188:191]
    buffer_load_dword v6, v5, s[8:11], s71 offen
    s_cbranch_scc1 L_moe
L_moe_ret7:
    v_mfma_f32_16x16x32_bf16 v[192:195], v[40:43], a[236:239], v[192:195]
    ds_read_b128 v[32:35], v7 offset:1024
    v_mfma_f32_16x16x32_bf16 v[184:187], v[40:43], a[232:235], v[184:187]
    s_xor_b32 s70, s70, 0x10000
    s_add_u32 s71, s71, 0x10000
    s_waitcnt lgkmcnt(4)
    v_mfma_f32_16x16x32_bf16 v[180:183], v[44:47], a[240:243], v[180:183]
    ds_read_b128 v[36:39], v8 offset:0
    v_mfma_f32_16x16x32_bf16 v[188:191], v[44:47], a[244:247], v[188:191]
    v_mfma_f32_16x16x32_bf16 v[192:195], v[48:51], a[244:247], v[192:195]
    ds_read_b128 v[40:43], v8 offset:1024
    v_mfma_f32_16x16x32_bf16 v[184:187], v[48:51], a[240:243], v[184:187]
    s_waitcnt lgkmcnt(4)
    v_mfma_f32_16x16x32_bf16 v[180:183], v[52:55], a[248:251], v[180:183]
    ds_read_b128 v[44:47], v7 offset:4096
    v_mfma_f32_16x16x32_bf16 v[188:191], v[52:55], a[252:255], v[188:191]
    s_add_u32 s68, s68, 1
    s_mov_b32 s86, s68
    v_mfma_f32_16x16x32_bf16 v[192:195], v[56:59], a[252:255], v[192:195]
    ds_read_b128 v[48:51], v7 offset:5120
    v_mfma_f32_16x16x32_bf16 v[184:187], v[56:59], a[248:251], v[184:187]
    s_lshr_b32 s64, s68, 1
    s_bitcmp1_b64 s[82:83], s64
    s_cbranch_scc1 L_v_loopm
    s_cmp_lt_u32 s68, 64
    s_cbranch_scc1 L_v_loop
L_kv_done:
    s_nop 7
    buffer_store_dwordx4 v[76:79], v73, s[4:7], s84 offen sc1
    v_cvt_pk_bf16_f32 v180, v180, v181
    v_cvt_pk_bf16_f32 v181, v182, v183
    v_cvt_pk_bf16_f32 v182, v184, v185
    v_cvt_pk_bf16_f32 v183, v186, v187
    v_cvt_pk_bf16_f32 v184, v188, v189
    v_cvt_pk_bf16_f32 v185, v190, v191
    v_cvt_pk_bf16_f32 v186, v192, v193
    v_cvt_pk_bf16_f32 v187, v194, v195
    buffer_store_dwordx4 v[180:183], v68, s[4:7], s72 offen offset:0 sc1
    buffer_store_dwordx4 v[184:187], v68, s[4:7], s72 offen offset:128 sc1
    s_waitcnt vmcnt(0) lgkmcnt(0)
    s_atomic_umax s86, s[46:47], s87
    s_waitcnt lgkmcnt(0)
    s_add_u32 s28, s73, 54
    s_cmp_eq_u32 s12, 7
    s_cselect_b32 s28, 0, s28
    s_branch L_o
L_moe:
    s_cmp_ge_u32 s79, 24
    s_cbranch_scc1 L_moe_f
    s_cmp_eq_u32 s79, 0
    s_cbranch_scc1 L_moe_a
    s_cmp_eq_u32 s79, 7
    s_cbranch_scc1 L_moe_u
    s_cmp_eq_u32 s79, 8
    s_cbranch_scc1 L_moe_g
    s_cmp_eq_u32 s79, 15
    s_cbranch_scc1 L_moe_x
    s_cmp_eq_u32 s79, 18
    s_cbranch_scc1 L_moe_b
    s_cmp_eq_u32 s79, 19
    s_cbranch_scc1 L_moe_c
    s_cmp_eq_u32 s79, 20
    s_cbranch_scc1 L_moe_d
    s_cmp_eq_u32 s79, 22
    s_cbranch_scc1 L_moe_e
    s_add_u32 m0, s75, 4096
    s_branch L_moe_more
L_moe_issue:
    s_mov_b32 m0, s75
L_moe_more:
    s_nop 0
    buffer_load_dwordx4 v80, s[48:51], s76 offen nt lds
    s_add_u32 m0, m0, 1024
    s_add_u32 s76, s76, s77
    buffer_load_dwordx4 v81, s[48:51], s76 offen nt lds
    s_add_u32 m0, m0, 1024
    s_add_u32 s76, s76, s77
    buffer_load_dwordx4 v80, s[48:51], s76 offen nt lds
    s_add_u32 m0, m0, 1024
    s_add_u32 s76, s76, s77
    buffer_load_dwordx4 v81, s[48:51], s76 offen nt lds
    s_add_u32 m0, m0, 1024
    s_add_u32 s76, s76, s77
L_moe_out:
    s_waitcnt lgkmcnt(0)
    s_cmp_ge_u32 s85, 4
    s_cbranch_scc1 L_moe_o2
    s_cmp_eq_u32 s85, 2
    s_cbranch_scc1 L_moe_ret2
    s_cmp_eq_u32 s85, 0
    s_cbranch_scc1 L_moe_ret0
    s_cmp_eq_u32 s85, 1
    s_cbranch_scc1 L_moe_ret1
    s_branch L_moe_ret3
L_moe_o2:
    s_cmp_eq_u32 s85, 6
    s_cbranch_scc1 L_moe_ret6
    s_cmp_eq_u32 s85, 4
    s_cbranch_scc1 L_moe_ret4
    s_cmp_eq_u32 s85, 5
    s_cbranch_scc1 L_moe_ret5
    s_branch L_moe_ret7
L_moe_u:
    s_mov_b32 s48, s36
    s_and_b32 s49, s37, 0xffff
    s_mov_b32 s50, 7340032
    s_mul_i32 s76, s14, 1835008
    s_lshl_b32 s64, s74, 7
    s_add_u32 s76, s76, s64
    s_branch L_moe_out
L_moe_g:
    v_mov_b64 v[132:133], v[116:117]
    v_mov_b64 v[134:135], v[118:119]
    v_mov_b64 v[136:137], v[120:121]
    v_mov_b64 v[138:139], v[122:123]
    v_mov_b64 v[140:141], v[124:125]
    v_mov_b64 v[142:143], v[126:127]
    v_mov_b64 v[144:145], v[128:129]
    v_mov_b64 v[146:147], v[130:131]
    v_mov_b64 v[116:117], 0
    v_mov_b64 v[118:119], 0
    v_mov_b64 v[120:121], 0
    v_mov_b64 v[122:123], 0
    v_mov_b64 v[124:125], 0
    v_mov_b64 v[126:127], 0
    v_mov_b64 v[128:129], 0
    v_mov_b64 v[130:131], 0
    s_branch L_moe_out
L_moe_y:
    v_mov_b32 v89, 1
    buffer_store_dword v89, v71, s[4:7], 0 offen sc1
    s_branch L_moe_out
L_moe_x:
    s_mov_b32 s76, 2147483648
    s_branch L_moe_out
L_moe_a:
    v_and_b32 v88, 7, v0
    v_lshlrev_b32 v88, 2, v88
    v_add_u32 v88, 85995648, v88
L_pl_9:
    buffer_load_dword v89, v88, s[4:7], 0 offen sc1
    s_waitcnt vmcnt(0)
    v_cmp_ge_u32 vcc, 0, v89
    s_cbranch_vccz L_pk_10
    s_sleep 2
    s_sub_u32 s15, s15, 1
    s_cbranch_scc0 L_pl_9
    s_branch L_abort
L_pk_10:
    v_not_b32 v89, v89
    v_and_b32 v89, 0x7ff, v89
    v_lshlrev_b32 v89, 11, v89
    v_lshrrev_b32 v88, 3, v0
    v_lshl_add_u32 v89, v88, 4, v89
    s_lshl_b32 s64, s14, 9
    buffer_load_dwordx4 v[96:99], v89, s[8:11], s64 offen offset:0
    buffer_load_dwordx4 v[100:103], v89, s[8:11], s64 offen offset:128
    buffer_load_dwordx4 v[104:107], v89, s[8:11], s64 offen offset:256
    buffer_load_dwordx4 v[108:111], v89, s[8:11], s64 offen offset:384
    v_mul_u32_u24 v80, 7168, v88
    v_add_u32 v80, v80, v82
    v_xor_b32 v81, 64, v80
    s_mov_b32 s77, 57344
    s_mov_b32 s78, 0
    v_mov_b64 v[116:117], 0
    v_mov_b64 v[118:119], 0
    v_mov_b64 v[120:121], 0
    v_mov_b64 v[122:123], 0
    v_mov_b64 v[124:125], 0
    v_mov_b64 v[126:127], 0
    v_mov_b64 v[128:129], 0
    v_mov_b64 v[130:131], 0
    s_mov_b32 s48, s34
    s_and_b32 s49, s35, 0xffff
    s_mov_b32 s50, 7340032
    s_mul_i32 s76, s14, 1835008
    s_lshl_b32 s64, s74, 7
    s_add_u32 s76, s76, s64
    s_branch L_moe_issue
L_moe_b:
    v_add_u32 v88, s75, v91
    ds_write_b128 v88, v[132:135] offset:0
    ds_write_b128 v88, v[136:139] offset:1024
    ds_write_b128 v88, v[140:143] offset:2048
    ds_write_b128 v88, v[144:147] offset:3072
    ds_write_b128 v88, v[116:119] offset:4096
    ds_write_b128 v88, v[120:123] offset:5120
    ds_write_b128 v88, v[124:127] offset:6144
    ds_write_b128 v88, v[128:131] offset:7168
    s_branch L_moe_out
L_moe_c:
    s_lshl_b32 s64, s14, 10
    s_add_u32 s65, s64, 131072
    v_add_u32 v88, s65, v91
    ds_read_b128 v[148:151], v88 offset:0
    ds_read_b128 v[152:155], v88 offset:4096
    ds_read_b128 v[156:159], v88 offset:8192
    ds_read_b128 v[160:163], v88 offset:12288
    ds_read_b128 v[164:167], v88 offset:16384
    ds_read_b128 v[168:171], v88 offset:20480
    ds_read_b128 v[172:175], v88 offset:24576
    ds_read_b128 v[176:179], v88 offset:28672
    s_waitcnt lgkmcnt(0)
    v_pk_add_f32 v[148:149], v[148:149], v[156:157]
    v_pk_add_f32 v[164:165], v[164:165], v[172:173]
    v_pk_add_f32 v[148:149], v[148:149], v[164:165]
    v_pk_add_f32 v[150:151], v[150:151], v[158:159]
    v_pk_add_f32 v[166:167], v[166:167], v[174:175]
    v_pk_add_f32 v[150:151], v[150:151], v[166:167]
    v_pk_add_f32 v[152:153], v[152:153], v[160:161]
    v_pk_add_f32 v[168:169], v[168:169], v[176:177]
    v_pk_add_f32 v[152:153], v[152:153], v[168:169]
    v_pk_add_f32 v[154:155], v[154:155], v[162:163]
    v_pk_add_f32 v[170:171], v[170:171], v[178:179]
    v_pk_add_f32 v[154:155], v[154:155], v[170:171]
    v_mov_b32 v156, v148
    v_mov_b32 v157, v149
    v_mov_b32 v158, v150
    v_mov_b32 v159, v151
    v_mov_b32 v160, v152
    v_mov_b32 v161, v153
    v_mov_b32 v162, v154
    v_mov_b32 v163, v155
    v_permlane32_swap_b32 v148, v156
    v_permlane32_swap_b32 v149, v157
    v_permlane32_swap_b32 v150, v158
    v_permlane32_swap_b32 v151, v159
    v_permlane32_swap_b32 v152, v160
    v_permlane32_swap_b32 v153, v161
    v_permlane32_swap_b32 v154, v162
    v_permlane32_swap_b32 v155, v163
    v_pk_add_f32 v[148:149], v[148:149], v[156:157]
    v_pk_add_f32 v[150:151], v[150:151], v[158:159]
    v_pk_add_f32 v[152:153], v[152:153], v[160:161]
    v_pk_add_f32 v[154:155], v[154:155], v[162:163]
    v_mul_f32 v156, 0xbfb8aa3b, v148
    v_mul_f32 v157, 0xbfb8aa3b, v149
    v_mul_f32 v158, 0xbfb8aa3b, v150
    v_mul_f32 v159, 0xbfb8aa3b, v151
    v_exp_f32 v156, v156
    v_exp_f32 v157, v157
    v_exp_f32 v158, v158
    v_exp_f32 v159, v159
    v_add_f32 v156, 1.0, v156
    v_add_f32 v157, 1.0, v157
    v_add_f32 v158, 1.0, v158
    v_add_f32 v159, 1.0, v159
    v_rcp_f32 v156, v156
    v_rcp_f32 v157, v157
    v_rcp_f32 v158, v158
    v_rcp_f32 v159, v159
    v_mul_f32 v148, v148, v156
    v_mul_f32 v149, v149, v157
    v_mul_f32 v150, v150, v158
    v_mul_f32 v151, v151, v159
    v_mul_f32 v148, v148, v152
    v_mul_f32 v149, v149, v153
    v_mul_f32 v150, v150, v154
    v_mul_f32 v151, v151, v155
    v_cvt_pk_bf16_f32 v148, v148, v148
    v_cvt_pk_bf16_f32 v149, v149, v149
    v_cvt_pk_bf16_f32 v150, v150, v150
    v_cvt_pk_bf16_f32 v151, v151, v151
    v_bfe_u32 v88, v0, 4, 1
    v_lshlrev_b32 v88, 7, v88
    v_and_b32 v89, 15, v0
    v_lshl_add_u32 v88, v89, 1, v88
    s_add_u32 s64, s64, s75
    v_add_u32 v88, s64, v88
    ds_write_b16 v88, v148 offset:0
    ds_write_b16 v88, v149 offset:32
    ds_write_b16 v88, v150 offset:64
    ds_write_b16 v88, v151 offset:96
    s_branch L_moe_out
L_moe_d:
    v_lshrrev_b32 v88, 4, v0
    v_mul_u32_u24 v88, 9216, v88
    v_and_b32 v89, 7, v0
    v_lshl_add_u32 v88, v89, 5, v88
    v_bfe_u32 v89, v0, 3, 1
    v_lshl_add_u32 v88, v89, 4, v88
    v_add_u32 v88, 131072, v88
    ds_read_b128 v[96:99], v88
    ds_read_b128 v[100:103], v88
    ds_read_b128 v[104:107], v88
    ds_read_b128 v[108:111], v88
    s_branch L_moe_out
L_moe_e:
    v_lshrrev_b32 v88, 3, v0
    v_lshl_add_u32 v80, v88, 11, v82
    v_xor_b32 v81, 64, v80
    s_mov_b32 s77, 16384
    s_mov_b32 s78, 4294836352
    s_lshl_b32 s76, s74, 17
    s_lshl_b32 s64, s14, 9
    s_add_u32 s76, s76, s64
    v_mov_b64 v[116:117], 0
    v_mov_b64 v[118:119], 0
    v_mov_b64 v[120:121], 0
    v_mov_b64 v[122:123], 0
    v_mov_b64 v[124:125], 0
    v_mov_b64 v[126:127], 0
    v_mov_b64 v[128:129], 0
    v_mov_b64 v[130:131], 0
    s_mov_b32 s48, s38
    s_and_b32 s49, s39, 0xffff
    s_mov_b32 s50, 7340032
    s_branch L_moe_issue
L_moe_f:
    s_cmp_eq_u32 s79, 29
    s_cbranch_scc1 L_moe_x
    s_cmp_eq_u32 s79, 32
    s_cbranch_scc1 L_moe_y
    v_permlane32_swap_b32 v116, v120
    v_permlane32_swap_b32 v117, v121
    v_permlane32_swap_b32 v118, v122
    v_permlane32_swap_b32 v119, v123
    v_pk_add_f32 v[132:133], v[116:117], v[120:121]
    v_pk_add_f32 v[134:135], v[118:119], v[122:123]
    buffer_store_dwordx4 v[132:135], v92, s[4:7], s88 offen offset:0 sc1
    v_permlane32_swap_b32 v124, v128
    v_permlane32_swap_b32 v125, v129
    v_permlane32_swap_b32 v126, v130
    v_permlane32_swap_b32 v127, v131
    v_pk_add_f32 v[136:137], v[124:125], v[128:129]
    v_pk_add_f32 v[138:139], v[126:127], v[130:131]
    buffer_store_dwordx4 v[136:139], v92, s[4:7], s88 offen offset:1024 sc1
    v_mov_b64 v[116:117], 0
    v_mov_b64 v[118:119], 0
    v_mov_b64 v[120:121], 0
    v_mov_b64 v[122:123], 0
    v_mov_b64 v[124:125], 0
    v_mov_b64 v[126:127], 0
    v_mov_b64 v[128:129], 0
    v_mov_b64 v[130:131], 0
    s_add_u32 s88, s88, 2048
    s_branch L_moe_out
L_q:
    s_lshl_b32 s69, s13, 8
    s_lshl_b32 s64, s14, 6
    s_add_u32 s69, s69, s64
    s_mov_b32 s48, s20
    s_and_b32 s49, s21, 0xffff
    s_mov_b32 s50, 8388608
    s_mov_b32 s51, 0x20000
    v_lshrrev_b32 v3, 2, v0
    v_and_b32 v1, 3, v0
    v_lshlrev_b32 v1, 4, v1
    v_lshl_add_u32 v1, v3, 13, v1
    s_mul_i32 s64, s14, 24576
    s_add_u32 m0, s64, 65536
    s_xor_b32 s65, s69, 0
    buffer_load_dwordx4 v1, s[48:51], s65 offen  lds
    s_add_u32 m0, m0, 1024
    s_xor_b32 s65, s69, 131072
    buffer_load_dwordx4 v1, s[48:51], s65 offen  lds
    s_add_u32 m0, m0, 1024
    s_xor_b32 s65, s69, 262144
    buffer_load_dwordx4 v1, s[48:51], s65 offen  lds
    s_add_u32 m0, m0, 1024
    s_xor_b32 s65, s69, 393216
    buffer_load_dwordx4 v1, s[48:51], s65 offen  lds
    s_add_u32 m0, m0, 1024
    s_xor_b32 s65, s69, 524288
    buffer_load_dwordx4 v1, s[48:51], s65 offen  lds
    s_add_u32 m0, m0, 1024
    s_xor_b32 s65, s69, 655360
    buffer_load_dwordx4 v1, s[48:51], s65 offen  lds
    s_add_u32 m0, m0, 1024
    s_xor_b32 s65, s69, 786432
    buffer_load_dwordx4 v1, s[48:51], s65 offen  lds
    s_add_u32 m0, m0, 1024
    s_xor_b32 s65, s69, 917504
    buffer_load_dwordx4 v1, s[48:51], s65 offen  lds
    s_mov_b32 s68, 0
    s_mov_b32 s71, 0
    s_lshr_b32 s64, s13, 3
    s_lshl_b32 s64, s64, 7
    s_and_b32 s65, s13, 7
    s_lshl_b32 s65, s65, 4
    s_add_u32 s64, s64, s65
    s_lshl_b32 s65, s14, 2
    s_add_u32 s64, s64, s65
    s_add_u32 s64, s64, 85991424
    v_mov_b32 v35, s64
    v_cmp_eq_u32 vcc, 0, v0
    v_mov_b32 v36, 2147483648
    s_nop 0
    v_cndmask_b32 v35, v36, v35, vcc
    s_mov_b32 s85, s64
    s_mov_b32 s84, 0
    v_mov_b32 v37, 0
    v_mov_b32 v34, 0
    buffer_store_dword v37, v35, s[4:7], 0 offen sc1
    s_lshl_b32 s64, s13, 7
    s_add_u32 s64, s64, 85131264
    v_and_b32 v33, 7, v0
    v_lshl_add_u32 v33, v33, 2, s64
    v_lshlrev_b32 v38, 4, v0
    s_lshl_b32 s64, s13, 14
    v_add_u32 v30, s64, v38
    s_lshl_b32 s64, s14, 13
    s_add_u32 s64, s64, 131072
    v_add_u32 v29, s64, v38
    v_and_b32 v28, 7, v0
    v_lshlrev_b32 v28, 4, v28
    v_lshrrev_b32 v3, 3, v0
    v_lshl_add_u32 v28, v3, 8, v28
    s_lshl_b32 s64, s14, 11
    s_add_u32 s64, s64, 131072
    v_add_u32 v28, s64, v28
    s_lshr_b32 s64, s13, 1
    s_lshl_b32 s64, s64, 14
    s_and_b32 s65, s13, 1
    s_lshl_b32 s65, s65, 12
    s_add_u32 s64, s64, s65
    s_add_u32 s64, s64, 67108864
    v_lshrrev_b32 v38, 5, v0
    v_and_b32 v31, 7, v0
    v_lshlrev_b32 v31, 4, v31
    v_lshl_add_u32 v31, v38, 7, v31
    v_add_u32 v31, s64, v31
    v_and_b32 v32, 31, v0
    v_lshlrev_b32 v32, 4, v32
    v_lshl_add_u32 v32, v38, 3, v32
    v_add_u32 v32, s64, v32
    v_mov_b32 v248, 0xf149f2ca
    v_mov_b32 v190, 0
    v_mov_b32 v191, 0
    v_mov_b32 v194, 0
    v_mov_b32 v195, 0
    v_mov_b32 v198, 0
    v_mov_b32 v199, 0
    v_mov_b32 v202, 0
    v_mov_b32 v203, 0
    v_mov_b32 v214, 0
    v_mov_b32 v215, 0
    v_mov_b32 v42, 0x3e0293ee
    v_mov_b32 v43, 0x3e0293ee
    s_mov_b32 s8, s16
    s_and_b32 s9, s17, 0xffff
    s_mov_b32 s10, 4194304
    s_mov_b32 s11, 0x20000
    v_lshrrev_b32 v3, 3, v0
    s_lshl_b32 s64, s14, 3
    v_add_u32 v3, s64, v3
    s_lshr_b32 s64, s14, 1
    s_lshl_b32 s64, s64, 2
    v_lshrrev_b32 v4, 4, v0
    v_or_b32 v4, s64, v4
    v_xor_b32 v4, v4, v0
    v_and_b32 v4, 7, v4
    v_lshlrev_b32 v4, 4, v4
    v_lshl_add_u32 v2, v3, 11, v4
    v_bfe_u32 v3, v0, 1, 3
    v_lshrrev_b32 v4, 4, v0
    v_xor_b32 v3, v3, v4
    v_lshlrev_b32 v3, 4, v3
    v_and_b32 v4, 7, v0
    v_lshl_add_u32 v3, v4, 7, v3
    v_bfe_u32 v4, v0, 3, 1
    v_lshl_add_u32 v7, v4, 11, v3
    v_xor_b32 v8, 64, v7
    s_lshl_b32 s64, s13, 11
    s_lshl_b32 s65, s14, 9
    s_add_u32 s64, s64, s65
    s_add_u32 s64, s64, 0x20000
    v_and_b32 v4, 7, v0
    v_lshlrev_b32 v4, 6, v4
    v_add_u32 v5, s64, v4
    s_lshl_b32 s70, s14, 10
    v_bfe_u32 v4, v0, 2, 2
    s_mul_i32 s64, s14, 24576
    s_add_u32 s64, s64, 65536
    v_lshrrev_b32 v3, 4, v0
    v_lshl_add_u32 v4, v3, 3, v4
    v_lshlrev_b32 v4, 6, v4
    v_bfe_u32 v3, v0, 1, 1
    v_lshl_add_u32 v4, v3, 5, v4
    v_and_b32 v3, 1, v0
    v_lshl_add_u32 v4, v3, 3, v4
    v_add_u32 v12, s64, v4
    v_add_u32 v13, 16, v12
    s_mul_i32 s64, s14, 24576
    s_add_u32 m0, s64, 73728
    s_xor_b32 s65, s69, 1048576
    buffer_load_dwordx4 v1, s[48:51], s65 offen  lds
    s_add_u32 m0, m0, 1024
    s_xor_b32 s65, s69, 1179648
    buffer_load_dwordx4 v1, s[48:51], s65 offen  lds
    s_add_u32 m0, m0, 1024
    s_xor_b32 s65, s69, 1310720
    buffer_load_dwordx4 v1, s[48:51], s65 offen  lds
    s_add_u32 m0, m0, 1024
    s_xor_b32 s65, s69, 1441792
    buffer_load_dwordx4 v1, s[48:51], s65 offen  lds
    s_add_u32 m0, m0, 1024
    s_xor_b32 s65, s69, 1572864
    buffer_load_dwordx4 v1, s[48:51], s65 offen  lds
    s_add_u32 m0, m0, 1024
    s_xor_b32 s65, s69, 1703936
    buffer_load_dwordx4 v1, s[48:51], s65 offen  lds
    s_add_u32 m0, m0, 1024
    s_xor_b32 s65, s69, 1835008
    buffer_load_dwordx4 v1, s[48:51], s65 offen  lds
    s_add_u32 m0, m0, 1024
    s_xor_b32 s65, s69, 1966080
    buffer_load_dwordx4 v1, s[48:51], s65 offen  lds
    s_waitcnt vmcnt(8)
    s_barrier
    s_cmp_lg_u32 s14, 3
    s_cbranch_scc1 L_arr_11
    s_mov_b32 s91, 0x100
    s_bfm_b32 s90, 1, s13
    s_lshl_b32 s92, s12, 3
    s_add_u32 s92, s92, s3
    s_atomic_add_x2 s[90:91], s[44:45], s92
L_arr_11:
    s_mul_i32 s64, s14, 24576
    s_add_u32 m0, s64, 81920
    s_xor_b32 s65, s69, 2097152
    buffer_load_dwordx4 v1, s[48:51], s65 offen  lds
    s_add_u32 m0, m0, 1024
    s_xor_b32 s65, s69, 2228224
    buffer_load_dwordx4 v1, s[48:51], s65 offen  lds
    s_add_u32 m0, m0, 1024
    s_xor_b32 s65, s69, 2359296
    buffer_load_dwordx4 v1, s[48:51], s65 offen  lds
    s_add_u32 m0, m0, 1024
    s_xor_b32 s65, s69, 2490368
    buffer_load_dwordx4 v1, s[48:51], s65 offen  lds
    s_add_u32 m0, m0, 1024
    s_xor_b32 s65, s69, 2621440
    buffer_load_dwordx4 v1, s[48:51], s65 offen  lds
    s_add_u32 m0, m0, 1024
    s_xor_b32 s65, s69, 2752512
    buffer_load_dwordx4 v1, s[48:51], s65 offen  lds
    s_add_u32 m0, m0, 1024
    s_xor_b32 s65, s69, 2883584
    buffer_load_dwordx4 v1, s[48:51], s65 offen  lds
    s_add_u32 m0, m0, 1024
    s_xor_b32 s65, s69, 3014656
    buffer_load_dwordx4 v1, s[48:51], s65 offen  lds
    s_waitcnt vmcnt(16)
    ds_read_b64_tr_b16 a[0:1], v12 offset:0
    ds_read_b64_tr_b16 a[2:3], v12 offset:256
    ds_read_b64_tr_b16 a[4:5], v13 offset:0
    ds_read_b64_tr_b16 a[6:7], v13 offset:256
    ds_read_b64_tr_b16 a[8:9], v12 offset:2048
    ds_read_b64_tr_b16 a[10:11], v12 offset:2304
    ds_read_b64_tr_b16 a[12:13], v13 offset:2048
    ds_read_b64_tr_b16 a[14:15], v13 offset:2304
    ds_read_b64_tr_b16 a[16:17], v12 offset:4096
    ds_read_b64_tr_b16 a[18:19], v12 offset:4352
    ds_read_b64_tr_b16 a[20:21], v13 offset:4096
    ds_read_b64_tr_b16 a[22:23], v13 offset:4352
    ds_read_b64_tr_b16 a[24:25], v12 offset:6144
    ds_read_b64_tr_b16 a[26:27], v12 offset:6400
    ds_read_b64_tr_b16 a[28:29], v13 offset:6144
    ds_read_b64_tr_b16 a[30:31], v13 offset:6400
    s_waitcnt lgkmcnt(0)
    s_mov_b32 m0, s70
    s_nop 0
    buffer_load_dwordx4 v2, s[8:11], s71 offen offset:0 lds
    s_add_u32 m0, m0, 3968
    s_nop 0
    buffer_load_dwordx4 v2, s[8:11], s71 offen offset:128 lds
    s_add_u32 m0, m0, 3968
    s_nop 0
    buffer_load_dwordx4 v2, s[8:11], s71 offen offset:256 lds
    s_add_u32 m0, m0, 3968
    s_nop 0
    buffer_load_dwordx4 v2, s[8:11], s71 offen offset:384 lds
    s_add_u32 m0, m0, 3968
    s_nop 0
    buffer_load_dwordx4 v2, s[8:11], s71 offen offset:512 lds
    s_add_u32 m0, m0, 3968
    s_nop 0
    buffer_load_dwordx4 v2, s[8:11], s71 offen offset:640 lds
    s_add_u32 m0, m0, 3968
    s_nop 0
    buffer_load_dwordx4 v2, s[8:11], s71 offen offset:768 lds
    s_add_u32 m0, m0, 3968
    s_nop 0
    buffer_load_dwordx4 v2, s[8:11], s71 offen offset:896 lds
    s_add_u32 m0, m0, 3968
    s_nop 0
    buffer_load_dwordx4 v2, s[8:11], s71 offen offset:1024 lds
    s_add_u32 m0, m0, 3968
    s_nop 0
    buffer_load_dwordx4 v2, s[8:11], s71 offen offset:1152 lds
    s_add_u32 m0, m0, 3968
    s_nop 0
    buffer_load_dwordx4 v2, s[8:11], s71 offen offset:1280 lds
    s_add_u32 m0, m0, 3968
    s_nop 0
    buffer_load_dwordx4 v2, s[8:11], s71 offen offset:1408 lds
    s_add_u32 m0, m0, 3968
    s_nop 0
    buffer_load_dwordx4 v2, s[8:11], s71 offen offset:1536 lds
    s_add_u32 m0, m0, 3968
    s_nop 0
    buffer_load_dwordx4 v2, s[8:11], s71 offen offset:1664 lds
    s_add_u32 m0, m0, 3968
    s_nop 0
    buffer_load_dwordx4 v2, s[8:11], s71 offen offset:1792 lds
    s_add_u32 m0, m0, 3968
    s_nop 0
    buffer_load_dwordx4 v2, s[8:11], s71 offen offset:1920 lds
    s_mul_i32 s64, s14, 24576
    s_add_u32 m0, s64, 65536
    s_xor_b32 s65, s69, 3145728
    buffer_load_dwordx4 v1, s[48:51], s65 offen  lds
    s_add_u32 m0, m0, 1024
    s_xor_b32 s65, s69, 3276800
    buffer_load_dwordx4 v1, s[48:51], s65 offen  lds
    s_add_u32 m0, m0, 1024
    s_xor_b32 s65, s69, 3407872
    buffer_load_dwordx4 v1, s[48:51], s65 offen  lds
    s_add_u32 m0, m0, 1024
    s_xor_b32 s65, s69, 3538944
    buffer_load_dwordx4 v1, s[48:51], s65 offen  lds
    s_add_u32 m0, m0, 1024
    s_xor_b32 s65, s69, 3670016
    buffer_load_dwordx4 v1, s[48:51], s65 offen  lds
    s_add_u32 m0, m0, 1024
    s_xor_b32 s65, s69, 3801088
    buffer_load_dwordx4 v1, s[48:51], s65 offen  lds
    s_add_u32 m0, m0, 1024
    s_xor_b32 s65, s69, 3932160
    buffer_load_dwordx4 v1, s[48:51], s65 offen  lds
    s_add_u32 m0, m0, 1024
    s_xor_b32 s65, s69, 4063232
    buffer_load_dwordx4 v1, s[48:51], s65 offen  lds
    s_waitcnt vmcnt(16)
    ds_read_b64_tr_b16 a[32:33], v12 offset:8192
    ds_read_b64_tr_b16 a[34:35], v12 offset:8448
    ds_read_b64_tr_b16 a[36:37], v13 offset:8192
    ds_read_b64_tr_b16 a[38:39], v13 offset:8448
    ds_read_b64_tr_b16 a[40:41], v12 offset:10240
    ds_read_b64_tr_b16 a[42:43], v12 offset:10496
    ds_read_b64_tr_b16 a[44:45], v13 offset:10240
    ds_read_b64_tr_b16 a[46:47], v13 offset:10496
    ds_read_b64_tr_b16 a[48:49], v12 offset:12288
    ds_read_b64_tr_b16 a[50:51], v12 offset:12544
    ds_read_b64_tr_b16 a[52:53], v13 offset:12288
    ds_read_b64_tr_b16 a[54:55], v13 offset:12544
    ds_read_b64_tr_b16 a[56:57], v12 offset:14336
    ds_read_b64_tr_b16 a[58:59], v12 offset:14592
    ds_read_b64_tr_b16 a[60:61], v13 offset:14336
    ds_read_b64_tr_b16 a[62:63], v13 offset:14592
    s_waitcnt lgkmcnt(0)
    s_mul_i32 s64, s14, 24576
    s_add_u32 m0, s64, 73728
    s_xor_b32 s65, s69, 4194304
    buffer_load_dwordx4 v1, s[48:51], s65 offen  lds
    s_add_u32 m0, m0, 1024
    s_xor_b32 s65, s69, 4325376
    buffer_load_dwordx4 v1, s[48:51], s65 offen  lds
    s_add_u32 m0, m0, 1024
    s_xor_b32 s65, s69, 4456448
    buffer_load_dwordx4 v1, s[48:51], s65 offen  lds
    s_add_u32 m0, m0, 1024
    s_xor_b32 s65, s69, 4587520
    buffer_load_dwordx4 v1, s[48:51], s65 offen  lds
    s_add_u32 m0, m0, 1024
    s_xor_b32 s65, s69, 4718592
    buffer_load_dwordx4 v1, s[48:51], s65 offen  lds
    s_add_u32 m0, m0, 1024
    s_xor_b32 s65, s69, 4849664
    buffer_load_dwordx4 v1, s[48:51], s65 offen  lds
    s_add_u32 m0, m0, 1024
    s_xor_b32 s65, s69, 4980736
    buffer_load_dwordx4 v1, s[48:51], s65 offen  lds
    s_add_u32 m0, m0, 1024
    s_xor_b32 s65, s69, 5111808
    buffer_load_dwordx4 v1, s[48:51], s65 offen  lds
    s_waitcnt vmcnt(16)
    ds_read_b64_tr_b16 a[64:65], v12 offset:16384
    ds_read_b64_tr_b16 a[66:67], v12 offset:16640
    ds_read_b64_tr_b16 a[68:69], v13 offset:16384
    ds_read_b64_tr_b16 a[70:71], v13 offset:16640
    ds_read_b64_tr_b16 a[72:73], v12 offset:18432
    ds_read_b64_tr_b16 a[74:75], v12 offset:18688
    ds_read_b64_tr_b16 a[76:77], v13 offset:18432
    ds_read_b64_tr_b16 a[78:79], v13 offset:18688
    ds_read_b64_tr_b16 a[80:81], v12 offset:20480
    ds_read_b64_tr_b16 a[82:83], v12 offset:20736
    ds_read_b64_tr_b16 a[84:85], v13 offset:20480
    ds_read_b64_tr_b16 a[86:87], v13 offset:20736
    ds_read_b64_tr_b16 a[88:89], v12 offset:22528
    ds_read_b64_tr_b16 a[90:91], v12 offset:22784
    ds_read_b64_tr_b16 a[92:93], v13 offset:22528
    ds_read_b64_tr_b16 a[94:95], v13 offset:22784
    s_waitcnt lgkmcnt(0)
    s_mul_i32 s64, s14, 24576
    s_add_u32 m0, s64, 81920
    s_xor_b32 s65, s69, 5242880
    buffer_load_dwordx4 v1, s[48:51], s65 offen  lds
    s_add_u32 m0, m0, 1024
    s_xor_b32 s65, s69, 5373952
    buffer_load_dwordx4 v1, s[48:51], s65 offen  lds
    s_add_u32 m0, m0, 1024
    s_xor_b32 s65, s69, 5505024
    buffer_load_dwordx4 v1, s[48:51], s65 offen  lds
    s_add_u32 m0, m0, 1024
    s_xor_b32 s65, s69, 5636096
    buffer_load_dwordx4 v1, s[48:51], s65 offen  lds
    s_add_u32 m0, m0, 1024
    s_xor_b32 s65, s69, 5767168
    buffer_load_dwordx4 v1, s[48:51], s65 offen  lds
    s_add_u32 m0, m0, 1024
    s_xor_b32 s65, s69, 5898240
    buffer_load_dwordx4 v1, s[48:51], s65 offen  lds
    s_add_u32 m0, m0, 1024
    s_xor_b32 s65, s69, 6029312
    buffer_load_dwordx4 v1, s[48:51], s65 offen  lds
    s_add_u32 m0, m0, 1024
    s_xor_b32 s65, s69, 6160384
    buffer_load_dwordx4 v1, s[48:51], s65 offen  lds
    s_waitcnt vmcnt(16)
    ds_read_b64_tr_b16 a[96:97], v12 offset:0
    ds_read_b64_tr_b16 a[98:99], v12 offset:256
    ds_read_b64_tr_b16 a[100:101], v13 offset:0
    ds_read_b64_tr_b16 a[102:103], v13 offset:256
    ds_read_b64_tr_b16 a[104:105], v12 offset:2048
    ds_read_b64_tr_b16 a[106:107], v12 offset:2304
    ds_read_b64_tr_b16 a[108:109], v13 offset:2048
    ds_read_b64_tr_b16 a[110:111], v13 offset:2304
    ds_read_b64_tr_b16 a[112:113], v12 offset:4096
    ds_read_b64_tr_b16 a[114:115], v12 offset:4352
    ds_read_b64_tr_b16 a[116:117], v13 offset:4096
    ds_read_b64_tr_b16 a[118:119], v13 offset:4352
    ds_read_b64_tr_b16 a[120:121], v12 offset:6144
    ds_read_b64_tr_b16 a[122:123], v12 offset:6400
    ds_read_b64_tr_b16 a[124:125], v13 offset:6144
    ds_read_b64_tr_b16 a[126:127], v13 offset:6400
    s_waitcnt lgkmcnt(0)
    s_mul_i32 s64, s14, 24576
    s_add_u32 m0, s64, 65536
    s_xor_b32 s65, s69, 6291456
    buffer_load_dwordx4 v1, s[48:51], s65 offen  lds
    s_add_u32 m0, m0, 1024
    s_xor_b32 s65, s69, 6422528
    buffer_load_dwordx4 v1, s[48:51], s65 offen  lds
    s_add_u32 m0, m0, 1024
    s_xor_b32 s65, s69, 6553600
    buffer_load_dwordx4 v1, s[48:51], s65 offen  lds
    s_add_u32 m0, m0, 1024
    s_xor_b32 s65, s69, 6684672
    buffer_load_dwordx4 v1, s[48:51], s65 offen  lds
    s_add_u32 m0, m0, 1024
    s_xor_b32 s65, s69, 6815744
    buffer_load_dwordx4 v1, s[48:51], s65 offen  lds
    s_add_u32 m0, m0, 1024
    s_xor_b32 s65, s69, 6946816
    buffer_load_dwordx4 v1, s[48:51], s65 offen  lds
    s_add_u32 m0, m0, 1024
    s_xor_b32 s65, s69, 7077888
    buffer_load_dwordx4 v1, s[48:51], s65 offen  lds
    s_add_u32 m0, m0, 1024
    s_xor_b32 s65, s69, 7208960
    buffer_load_dwordx4 v1, s[48:51], s65 offen  lds
    s_waitcnt vmcnt(16)
    ds_read_b64_tr_b16 a[128:129], v12 offset:8192
    ds_read_b64_tr_b16 a[130:131], v12 offset:8448
    ds_read_b64_tr_b16 a[132:133], v13 offset:8192
    ds_read_b64_tr_b16 a[134:135], v13 offset:8448
    ds_read_b64_tr_b16 a[136:137], v12 offset:10240
    ds_read_b64_tr_b16 a[138:139], v12 offset:10496
    ds_read_b64_tr_b16 a[140:141], v13 offset:10240
    ds_read_b64_tr_b16 a[142:143], v13 offset:10496
    ds_read_b64_tr_b16 a[144:145], v12 offset:12288
    ds_read_b64_tr_b16 a[146:147], v12 offset:12544
    ds_read_b64_tr_b16 a[148:149], v13 offset:12288
    ds_read_b64_tr_b16 a[150:151], v13 offset:12544
    ds_read_b64_tr_b16 a[152:153], v12 offset:14336
    ds_read_b64_tr_b16 a[154:155], v12 offset:14592
    ds_read_b64_tr_b16 a[156:157], v13 offset:14336
    ds_read_b64_tr_b16 a[158:159], v13 offset:14592
    s_waitcnt lgkmcnt(0)
    s_mul_i32 s64, s14, 24576
    s_add_u32 m0, s64, 73728
    s_xor_b32 s65, s69, 7340032
    buffer_load_dwordx4 v1, s[48:51], s65 offen  lds
    s_add_u32 m0, m0, 1024
    s_xor_b32 s65, s69, 7471104
    buffer_load_dwordx4 v1, s[48:51], s65 offen  lds
    s_add_u32 m0, m0, 1024
    s_xor_b32 s65, s69, 7602176
    buffer_load_dwordx4 v1, s[48:51], s65 offen  lds
    s_add_u32 m0, m0, 1024
    s_xor_b32 s65, s69, 7733248
    buffer_load_dwordx4 v1, s[48:51], s65 offen  lds
    s_add_u32 m0, m0, 1024
    s_xor_b32 s65, s69, 7864320
    buffer_load_dwordx4 v1, s[48:51], s65 offen  lds
    s_add_u32 m0, m0, 1024
    s_xor_b32 s65, s69, 7995392
    buffer_load_dwordx4 v1, s[48:51], s65 offen  lds
    s_add_u32 m0, m0, 1024
    s_xor_b32 s65, s69, 8126464
    buffer_load_dwordx4 v1, s[48:51], s65 offen  lds
    s_add_u32 m0, m0, 1024
    s_xor_b32 s65, s69, 8257536
    buffer_load_dwordx4 v1, s[48:51], s65 offen  lds
    s_waitcnt vmcnt(16)
    ds_read_b64_tr_b16 a[160:161], v12 offset:16384
    ds_read_b64_tr_b16 a[162:163], v12 offset:16640
    ds_read_b64_tr_b16 a[164:165], v13 offset:16384
    ds_read_b64_tr_b16 a[166:167], v13 offset:16640
    ds_read_b64_tr_b16 a[168:169], v12 offset:18432
    ds_read_b64_tr_b16 a[170:171], v12 offset:18688
    ds_read_b64_tr_b16 a[172:173], v13 offset:18432
    ds_read_b64_tr_b16 a[174:175], v13 offset:18688
    ds_read_b64_tr_b16 a[176:177], v12 offset:20480
    ds_read_b64_tr_b16 a[178:179], v12 offset:20736
    ds_read_b64_tr_b16 a[180:181], v13 offset:20480
    ds_read_b64_tr_b16 a[182:183], v13 offset:20736
    ds_read_b64_tr_b16 a[184:185], v12 offset:22528
    ds_read_b64_tr_b16 a[186:187], v12 offset:22784
    ds_read_b64_tr_b16 a[188:189], v13 offset:22528
    ds_read_b64_tr_b16 a[190:191], v13 offset:22784
    s_waitcnt lgkmcnt(0)
    s_waitcnt vmcnt(8)
    ds_read_b64_tr_b16 a[192:193], v12 offset:0
    ds_read_b64_tr_b16 a[194:195], v12 offset:256
    ds_read_b64_tr_b16 a[196:197], v13 offset:0
    ds_read_b64_tr_b16 a[198:199], v13 offset:256
    ds_read_b64_tr_b16 a[200:201], v12 offset:2048
    ds_read_b64_tr_b16 a[202:203], v12 offset:2304
    ds_read_b64_tr_b16 a[204:205], v13 offset:2048
    ds_read_b64_tr_b16 a[206:207], v13 offset:2304
    ds_read_b64_tr_b16 a[208:209], v12 offset:4096
    ds_read_b64_tr_b16 a[210:211], v12 offset:4352
    ds_read_b64_tr_b16 a[212:213], v13 offset:4096
    ds_read_b64_tr_b16 a[214:215], v13 offset:4352
    ds_read_b64_tr_b16 a[216:217], v12 offset:6144
    ds_read_b64_tr_b16 a[218:219], v12 offset:6400
    ds_read_b64_tr_b16 a[220:221], v13 offset:6144
    ds_read_b64_tr_b16 a[222:223], v13 offset:6400
    s_waitcnt lgkmcnt(0)
    s_waitcnt vmcnt(0)
    ds_read_b64_tr_b16 a[224:225], v12 offset:8192
    ds_read_b64_tr_b16 a[226:227], v12 offset:8448
    ds_read_b64_tr_b16 a[228:229], v13 offset:8192
    ds_read_b64_tr_b16 a[230:231], v13 offset:8448
    ds_read_b64_tr_b16 a[232:233], v12 offset:10240
    ds_read_b64_tr_b16 a[234:235], v12 offset:10496
    ds_read_b64_tr_b16 a[236:237], v13 offset:10240
    ds_read_b64_tr_b16 a[238:239], v13 offset:10496
    ds_read_b64_tr_b16 a[240:241], v12 offset:12288
    ds_read_b64_tr_b16 a[242:243], v12 offset:12544
    ds_read_b64_tr_b16 a[244:245], v13 offset:12288
    ds_read_b64_tr_b16 a[246:247], v13 offset:12544
    ds_read_b64_tr_b16 a[248:249], v12 offset:14336
    ds_read_b64_tr_b16 a[250:251], v12 offset:14592
    ds_read_b64_tr_b16 a[252:253], v13 offset:14336
    ds_read_b64_tr_b16 a[254:255], v13 offset:14592
    s_waitcnt lgkmcnt(0)
    v_and_b32 v254, 7, v0
    v_lshl_add_u32 v254, v254, 3, s3
L_wall_12:
    global_load_dwordx2 v[250:251], v254, s[44:45] sc1
    s_waitcnt vmcnt(0)
    v_lshrrev_b32 v255, 8, v251
    s_nop 1
    v_add_u32_dpp v255, v255, v255 row_ror:1 row_mask:0xf bank_mask:0xf
    s_nop 1
    v_add_u32_dpp v255, v255, v255 row_ror:2 row_mask:0xf bank_mask:0xf
    s_nop 1
    v_add_u32_dpp v255, v255, v255 row_ror:4 row_mask:0xf bank_mask:0xf
    s_nop 0
    v_readfirstlane_b32 s100, v255
    s_nop 0
    s_and_b32 s64, s100, 0x1ff
    s_cmp_eq_u32 s64, 256
    s_cbranch_scc1 L_walld_13
    s_sleep 4
    s_sub_u32 s15, s15, 1
    s_cbranch_scc0 L_wall_12
    s_branch L_abort
L_walld_13:
    v_cmp_ne_u32 vcc, -1, v250
    s_cbranch_vccnz L_restart
    s_bfe_u32 s64, s100, 0x80009
    s_lshr_b32 s100, s100, 17
    s_cmp_gt_u32 s100, s64
    s_cselect_b32 s100, 0x2000, 0
    v_add_u32 v33, s100, v33
    s_lshl_b32 s64, s13, 14
    v_lshl_add_u32 v1, v0, 7, s64
    s_mov_b32 s16, 0x0
    s_mov_b32 s17, 0xf
    s_mov_b32 s18, 0x1
    s_mov_b32 s19, 0x1f
    s_mov_b32 s20, 0x3
    s_mov_b32 s21, 0x3f
    s_mov_b32 s22, 0x7
    s_mov_b32 s23, 0x7f
    s_mov_b32 s24, 0xff
    s_mov_b32 s25, 0xfff
    s_mov_b32 s26, 0x1ff
    s_mov_b32 s27, 0x1fff
    s_mov_b32 s28, 0x3ff
    s_mov_b32 s29, 0x3fff
    s_mov_b32 s30, 0x7ff
    s_mov_b32 s31, 0x7fff
    s_mov_b32 s32, 0xffff
    s_mov_b32 s33, 0xfffff
    s_mov_b32 s34, 0x1ffff
    s_mov_b32 s35, 0x1fffff
    s_mov_b32 s36, 0x3ffff
    s_mov_b32 s37, 0x3fffff
    s_mov_b32 s38, 0x7ffff
    s_mov_b32 s39, 0x7fffff
    s_mov_b32 s40, 0xffffff
    s_mov_b32 s41, 0xfffffff
    s_mov_b32 s42, 0x1ffffff
    s_mov_b32 s43, 0x1fffffff
    s_mov_b32 s52, 0x3ffffff
    s_mov_b32 s53, 0x3fffffff
    s_mov_b32 s54, 0x7ffffff
    s_mov_b32 s55, 0x7fffffff
    s_sub_u32 s73, s14, 4
    s_barrier
    s_xor_b32 s70, s70, 0x10000
    s_add_u32 s71, s71, 0x10000
    ds_read_b128 v[216:219], v7 offset:0
    ds_read_b128 v[220:223], v7 offset:1024
    ds_read_b128 v[224:227], v8 offset:0
    ds_read_b128 v[228:231], v8 offset:1024
    ds_read_b128 v[232:235], v7 offset:4096
    ds_read_b128 v[236:239], v7 offset:5120
L_q_loop:
    s_waitcnt lgkmcnt(4)
    v_mfma_f32_16x16x32_bf16 v[12:15], a[0:3], v[216:219], 0
    ds_read_b128 v[240:243], v8 offset:4096
    v_mfma_f32_16x16x32_bf16 v[16:19], a[4:7], v[216:219], 0
    s_lshl_b32 s77, s73, 11
    s_and_b32 s77, s77, 0x2000
    v_mfma_f32_16x16x32_bf16 v[24:27], a[4:7], v[220:223], 0
    ds_read_b128 v[244:247], v8 offset:5120
    v_mfma_f32_16x16x32_bf16 v[20:23], a[0:3], v[220:223], 0
    s_xor_b32 s77, s77, s100
    s_lshl_b32 s67, s73, 19
    s_waitcnt lgkmcnt(4)
    v_mfma_f32_16x16x32_bf16 v[12:15], a[8:11], v[224:227], v[12:15]
    ds_read_b128 v[216:219], v7 offset:8192
    v_mfma_f32_16x16x32_bf16 v[16:19], a[12:15], v[224:227], v[16:19]
    s_or_b32 s77, s77, s67
    s_lshl_b32 s81, s73, 10
    v_mfma_f32_16x16x32_bf16 v[24:27], a[12:15], v[228:231], v[24:27]
    ds_read_b128 v[220:223], v7 offset:9216
    v_mfma_f32_16x16x32_bf16 v[20:23], a[8:11], v[228:231], v[20:23]
    s_and_b32 s81, s81, 0x2000
    s_xor_b32 s81, s81, s100
    s_waitcnt lgkmcnt(4)
    v_mfma_f32_16x16x32_bf16 v[12:15], a[16:19], v[232:235], v[12:15]
    ds_read_b128 v[224:227], v8 offset:8192
    v_mfma_f32_16x16x32_bf16 v[16:19], a[20:23], v[232:235], v[16:19]
    s_lshl_b32 s67, s73, 18
    s_or_b32 s81, s81, s67
    v_mfma_f32_16x16x32_bf16 v[24:27], a[20:23], v[236:239], v[24:27]
    ds_read_b128 v[228:231], v8 offset:9216
    v_mfma_f32_16x16x32_bf16 v[20:23], a[16:19], v[236:239], v[20:23]
    s_add_u32 s78, s77, 4096
    s_or_b32 s79, s77, 33554432
    s_waitcnt lgkmcnt(4)
    v_mfma_f32_16x16x32_bf16 v[12:15], a[24:27], v[240:243], v[12:15]
    ds_read_b128 v[232:235], v7 offset:12288
    v_mfma_f32_16x16x32_bf16 v[16:19], a[28:31], v[240:243], v[16:19]
    s_or_b32 s80, s78, 33554432
    s_add_u32 s82, s77, 2097152
    v_mfma_f32_16x16x32_bf16 v[24:27], a[28:31], v[244:247], v[24:27]
    ds_read_b128 v[236:239], v7 offset:13312
    v_mfma_f32_16x16x32_bf16 v[20:23], a[24:27], v[244:247], v[20:23]
    s_xor_b32 s82, s82, 0x2000
    s_waitcnt lgkmcnt(4)
    v_mfma_f32_16x16x32_bf16 v[12:15], a[32:35], v[216:219], v[12:15]
    ds_read_b128 v[240:243], v8 offset:12288
    v_mfma_f32_16x16x32_bf16 v[16:19], a[36:39], v[216:219], v[16:19]
    s_mov_b32 m0, s70
    v_mfma_f32_16x16x32_bf16 v[24:27], a[36:39], v[220:223], v[24:27]
    ds_read_b128 v[244:247], v8 offset:13312
    v_mfma_f32_16x16x32_bf16 v[20:23], a[32:35], v[220:223], v[20:23]
    buffer_load_dwordx4 v2, s[8:11], s71 offen offset:0 lds
    s_waitcnt lgkmcnt(4)
    v_mfma_f32_16x16x32_bf16 v[12:15], a[40:43], v[224:227], v[12:15]
    ds_read_b128 v[216:219], v7 offset:16384
    v_mfma_f32_16x16x32_bf16 v[16:19], a[44:47], v[224:227], v[16:19]
    s_add_u32 m0, m0, 3968
    v_mfma_f32_16x16x32_bf16 v[24:27], a[44:47], v[228:231], v[24:27]
    ds_read_b128 v[220:223], v7 offset:17408
    v_mfma_f32_16x16x32_bf16 v[20:23], a[40:43], v[228:231], v[20:23]
    buffer_load_dwordx4 v2, s[8:11], s71 offen offset:128 lds
    s_waitcnt lgkmcnt(4)
    v_mfma_f32_16x16x32_bf16 v[12:15], a[48:51], v[232:235], v[12:15]
    ds_read_b128 v[224:227], v8 offset:16384
    v_mfma_f32_16x16x32_bf16 v[16:19], a[52:55], v[232:235], v[16:19]
    s_add_u32 m0, m0, 3968
    v_mfma_f32_16x16x32_bf16 v[24:27], a[52:55], v[236:239], v[24:27]
    ds_read_b128 v[228:231], v8 offset:17408
    v_mfma_f32_16x16x32_bf16 v[20:23], a[48:51], v[236:239], v[20:23]
    buffer_load_dwordx4 v2, s[8:11], s71 offen offset:256 lds
    s_waitcnt lgkmcnt(4)
    v_mfma_f32_16x16x32_bf16 v[12:15], a[56:59], v[240:243], v[12:15]
    ds_read_b128 v[232:235], v7 offset:20480
    v_mfma_f32_16x16x32_bf16 v[16:19], a[60:63], v[240:243], v[16:19]
    s_add_u32 m0, m0, 3968
    v_mfma_f32_16x16x32_bf16 v[24:27], a[60:63], v[244:247], v[24:27]
    ds_read_b128 v[236:239], v7 offset:21504
    v_mfma_f32_16x16x32_bf16 v[20:23], a[56:59], v[244:247], v[20:23]
    buffer_load_dwordx4 v2, s[8:11], s71 offen offset:384 lds
    s_waitcnt lgkmcnt(4)
    v_mfma_f32_16x16x32_bf16 v[12:15], a[64:67], v[216:219], v[12:15]
    ds_read_b128 v[240:243], v8 offset:20480
    v_mfma_f32_16x16x32_bf16 v[16:19], a[68:71], v[216:219], v[16:19]
    s_add_u32 m0, m0, 3968
    v_mfma_f32_16x16x32_bf16 v[24:27], a[68:71], v[220:223], v[24:27]
    ds_read_b128 v[244:247], v8 offset:21504
    v_mfma_f32_16x16x32_bf16 v[20:23], a[64:67], v[220:223], v[20:23]
    buffer_load_dwordx4 v2, s[8:11], s71 offen offset:512 lds
    s_waitcnt lgkmcnt(4)
    v_mfma_f32_16x16x32_bf16 v[12:15], a[72:75], v[224:227], v[12:15]
    ds_read_b128 v[216:219], v7 offset:24576
    v_mfma_f32_16x16x32_bf16 v[16:19], a[76:79], v[224:227], v[16:19]
    s_add_u32 m0, m0, 3968
    s_waitcnt vmcnt(5)
    s_atomic_umax s84, s[46:47], s85
    v_mfma_f32_16x16x32_bf16 v[24:27], a[76:79], v[228:231], v[24:27]
    ds_read_b128 v[220:223], v7 offset:25600
    v_mfma_f32_16x16x32_bf16 v[20:23], a[72:75], v[228:231], v[20:23]
    buffer_load_dwordx4 v2, s[8:11], s71 offen offset:640 lds
    s_waitcnt lgkmcnt(4)
    v_mfma_f32_16x16x32_bf16 v[12:15], a[80:83], v[232:235], v[12:15]
    ds_read_b128 v[224:227], v8 offset:24576
    v_mfma_f32_16x16x32_bf16 v[16:19], a[84:87], v[232:235], v[16:19]
    s_add_u32 m0, m0, 3968
    v_mfma_f32_16x16x32_bf16 v[24:27], a[84:87], v[236:239], v[24:27]
    ds_read_b128 v[228:231], v8 offset:25600
    v_mfma_f32_16x16x32_bf16 v[20:23], a[80:83], v[236:239], v[20:23]
    buffer_load_dwordx4 v2, s[8:11], s71 offen offset:768 lds
    s_waitcnt lgkmcnt(4)
    v_mfma_f32_16x16x32_bf16 v[12:15], a[88:91], v[240:243], v[12:15]
    ds_read_b128 v[232:235], v7 offset:28672
    v_mfma_f32_16x16x32_bf16 v[16:19], a[92:95], v[240:243], v[16:19]
    s_add_u32 m0, m0, 3968
    v_mfma_f32_16x16x32_bf16 v[24:27], a[92:95], v[244:247], v[24:27]
    ds_read_b128 v[236:239], v7 offset:29696
    v_mfma_f32_16x16x32_bf16 v[20:23], a[88:91], v[244:247], v[20:23]
    buffer_load_dwordx4 v2, s[8:11], s71 offen offset:896 lds
    s_waitcnt lgkmcnt(4)
    v_mfma_f32_16x16x32_bf16 v[12:15], a[96:99], v[216:219], v[12:15]
    ds_read_b128 v[240:243], v8 offset:28672
    v_mfma_f32_16x16x32_bf16 v[16:19], a[100:103], v[216:219], v[16:19]
    s_add_u32 m0, m0, 3968
    v_mfma_f32_16x16x32_bf16 v[24:27], a[100:103], v[220:223], v[24:27]
    ds_read_b128 v[244:247], v8 offset:29696
    v_mfma_f32_16x16x32_bf16 v[20:23], a[96:99], v[220:223], v[20:23]
    buffer_load_dwordx4 v2, s[8:11], s71 offen offset:1024 lds
    s_waitcnt lgkmcnt(4)
    v_mfma_f32_16x16x32_bf16 v[12:15], a[104:107], v[224:227], v[12:15]
    ds_read_b128 v[216:219], v7 offset:32768
    v_mfma_f32_16x16x32_bf16 v[16:19], a[108:111], v[224:227], v[16:19]
    s_add_u32 m0, m0, 3968
    v_mfma_f32_16x16x32_bf16 v[24:27], a[108:111], v[228:231], v[24:27]
    ds_read_b128 v[220:223], v7 offset:33792
    v_mfma_f32_16x16x32_bf16 v[20:23], a[104:107], v[228:231], v[20:23]
    buffer_load_dwordx4 v2, s[8:11], s71 offen offset:1152 lds
    s_waitcnt lgkmcnt(4)
    v_mfma_f32_16x16x32_bf16 v[12:15], a[112:115], v[232:235], v[12:15]
    ds_read_b128 v[224:227], v8 offset:32768
    v_mfma_f32_16x16x32_bf16 v[16:19], a[116:119], v[232:235], v[16:19]
    s_add_u32 m0, m0, 3968
    v_mfma_f32_16x16x32_bf16 v[24:27], a[116:119], v[236:239], v[24:27]
    ds_read_b128 v[228:231], v8 offset:33792
    v_mfma_f32_16x16x32_bf16 v[20:23], a[112:115], v[236:239], v[20:23]
    buffer_load_dwordx4 v2, s[8:11], s71 offen offset:1280 lds
    s_waitcnt lgkmcnt(4)
    v_mfma_f32_16x16x32_bf16 v[12:15], a[120:123], v[240:243], v[12:15]
    ds_read_b128 v[232:235], v7 offset:36864
    v_mfma_f32_16x16x32_bf16 v[16:19], a[124:127], v[240:243], v[16:19]
    s_add_u32 m0, m0, 3968
    v_mfma_f32_16x16x32_bf16 v[24:27], a[124:127], v[244:247], v[24:27]
    ds_read_b128 v[236:239], v7 offset:37888
    v_mfma_f32_16x16x32_bf16 v[20:23], a[120:123], v[244:247], v[20:23]
    buffer_load_dwordx4 v2, s[8:11], s71 offen offset:1408 lds
    s_waitcnt lgkmcnt(4)
    v_mfma_f32_16x16x32_bf16 v[12:15], a[128:131], v[216:219], v[12:15]
    ds_read_b128 v[240:243], v8 offset:36864
    v_mfma_f32_16x16x32_bf16 v[16:19], a[132:135], v[216:219], v[16:19]
    s_add_u32 m0, m0, 3968
    v_mfma_f32_16x16x32_bf16 v[24:27], a[132:135], v[220:223], v[24:27]
    ds_read_b128 v[244:247], v8 offset:37888
    v_mfma_f32_16x16x32_bf16 v[20:23], a[128:131], v[220:223], v[20:23]
    buffer_load_dwordx4 v2, s[8:11], s71 offen offset:1536 lds
    s_waitcnt lgkmcnt(4)
    v_mfma_f32_16x16x32_bf16 v[12:15], a[136:139], v[224:227], v[12:15]
    ds_read_b128 v[216:219], v7 offset:40960
    v_mfma_f32_16x16x32_bf16 v[16:19], a[140:143], v[224:227], v[16:19]
    s_add_u32 m0, m0, 3968
    v_mfma_f32_16x16x32_bf16 v[24:27], a[140:143], v[228:231], v[24:27]
    ds_read_b128 v[220:223], v7 offset:41984
    v_mfma_f32_16x16x32_bf16 v[20:23], a[136:139], v[228:231], v[20:23]
    buffer_load_dwordx4 v2, s[8:11], s71 offen offset:1664 lds
    s_waitcnt lgkmcnt(4)
    v_mfma_f32_16x16x32_bf16 v[12:15], a[144:147], v[232:235], v[12:15]
    ds_read_b128 v[224:227], v8 offset:40960
    v_mfma_f32_16x16x32_bf16 v[16:19], a[148:151], v[232:235], v[16:19]
    s_add_u32 m0, m0, 3968
    v_mfma_f32_16x16x32_bf16 v[24:27], a[148:151], v[236:239], v[24:27]
    ds_read_b128 v[228:231], v8 offset:41984
    v_mfma_f32_16x16x32_bf16 v[20:23], a[144:147], v[236:239], v[20:23]
    buffer_load_dwordx4 v2, s[8:11], s71 offen offset:1792 lds
    s_waitcnt lgkmcnt(4)
    v_mfma_f32_16x16x32_bf16 v[12:15], a[152:155], v[240:243], v[12:15]
    ds_read_b128 v[232:235], v7 offset:45056
    v_mfma_f32_16x16x32_bf16 v[16:19], a[156:159], v[240:243], v[16:19]
    s_add_u32 m0, m0, 3968
    v_mfma_f32_16x16x32_bf16 v[24:27], a[156:159], v[244:247], v[24:27]
    ds_read_b128 v[236:239], v7 offset:46080
    v_mfma_f32_16x16x32_bf16 v[20:23], a[152:155], v[244:247], v[20:23]
    buffer_load_dwordx4 v2, s[8:11], s71 offen offset:1920 lds
    s_waitcnt lgkmcnt(4)
    v_mfma_f32_16x16x32_bf16 v[12:15], a[160:163], v[216:219], v[12:15]
    ds_read_b128 v[240:243], v8 offset:45056
    v_mfma_f32_16x16x32_bf16 v[16:19], a[164:167], v[216:219], v[16:19]
    s_cmp_eq_u32 s68, 52
    s_cselect_b32 s82, s82, 2147483648
    s_or_b32 s83, s82, 33554432
    s_waitcnt vmcnt(16)
    v_cmp_ge_u32 vcc, s73, v34
    s_nop 0
    s_and_b32 s64, vcc_lo, 0x55
    s_cselect_b32 s64, 2147483648, 0
    s_or_b32 s77, s77, s64
    s_or_b32 s78, s78, s64
    s_mov_b32 s76, s64
    v_mfma_f32_16x16x32_bf16 v[24:27], a[164:167], v[220:223], v[24:27]
    ds_read_b128 v[244:247], v8 offset:46080
    v_mfma_f32_16x16x32_bf16 v[20:23], a[160:163], v[220:223], v[20:23]
    buffer_load_dwordx4 v[76:79], v30, s[4:7], s77 offen offset:0 sc1
    s_waitcnt lgkmcnt(4)
    v_mfma_f32_16x16x32_bf16 v[12:15], a[168:171], v[224:227], v[12:15]
    ds_read_b128 v[216:219], v7 offset:49152
    v_mfma_f32_16x16x32_bf16 v[16:19], a[172:175], v[224:227], v[16:19]
    v_mfma_f32_16x16x32_bf16 v[24:27], a[172:175], v[228:231], v[24:27]
    ds_read_b128 v[220:223], v7 offset:50176
    v_mfma_f32_16x16x32_bf16 v[20:23], a[168:171], v[228:231], v[20:23]
    buffer_load_dwordx4 v[80:83], v30, s[4:7], s77 offen offset:1024 sc1
    s_waitcnt lgkmcnt(4)
    v_mfma_f32_16x16x32_bf16 v[12:15], a[176:179], v[232:235], v[12:15]
    ds_read_b128 v[224:227], v8 offset:49152
    v_mfma_f32_16x16x32_bf16 v[16:19], a[180:183], v[232:235], v[16:19]
    v_mfma_f32_16x16x32_bf16 v[24:27], a[180:183], v[236:239], v[24:27]
    ds_read_b128 v[228:231], v8 offset:50176
    v_mfma_f32_16x16x32_bf16 v[20:23], a[176:179], v[236:239], v[20:23]
    buffer_load_dwordx4 v[84:87], v30, s[4:7], s77 offen offset:2048 sc1
    s_waitcnt lgkmcnt(4)
    v_mfma_f32_16x16x32_bf16 v[12:15], a[184:187], v[240:243], v[12:15]
    ds_read_b128 v[232:235], v7 offset:53248
    v_mfma_f32_16x16x32_bf16 v[16:19], a[188:191], v[240:243], v[16:19]
    v_mfma_f32_16x16x32_bf16 v[24:27], a[188:191], v[244:247], v[24:27]
    ds_read_b128 v[236:239], v7 offset:54272
    v_mfma_f32_16x16x32_bf16 v[20:23], a[184:187], v[244:247], v[20:23]
    buffer_load_dwordx4 v[88:91], v30, s[4:7], s77 offen offset:3072 sc1
    s_waitcnt lgkmcnt(4)
    v_mfma_f32_16x16x32_bf16 v[12:15], a[192:195], v[216:219], v[12:15]
    ds_read_b128 v[240:243], v8 offset:53248
    v_mfma_f32_16x16x32_bf16 v[16:19], a[196:199], v[216:219], v[16:19]
    v_mfma_f32_16x16x32_bf16 v[24:27], a[196:199], v[220:223], v[24:27]
    ds_read_b128 v[244:247], v8 offset:54272
    v_mfma_f32_16x16x32_bf16 v[20:23], a[192:195], v[220:223], v[20:23]
    buffer_load_dword v6, v5, s[8:11], s71 offen
    s_waitcnt lgkmcnt(4)
    v_mfma_f32_16x16x32_bf16 v[12:15], a[200:203], v[224:227], v[12:15]
    ds_read_b128 v[216:219], v7 offset:57344
    v_mfma_f32_16x16x32_bf16 v[16:19], a[204:207], v[224:227], v[16:19]
    v_mfma_f32_16x16x32_bf16 v[24:27], a[204:207], v[228:231], v[24:27]
    ds_read_b128 v[220:223], v7 offset:58368
    v_mfma_f32_16x16x32_bf16 v[20:23], a[200:203], v[228:231], v[20:23]
    s_waitcnt lgkmcnt(4)
    v_mfma_f32_16x16x32_bf16 v[12:15], a[208:211], v[232:235], v[12:15]
    ds_read_b128 v[224:227], v8 offset:57344
    v_mfma_f32_16x16x32_bf16 v[16:19], a[212:215], v[232:235], v[16:19]
    v_mfma_f32_16x16x32_bf16 v[24:27], a[212:215], v[236:239], v[24:27]
    ds_read_b128 v[228:231], v8 offset:58368
    v_mfma_f32_16x16x32_bf16 v[20:23], a[208:211], v[236:239], v[20:23]
    s_waitcnt lgkmcnt(4)
    v_mfma_f32_16x16x32_bf16 v[12:15], a[216:219], v[240:243], v[12:15]
    ds_read_b128 v[232:235], v7 offset:61440
    v_mfma_f32_16x16x32_bf16 v[16:19], a[220:223], v[240:243], v[16:19]
    v_mfma_f32_16x16x32_bf16 v[24:27], a[220:223], v[244:247], v[24:27]
    ds_read_b128 v[236:239], v7 offset:62464
    v_mfma_f32_16x16x32_bf16 v[20:23], a[216:219], v[244:247], v[20:23]
    s_waitcnt lgkmcnt(4)
    v_mfma_f32_16x16x32_bf16 v[12:15], a[224:227], v[216:219], v[12:15]
    ds_read_b128 v[240:243], v8 offset:61440
    v_mfma_f32_16x16x32_bf16 v[16:19], a[228:231], v[216:219], v[16:19]
    v_mfma_f32_16x16x32_bf16 v[24:27], a[228:231], v[220:223], v[24:27]
    ds_read_b128 v[244:247], v8 offset:62464
    v_xor_b32 v7, 0x10000, v7
    v_xor_b32 v8, 0x10000, v8
    v_mfma_f32_16x16x32_bf16 v[20:23], a[224:227], v[220:223], v[20:23]
    s_waitcnt vmcnt(5)
    s_barrier
    s_waitcnt lgkmcnt(4)
    v_mfma_f32_16x16x32_bf16 v[12:15], a[232:235], v[224:227], v[12:15]
    ds_read_b128 v[216:219], v7 offset:0
    v_mfma_f32_16x16x32_bf16 v[16:19], a[236:239], v[224:227], v[16:19]
    v_mfma_f32_16x16x32_bf16 v[24:27], a[236:239], v[228:231], v[24:27]
    ds_read_b128 v[220:223], v7 offset:1024
    v_mfma_f32_16x16x32_bf16 v[20:23], a[232:235], v[228:231], v[20:23]
    s_xor_b32 s70, s70, 0x10000
    s_add_u32 s71, s71, 0x10000
    s_waitcnt lgkmcnt(4)
    v_mfma_f32_16x16x32_bf16 v[12:15], a[240:243], v[232:235], v[12:15]
    ds_read_b128 v[224:227], v8 offset:0
    v_mfma_f32_16x16x32_bf16 v[16:19], a[244:247], v[232:235], v[16:19]
    v_mfma_f32_16x16x32_bf16 v[24:27], a[244:247], v[236:239], v[24:27]
    ds_read_b128 v[228:231], v8 offset:1024
    v_mfma_f32_16x16x32_bf16 v[20:23], a[240:243], v[236:239], v[20:23]
    s_waitcnt lgkmcnt(4)
    v_mfma_f32_16x16x32_bf16 v[12:15], a[248:251], v[240:243], v[12:15]
    ds_read_b128 v[232:235], v7 offset:4096
    v_mfma_f32_16x16x32_bf16 v[16:19], a[252:255], v[240:243], v[16:19]
    v_mfma_f32_16x16x32_bf16 v[24:27], a[252:255], v[244:247], v[24:27]
    ds_read_b128 v[236:239], v7 offset:5120
    v_mfma_f32_16x16x32_bf16 v[20:23], a[248:251], v[244:247], v[20:23]
    s_add_u32 s68, s68, 1
    s_waitcnt lgkmcnt(4)
    v_mfma_f32_16x16x32_bf16 v[172:175], a[0:3], v[216:219], 0
    ds_read_b128 v[240:243], v8 offset:4096
    v_mfma_f32_16x16x32_bf16 v[176:179], a[4:7], v[216:219], 0
    s_mov_b32 m0, s70
    v_mfma_f32_16x16x32_bf16 v[184:187], a[4:7], v[220:223], 0
    ds_read_b128 v[244:247], v8 offset:5120
    v_mfma_f32_16x16x32_bf16 v[180:183], a[0:3], v[220:223], 0
    buffer_load_dwordx4 v2, s[8:11], s71 offen offset:0 lds
    s_waitcnt lgkmcnt(4)
    v_mfma_f32_16x16x32_bf16 v[172:175], a[8:11], v[224:227], v[172:175]
    ds_read_b128 v[216:219], v7 offset:8192
    v_mfma_f32_16x16x32_bf16 v[176:179], a[12:15], v[224:227], v[176:179]
    s_add_u32 m0, m0, 3968
    v_cvt_pk_bf16_f32 v12, v12, v13
    v_mfma_f32_16x16x32_bf16 v[184:187], a[12:15], v[228:231], v[184:187]
    ds_read_b128 v[220:223], v7 offset:9216
    v_mfma_f32_16x16x32_bf16 v[180:183], a[8:11], v[228:231], v[180:183]
    buffer_load_dwordx4 v2, s[8:11], s71 offen offset:128 lds
    s_waitcnt lgkmcnt(4)
    v_mfma_f32_16x16x32_bf16 v[172:175], a[16:19], v[232:235], v[172:175]
    ds_read_b128 v[224:227], v8 offset:8192
    v_mfma_f32_16x16x32_bf16 v[176:179], a[20:23], v[232:235], v[176:179]
    s_add_u32 m0, m0, 3968
    v_cvt_pk_bf16_f32 v13, v14, v15
    v_mfma_f32_16x16x32_bf16 v[184:187], a[20:23], v[236:239], v[184:187]
    ds_read_b128 v[228:231], v8 offset:9216
    v_mfma_f32_16x16x32_bf16 v[180:183], a[16:19], v[236:239], v[180:183]
    buffer_load_dwordx4 v2, s[8:11], s71 offen offset:256 lds
    s_waitcnt lgkmcnt(4)
    v_mfma_f32_16x16x32_bf16 v[172:175], a[24:27], v[240:243], v[172:175]
    ds_read_b128 v[232:235], v7 offset:12288
    v_mfma_f32_16x16x32_bf16 v[176:179], a[28:31], v[240:243], v[176:179]
    s_add_u32 m0, m0, 3968
    v_cvt_pk_bf16_f32 v14, v16, v17
    v_mfma_f32_16x16x32_bf16 v[184:187], a[28:31], v[244:247], v[184:187]
    ds_read_b128 v[236:239], v7 offset:13312
    v_mfma_f32_16x16x32_bf16 v[180:183], a[24:27], v[244:247], v[180:183]
    buffer_load_dwordx4 v2, s[8:11], s71 offen offset:384 lds
    s_waitcnt lgkmcnt(4)
    v_mfma_f32_16x16x32_bf16 v[172:175], a[32:35], v[216:219], v[172:175]
    ds_read_b128 v[240:243], v8 offset:12288
    v_mfma_f32_16x16x32_bf16 v[176:179], a[36:39], v[216:219], v[176:179]
    s_add_u32 m0, m0, 3968
    v_cvt_pk_bf16_f32 v15, v18, v19
    v_mfma_f32_16x16x32_bf16 v[184:187], a[36:39], v[220:223], v[184:187]
    ds_read_b128 v[244:247], v8 offset:13312
    v_mfma_f32_16x16x32_bf16 v[180:183], a[32:35], v[220:223], v[180:183]
    buffer_load_dwordx4 v2, s[8:11], s71 offen offset:512 lds
    s_waitcnt lgkmcnt(4)
    v_mfma_f32_16x16x32_bf16 v[172:175], a[40:43], v[224:227], v[172:175]
    ds_read_b128 v[216:219], v7 offset:16384
    v_mfma_f32_16x16x32_bf16 v[176:179], a[44:47], v[224:227], v[176:179]
    s_add_u32 m0, m0, 3968
    v_cvt_pk_bf16_f32 v16, v20, v21
    v_mfma_f32_16x16x32_bf16 v[184:187], a[44:47], v[228:231], v[184:187]
    ds_read_b128 v[220:223], v7 offset:17408
    v_mfma_f32_16x16x32_bf16 v[180:183], a[40:43], v[228:231], v[180:183]
    buffer_load_dwordx4 v2, s[8:11], s71 offen offset:640 lds
    s_waitcnt lgkmcnt(4)
    v_mfma_f32_16x16x32_bf16 v[172:175], a[48:51], v[232:235], v[172:175]
    ds_read_b128 v[224:227], v8 offset:16384
    v_mfma_f32_16x16x32_bf16 v[176:179], a[52:55], v[232:235], v[176:179]
    s_add_u32 m0, m0, 3968
    v_cvt_pk_bf16_f32 v17, v22, v23
    v_mfma_f32_16x16x32_bf16 v[184:187], a[52:55], v[236:239], v[184:187]
    ds_read_b128 v[228:231], v8 offset:17408
    v_mfma_f32_16x16x32_bf16 v[180:183], a[48:51], v[236:239], v[180:183]
    buffer_load_dwordx4 v2, s[8:11], s71 offen offset:768 lds
    s_waitcnt lgkmcnt(4)
    v_mfma_f32_16x16x32_bf16 v[172:175], a[56:59], v[240:243], v[172:175]
    ds_read_b128 v[232:235], v7 offset:20480
    v_mfma_f32_16x16x32_bf16 v[176:179], a[60:63], v[240:243], v[176:179]
    s_add_u32 m0, m0, 3968
    v_cvt_pk_bf16_f32 v18, v24, v25
    v_mfma_f32_16x16x32_bf16 v[184:187], a[60:63], v[244:247], v[184:187]
    ds_read_b128 v[236:239], v7 offset:21504
    v_mfma_f32_16x16x32_bf16 v[180:183], a[56:59], v[244:247], v[180:183]
    buffer_load_dwordx4 v2, s[8:11], s71 offen offset:896 lds
    s_waitcnt lgkmcnt(4)
    v_mfma_f32_16x16x32_bf16 v[172:175], a[64:67], v[216:219], v[172:175]
    ds_read_b128 v[240:243], v8 offset:20480
    v_mfma_f32_16x16x32_bf16 v[176:179], a[68:71], v[216:219], v[176:179]
    s_add_u32 m0, m0, 3968
    v_cvt_pk_bf16_f32 v19, v26, v27
    v_mfma_f32_16x16x32_bf16 v[184:187], a[68:71], v[220:223], v[184:187]
    ds_read_b128 v[244:247], v8 offset:21504
    v_mfma_f32_16x16x32_bf16 v[180:183], a[64:67], v[220:223], v[180:183]
    buffer_load_dwordx4 v2, s[8:11], s71 offen offset:1024 lds
    s_waitcnt lgkmcnt(4)
    v_mfma_f32_16x16x32_bf16 v[172:175], a[72:75], v[224:227], v[172:175]
    ds_read_b128 v[216:219], v7 offset:24576
    v_mfma_f32_16x16x32_bf16 v[176:179], a[76:79], v[224:227], v[176:179]
    s_add_u32 m0, m0, 3968
    ds_write_b128 v28, v[12:15] offset:0
    v_mfma_f32_16x16x32_bf16 v[184:187], a[76:79], v[228:231], v[184:187]
    ds_read_b128 v[220:223], v7 offset:25600
    v_mfma_f32_16x16x32_bf16 v[180:183], a[72:75], v[228:231], v[180:183]
    buffer_load_dwordx4 v2, s[8:11], s71 offen offset:1152 lds
    s_waitcnt lgkmcnt(5)
    v_mfma_f32_16x16x32_bf16 v[172:175], a[80:83], v[232:235], v[172:175]
    ds_read_b128 v[224:227], v8 offset:24576
    v_mfma_f32_16x16x32_bf16 v[176:179], a[84:87], v[232:235], v[176:179]
    s_add_u32 m0, m0, 3968
    ds_write_b128 v28, v[16:19] offset:128
    v_mfma_f32_16x16x32_bf16 v[184:187], a[84:87], v[236:239], v[184:187]
    ds_read_b128 v[228:231], v8 offset:25600
    v_mfma_f32_16x16x32_bf16 v[180:183], a[80:83], v[236:239], v[180:183]
    buffer_load_dwordx4 v2, s[8:11], s71 offen offset:1280 lds
    s_waitcnt lgkmcnt(6)
    v_mfma_f32_16x16x32_bf16 v[172:175], a[88:91], v[240:243], v[172:175]
    ds_read_b128 v[232:235], v7 offset:28672
    v_mfma_f32_16x16x32_bf16 v[176:179], a[92:95], v[240:243], v[176:179]
    s_add_u32 m0, m0, 3968
    v_mfma_f32_16x16x32_bf16 v[184:187], a[92:95], v[244:247], v[184:187]
    ds_read_b128 v[236:239], v7 offset:29696
    v_mfma_f32_16x16x32_bf16 v[180:183], a[88:91], v[244:247], v[180:183]
    buffer_load_dwordx4 v2, s[8:11], s71 offen offset:1408 lds
    s_waitcnt lgkmcnt(5)
    v_mfma_f32_16x16x32_bf16 v[172:175], a[96:99], v[216:219], v[172:175]
    ds_read_b128 v[240:243], v8 offset:28672
    v_mfma_f32_16x16x32_bf16 v[176:179], a[100:103], v[216:219], v[176:179]
    s_add_u32 m0, m0, 3968
    v_mfma_f32_16x16x32_bf16 v[184:187], a[100:103], v[220:223], v[184:187]
    ds_read_b128 v[244:247], v8 offset:29696
    v_mfma_f32_16x16x32_bf16 v[180:183], a[96:99], v[220:223], v[180:183]
    buffer_load_dwordx4 v2, s[8:11], s71 offen offset:1536 lds
    s_waitcnt lgkmcnt(4)
    v_mfma_f32_16x16x32_bf16 v[172:175], a[104:107], v[224:227], v[172:175]
    ds_read_b128 v[216:219], v7 offset:32768
    v_mfma_f32_16x16x32_bf16 v[176:179], a[108:111], v[224:227], v[176:179]
    s_add_u32 m0, m0, 3968
    v_mfma_f32_16x16x32_bf16 v[184:187], a[108:111], v[228:231], v[184:187]
    ds_read_b128 v[220:223], v7 offset:33792
    v_mfma_f32_16x16x32_bf16 v[180:183], a[104:107], v[228:231], v[180:183]
    buffer_load_dwordx4 v2, s[8:11], s71 offen offset:1664 lds
    s_waitcnt lgkmcnt(4)
    v_mfma_f32_16x16x32_bf16 v[172:175], a[112:115], v[232:235], v[172:175]
    ds_read_b128 v[224:227], v8 offset:32768
    v_mfma_f32_16x16x32_bf16 v[176:179], a[116:119], v[232:235], v[176:179]
    s_add_u32 m0, m0, 3968
    v_mfma_f32_16x16x32_bf16 v[184:187], a[116:119], v[236:239], v[184:187]
    ds_read_b128 v[228:231], v8 offset:33792
    v_mfma_f32_16x16x32_bf16 v[180:183], a[112:115], v[236:239], v[180:183]
    buffer_load_dwordx4 v2, s[8:11], s71 offen offset:1792 lds
    s_waitcnt lgkmcnt(4)
    v_mfma_f32_16x16x32_bf16 v[172:175], a[120:123], v[240:243], v[172:175]
    ds_read_b128 v[232:235], v7 offset:36864
    v_mfma_f32_16x16x32_bf16 v[176:179], a[124:127], v[240:243], v[176:179]
    s_add_u32 m0, m0, 3968
    v_mfma_f32_16x16x32_bf16 v[184:187], a[124:127], v[244:247], v[184:187]
    ds_read_b128 v[236:239], v7 offset:37888
    v_mfma_f32_16x16x32_bf16 v[180:183], a[120:123], v[244:247], v[180:183]
    buffer_load_dwordx4 v2, s[8:11], s71 offen offset:1920 lds
    s_waitcnt lgkmcnt(4)
    v_mfma_f32_16x16x32_bf16 v[172:175], a[128:131], v[216:219], v[172:175]
    ds_read_b128 v[240:243], v8 offset:36864
    v_mfma_f32_16x16x32_bf16 v[176:179], a[132:135], v[216:219], v[176:179]
    v_mfma_f32_16x16x32_bf16 v[184:187], a[132:135], v[220:223], v[184:187]
    ds_read_b128 v[244:247], v8 offset:37888
    v_mfma_f32_16x16x32_bf16 v[180:183], a[128:131], v[220:223], v[180:183]
    buffer_load_dwordx4 v[92:95], v30, s[4:7], s78 offen offset:0 sc1
    s_waitcnt lgkmcnt(4)
    v_mfma_f32_16x16x32_bf16 v[172:175], a[136:139], v[224:227], v[172:175]
    ds_read_b128 v[216:219], v7 offset:40960
    v_mfma_f32_16x16x32_bf16 v[176:179], a[140:143], v[224:227], v[176:179]
    v_mfma_f32_16x16x32_bf16 v[184:187], a[140:143], v[228:231], v[184:187]
    ds_read_b128 v[220:223], v7 offset:41984
    v_mfma_f32_16x16x32_bf16 v[180:183], a[136:139], v[228:231], v[180:183]
    buffer_load_dwordx4 v[96:99], v30, s[4:7], s78 offen offset:1024 sc1
    s_waitcnt lgkmcnt(4)
    v_mfma_f32_16x16x32_bf16 v[172:175], a[144:147], v[232:235], v[172:175]
    ds_read_b128 v[224:227], v8 offset:40960
    v_mfma_f32_16x16x32_bf16 v[176:179], a[148:151], v[232:235], v[176:179]
    v_mfma_f32_16x16x32_bf16 v[184:187], a[148:151], v[236:239], v[184:187]
    ds_read_b128 v[228:231], v8 offset:41984
    v_mfma_f32_16x16x32_bf16 v[180:183], a[144:147], v[236:239], v[180:183]
    buffer_load_dwordx4 v[100:103], v30, s[4:7], s78 offen offset:2048 sc1
    s_waitcnt lgkmcnt(4)
    v_mfma_f32_16x16x32_bf16 v[172:175], a[152:155], v[240:243], v[172:175]
    ds_read_b128 v[232:235], v7 offset:45056
    v_mfma_f32_16x16x32_bf16 v[176:179], a[156:159], v[240:243], v[176:179]
    v_mfma_f32_16x16x32_bf16 v[184:187], a[156:159], v[244:247], v[184:187]
    ds_read_b128 v[236:239], v7 offset:46080
    v_mfma_f32_16x16x32_bf16 v[180:183], a[152:155], v[244:247], v[180:183]
    buffer_load_dwordx4 v[104:107], v30, s[4:7], s78 offen offset:3072 sc1
    s_waitcnt lgkmcnt(4)
    v_mfma_f32_16x16x32_bf16 v[172:175], a[160:163], v[216:219], v[172:175]
    ds_read_b128 v[240:243], v8 offset:45056
    v_mfma_f32_16x16x32_bf16 v[176:179], a[164:167], v[216:219], v[176:179]
    v_mfma_f32_16x16x32_bf16 v[184:187], a[164:167], v[220:223], v[184:187]
    ds_read_b128 v[244:247], v8 offset:46080
    v_mfma_f32_16x16x32_bf16 v[180:183], a[160:163], v[220:223], v[180:183]
    buffer_load_dword v6, v5, s[8:11], s71 offen
    s_waitcnt lgkmcnt(4)
    v_mfma_f32_16x16x32_bf16 v[172:175], a[168:171], v[224:227], v[172:175]
    ds_read_b128 v[216:219], v7 offset:49152
    v_mfma_f32_16x16x32_bf16 v[176:179], a[172:175], v[224:227], v[176:179]
    v_mfma_f32_16x16x32_bf16 v[184:187], a[172:175], v[228:231], v[184:187]
    ds_read_b128 v[220:223], v7 offset:50176
    v_mfma_f32_16x16x32_bf16 v[180:183], a[168:171], v[228:231], v[180:183]
    buffer_load_dword v6, v1, s[4:7], s82 offen sc1
    s_waitcnt lgkmcnt(4)
    v_mfma_f32_16x16x32_bf16 v[172:175], a[176:179], v[232:235], v[172:175]
    ds_read_b128 v[224:227], v8 offset:49152
    v_mfma_f32_16x16x32_bf16 v[176:179], a[180:183], v[232:235], v[176:179]
    v_mfma_f32_16x16x32_bf16 v[184:187], a[180:183], v[236:239], v[184:187]
    ds_read_b128 v[228:231], v8 offset:50176
    v_mfma_f32_16x16x32_bf16 v[180:183], a[176:179], v[236:239], v[180:183]
    buffer_load_dword v34, v33, s[4:7], 0 offen sc1
    s_waitcnt lgkmcnt(4)
    v_mfma_f32_16x16x32_bf16 v[172:175], a[184:187], v[240:243], v[172:175]
    ds_read_b128 v[232:235], v7 offset:53248
    v_mfma_f32_16x16x32_bf16 v[176:179], a[188:191], v[240:243], v[176:179]
    v_mfma_f32_16x16x32_bf16 v[184:187], a[188:191], v[244:247], v[184:187]
    ds_read_b128 v[236:239], v7 offset:54272
    v_mfma_f32_16x16x32_bf16 v[180:183], a[184:187], v[244:247], v[180:183]
    s_waitcnt lgkmcnt(4)
    v_mfma_f32_16x16x32_bf16 v[172:175], a[192:195], v[216:219], v[172:175]
    ds_read_b128 v[240:243], v8 offset:53248
    v_mfma_f32_16x16x32_bf16 v[176:179], a[196:199], v[216:219], v[176:179]
    v_mfma_f32_16x16x32_bf16 v[184:187], a[196:199], v[220:223], v[184:187]
    ds_read_b128 v[244:247], v8 offset:54272
    v_mfma_f32_16x16x32_bf16 v[180:183], a[192:195], v[220:223], v[180:183]
    s_waitcnt lgkmcnt(4)
    v_mfma_f32_16x16x32_bf16 v[172:175], a[200:203], v[224:227], v[172:175]
    ds_read_b128 v[216:219], v7 offset:57344
    v_mfma_f32_16x16x32_bf16 v[176:179], a[204:207], v[224:227], v[176:179]
    v_mfma_f32_16x16x32_bf16 v[184:187], a[204:207], v[228:231], v[184:187]
    ds_read_b128 v[220:223], v7 offset:58368
    v_mfma_f32_16x16x32_bf16 v[180:183], a[200:203], v[228:231], v[180:183]
    s_waitcnt lgkmcnt(4)
    v_mfma_f32_16x16x32_bf16 v[172:175], a[208:211], v[232:235], v[172:175]
    ds_read_b128 v[224:227], v8 offset:57344
    v_mfma_f32_16x16x32_bf16 v[176:179], a[212:215], v[232:235], v[176:179]
    v_mfma_f32_16x16x32_bf16 v[184:187], a[212:215], v[236:239], v[184:187]
    ds_read_b128 v[228:231], v8 offset:58368
    v_mfma_f32_16x16x32_bf16 v[180:183], a[208:211], v[236:239], v[180:183]
    s_waitcnt lgkmcnt(4)
    v_mfma_f32_16x16x32_bf16 v[172:175], a[216:219], v[240:243], v[172:175]
    ds_read_b128 v[232:235], v7 offset:61440
    v_mfma_f32_16x16x32_bf16 v[176:179], a[220:223], v[240:243], v[176:179]
    v_mfma_f32_16x16x32_bf16 v[184:187], a[220:223], v[244:247], v[184:187]
    ds_read_b128 v[236:239], v7 offset:62464
    v_mfma_f32_16x16x32_bf16 v[180:183], a[216:219], v[244:247], v[180:183]
    s_waitcnt lgkmcnt(4)
    v_mfma_f32_16x16x32_bf16 v[172:175], a[224:227], v[216:219], v[172:175]
    ds_read_b128 v[240:243], v8 offset:61440
    v_mfma_f32_16x16x32_bf16 v[176:179], a[228:231], v[216:219], v[176:179]
    v_mfma_f32_16x16x32_bf16 v[184:187], a[228:231], v[220:223], v[184:187]
    ds_read_b128 v[244:247], v8 offset:62464
    v_xor_b32 v7, 0x10000, v7
    v_xor_b32 v8, 0x10000, v8
    v_mfma_f32_16x16x32_bf16 v[180:183], a[224:227], v[220:223], v[180:183]
    s_waitcnt vmcnt(7)
    s_barrier
    s_waitcnt lgkmcnt(4)
    v_mfma_f32_16x16x32_bf16 v[172:175], a[232:235], v[224:227], v[172:175]
    ds_read_b128 v[216:219], v7 offset:0
    v_mfma_f32_16x16x32_bf16 v[176:179], a[236:239], v[224:227], v[176:179]
    v_mfma_f32_16x16x32_bf16 v[184:187], a[236:239], v[228:231], v[184:187]
    ds_read_b128 v[220:223], v7 offset:1024
    v_mfma_f32_16x16x32_bf16 v[180:183], a[232:235], v[228:231], v[180:183]
    s_xor_b32 s70, s70, 0x10000
    s_add_u32 s71, s71, 0x10000
    s_waitcnt lgkmcnt(4)
    v_mfma_f32_16x16x32_bf16 v[172:175], a[240:243], v[232:235], v[172:175]
    ds_read_b128 v[224:227], v8 offset:0
    v_mfma_f32_16x16x32_bf16 v[176:179], a[244:247], v[232:235], v[176:179]
    v_mfma_f32_16x16x32_bf16 v[184:187], a[244:247], v[236:239], v[184:187]
    ds_read_b128 v[228:231], v8 offset:1024
    v_mfma_f32_16x16x32_bf16 v[180:183], a[240:243], v[236:239], v[180:183]
    s_waitcnt lgkmcnt(4)
    v_mfma_f32_16x16x32_bf16 v[172:175], a[248:251], v[240:243], v[172:175]
    ds_read_b128 v[232:235], v7 offset:4096
    v_mfma_f32_16x16x32_bf16 v[176:179], a[252:255], v[240:243], v[176:179]
    v_mfma_f32_16x16x32_bf16 v[184:187], a[252:255], v[244:247], v[184:187]
    ds_read_b128 v[236:239], v7 offset:5120
    v_mfma_f32_16x16x32_bf16 v[180:183], a[248:251], v[244:247], v[180:183]
    s_add_u32 s68, s68, 1
    s_waitcnt lgkmcnt(4)
    v_mfma_f32_16x16x32_bf16 v[12:15], a[0:3], v[216:219], 0
    ds_read_b128 v[240:243], v8 offset:4096
    v_mfma_f32_16x16x32_bf16 v[16:19], a[4:7], v[216:219], 0
    s_mov_b32 m0, s70
    v_mfma_f32_16x16x32_bf16 v[24:27], a[4:7], v[220:223], 0
    ds_read_b128 v[244:247], v8 offset:5120
    v_mfma_f32_16x16x32_bf16 v[20:23], a[0:3], v[220:223], 0
    buffer_load_dwordx4 v2, s[8:11], s71 offen offset:0 lds
    s_waitcnt lgkmcnt(4)
    v_mfma_f32_16x16x32_bf16 v[12:15], a[8:11], v[224:227], v[12:15]
    ds_read_b128 v[216:219], v7 offset:8192
    v_mfma_f32_16x16x32_bf16 v[16:19], a[12:15], v[224:227], v[16:19]
    s_add_u32 m0, m0, 3968
    v_cvt_pk_bf16_f32 v172, v172, v173
    v_mfma_f32_16x16x32_bf16 v[24:27], a[12:15], v[228:231], v[24:27]
    ds_read_b128 v[220:223], v7 offset:9216
    v_mfma_f32_16x16x32_bf16 v[20:23], a[8:11], v[228:231], v[20:23]
    buffer_load_dwordx4 v2, s[8:11], s71 offen offset:128 lds
    s_waitcnt lgkmcnt(4)
    v_mfma_f32_16x16x32_bf16 v[12:15], a[16:19], v[232:235], v[12:15]
    ds_read_b128 v[224:227], v8 offset:8192
    v_mfma_f32_16x16x32_bf16 v[16:19], a[20:23], v[232:235], v[16:19]
    s_add_u32 m0, m0, 3968
    v_cvt_pk_bf16_f32 v173, v174, v175
    v_mfma_f32_16x16x32_bf16 v[24:27], a[20:23], v[236:239], v[24:27]
    ds_read_b128 v[228:231], v8 offset:9216
    v_mfma_f32_16x16x32_bf16 v[20:23], a[16:19], v[236:239], v[20:23]
    buffer_load_dwordx4 v2, s[8:11], s71 offen offset:256 lds
    s_waitcnt lgkmcnt(4)
    v_mfma_f32_16x16x32_bf16 v[12:15], a[24:27], v[240:243], v[12:15]
    ds_read_b128 v[232:235], v7 offset:12288
    v_mfma_f32_16x16x32_bf16 v[16:19], a[28:31], v[240:243], v[16:19]
    s_add_u32 m0, m0, 3968
    v_cvt_pk_bf16_f32 v174, v176, v177
    v_mfma_f32_16x16x32_bf16 v[24:27], a[28:31], v[244:247], v[24:27]
    ds_read_b128 v[236:239], v7 offset:13312
    v_mfma_f32_16x16x32_bf16 v[20:23], a[24:27], v[244:247], v[20:23]
    buffer_load_dwordx4 v2, s[8:11], s71 offen offset:384 lds
    s_waitcnt lgkmcnt(4)
    v_mfma_f32_16x16x32_bf16 v[12:15], a[32:35], v[216:219], v[12:15]
    ds_read_b128 v[240:243], v8 offset:12288
    v_mfma_f32_16x16x32_bf16 v[16:19], a[36:39], v[216:219], v[16:19]
    s_add_u32 m0, m0, 3968
    v_cvt_pk_bf16_f32 v175, v178, v179
    v_mfma_f32_16x16x32_bf16 v[24:27], a[36:39], v[220:223], v[24:27]
    ds_read_b128 v[244:247], v8 offset:13312
    v_mfma_f32_16x16x32_bf16 v[20:23], a[32:35], v[220:223], v[20:23]
    buffer_load_dwordx4 v2, s[8:11], s71 offen offset:512 lds
    s_waitcnt lgkmcnt(4)
    v_mfma_f32_16x16x32_bf16 v[12:15], a[40:43], v[224:227], v[12:15]
    ds_read_b128 v[216:219], v7 offset:16384
    v_mfma_f32_16x16x32_bf16 v[16:19], a[44:47], v[224:227], v[16:19]
    s_add_u32 m0, m0, 3968
    v_cvt_pk_bf16_f32 v176, v180, v181
    v_mfma_f32_16x16x32_bf16 v[24:27], a[44:47], v[228:231], v[24:27]
    ds_read_b128 v[220:223], v7 offset:17408
    v_mfma_f32_16x16x32_bf16 v[20:23], a[40:43], v[228:231], v[20:23]
    buffer_load_dwordx4 v2, s[8:11], s71 offen offset:640 lds
    s_waitcnt lgkmcnt(4)
    v_mfma_f32_16x16x32_bf16 v[12:15], a[48:51], v[232:235], v[12:15]
    ds_read_b128 v[224:227], v8 offset:16384
    v_mfma_f32_16x16x32_bf16 v[16:19], a[52:55], v[232:235], v[16:19]
    s_add_u32 m0, m0, 3968
    v_cvt_pk_bf16_f32 v177, v182, v183
    v_mfma_f32_16x16x32_bf16 v[24:27], a[52:55], v[236:239], v[24:27]
    ds_read_b128 v[228:231], v8 offset:17408
    v_mfma_f32_16x16x32_bf16 v[20:23], a[48:51], v[236:239], v[20:23]
    buffer_load_dwordx4 v2, s[8:11], s71 offen offset:768 lds
    s_waitcnt lgkmcnt(4)
    v_mfma_f32_16x16x32_bf16 v[12:15], a[56:59], v[240:243], v[12:15]
    ds_read_b128 v[232:235], v7 offset:20480
    v_mfma_f32_16x16x32_bf16 v[16:19], a[60:63], v[240:243], v[16:19]
    s_add_u32 m0, m0, 3968
    v_cvt_pk_bf16_f32 v178, v184, v185
    v_mfma_f32_16x16x32_bf16 v[24:27], a[60:63], v[244:247], v[24:27]
    ds_read_b128 v[236:239], v7 offset:21504
    v_mfma_f32_16x16x32_bf16 v[20:23], a[56:59], v[244:247], v[20:23]
    buffer_load_dwordx4 v2, s[8:11], s71 offen offset:896 lds
    s_waitcnt lgkmcnt(4)
    v_mfma_f32_16x16x32_bf16 v[12:15], a[64:67], v[216:219], v[12:15]
    ds_read_b128 v[240:243], v8 offset:20480
    v_mfma_f32_16x16x32_bf16 v[16:19], a[68:71], v[216:219], v[16:19]
    s_add_u32 m0, m0, 3968
    v_cvt_pk_bf16_f32 v179, v186, v187
    v_mfma_f32_16x16x32_bf16 v[24:27], a[68:71], v[220:223], v[24:27]
    ds_read_b128 v[244:247], v8 offset:21504
    v_mfma_f32_16x16x32_bf16 v[20:23], a[64:67], v[220:223], v[20:23]
    buffer_load_dwordx4 v2, s[8:11], s71 offen offset:1024 lds
    s_waitcnt lgkmcnt(4)
    v_mfma_f32_16x16x32_bf16 v[12:15], a[72:75], v[224:227], v[12:15]
    ds_read_b128 v[216:219], v7 offset:24576
    v_mfma_f32_16x16x32_bf16 v[16:19], a[76:79], v[224:227], v[16:19]
    s_add_u32 m0, m0, 3968
    ds_write_b128 v28, v[172:175] offset:8192
    v_mfma_f32_16x16x32_bf16 v[24:27], a[76:79], v[228:231], v[24:27]
    ds_read_b128 v[220:223], v7 offset:25600
    v_mfma_f32_16x16x32_bf16 v[20:23], a[72:75], v[228:231], v[20:23]
    buffer_load_dwordx4 v2, s[8:11], s71 offen offset:1152 lds
    s_waitcnt lgkmcnt(5)
    v_mfma_f32_16x16x32_bf16 v[12:15], a[80:83], v[232:235], v[12:15]
    ds_read_b128 v[224:227], v8 offset:24576
    v_mfma_f32_16x16x32_bf16 v[16:19], a[84:87], v[232:235], v[16:19]
    s_add_u32 m0, m0, 3968
    ds_write_b128 v28, v[176:179] offset:8320
    v_mfma_f32_16x16x32_bf16 v[24:27], a[84:87], v[236:239], v[24:27]
    ds_read_b128 v[228:231], v8 offset:25600
    v_mfma_f32_16x16x32_bf16 v[20:23], a[80:83], v[236:239], v[20:23]
    buffer_load_dwordx4 v2, s[8:11], s71 offen offset:1280 lds
    s_waitcnt lgkmcnt(6)
    v_mfma_f32_16x16x32_bf16 v[12:15], a[88:91], v[240:243], v[12:15]
    ds_read_b128 v[232:235], v7 offset:28672
    v_mfma_f32_16x16x32_bf16 v[16:19], a[92:95], v[240:243], v[16:19]
    s_add_u32 m0, m0, 3968
    v_mfma_f32_16x16x32_bf16 v[24:27], a[92:95], v[244:247], v[24:27]
    ds_read_b128 v[236:239], v7 offset:29696
    v_mfma_f32_16x16x32_bf16 v[20:23], a[88:91], v[244:247], v[20:23]
    buffer_load_dwordx4 v2, s[8:11], s71 offen offset:1408 lds
    s_waitcnt lgkmcnt(5)
    v_mfma_f32_16x16x32_bf16 v[12:15], a[96:99], v[216:219], v[12:15]
    ds_read_b128 v[240:243], v8 offset:28672
    v_mfma_f32_16x16x32_bf16 v[16:19], a[100:103], v[216:219], v[16:19]
    s_add_u32 m0, m0, 3968
    v_mfma_f32_16x16x32_bf16 v[24:27], a[100:103], v[220:223], v[24:27]
    ds_read_b128 v[244:247], v8 offset:29696
    v_mfma_f32_16x16x32_bf16 v[20:23], a[96:99], v[220:223], v[20:23]
    buffer_load_dwordx4 v2, s[8:11], s71 offen offset:1536 lds
    s_waitcnt lgkmcnt(4)
    v_mfma_f32_16x16x32_bf16 v[12:15], a[104:107], v[224:227], v[12:15]
    ds_read_b128 v[216:219], v7 offset:32768
    v_mfma_f32_16x16x32_bf16 v[16:19], a[108:111], v[224:227], v[16:19]
    s_add_u32 m0, m0, 3968
    v_mfma_f32_16x16x32_bf16 v[24:27], a[108:111], v[228:231], v[24:27]
    ds_read_b128 v[220:223], v7 offset:33792
    v_mfma_f32_16x16x32_bf16 v[20:23], a[104:107], v[228:231], v[20:23]
    buffer_load_dwordx4 v2, s[8:11], s71 offen offset:1664 lds
    s_waitcnt lgkmcnt(4)
    v_mfma_f32_16x16x32_bf16 v[12:15], a[112:115], v[232:235], v[12:15]
    ds_read_b128 v[224:227], v8 offset:32768
    v_mfma_f32_16x16x32_bf16 v[16:19], a[116:119], v[232:235], v[16:19]
    s_add_u32 m0, m0, 3968
    v_mfma_f32_16x16x32_bf16 v[24:27], a[116:119], v[236:239], v[24:27]
    ds_read_b128 v[228:231], v8 offset:33792
    v_mfma_f32_16x16x32_bf16 v[20:23], a[112:115], v[236:239], v[20:23]
    buffer_load_dwordx4 v2, s[8:11], s71 offen offset:1792 lds
    s_waitcnt lgkmcnt(4)
    v_mfma_f32_16x16x32_bf16 v[12:15], a[120:123], v[240:243], v[12:15]
    ds_read_b128 v[232:235], v7 offset:36864
    v_mfma_f32_16x16x32_bf16 v[16:19], a[124:127], v[240:243], v[16:19]
    s_add_u32 m0, m0, 3968
    v_mfma_f32_16x16x32_bf16 v[24:27], a[124:127], v[244:247], v[24:27]
    ds_read_b128 v[236:239], v7 offset:37888
    v_mfma_f32_16x16x32_bf16 v[20:23], a[120:123], v[244:247], v[20:23]
    buffer_load_dwordx4 v2, s[8:11], s71 offen offset:1920 lds
    s_waitcnt lgkmcnt(4)
    v_mfma_f32_16x16x32_bf16 v[12:15], a[128:131], v[216:219], v[12:15]
    ds_read_b128 v[240:243], v8 offset:36864
    v_mfma_f32_16x16x32_bf16 v[16:19], a[132:135], v[216:219], v[16:19]
    s_waitcnt vmcnt(16)
    v_cmp_ge_u32 vcc, s73, v34
    s_nop 0
    s_and_b32 s64, vcc_lo, 0xff
    s_cselect_b32 s64, 2147483648, 0
    s_or_b32 s79, s79, s64
    s_or_b32 s80, s80, s64
    s_or_b32 s81, s81, s64
    s_or_b32 s76, s76, s64
    v_mfma_f32_16x16x32_bf16 v[24:27], a[132:135], v[220:223], v[24:27]
    ds_read_b128 v[244:247], v8 offset:37888
    v_mfma_f32_16x16x32_bf16 v[20:23], a[128:131], v[220:223], v[20:23]
    buffer_load_dwordx4 v[108:111], v30, s[4:7], s79 offen offset:0 sc1
    s_waitcnt lgkmcnt(4)
    v_mfma_f32_16x16x32_bf16 v[12:15], a[136:139], v[224:227], v[12:15]
    ds_read_b128 v[216:219], v7 offset:40960
    v_mfma_f32_16x16x32_bf16 v[16:19], a[140:143], v[224:227], v[16:19]
    v_mfma_f32_16x16x32_bf16 v[24:27], a[140:143], v[228:231], v[24:27]
    ds_read_b128 v[220:223], v7 offset:41984
    v_mfma_f32_16x16x32_bf16 v[20:23], a[136:139], v[228:231], v[20:23]
    buffer_load_dwordx4 v[112:115], v30, s[4:7], s79 offen offset:1024 sc1
    s_waitcnt lgkmcnt(4)
    v_mfma_f32_16x16x32_bf16 v[12:15], a[144:147], v[232:235], v[12:15]
    ds_read_b128 v[224:227], v8 offset:40960
    v_mfma_f32_16x16x32_bf16 v[16:19], a[148:151], v[232:235], v[16:19]
    v_mfma_f32_16x16x32_bf16 v[24:27], a[148:151], v[236:239], v[24:27]
    ds_read_b128 v[228:231], v8 offset:41984
    v_mfma_f32_16x16x32_bf16 v[20:23], a[144:147], v[236:239], v[20:23]
    buffer_load_dwordx4 v[116:119], v30, s[4:7], s79 offen offset:2048 sc1
    s_waitcnt lgkmcnt(4)
    v_mfma_f32_16x16x32_bf16 v[12:15], a[152:155], v[240:243], v[12:15]
    ds_read_b128 v[232:235], v7 offset:45056
    v_mfma_f32_16x16x32_bf16 v[16:19], a[156:159], v[240:243], v[16:19]
    v_mfma_f32_16x16x32_bf16 v[24:27], a[156:159], v[244:247], v[24:27]
    ds_read_b128 v[236:239], v7 offset:46080
    v_mfma_f32_16x16x32_bf16 v[20:23], a[152:155], v[244:247], v[20:23]
    buffer_load_dwordx4 v[120:123], v30, s[4:7], s79 offen offset:3072 sc1
    s_waitcnt lgkmcnt(4)
    v_mfma_f32_16x16x32_bf16 v[12:15], a[160:163], v[216:219], v[12:15]
    ds_read_b128 v[240:243], v8 offset:45056
    v_mfma_f32_16x16x32_bf16 v[16:19], a[164:167], v[216:219], v[16:19]
    v_mfma_f32_16x16x32_bf16 v[24:27], a[164:167], v[220:223], v[24:27]
    ds_read_b128 v[244:247], v8 offset:46080
    v_mfma_f32_16x16x32_bf16 v[20:23], a[160:163], v[220:223], v[20:23]
    buffer_load_dword v6, v5, s[8:11], s71 offen
    s_waitcnt lgkmcnt(4)
    v_mfma_f32_16x16x32_bf16 v[12:15], a[168:171], v[224:227], v[12:15]
    ds_read_b128 v[216:219], v7 offset:49152
    v_mfma_f32_16x16x32_bf16 v[16:19], a[172:175], v[224:227], v[16:19]
    v_mfma_f32_16x16x32_bf16 v[24:27], a[172:175], v[228:231], v[24:27]
    ds_read_b128 v[220:223], v7 offset:50176
    v_mfma_f32_16x16x32_bf16 v[20:23], a[168:171], v[228:231], v[20:23]
    buffer_load_dword v6, v1, s[4:7], s83 offen sc1
    s_waitcnt lgkmcnt(4)
    v_mfma_f32_16x16x32_bf16 v[12:15], a[176:179], v[232:235], v[12:15]
    ds_read_b128 v[224:227], v8 offset:49152
    v_mfma_f32_16x16x32_bf16 v[16:19], a[180:183], v[232:235], v[16:19]
    v_mfma_f32_16x16x32_bf16 v[24:27], a[180:183], v[236:239], v[24:27]
    ds_read_b128 v[228:231], v8 offset:50176
    v_mfma_f32_16x16x32_bf16 v[20:23], a[176:179], v[236:239], v[20:23]
    s_waitcnt lgkmcnt(4)
    v_mfma_f32_16x16x32_bf16 v[12:15], a[184:187], v[240:243], v[12:15]
    ds_read_b128 v[232:235], v7 offset:53248
    v_mfma_f32_16x16x32_bf16 v[16:19], a[188:191], v[240:243], v[16:19]
    v_mfma_f32_16x16x32_bf16 v[24:27], a[188:191], v[244:247], v[24:27]
    ds_read_b128 v[236:239], v7 offset:54272
    v_mfma_f32_16x16x32_bf16 v[20:23], a[184:187], v[244:247], v[20:23]
    s_waitcnt lgkmcnt(4)
    v_mfma_f32_16x16x32_bf16 v[12:15], a[192:195], v[216:219], v[12:15]
    ds_read_b128 v[240:243], v8 offset:53248
    v_mfma_f32_16x16x32_bf16 v[16:19], a[196:199], v[216:219], v[16:19]
    v_mfma_f32_16x16x32_bf16 v[24:27], a[196:199], v[220:223], v[24:27]
    ds_read_b128 v[244:247], v8 offset:54272
    v_mfma_f32_16x16x32_bf16 v[20:23], a[192:195], v[220:223], v[20:23]
    s_waitcnt lgkmcnt(4)
    v_mfma_f32_16x16x32_bf16 v[12:15], a[200:203], v[224:227], v[12:15]
    ds_read_b128 v[216:219], v7 offset:57344
    v_mfma_f32_16x16x32_bf16 v[16:19], a[204:207], v[224:227], v[16:19]
    v_mfma_f32_16x16x32_bf16 v[24:27], a[204:207], v[228:231], v[24:27]
    ds_read_b128 v[220:223], v7 offset:58368
    v_mfma_f32_16x16x32_bf16 v[20:23], a[200:203], v[228:231], v[20:23]
    s_waitcnt lgkmcnt(4)
    v_mfma_f32_16x16x32_bf16 v[12:15], a[208:211], v[232:235], v[12:15]
    ds_read_b128 v[224:227], v8 offset:57344
    v_mfma_f32_16x16x32_bf16 v[16:19], a[212:215], v[232:235], v[16:19]
    v_mfma_f32_16x16x32_bf16 v[24:27], a[212:215], v[236:239], v[24:27]
    ds_read_b128 v[228:231], v8 offset:58368
    v_mfma_f32_16x16x32_bf16 v[20:23], a[208:211], v[236:239], v[20:23]
    s_waitcnt lgkmcnt(4)
    v_mfma_f32_16x16x32_bf16 v[12:15], a[216:219], v[240:243], v[12:15]
    ds_read_b128 v[232:235], v7 offset:61440
    v_mfma_f32_16x16x32_bf16 v[16:19], a[220:223], v[240:243], v[16:19]
    v_mfma_f32_16x16x32_bf16 v[24:27], a[220:223], v[244:247], v[24:27]
    ds_read_b128 v[236:239], v7 offset:62464
    v_mfma_f32_16x16x32_bf16 v[20:23], a[216:219], v[244:247], v[20:23]
    s_waitcnt lgkmcnt(4)
    v_mfma_f32_16x16x32_bf16 v[12:15], a[224:227], v[216:219], v[12:15]
    ds_read_b128 v[240:243], v8 offset:61440
    v_mfma_f32_16x16x32_bf16 v[16:19], a[228:231], v[216:219], v[16:19]
    v_mfma_f32_16x16x32_bf16 v[24:27], a[228:231], v[220:223], v[24:27]
    ds_read_b128 v[244:247], v8 offset:62464
    v_xor_b32 v7, 0x10000, v7
    v_xor_b32 v8, 0x10000, v8
    v_mfma_f32_16x16x32_bf16 v[20:23], a[224:227], v[220:223], v[20:23]
    s_waitcnt vmcnt(6)
    s_barrier
    s_waitcnt lgkmcnt(4)
    v_mfma_f32_16x16x32_bf16 v[12:15], a[232:235], v[224:227], v[12:15]
    ds_read_b128 v[216:219], v7 offset:0
    v_mfma_f32_16x16x32_bf16 v[16:19], a[236:239], v[224:227], v[16:19]
    v_mfma_f32_16x16x32_bf16 v[24:27], a[236:239], v[228:231], v[24:27]
    ds_read_b128 v[220:223], v7 offset:1024
    v_mfma_f32_16x16x32_bf16 v[20:23], a[232:235], v[228:231], v[20:23]
    s_xor_b32 s70, s70, 0x10000
    s_add_u32 s71, s71, 0x10000
    s_waitcnt lgkmcnt(4)
    v_mfma_f32_16x16x32_bf16 v[12:15], a[240:243], v[232:235], v[12:15]
    ds_read_b128 v[224:227], v8 offset:0
    v_mfma_f32_16x16x32_bf16 v[16:19], a[244:247], v[232:235], v[16:19]
    v_mfma_f32_16x16x32_bf16 v[24:27], a[244:247], v[236:239], v[24:27]
    ds_read_b128 v[228:231], v8 offset:1024
    v_mfma_f32_16x16x32_bf16 v[20:23], a[240:243], v[236:239], v[20:23]
    s_waitcnt lgkmcnt(4)
    v_mfma_f32_16x16x32_bf16 v[12:15], a[248:251], v[240:243], v[12:15]
    ds_read_b128 v[232:235], v7 offset:4096
    v_mfma_f32_16x16x32_bf16 v[16:19], a[252:255], v[240:243], v[16:19]
    v_mfma_f32_16x16x32_bf16 v[24:27], a[252:255], v[244:247], v[24:27]
    ds_read_b128 v[236:239], v7 offset:5120
    v_mfma_f32_16x16x32_bf16 v[20:23], a[248:251], v[244:247], v[20:23]
    s_add_u32 s68, s68, 1
    s_waitcnt lgkmcnt(4)
    v_mfma_f32_16x16x32_bf16 v[172:175], a[0:3], v[216:219], 0
    ds_read_b128 v[240:243], v8 offset:4096
    v_mfma_f32_16x16x32_bf16 v[176:179], a[4:7], v[216:219], 0
    s_mov_b32 m0, s70
    v_mfma_f32_16x16x32_bf16 v[184:187], a[4:7], v[220:223], 0
    ds_read_b128 v[244:247], v8 offset:5120
    v_mfma_f32_16x16x32_bf16 v[180:183], a[0:3], v[220:223], 0
    buffer_load_dwordx4 v2, s[8:11], s71 offen offset:0 lds
    s_waitcnt lgkmcnt(4)
    v_mfma_f32_16x16x32_bf16 v[172:175], a[8:11], v[224:227], v[172:175]
    ds_read_b128 v[216:219], v7 offset:8192
    v_mfma_f32_16x16x32_bf16 v[176:179], a[12:15], v[224:227], v[176:179]
    s_add_u32 m0, m0, 3968
    v_cvt_pk_bf16_f32 v12, v12, v13
    v_mfma_f32_16x16x32_bf16 v[184:187], a[12:15], v[228:231], v[184:187]
    ds_read_b128 v[220:223], v7 offset:9216
    v_mfma_f32_16x16x32_bf16 v[180:183], a[8:11], v[228:231], v[180:183]
    buffer_load_dwordx4 v2, s[8:11], s71 offen offset:128 lds
    s_waitcnt lgkmcnt(4)
    v_mfma_f32_16x16x32_bf16 v[172:175], a[16:19], v[232:235], v[172:175]
    ds_read_b128 v[224:227], v8 offset:8192
    v_mfma_f32_16x16x32_bf16 v[176:179], a[20:23], v[232:235], v[176:179]
    s_add_u32 m0, m0, 3968
    v_cvt_pk_bf16_f32 v13, v14, v15
    v_mfma_f32_16x16x32_bf16 v[184:187], a[20:23], v[236:239], v[184:187]
    ds_read_b128 v[228:231], v8 offset:9216
    v_mfma_f32_16x16x32_bf16 v[180:183], a[16:19], v[236:239], v[180:183]
    buffer_load_dwordx4 v2, s[8:11], s71 offen offset:256 lds
    s_waitcnt lgkmcnt(4)
    v_mfma_f32_16x16x32_bf16 v[172:175], a[24:27], v[240:243], v[172:175]
    ds_read_b128 v[232:235], v7 offset:12288
    v_mfma_f32_16x16x32_bf16 v[176:179], a[28:31], v[240:243], v[176:179]
    s_add_u32 m0, m0, 3968
    v_cvt_pk_bf16_f32 v14, v16, v17
    v_mfma_f32_16x16x32_bf16 v[184:187], a[28:31], v[244:247], v[184:187]
    ds_read_b128 v[236:239], v7 offset:13312
    v_mfma_f32_16x16x32_bf16 v[180:183], a[24:27], v[244:247], v[180:183]
    buffer_load_dwordx4 v2, s[8:11], s71 offen offset:384 lds
    s_waitcnt lgkmcnt(4)
    v_mfma_f32_16x16x32_bf16 v[172:175], a[32:35], v[216:219], v[172:175]
    ds_read_b128 v[240:243], v8 offset:12288
    v_mfma_f32_16x16x32_bf16 v[176:179], a[36:39], v[216:219], v[176:179]
    s_add_u32 m0, m0, 3968
    v_cvt_pk_bf16_f32 v15, v18, v19
    v_mfma_f32_16x16x32_bf16 v[184:187], a[36:39], v[220:223], v[184:187]
    ds_read_b128 v[244:247], v8 offset:13312
    v_mfma_f32_16x16x32_bf16 v[180:183], a[32:35], v[220:223], v[180:183]
    buffer_load_dwordx4 v2, s[8:11], s71 offen offset:512 lds
    s_waitcnt lgkmcnt(4)
    v_mfma_f32_16x16x32_bf16 v[172:175], a[40:43], v[224:227], v[172:175]
    ds_read_b128 v[216:219], v7 offset:16384
    v_mfma_f32_16x16x32_bf16 v[176:179], a[44:47], v[224:227], v[176:179]
    s_add_u32 m0, m0, 3968
    v_cvt_pk_bf16_f32 v16, v20, v21
    v_mfma_f32_16x16x32_bf16 v[184:187], a[44:47], v[228:231], v[184:187]
    ds_read_b128 v[220:223], v7 offset:17408
    v_mfma_f32_16x16x32_bf16 v[180:183], a[40:43], v[228:231], v[180:183]
    buffer_load_dwordx4 v2, s[8:11], s71 offen offset:640 lds
    s_waitcnt lgkmcnt(4)
    v_mfma_f32_16x16x32_bf16 v[172:175], a[48:51], v[232:235], v[172:175]
    ds_read_b128 v[224:227], v8 offset:16384
    v_mfma_f32_16x16x32_bf16 v[176:179], a[52:55], v[232:235], v[176:179]
    s_add_u32 m0, m0, 3968
    v_cvt_pk_bf16_f32 v17, v22, v23
    v_mfma_f32_16x16x32_bf16 v[184:187], a[52:55], v[236:239], v[184:187]
    ds_read_b128 v[228:231], v8 offset:17408
    v_mfma_f32_16x16x32_bf16 v[180:183], a[48:51], v[236:239], v[180:183]
    buffer_load_dwordx4 v2, s[8:11], s71 offen offset:768 lds
    s_waitcnt lgkmcnt(4)
    v_mfma_f32_16x16x32_bf16 v[172:175], a[56:59], v[240:243], v[172:175]
    ds_read_b128 v[232:235], v7 offset:20480
    v_mfma_f32_16x16x32_bf16 v[176:179], a[60:63], v[240:243], v[176:179]
    s_add_u32 m0, m0, 3968
    v_cvt_pk_bf16_f32 v18, v24, v25
    v_mfma_f32_16x16x32_bf16 v[184:187], a[60:63], v[244:247], v[184:187]
    ds_read_b128 v[236:239], v7 offset:21504
    v_mfma_f32_16x16x32_bf16 v[180:183], a[56:59], v[244:247], v[180:183]
    buffer_load_dwordx4 v2, s[8:11], s71 offen offset:896 lds
    s_waitcnt lgkmcnt(4)
    v_mfma_f32_16x16x32_bf16 v[172:175], a[64:67], v[216:219], v[172:175]
    ds_read_b128 v[240:243], v8 offset:20480
    v_mfma_f32_16x16x32_bf16 v[176:179], a[68:71], v[216:219], v[176:179]
    s_add_u32 m0, m0, 3968
    v_cvt_pk_bf16_f32 v19, v26, v27
    v_mfma_f32_16x16x32_bf16 v[184:187], a[68:71], v[220:223], v[184:187]
    ds_read_b128 v[244:247], v8 offset:21504
    v_mfma_f32_16x16x32_bf16 v[180:183], a[64:67], v[220:223], v[180:183]
    buffer_load_dwordx4 v2, s[8:11], s71 offen offset:1024 lds
    s_waitcnt lgkmcnt(4)
    v_mfma_f32_16x16x32_bf16 v[172:175], a[72:75], v[224:227], v[172:175]
    ds_read_b128 v[216:219], v7 offset:24576
    v_mfma_f32_16x16x32_bf16 v[176:179], a[76:79], v[224:227], v[176:179]
    s_add_u32 m0, m0, 3968
    ds_write_b128 v28, v[12:15] offset:16384
    v_mfma_f32_16x16x32_bf16 v[184:187], a[76:79], v[228:231], v[184:187]
    ds_read_b128 v[220:223], v7 offset:25600
    v_mfma_f32_16x16x32_bf16 v[180:183], a[72:75], v[228:231], v[180:183]
    buffer_load_dwordx4 v2, s[8:11], s71 offen offset:1152 lds
    s_waitcnt lgkmcnt(5)
    v_mfma_f32_16x16x32_bf16 v[172:175], a[80:83], v[232:235], v[172:175]
    ds_read_b128 v[224:227], v8 offset:24576
    v_mfma_f32_16x16x32_bf16 v[176:179], a[84:87], v[232:235], v[176:179]
    s_add_u32 m0, m0, 3968
    ds_write_b128 v28, v[16:19] offset:16512
    v_mfma_f32_16x16x32_bf16 v[184:187], a[84:87], v[236:239], v[184:187]
    ds_read_b128 v[228:231], v8 offset:25600
    v_mfma_f32_16x16x32_bf16 v[180:183], a[80:83], v[236:239], v[180:183]
    buffer_load_dwordx4 v2, s[8:11], s71 offen offset:1280 lds
    s_waitcnt lgkmcnt(6)
    v_mfma_f32_16x16x32_bf16 v[172:175], a[88:91], v[240:243], v[172:175]
    ds_read_b128 v[232:235], v7 offset:28672
    v_mfma_f32_16x16x32_bf16 v[176:179], a[92:95], v[240:243], v[176:179]
    s_add_u32 m0, m0, 3968
    v_mfma_f32_16x16x32_bf16 v[184:187], a[92:95], v[244:247], v[184:187]
    ds_read_b128 v[236:239], v7 offset:29696
    v_mfma_f32_16x16x32_bf16 v[180:183], a[88:91], v[244:247], v[180:183]
    buffer_load_dwordx4 v2, s[8:11], s71 offen offset:1408 lds
    s_waitcnt lgkmcnt(5)
    v_mfma_f32_16x16x32_bf16 v[172:175], a[96:99], v[216:219], v[172:175]
    ds_read_b128 v[240:243], v8 offset:28672
    v_mfma_f32_16x16x32_bf16 v[176:179], a[100:103], v[216:219], v[176:179]
    s_add_u32 m0, m0, 3968
    v_mfma_f32_16x16x32_bf16 v[184:187], a[100:103], v[220:223], v[184:187]
    ds_read_b128 v[244:247], v8 offset:29696
    v_mfma_f32_16x16x32_bf16 v[180:183], a[96:99], v[220:223], v[180:183]
    buffer_load_dwordx4 v2, s[8:11], s71 offen offset:1536 lds
    s_waitcnt lgkmcnt(4)
    v_mfma_f32_16x16x32_bf16 v[172:175], a[104:107], v[224:227], v[172:175]
    ds_read_b128 v[216:219], v7 offset:32768
    v_mfma_f32_16x16x32_bf16 v[176:179], a[108:111], v[224:227], v[176:179]
    s_add_u32 m0, m0, 3968
    v_mfma_f32_16x16x32_bf16 v[184:187], a[108:111], v[228:231], v[184:187]
    ds_read_b128 v[220:223], v7 offset:33792
    v_mfma_f32_16x16x32_bf16 v[180:183], a[104:107], v[228:231], v[180:183]
    buffer_load_dwordx4 v2, s[8:11], s71 offen offset:1664 lds
    s_waitcnt lgkmcnt(4)
    v_mfma_f32_16x16x32_bf16 v[172:175], a[112:115], v[232:235], v[172:175]
    ds_read_b128 v[224:227], v8 offset:32768
    v_mfma_f32_16x16x32_bf16 v[176:179], a[116:119], v[232:235], v[176:179]
    s_add_u32 m0, m0, 3968
    v_mfma_f32_16x16x32_bf16 v[184:187], a[116:119], v[236:239], v[184:187]
    ds_read_b128 v[228:231], v8 offset:33792
    v_mfma_f32_16x16x32_bf16 v[180:183], a[112:115], v[236:239], v[180:183]
    buffer_load_dwordx4 v2, s[8:11], s71 offen offset:1792 lds
    s_waitcnt lgkmcnt(4)
    v_mfma_f32_16x16x32_bf16 v[172:175], a[120:123], v[240:243], v[172:175]
    ds_read_b128 v[232:235], v7 offset:36864
    v_mfma_f32_16x16x32_bf16 v[176:179], a[124:127], v[240:243], v[176:179]
    s_add_u32 m0, m0, 3968
    v_mfma_f32_16x16x32_bf16 v[184:187], a[124:127], v[244:247], v[184:187]
    ds_read_b128 v[236:239], v7 offset:37888
    v_mfma_f32_16x16x32_bf16 v[180:183], a[120:123], v[244:247], v[180:183]
    buffer_load_dwordx4 v2, s[8:11], s71 offen offset:1920 lds
    s_waitcnt lgkmcnt(4)
    v_mfma_f32_16x16x32_bf16 v[172:175], a[128:131], v[216:219], v[172:175]
    ds_read_b128 v[240:243], v8 offset:36864
    v_mfma_f32_16x16x32_bf16 v[176:179], a[132:135], v[216:219], v[176:179]
    v_cndmask_b32 v12, 0, v248, s[16:17]
    v_cndmask_b32 v13, 0, v248, s[18:19]
    v_mfma_f32_16x16x32_bf16 v[184:187], a[132:135], v[220:223], v[184:187]
    ds_read_b128 v[244:247], v8 offset:37888
    v_mfma_f32_16x16x32_bf16 v[180:183], a[128:131], v[220:223], v[180:183]
    buffer_load_dwordx4 v[124:127], v30, s[4:7], s80 offen offset:0 sc1
    s_waitcnt lgkmcnt(4)
    v_mfma_f32_16x16x32_bf16 v[172:175], a[136:139], v[224:227], v[172:175]
    ds_read_b128 v[216:219], v7 offset:40960
    v_mfma_f32_16x16x32_bf16 v[176:179], a[140:143], v[224:227], v[176:179]
    v_cndmask_b32 v14, 0, v248, s[20:21]
    v_cndmask_b32 v15, 0, v248, s[22:23]
    v_mfma_f32_16x16x32_bf16 v[184:187], a[140:143], v[228:231], v[184:187]
    ds_read_b128 v[220:223], v7 offset:41984
    v_mfma_f32_16x16x32_bf16 v[180:183], a[136:139], v[228:231], v[180:183]
    buffer_load_dwordx4 v[128:131], v30, s[4:7], s80 offen offset:1024 sc1
    s_waitcnt lgkmcnt(4)
    v_mfma_f32_16x16x32_bf16 v[172:175], a[144:147], v[232:235], v[172:175]
    ds_read_b128 v[224:227], v8 offset:40960
    v_mfma_f32_16x16x32_bf16 v[176:179], a[148:151], v[232:235], v[176:179]
    v_cndmask_b32 v16, 0, v248, s[24:25]
    v_cndmask_b32 v17, 0, v248, s[26:27]
    v_mfma_f32_16x16x32_bf16 v[184:187], a[148:151], v[236:239], v[184:187]
    ds_read_b128 v[228:231], v8 offset:41984
    v_mfma_f32_16x16x32_bf16 v[180:183], a[144:147], v[236:239], v[180:183]
    buffer_load_dwordx4 v[132:135], v30, s[4:7], s80 offen offset:2048 sc1
    s_waitcnt lgkmcnt(4)
    v_mfma_f32_16x16x32_bf16 v[172:175], a[152:155], v[240:243], v[172:175]
    ds_read_b128 v[232:235], v7 offset:45056
    v_mfma_f32_16x16x32_bf16 v[176:179], a[156:159], v[240:243], v[176:179]
    v_cndmask_b32 v18, 0, v248, s[28:29]
    v_cndmask_b32 v19, 0, v248, s[30:31]
    v_mfma_f32_16x16x32_bf16 v[184:187], a[156:159], v[244:247], v[184:187]
    ds_read_b128 v[236:239], v7 offset:46080
    v_mfma_f32_16x16x32_bf16 v[180:183], a[152:155], v[244:247], v[180:183]
    buffer_load_dwordx4 v[136:139], v30, s[4:7], s80 offen offset:3072 sc1
    s_waitcnt lgkmcnt(4)
    v_mfma_f32_16x16x32_bf16 v[172:175], a[160:163], v[216:219], v[172:175]
    ds_read_b128 v[240:243], v8 offset:45056
    v_mfma_f32_16x16x32_bf16 v[176:179], a[164:167], v[216:219], v[176:179]
    v_cndmask_b32 v20, 0, v248, s[32:33]
    v_cndmask_b32 v21, 0, v248, s[34:35]
    v_mfma_f32_16x16x32_bf16 v[184:187], a[164:167], v[220:223], v[184:187]
    ds_read_b128 v[244:247], v8 offset:46080
    v_mfma_f32_16x16x32_bf16 v[180:183], a[160:163], v[220:223], v[180:183]
    buffer_load_dword v6, v5, s[8:11], s71 offen
    s_waitcnt lgkmcnt(4)
    v_mfma_f32_16x16x32_bf16 v[172:175], a[168:171], v[224:227], v[172:175]
    ds_read_b128 v[216:219], v7 offset:49152
    v_mfma_f32_16x16x32_bf16 v[176:179], a[172:175], v[224:227], v[176:179]
    v_cndmask_b32 v22, 0, v248, s[36:37]
    v_cndmask_b32 v23, 0, v248, s[38:39]
    v_mfma_f32_16x16x32_bf16 v[184:187], a[172:175], v[228:231], v[184:187]
    ds_read_b128 v[220:223], v7 offset:50176
    v_mfma_f32_16x16x32_bf16 v[180:183], a[168:171], v[228:231], v[180:183]
    s_waitcnt lgkmcnt(4)
    v_mfma_f32_16x16x32_bf16 v[172:175], a[176:179], v[232:235], v[172:175]
    ds_read_b128 v[224:227], v8 offset:49152
    v_mfma_f32_16x16x32_bf16 v[176:179], a[180:183], v[232:235], v[176:179]
    v_cndmask_b32 v24, 0, v248, s[40:41]
    v_cndmask_b32 v25, 0, v248, s[42:43]
    buffer_load_dwordx4 v[140:143], v31, s[4:7], s81 offen offset:0 sc1
    v_mfma_f32_16x16x32_bf16 v[184:187], a[180:183], v[236:239], v[184:187]
    ds_read_b128 v[228:231], v8 offset:50176
    v_mfma_f32_16x16x32_bf16 v[180:183], a[176:179], v[236:239], v[180:183]
    buffer_load_dwordx4 v[144:147], v31, s[4:7], s81 offen offset:256 sc1
    s_waitcnt lgkmcnt(4)
    v_mfma_f32_16x16x32_bf16 v[172:175], a[184:187], v[240:243], v[172:175]
    ds_read_b128 v[232:235], v7 offset:53248
    v_mfma_f32_16x16x32_bf16 v[176:179], a[188:191], v[240:243], v[176:179]
    v_cndmask_b32 v26, 0, v248, s[52:53]
    v_cndmask_b32 v27, 0, v248, s[54:55]
    buffer_load_dwordx4 v[148:151], v31, s[4:7], s81 offen offset:1024 sc1
    v_mfma_f32_16x16x32_bf16 v[184:187], a[188:191], v[244:247], v[184:187]
    ds_read_b128 v[236:239], v7 offset:54272
    v_mfma_f32_16x16x32_bf16 v[180:183], a[184:187], v[244:247], v[180:183]
    buffer_load_dwordx4 v[152:155], v31, s[4:7], s81 offen offset:1280 sc1
    s_waitcnt lgkmcnt(4)
    v_mfma_f32_16x16x32_bf16 v[172:175], a[192:195], v[216:219], v[172:175]
    ds_read_b128 v[240:243], v8 offset:53248
    v_mfma_f32_16x16x32_bf16 v[176:179], a[196:199], v[216:219], v[176:179]
    buffer_load_dwordx4 v[156:159], v31, s[4:7], s81 offen offset:2048 sc1
    v_mfma_f32_16x16x32_bf16 v[184:187], a[196:199], v[220:223], v[184:187]
    ds_read_b128 v[244:247], v8 offset:54272
    v_mfma_f32_16x16x32_bf16 v[180:183], a[192:195], v[220:223], v[180:183]
    buffer_load_dwordx4 v[160:163], v31, s[4:7], s81 offen offset:2304 sc1
    s_waitcnt lgkmcnt(4)
    v_mfma_f32_16x16x32_bf16 v[172:175], a[200:203], v[224:227], v[172:175]
    ds_read_b128 v[216:219], v7 offset:57344
    v_mfma_f32_16x16x32_bf16 v[176:179], a[204:207], v[224:227], v[176:179]
    buffer_load_dwordx4 v[164:167], v31, s[4:7], s81 offen offset:3072 sc1
    v_mfma_f32_16x16x32_bf16 v[184:187], a[204:207], v[228:231], v[184:187]
    ds_read_b128 v[220:223], v7 offset:58368
    v_mfma_f32_16x16x32_bf16 v[180:183], a[200:203], v[228:231], v[180:183]
    buffer_load_dwordx4 v[168:171], v31, s[4:7], s81 offen offset:3328 sc1
    s_waitcnt lgkmcnt(4)
    v_mfma_f32_16x16x32_bf16 v[172:175], a[208:211], v[232:235], v[172:175]
    ds_read_b128 v[224:227], v8 offset:57344
    v_mfma_f32_16x16x32_bf16 v[176:179], a[212:215], v[232:235], v[176:179]
    buffer_load_dwordx2 v[188:189], v32, s[4:7], s81 offen offset:512 sc1
    v_mfma_f32_16x16x32_bf16 v[184:187], a[212:215], v[236:239], v[184:187]
    ds_read_b128 v[228:231], v8 offset:58368
    v_mfma_f32_16x16x32_bf16 v[180:183], a[208:211], v[236:239], v[180:183]
    buffer_load_dwordx2 v[192:193], v32, s[4:7], s81 offen offset:1536 sc1
    s_waitcnt lgkmcnt(4)
    v_mfma_f32_16x16x32_bf16 v[172:175], a[216:219], v[240:243], v[172:175]
    ds_read_b128 v[232:235], v7 offset:61440
    v_mfma_f32_16x16x32_bf16 v[176:179], a[220:223], v[240:243], v[176:179]
    buffer_load_dwordx2 v[196:197], v32, s[4:7], s81 offen offset:2560 sc1
    v_mfma_f32_16x16x32_bf16 v[184:187], a[220:223], v[244:247], v[184:187]
    ds_read_b128 v[236:239], v7 offset:62464
    v_mfma_f32_16x16x32_bf16 v[180:183], a[216:219], v[244:247], v[180:183]
    buffer_load_dwordx2 v[200:201], v32, s[4:7], s81 offen offset:3584 sc1
    s_waitcnt lgkmcnt(4)
    v_mfma_f32_16x16x32_bf16 v[172:175], a[224:227], v[216:219], v[172:175]
    ds_read_b128 v[240:243], v8 offset:61440
    v_mfma_f32_16x16x32_bf16 v[176:179], a[228:231], v[216:219], v[176:179]
    v_mfma_f32_16x16x32_bf16 v[184:187], a[228:231], v[220:223], v[184:187]
    ds_read_b128 v[244:247], v8 offset:62464
    v_xor_b32 v7, 0x10000, v7
    v_xor_b32 v8, 0x10000, v8
    v_mfma_f32_16x16x32_bf16 v[180:183], a[224:227], v[220:223], v[180:183]
    s_waitcnt vmcnt(17)
    s_barrier
    s_waitcnt lgkmcnt(4)
    v_mfma_f32_16x16x32_bf16 v[172:175], a[232:235], v[224:227], v[172:175]
    ds_read_b128 v[216:219], v7 offset:0
    v_mfma_f32_16x16x32_bf16 v[176:179], a[236:239], v[224:227], v[176:179]
    v_mfma_f32_16x16x32_bf16 v[184:187], a[236:239], v[228:231], v[184:187]
    ds_read_b128 v[220:223], v7 offset:1024
    v_mfma_f32_16x16x32_bf16 v[180:183], a[232:235], v[228:231], v[180:183]
    s_xor_b32 s70, s70, 0x10000
    s_add_u32 s71, s71, 0x10000
    s_waitcnt lgkmcnt(4)
    v_mfma_f32_16x16x32_bf16 v[172:175], a[240:243], v[232:235], v[172:175]
    ds_read_b128 v[224:227], v8 offset:0
    v_mfma_f32_16x16x32_bf16 v[176:179], a[244:247], v[232:235], v[176:179]
    v_mfma_f32_16x16x32_bf16 v[184:187], a[244:247], v[236:239], v[184:187]
    ds_read_b128 v[228:231], v8 offset:1024
    v_mfma_f32_16x16x32_bf16 v[180:183], a[240:243], v[236:239], v[180:183]
    s_waitcnt lgkmcnt(4)
    v_mfma_f32_16x16x32_bf16 v[172:175], a[248:251], v[240:243], v[172:175]
    ds_read_b128 v[232:235], v7 offset:4096
    v_mfma_f32_16x16x32_bf16 v[176:179], a[252:255], v[240:243], v[176:179]
    v_mfma_f32_16x16x32_bf16 v[184:187], a[252:255], v[244:247], v[184:187]
    ds_read_b128 v[236:239], v7 offset:5120
    v_mfma_f32_16x16x32_bf16 v[180:183], a[248:251], v[244:247], v[180:183]
    s_add_u32 s68, s68, 1
    s_waitcnt vmcnt(12)
    v_mfma_f32_32x32x16_bf16 v[12:27], v[76:79], v[44:47], v[12:27]
    v_mfma_f32_32x32x16_bf16 v[12:27], v[80:83], v[48:51], v[12:27]
    v_cvt_pk_bf16_f32 v172, v172, v173
    v_cvt_pk_bf16_f32 v173, v174, v175
    v_cvt_pk_bf16_f32 v174, v176, v177
    v_cvt_pk_bf16_f32 v175, v178, v179
    v_mfma_f32_32x32x16_bf16 v[12:27], v[84:87], v[52:55], v[12:27]
    v_cvt_pk_bf16_f32 v176, v180, v181
    v_cvt_pk_bf16_f32 v177, v182, v183
    v_cvt_pk_bf16_f32 v178, v184, v185
    v_cvt_pk_bf16_f32 v179, v186, v187
    v_mfma_f32_32x32x16_bf16 v[12:27], v[88:91], v[56:59], v[12:27]
    ds_write_b128 v28, v[172:175] offset:24576
    ds_write_b128 v28, v[176:179] offset:24704
    v_mfma_f32_32x32x16_bf16 v[12:27], v[92:95], v[60:63], v[12:27]
    v_mfma_f32_32x32x16_bf16 v[12:27], v[96:99], v[64:67], v[12:27]
    v_mfma_f32_32x32x16_bf16 v[12:27], v[100:103], v[68:71], v[12:27]
    v_mfma_f32_32x32x16_bf16 v[12:27], v[104:107], v[72:75], v[12:27]
    s_waitcnt lgkmcnt(0)
    s_barrier
    s_cmp_eq_u32 s76, 0
    s_cbranch_scc1 L_q_chk
    s_cmp_lt_i32 s73, 0
    s_cbranch_scc0 L_q_block
    ds_read_b128 v[44:47], v29 offset:0
    ds_read_b128 v[48:51], v29 offset:1024
    ds_read_b128 v[52:55], v29 offset:2048
    ds_read_b128 v[56:59], v29 offset:3072
    ds_read_b128 v[60:63], v29 offset:4096
    ds_read_b128 v[64:67], v29 offset:5120
    ds_read_b128 v[68:71], v29 offset:6144
    ds_read_b128 v[72:75], v29 offset:7168
    buffer_load_dword v34, v33, s[4:7], 0 offen sc1
    s_branch L_q_next
L_q_block:
    s_lshl_b32 s77, s73, 11
    s_and_b32 s77, s77, 0x2000
    s_xor_b32 s77, s77, s100
    s_lshl_b32 s67, s73, 19
    s_or_b32 s77, s77, s67
    s_lshl_b32 s81, s73, 10
    s_and_b32 s81, s81, 0x2000
    s_xor_b32 s81, s81, s100
    s_lshl_b32 s67, s73, 18
    s_or_b32 s81, s81, s67
    s_add_u32 s78, s77, 4096
    s_or_b32 s79, s77, 33554432
    s_or_b32 s80, s78, 33554432
    v_cmp_ge_u32 vcc, s73, v34
    s_cbranch_vccz L_qh_15
L_pl_16:
    buffer_load_dword v34, v33, s[4:7], 0 offen sc1
    s_waitcnt vmcnt(0)
    v_cmp_ge_u32 vcc, s73, v34
    s_cbranch_vccz L_pk_17
    s_sleep 2
    s_sub_u32 s15, s15, 1
    s_cbranch_scc0 L_pl_16
    s_branch L_abort
L_pk_17:
L_qh_15:
    s_cmp_lt_u32 s73, 56
    s_cbranch_scc1 L_qg_14
    s_cmp_ge_u32 s73, 60
    s_cbranch_scc1 L_qi_18
    v_and_b32 v38, 0xfffffffb, v33
    v_add_u32 v38, 4096, v38
L_pl_19:
    buffer_load_dword v39, v38, s[4:7], 0 offen sc1
    s_waitcnt vmcnt(0)
    v_cmp_ge_u32 vcc, 63, v39
    s_cbranch_vccz L_pk_20
    s_sleep 2
    s_sub_u32 s15, s15, 1
    s_cbranch_scc0 L_pl_19
    s_branch L_abort
L_pk_20:
L_qi_18:
    s_add_u32 s82, s77, 134217728
    s_add_u32 s83, s78, 134217728
    buffer_load_dwordx4 v[44:47], v30, s[4:7], s82 offen offset:0 sc1
    buffer_load_dwordx4 v[48:51], v30, s[4:7], s82 offen offset:1024 sc1
    buffer_load_dwordx4 v[52:55], v30, s[4:7], s82 offen offset:2048 sc1
    buffer_load_dwordx4 v[56:59], v30, s[4:7], s82 offen offset:3072 sc1
    buffer_load_dwordx4 v[60:63], v30, s[4:7], s83 offen offset:0 sc1
    buffer_load_dwordx4 v[64:67], v30, s[4:7], s83 offen offset:1024 sc1
    buffer_load_dwordx4 v[68:71], v30, s[4:7], s83 offen offset:2048 sc1
    buffer_load_dwordx4 v[72:75], v30, s[4:7], s83 offen offset:3072 sc1
L_qg_14:
    buffer_load_dwordx4 v[76:79], v30, s[4:7], s77 offen offset:0 sc1
    buffer_load_dwordx4 v[80:83], v30, s[4:7], s77 offen offset:1024 sc1
    buffer_load_dwordx4 v[84:87], v30, s[4:7], s77 offen offset:2048 sc1
    buffer_load_dwordx4 v[88:91], v30, s[4:7], s77 offen offset:3072 sc1
    buffer_load_dwordx4 v[92:95], v30, s[4:7], s78 offen offset:0 sc1
    buffer_load_dwordx4 v[96:99], v30, s[4:7], s78 offen offset:1024 sc1
    buffer_load_dwordx4 v[100:103], v30, s[4:7], s78 offen offset:2048 sc1
    buffer_load_dwordx4 v[104:107], v30, s[4:7], s78 offen offset:3072 sc1
    buffer_load_dwordx4 v[108:111], v30, s[4:7], s79 offen offset:0 sc1
    buffer_load_dwordx4 v[112:115], v30, s[4:7], s79 offen offset:1024 sc1
    buffer_load_dwordx4 v[116:119], v30, s[4:7], s79 offen offset:2048 sc1
    buffer_load_dwordx4 v[120:123], v30, s[4:7], s79 offen offset:3072 sc1
    buffer_load_dwordx4 v[124:127], v30, s[4:7], s80 offen offset:0 sc1
    buffer_load_dwordx4 v[128:131], v30, s[4:7], s80 offen offset:1024 sc1
    buffer_load_dwordx4 v[132:135], v30, s[4:7], s80 offen offset:2048 sc1
    buffer_load_dwordx4 v[136:139], v30, s[4:7], s80 offen offset:3072 sc1
    v_cndmask_b32 v12, 0, v248, s[16:17]
    v_cndmask_b32 v13, 0, v248, s[18:19]
    v_cndmask_b32 v14, 0, v248, s[20:21]
    v_cndmask_b32 v15, 0, v248, s[22:23]
    v_cndmask_b32 v16, 0, v248, s[24:25]
    v_cndmask_b32 v17, 0, v248, s[26:27]
    v_cndmask_b32 v18, 0, v248, s[28:29]
    v_cndmask_b32 v19, 0, v248, s[30:31]
    v_cndmask_b32 v20, 0, v248, s[32:33]
    v_cndmask_b32 v21, 0, v248, s[34:35]
    v_cndmask_b32 v22, 0, v248, s[36:37]
    v_cndmask_b32 v23, 0, v248, s[38:39]
    v_cndmask_b32 v24, 0, v248, s[40:41]
    v_cndmask_b32 v25, 0, v248, s[42:43]
    v_cndmask_b32 v26, 0, v248, s[52:53]
    v_cndmask_b32 v27, 0, v248, s[54:55]
    s_waitcnt vmcnt(15)
    s_nop 0
    v_mfma_f32_32x32x16_bf16 v[12:27], v[76:79], v[44:47], v[12:27]
    s_waitcnt vmcnt(14)
    v_mfma_f32_32x32x16_bf16 v[12:27], v[80:83], v[48:51], v[12:27]
    s_waitcnt vmcnt(13)
    v_mfma_f32_32x32x16_bf16 v[12:27], v[84:87], v[52:55], v[12:27]
    s_waitcnt vmcnt(12)
    v_mfma_f32_32x32x16_bf16 v[12:27], v[88:91], v[56:59], v[12:27]
    s_waitcnt vmcnt(11)
    v_mfma_f32_32x32x16_bf16 v[12:27], v[92:95], v[60:63], v[12:27]
    s_waitcnt vmcnt(10)
    v_mfma_f32_32x32x16_bf16 v[12:27], v[96:99], v[64:67], v[12:27]
    s_waitcnt vmcnt(9)
    v_mfma_f32_32x32x16_bf16 v[12:27], v[100:103], v[68:71], v[12:27]
    s_waitcnt vmcnt(8)
    v_mfma_f32_32x32x16_bf16 v[12:27], v[104:107], v[72:75], v[12:27]
L_q_again:
    buffer_load_dwordx4 v[140:143], v31, s[4:7], s81 offen offset:0 sc1
    buffer_load_dwordx4 v[144:147], v31, s[4:7], s81 offen offset:256 sc1
    buffer_load_dwordx4 v[148:151], v31, s[4:7], s81 offen offset:1024 sc1
    buffer_load_dwordx4 v[152:155], v31, s[4:7], s81 offen offset:1280 sc1
    buffer_load_dwordx4 v[156:159], v31, s[4:7], s81 offen offset:2048 sc1
    buffer_load_dwordx4 v[160:163], v31, s[4:7], s81 offen offset:2304 sc1
    buffer_load_dwordx4 v[164:167], v31, s[4:7], s81 offen offset:3072 sc1
    buffer_load_dwordx4 v[168:171], v31, s[4:7], s81 offen offset:3328 sc1
    buffer_load_dwordx2 v[188:189], v32, s[4:7], s81 offen offset:512 sc1
    buffer_load_dwordx2 v[192:193], v32, s[4:7], s81 offen offset:1536 sc1
    buffer_load_dwordx2 v[196:197], v32, s[4:7], s81 offen offset:2560 sc1
    buffer_load_dwordx2 v[200:201], v32, s[4:7], s81 offen offset:3584 sc1
    s_sub_u32 s15, s15, 1
    s_cbranch_scc1 L_abort
L_q_chk:
    s_waitcnt vmcnt(0)
    v_max3_u32 v38, v140, v144, v148
    v_max3_u32 v38, v38, v152, v156
    v_max3_u32 v38, v38, v160, v164
    v_max3_u32 v38, v38, v168, v188
    v_max3_u32 v38, v38, v192, v196
    v_max_u32 v38, v38, v200
    v_cmp_eq_u32 vcc, -1, v38
    s_cbranch_vccnz L_q_again
L_q_att:
    buffer_load_dword v34, v33, s[4:7], 0 offen sc1
    v_mfma_f32_32x32x16_bf16 v[172:187], v[140:143], v[44:47], 0
    v_mfma_f32_32x32x16_bf16 v[172:187], v[144:147], v[48:51], v[172:187]
    v_mfma_f32_32x32x16_bf16 v[172:187], v[148:151], v[52:55], v[172:187]
    v_max3_f32 v40, v12, v13, v14
    v_max3_f32 v40, v40, v15, v16
    v_max3_f32 v40, v40, v17, v18
    v_max3_f32 v40, v40, v19, v20
    v_max3_f32 v40, v40, v21, v22
    v_mfma_f32_32x32x16_bf16 v[172:187], v[152:155], v[56:59], v[172:187]
    v_max3_f32 v40, v40, v23, v24
    v_max3_f32 v40, v40, v25, v26
    v_max_f32 v40, v40, v27
    s_xor_b32 s79, s77, 0x2000
    s_xor_b32 s80, s78, 0x2000
    v_mfma_f32_32x32x16_bf16 v[172:187], v[156:159], v[60:63], v[172:187]
    v_mfma_f32_32x32x16_bf16 v[172:187], v[160:163], v[64:67], v[172:187]
    v_mfma_f32_32x32x16_bf16 v[172:187], v[164:167], v[68:71], v[172:187]
    v_mfma_f32_32x32x16_bf16 v[172:187], v[168:171], v[72:75], v[172:187]
    ds_read_b128 v[44:47], v29 offset:0
    ds_read_b128 v[48:51], v29 offset:1024
    ds_read_b128 v[52:55], v29 offset:2048
    ds_read_b128 v[56:59], v29 offset:3072
    ds_read_b128 v[60:63], v29 offset:4096
    ds_read_b128 v[64:67], v29 offset:5120
    ds_read_b128 v[68:71], v29 offset:6144
    ds_read_b128 v[72:75], v29 offset:7168
    s_nop 3
    v_max3_f32 v40, v40, v172, v173
    v_max3_f32 v40, v40, v174, v175
    v_mov_b32 v38, v40
    s_nop 1
    v_permlane32_swap_b32 v40, v38
    v_max_f32 v40, v40, v38
    v_mul_f32 v40, v40, v42
    v_pk_fma_f32 v[12:13], v[12:13], v[42:43], v[40:41] op_sel_hi:[1,1,0] neg_lo:[0,0,1] neg_hi:[0,0,1]
    v_exp_f32 v12, v12
    v_exp_f32 v13, v13
    v_pk_fma_f32 v[14:15], v[14:15], v[42:43], v[40:41] op_sel_hi:[1,1,0] neg_lo:[0,0,1] neg_hi:[0,0,1]
    v_exp_f32 v14, v14
    v_exp_f32 v15, v15
    v_pk_fma_f32 v[16:17], v[16:17], v[42:43], v[40:41] op_sel_hi:[1,1,0] neg_lo:[0,0,1] neg_hi:[0,0,1]
    v_exp_f32 v16, v16
    v_exp_f32 v17, v17
    v_pk_fma_f32 v[18:19], v[18:19], v[42:43], v[40:41] op_sel_hi:[1,1,0] neg_lo:[0,0,1] neg_hi:[0,0,1]
    v_exp_f32 v18, v18
    v_exp_f32 v19, v19
    v_cvt_pk_bf16_f32 v204, v12, v13
    v_cvt_pk_bf16_f32 v205, v14, v15
    v_cvt_pk_bf16_f32 v206, v16, v17
    v_cvt_pk_bf16_f32 v207, v18, v19
    v_pk_fma_f32 v[20:21], v[20:21], v[42:43], v[40:41] op_sel_hi:[1,1,0] neg_lo:[0,0,1] neg_hi:[0,0,1]
    v_exp_f32 v20, v20
    v_exp_f32 v21, v21
    v_mfma_f32_32x32x16_bf16 v[140:155], v[108:111], v[204:207], 0
    v_pk_fma_f32 v[22:23], v[22:23], v[42:43], v[40:41] op_sel_hi:[1,1,0] neg_lo:[0,0,1] neg_hi:[0,0,1]
    v_exp_f32 v22, v22
    v_exp_f32 v23, v23
    v_cvt_pk_bf16_f32 v208, v20, v21
    v_pk_fma_f32 v[24:25], v[24:25], v[42:43], v[40:41] op_sel_hi:[1,1,0] neg_lo:[0,0,1] neg_hi:[0,0,1]
    v_exp_f32 v24, v24
    v_exp_f32 v25, v25
    v_mfma_f32_32x32x16_bf16 v[156:171], v[116:119], v[204:207], 0
    v_pk_fma_f32 v[26:27], v[26:27], v[42:43], v[40:41] op_sel_hi:[1,1,0] neg_lo:[0,0,1] neg_hi:[0,0,1]
    v_exp_f32 v26, v26
    v_exp_f32 v27, v27
    v_cvt_pk_bf16_f32 v209, v22, v23
    v_cvt_pk_bf16_f32 v210, v24, v25
    v_cvt_pk_bf16_f32 v211, v26, v27
    v_pk_fma_f32 v[172:173], v[172:173], v[42:43], v[40:41] op_sel_hi:[1,1,0] neg_lo:[0,0,1] neg_hi:[0,0,1]
    v_exp_f32 v172, v172
    v_exp_f32 v173, v173
    v_mfma_f32_32x32x16_bf16 v[140:155], v[112:115], v[208:211], v[140:155]
    v_pk_fma_f32 v[174:175], v[174:175], v[42:43], v[40:41] op_sel_hi:[1,1,0] neg_lo:[0,0,1] neg_hi:[0,0,1]
    v_exp_f32 v174, v174
    v_exp_f32 v175, v175
    v_cvt_pk_bf16_f32 v212, v172, v173
    v_cvt_pk_bf16_f32 v213, v174, v175
    v_mfma_f32_32x32x16_bf16 v[156:171], v[120:123], v[208:211], v[156:171]
    v_pk_add_f32 v[40:41], v[12:13], v[14:15]
    v_pk_add_f32 v[40:41], v[40:41], v[16:17]
    v_pk_add_f32 v[40:41], v[40:41], v[18:19]
    v_pk_add_f32 v[40:41], v[40:41], v[20:21]
    v_pk_add_f32 v[40:41], v[40:41], v[22:23]
    v_mfma_f32_32x32x16_bf16 v[140:155], v[188:191], v[212:215], v[140:155]
    v_pk_add_f32 v[40:41], v[40:41], v[24:25]
    v_pk_add_f32 v[40:41], v[40:41], v[26:27]
    v_pk_add_f32 v[40:41], v[40:41], v[172:173]
    v_pk_add_f32 v[40:41], v[40:41], v[174:175]
    v_add_f32 v40, v40, v41
    v_mov_b32 v38, v40
    v_mfma_f32_32x32x16_bf16 v[156:171], v[192:195], v[212:215], v[156:171]
    s_nop 0
    v_permlane32_swap_b32 v40, v38
    v_add_f32 v40, v40, v38
    v_rcp_f32 v40, v40
    v_mfma_f32_32x32x16_bf16 v[12:27], v[124:127], v[204:207], 0
    v_pk_mul_f32 v[140:141], v[140:141], v[40:41] op_sel_hi:[1,0]
    v_pk_mul_f32 v[142:143], v[142:143], v[40:41] op_sel_hi:[1,0]
    v_pk_mul_f32 v[144:145], v[144:145], v[40:41] op_sel_hi:[1,0]
    v_pk_mul_f32 v[146:147], v[146:147], v[40:41] op_sel_hi:[1,0]
    v_cvt_pk_bf16_f32 v76, v140, v141
    v_cvt_pk_bf16_f32 v77, v142, v143
    v_mfma_f32_32x32x16_bf16 v[12:27], v[128:131], v[208:211], v[12:27]
    v_cvt_pk_bf16_f32 v78, v144, v145
    v_cvt_pk_bf16_f32 v79, v146, v147
    v_pk_mul_f32 v[148:149], v[148:149], v[40:41] op_sel_hi:[1,0]
    v_pk_mul_f32 v[150:151], v[150:151], v[40:41] op_sel_hi:[1,0]
    v_pk_mul_f32 v[152:153], v[152:153], v[40:41] op_sel_hi:[1,0]
    v_pk_mul_f32 v[154:155], v[154:155], v[40:41] op_sel_hi:[1,0]
    v_mfma_f32_32x32x16_bf16 v[12:27], v[196:199], v[212:215], v[12:27]
    v_cvt_pk_bf16_f32 v80, v148, v149
    v_cvt_pk_bf16_f32 v81, v150, v151
    v_cvt_pk_bf16_f32 v82, v152, v153
    v_cvt_pk_bf16_f32 v83, v154, v155
    buffer_store_dwordx4 v[76:79], v30, s[4:7], s79 offen offset:0 sc1
    buffer_store_dwordx4 v[80:83], v30, s[4:7], s79 offen offset:1024 sc1
    v_mfma_f32_32x32x16_bf16 v[172:187], v[132:135], v[204:207], 0
    v_pk_mul_f32 v[156:157], v[156:157], v[40:41] op_sel_hi:[1,0]
    v_pk_mul_f32 v[158:159], v[158:159], v[40:41] op_sel_hi:[1,0]
    v_pk_mul_f32 v[160:161], v[160:161], v[40:41] op_sel_hi:[1,0]
    v_pk_mul_f32 v[162:163], v[162:163], v[40:41] op_sel_hi:[1,0]
    v_cvt_pk_bf16_f32 v84, v156, v157
    v_cvt_pk_bf16_f32 v85, v158, v159
    v_mfma_f32_32x32x16_bf16 v[172:187], v[136:139], v[208:211], v[172:187]
    v_cvt_pk_bf16_f32 v86, v160, v161
    v_cvt_pk_bf16_f32 v87, v162, v163
    v_pk_mul_f32 v[164:165], v[164:165], v[40:41] op_sel_hi:[1,0]
    v_pk_mul_f32 v[166:167], v[166:167], v[40:41] op_sel_hi:[1,0]
    v_pk_mul_f32 v[168:169], v[168:169], v[40:41] op_sel_hi:[1,0]
    v_pk_mul_f32 v[170:171], v[170:171], v[40:41] op_sel_hi:[1,0]
    v_mfma_f32_32x32x16_bf16 v[172:187], v[200:203], v[212:215], v[172:187]
    v_cvt_pk_bf16_f32 v88, v164, v165
    v_cvt_pk_bf16_f32 v89, v166, v167
    v_cvt_pk_bf16_f32 v90, v168, v169
    v_cvt_pk_bf16_f32 v91, v170, v171
    buffer_store_dwordx4 v[84:87], v30, s[4:7], s79 offen offset:2048 sc1
    buffer_store_dwordx4 v[88:91], v30, s[4:7], s79 offen offset:3072 sc1
    v_pk_mul_f32 v[12:13], v[12:13], v[40:41] op_sel_hi:[1,0]
    v_pk_mul_f32 v[14:15], v[14:15], v[40:41] op_sel_hi:[1,0]
    v_pk_mul_f32 v[16:17], v[16:17], v[40:41] op_sel_hi:[1,0]
    v_pk_mul_f32 v[18:19], v[18:19], v[40:41] op_sel_hi:[1,0]
    v_cvt_pk_bf16_f32 v92, v12, v13
    v_cvt_pk_bf16_f32 v93, v14, v15
    v_cvt_pk_bf16_f32 v94, v16, v17
    v_cvt_pk_bf16_f32 v95, v18, v19
    v_pk_mul_f32 v[20:21], v[20:21], v[40:41] op_sel_hi:[1,0]
    v_pk_mul_f32 v[22:23], v[22:23], v[40:41] op_sel_hi:[1,0]
    v_pk_mul_f32 v[24:25], v[24:25], v[40:41] op_sel_hi:[1,0]
    v_pk_mul_f32 v[26:27], v[26:27], v[40:41] op_sel_hi:[1,0]
    v_cvt_pk_bf16_f32 v96, v20, v21
    v_cvt_pk_bf16_f32 v97, v22, v23
    v_cvt_pk_bf16_f32 v98, v24, v25
    v_cvt_pk_bf16_f32 v99, v26, v27
    buffer_store_dwordx4 v[92:95], v30, s[4:7], s80 offen offset:0 sc1
    buffer_store_dwordx4 v[96:99], v30, s[4:7], s80 offen offset:1024 sc1
    v_pk_mul_f32 v[172:173], v[172:173], v[40:41] op_sel_hi:[1,0]
    v_pk_mul_f32 v[174:175], v[174:175], v[40:41] op_sel_hi:[1,0]
    v_pk_mul_f32 v[176:177], v[176:177], v[40:41] op_sel_hi:[1,0]
    v_pk_mul_f32 v[178:179], v[178:179], v[40:41] op_sel_hi:[1,0]
    v_cvt_pk_bf16_f32 v100, v172, v173
    v_cvt_pk_bf16_f32 v101, v174, v175
    v_cvt_pk_bf16_f32 v102, v176, v177
    v_cvt_pk_bf16_f32 v103, v178, v179
    v_pk_mul_f32 v[180:181], v[180:181], v[40:41] op_sel_hi:[1,0]
    v_pk_mul_f32 v[182:183], v[182:183], v[40:41] op_sel_hi:[1,0]
    v_pk_mul_f32 v[184:185], v[184:185], v[40:41] op_sel_hi:[1,0]
    v_pk_mul_f32 v[186:187], v[186:187], v[40:41] op_sel_hi:[1,0]
    v_cvt_pk_bf16_f32 v104, v180, v181
    v_cvt_pk_bf16_f32 v105, v182, v183
    v_cvt_pk_bf16_f32 v106, v184, v185
    v_cvt_pk_bf16_f32 v107, v186, v187
    buffer_store_dwordx4 v[100:103], v30, s[4:7], s80 offen offset:2048 sc1
    buffer_store_dwordx4 v[104:107], v30, s[4:7], s80 offen offset:3072 sc1
    s_add_u32 s84, s84, 1
    s_cmp_lt_u32 s68, 56
    s_cbranch_scc1 L_q_next
    s_waitcnt vmcnt(0)
    s_atomic_umax s84, s[46:47], s85
    s_waitcnt lgkmcnt(0)
    s_cmp_ge_u32 s73, 60
    s_cbranch_scc1 L_drain
    s_add_u32 s73, s73, 4
    s_branch L_q_block
L_q_next:
    s_add_u32 s73, s73, 4
    s_branch L_q_loop
L_o:
    s_barrier
    s_xor_b32 s13, s13, 1
    s_mov_b32 s8, s16
    s_and_b32 s9, s17, 0xffff
    s_mov_b32 s10, 4194304
    s_mov_b32 s11, 0x20000
    v_and_b32 v28, 7, v0
    v_and_b32 v30, 48, v0
    v_lshl_add_u32 v38, v28, 11, v30
    v_and_b32 v28, 8, v0
    v_lshl_add_u32 v38, v28, 3, v38
    v_add_u32 v39, 0x4000, v38
    s_lshl_b32 s72, s13, 17
    s_lshl_b32 s64, s14, 15
    s_add_u32 s72, s72, s64
    v_and_b32 v28, 2, v0
    v_lshl_add_u32 v30, v28, 5, v30
    v_and_b32 v28, 1, v0
    v_cmp_eq_u32 vcc, 0, v28
    v_mov_b32 v44, s40
    v_mov_b32 v45, s41
    v_mov_b32 v46, s32
    v_mov_b32 v47, s33
    v_cndmask_b32 v44, v44, v46, vcc
    v_cndmask_b32 v45, v45, v47, vcc
    v_add_co_u32 v44, vcc, v44, v30
    s_nop 1
    v_addc_co_u32 v45, vcc, 0, v45, vcc
    s_cmp_lg_u32 s28, 0
    s_cbranch_scc1 L_rg_21
    global_load_dwordx4 v[76:79], v[44:45], off offset:0
    global_load_dwordx4 v[80:83], v[44:45], off offset:128
    global_load_dwordx4 v[84:87], v[44:45], off offset:256
    global_load_dwordx4 v[88:91], v[44:45], off offset:384
    global_load_dwordx4 v[92:95], v[44:45], off offset:512
    global_load_dwordx4 v[96:99], v[44:45], off offset:640
    global_load_dwordx4 v[100:103], v[44:45], off offset:768
    global_load_dwordx4 v[104:107], v[44:45], off offset:896
    global_load_dwordx4 v[108:111], v[44:45], off offset:1024
    global_load_dwordx4 v[112:115], v[44:45], off offset:1152
    global_load_dwordx4 v[116:119], v[44:45], off offset:1280
    global_load_dwordx4 v[120:123], v[44:45], off offset:1408
    global_load_dwordx4 v[124:127], v[44:45], off offset:1536
    global_load_dwordx4 v[128:131], v[44:45], off offset:1664
    global_load_dwordx4 v[132:135], v[44:45], off offset:1792
    global_load_dwordx4 v[136:139], v[44:45], off offset:1920
    buffer_load_dwordx4 a[128:131], v38, s[8:11], s72 offen offset:0
    buffer_load_dwordx4 a[132:135], v39, s[8:11], s72 offen offset:0
    buffer_load_dwordx4 a[136:139], v38, s[8:11], s72 offen offset:128
    buffer_load_dwordx4 a[140:143], v39, s[8:11], s72 offen offset:128
    buffer_load_dwordx4 a[144:147], v38, s[8:11], s72 offen offset:256
    buffer_load_dwordx4 a[148:151], v39, s[8:11], s72 offen offset:256
    buffer_load_dwordx4 a[152:155], v38, s[8:11], s72 offen offset:384
    buffer_load_dwordx4 a[156:159], v39, s[8:11], s72 offen offset:384
    buffer_load_dwordx4 a[160:163], v38, s[8:11], s72 offen offset:512
    buffer_load_dwordx4 a[164:167], v39, s[8:11], s72 offen offset:512
    buffer_load_dwordx4 a[168:171], v38, s[8:11], s72 offen offset:640
    buffer_load_dwordx4 a[172:175], v39, s[8:11], s72 offen offset:640
    buffer_load_dwordx4 a[176:179], v38, s[8:11], s72 offen offset:768
    buffer_load_dwordx4 a[180:183], v39, s[8:11], s72 offen offset:768
    buffer_load_dwordx4 a[184:187], v38, s[8:11], s72 offen offset:896
    buffer_load_dwordx4 a[188:191], v39, s[8:11], s72 offen offset:896
    buffer_load_dwordx4 a[192:195], v38, s[8:11], s72 offen offset:1024
    buffer_load_dwordx4 a[196:199], v39, s[8:11], s72 offen offset:1024
    buffer_load_dwordx4 a[200:203], v38, s[8:11], s72 offen offset:1152
    buffer_load_dwordx4 a[204:207], v39, s[8:11], s72 offen offset:1152
    buffer_load_dwordx4 a[208:211], v38, s[8:11], s72 offen offset:1280
    buffer_load_dwordx4 a[212:215], v39, s[8:11], s72 offen offset:1280
    buffer_load_dwordx4 a[216:219], v38, s[8:11], s72 offen offset:1408
    buffer_load_dwordx4 a[220:223], v39, s[8:11], s72 offen offset:1408
    buffer_load_dwordx4 a[224:227], v38, s[8:11], s72 offen offset:1536
    buffer_load_dwordx4 a[228:231], v39, s[8:11], s72 offen offset:1536
    buffer_load_dwordx4 a[232:235], v38, s[8:11], s72 offen offset:1664
    buffer_load_dwordx4 a[236:239], v39, s[8:11], s72 offen offset:1664
    buffer_load_dwordx4 a[240:243], v38, s[8:11], s72 offen offset:1792
    buffer_load_dwordx4 a[244:247], v39, s[8:11], s72 offen offset:1792
    buffer_load_dwordx4 a[248:251], v38, s[8:11], s72 offen offset:1920
    buffer_load_dwordx4 a[252:255], v39, s[8:11], s72 offen offset:1920
    s_waitcnt vmcnt(40)
    s_branch L_y2_22
L_rg_21:
    s_and_b32 s72, s12, 1
    s_lshl_b32 s72, s72, 5
    s_add_u32 s72, s72, s13
    s_lshr_b32 s64, s72, 4
    s_lshl_b32 s64, s64, 8
    s_add_u32 s64, s64, 85997568
    v_min_u32 v28, 55, v0
    v_lshlrev_b32 v28, 2, v28
    v_add_u32 v28, s64, v28
L_pl_23:
    buffer_load_dword v30, v28, s[4:7], 0 offen sc1
    s_waitcnt vmcnt(0)
    v_cmp_ge_u32 vcc, 0, v30
    s_cbranch_vccz L_pk_24
    s_sleep 2
    s_sub_u32 s15, s15, 1
    s_cbranch_scc0 L_pl_23
    s_branch L_abort
L_pk_24:
    s_lshl_b32 s72, s72, 2
    s_add_u32 s72, s72, s14
    s_lshl_b32 s75, s72, 7
    s_add_u32 s64, s75, 93323264
    v_and_b32 v38, 31, v0
    v_lshlrev_b32 v38, 2, v38
    v_lshrrev_b32 v30, 5, v0
    v_lshl_add_u32 v28, v30, 15, v38
    buffer_load_dword v108, v28, s[4:7], s64 offen sc1
    s_add_u32 s64, s64, 0x10000
    buffer_load_dword v109, v28, s[4:7], s64 offen sc1
    s_add_u32 s64, s64, 0x10000
    buffer_load_dword v110, v28, s[4:7], s64 offen sc1
    s_add_u32 s64, s64, 0x10000
    buffer_load_dword v111, v28, s[4:7], s64 offen sc1
    s_add_u32 s64, s64, 0x10000
    buffer_load_dword v112, v28, s[4:7], s64 offen sc1
    s_add_u32 s64, s64, 0x10000
    buffer_load_dword v113, v28, s[4:7], s64 offen sc1
    s_add_u32 s64, s64, 0x10000
    buffer_load_dword v114, v28, s[4:7], s64 offen sc1
    s_add_u32 s64, s64, 0x10000
    buffer_load_dword v115, v28, s[4:7], s64 offen sc1
    s_add_u32 s64, s64, 0x10000
    buffer_load_dword v116, v28, s[4:7], s64 offen sc1
    s_add_u32 s64, s64, 0x10000
    buffer_load_dword v117, v28, s[4:7], s64 offen sc1
    s_add_u32 s64, s64, 0x10000
    buffer_load_dword v118, v28, s[4:7], s64 offen sc1
    s_add_u32 s64, s64, 0x10000
    buffer_load_dword v119, v28, s[4:7], s64 offen sc1
    s_add_u32 s64, s64, 0x10000
    buffer_load_dword v120, v28, s[4:7], s64 offen sc1
    s_add_u32 s64, s64, 0x10000
    buffer_load_dword v121, v28, s[4:7], s64 offen sc1
    s_add_u32 s64, s64, 0x10000
    buffer_load_dword v122, v28, s[4:7], s64 offen sc1
    s_add_u32 s64, s64, 0x10000
    buffer_load_dword v123, v28, s[4:7], s64 offen sc1
    s_add_u32 s64, s64, 0x10000
    buffer_load_dword v124, v28, s[4:7], s64 offen sc1
    s_add_u32 s64, s64, 0x10000
    buffer_load_dword v125, v28, s[4:7], s64 offen sc1
    s_add_u32 s64, s64, 0x10000
    buffer_load_dword v126, v28, s[4:7], s64 offen sc1
    s_add_u32 s64, s64, 0x10000
    buffer_load_dword v127, v28, s[4:7], s64 offen sc1
    s_add_u32 s64, s64, 0x10000
    buffer_load_dword v128, v28, s[4:7], s64 offen sc1
    s_add_u32 s64, s64, 0x10000
    buffer_load_dword v129, v28, s[4:7], s64 offen sc1
    s_add_u32 s64, s64, 0x10000
    buffer_load_dword v130, v28, s[4:7], s64 offen sc1
    s_add_u32 s64, s64, 0x10000
    buffer_load_dword v131, v28, s[4:7], s64 offen sc1
    s_add_u32 s64, s64, 0x10000
    buffer_load_dword v132, v28, s[4:7], s64 offen sc1
    s_add_u32 s64, s64, 0x10000
    buffer_load_dword v133, v28, s[4:7], s64 offen sc1
    s_add_u32 s64, s64, 0x10000
    buffer_load_dword v134, v28, s[4:7], s64 offen sc1
    s_add_u32 s64, s64, 0x10000
    buffer_load_dword v135, v28, s[4:7], s64 offen sc1
    s_add_u32 s64, s64, 0x10000
L_y2_22:
    s_lshr_b32 s84, s13, 3
    s_and_b32 s73, s13, 7
    s_lshl_b32 s88, s73, 8
    s_lshl_b32 s64, s14, 6
    s_add_u32 s88, s88, s64
    s_lshl_b32 s69, s84, 21
    s_add_u32 s69, s69, s88
    s_and_b32 s74, s84, 1
    s_lshl_b32 s74, s74, 5
    s_add_u32 s88, s88, s74
    s_mov_b32 s48, s26
    s_and_b32 s49, s27, 0xffff
    s_mov_b32 s50, 8388608
    s_mov_b32 s51, 0x20000
    v_lshrrev_b32 v3, 2, v0
    v_and_b32 v1, 3, v0
    v_lshlrev_b32 v1, 4, v1
    v_lshl_add_u32 v1, v3, 11, v1
    s_mul_i32 s64, s14, 32768
    s_add_u32 m0, s64, 0
    s_xor_b32 s65, s69, 0
    buffer_load_dwordx4 v1, s[48:51], s65 offen  lds
    s_add_u32 m0, m0, 1024
    s_xor_b32 s65, s69, 32768
    buffer_load_dwordx4 v1, s[48:51], s65 offen  lds
    s_add_u32 m0, m0, 1024
    s_xor_b32 s65, s69, 65536
    buffer_load_dwordx4 v1, s[48:51], s65 offen  lds
    s_add_u32 m0, m0, 1024
    s_xor_b32 s65, s69, 98304
    buffer_load_dwordx4 v1, s[48:51], s65 offen  lds
    s_add_u32 m0, m0, 1024
    s_xor_b32 s65, s69, 131072
    buffer_load_dwordx4 v1, s[48:51], s65 offen  lds
    s_add_u32 m0, m0, 1024
    s_xor_b32 s65, s69, 163840
    buffer_load_dwordx4 v1, s[48:51], s65 offen  lds
    s_add_u32 m0, m0, 1024
    s_xor_b32 s65, s69, 196608
    buffer_load_dwordx4 v1, s[48:51], s65 offen  lds
    s_add_u32 m0, m0, 1024
    s_xor_b32 s65, s69, 229376
    buffer_load_dwordx4 v1, s[48:51], s65 offen  lds
    s_mov_b32 s68, 0
    s_mov_b32 s71, 0
    s_and_b32 s64, s13, 7
    s_lshl_b32 s64, s64, 16
    s_lshl_b32 s65, s14, 14
    s_add_u32 s64, s64, s65
    s_lshr_b32 s65, s13, 3
    s_lshl_b32 s65, s65, 12
    s_add_u32 s64, s64, s65
    s_and_b32 s65, s12, 3
    s_lshl_b32 s65, s65, 20
    s_add_u32 s64, s64, s65
    s_add_u32 s64, s64, 88080384
    v_lshlrev_b32 v34, 4, v0
    v_add_u32 v34, s64, v34
    v_xor_b32 v35, 4096, v34
    v_xor_b32 v36, 8192, v34
    v_xor_b32 v37, 12288, v34
    v_and_b32 v44, 7, v0
    v_lshlrev_b32 v44, 2, v44
    v_add_u32 v44, 85995648, v44
    s_lshl_b32 s64, s13, 2
    s_add_u32 s64, s64, 85995520
    s_cmp_lg_u32 s14, 0
    s_cselect_b32 s64, 2147483648, s64
    s_lshl_b32 s65, s72, 2
    s_add_u32 s65, s65, 85996544
    s_cmp_lg_u32 s28, 0
    s_cselect_b32 s64, s65, s64
    v_mov_b32 v33, s64
    v_cmp_eq_u32 vcc, 0, v0
    v_mov_b32 v28, 2147483648
    s_nop 0
    v_cndmask_b32 v33, v28, v33, vcc
    v_lshlrev_b32 v3, 4, v0
    s_and_b32 s64, s14, 2
    s_add_u32 s64, s64, s14
    s_lshl_b32 s64, s64, 12
    s_lshl_b32 s65, s84, 17
    s_add_u32 s64, s64, s65
    v_add_u32 v2, s64, v3
    v_and_b32 v3, 15, v0
    v_lshlrev_b32 v3, 4, v3
    v_lshrrev_b32 v4, 4, v0
    v_lshl_add_u32 v3, v4, 9, v3
    s_lshl_b32 s64, s13, 14
    s_lshl_b32 s65, s14, 11
    s_add_u32 s64, s64, s65
    v_and_b32 v4, 15, v0
    v_lshl_add_u32 v5, v4, 7, s64
    s_lshr_b32 s64, s84, 1
    s_lshl_b32 s64, s64, 8
    v_add_u32 v7, s64, v3
    v_xor_b32 v8, 256, v7
    s_lshl_b32 s70, s14, 12
    v_bfe_u32 v4, v0, 2, 2
    s_mul_i32 s64, s14, 32768
    s_add_u32 s64, s64, 0
    v_lshrrev_b32 v3, 5, v0
    v_lshl_add_u32 v4, v3, 4, v4
    v_bfe_u32 v3, v0, 4, 1
    v_lshl_add_u32 v4, v3, 2, v4
    v_lshlrev_b32 v4, 6, v4
    v_and_b32 v3, 3, v0
    v_lshl_add_u32 v4, v3, 3, v4
    s_and_b32 s65, s84, 1
    s_lshl_b32 s65, s65, 5
    s_add_u32 s64, s64, s65
    v_add_u32 v12, s64, v4
    v_xor_b32 v13, 32, v12
    s_mul_i32 s64, s14, 32768
    s_add_u32 m0, s64, 8192
    s_xor_b32 s65, s69, 262144
    buffer_load_dwordx4 v1, s[48:51], s65 offen  lds
    s_add_u32 m0, m0, 1024
    s_xor_b32 s65, s69, 294912
    buffer_load_dwordx4 v1, s[48:51], s65 offen  lds
    s_add_u32 m0, m0, 1024
    s_xor_b32 s65, s69, 327680
    buffer_load_dwordx4 v1, s[48:51], s65 offen  lds
    s_add_u32 m0, m0, 1024
    s_xor_b32 s65, s69, 360448
    buffer_load_dwordx4 v1, s[48:51], s65 offen  lds
    s_add_u32 m0, m0, 1024
    s_xor_b32 s65, s69, 393216
    buffer_load_dwordx4 v1, s[48:51], s65 offen  lds
    s_add_u32 m0, m0, 1024
    s_xor_b32 s65, s69, 425984
    buffer_load_dwordx4 v1, s[48:51], s65 offen  lds
    s_add_u32 m0, m0, 1024
    s_xor_b32 s65, s69, 458752
    buffer_load_dwordx4 v1, s[48:51], s65 offen  lds
    s_add_u32 m0, m0, 1024
    s_xor_b32 s65, s69, 491520
    buffer_load_dwordx4 v1, s[48:51], s65 offen  lds
    s_waitcnt vmcnt(8)
    s_cmp_lg_u32 s28, 0
    s_cbranch_scc1 L_rg_25
    v_mfma_f32_16x16x32_bf16 v[64:67], a[128:131], v[76:79], 0
    v_mfma_f32_16x16x32_bf16 v[68:71], a[132:135], v[76:79], 0
    v_mfma_f32_16x16x32_bf16 v[64:67], a[136:139], v[80:83], v[64:67]
    v_mfma_f32_16x16x32_bf16 v[68:71], a[140:143], v[80:83], v[68:71]
    v_mfma_f32_16x16x32_bf16 v[64:67], a[144:147], v[84:87], v[64:67]
    v_mfma_f32_16x16x32_bf16 v[68:71], a[148:151], v[84:87], v[68:71]
    v_mfma_f32_16x16x32_bf16 v[64:67], a[152:155], v[88:91], v[64:67]
    v_mfma_f32_16x16x32_bf16 v[68:71], a[156:159], v[88:91], v[68:71]
    v_mfma_f32_16x16x32_bf16 v[64:67], a[160:163], v[92:95], v[64:67]
    v_mfma_f32_16x16x32_bf16 v[68:71], a[164:167], v[92:95], v[68:71]
    v_mfma_f32_16x16x32_bf16 v[64:67], a[168:171], v[96:99], v[64:67]
    v_mfma_f32_16x16x32_bf16 v[68:71], a[172:175], v[96:99], v[68:71]
    v_mfma_f32_16x16x32_bf16 v[64:67], a[176:179], v[100:103], v[64:67]
    v_mfma_f32_16x16x32_bf16 v[68:71], a[180:183], v[100:103], v[68:71]
    v_mfma_f32_16x16x32_bf16 v[64:67], a[184:187], v[104:107], v[64:67]
    v_mfma_f32_16x16x32_bf16 v[68:71], a[188:191], v[104:107], v[68:71]
    v_mfma_f32_16x16x32_bf16 v[64:67], a[192:195], v[108:111], v[64:67]
    v_mfma_f32_16x16x32_bf16 v[68:71], a[196:199], v[108:111], v[68:71]
    v_mfma_f32_16x16x32_bf16 v[64:67], a[200:203], v[112:115], v[64:67]
    v_mfma_f32_16x16x32_bf16 v[68:71], a[204:207], v[112:115], v[68:71]
    v_mfma_f32_16x16x32_bf16 v[64:67], a[208:211], v[116:119], v[64:67]
    v_mfma_f32_16x16x32_bf16 v[68:71], a[212:215], v[116:119], v[68:71]
    v_mfma_f32_16x16x32_bf16 v[64:67], a[216:219], v[120:123], v[64:67]
    v_mfma_f32_16x16x32_bf16 v[68:71], a[220:223], v[120:123], v[68:71]
    v_mfma_f32_16x16x32_bf16 v[64:67], a[224:227], v[124:127], v[64:67]
    v_mfma_f32_16x16x32_bf16 v[68:71], a[228:231], v[124:127], v[68:71]
    v_mfma_f32_16x16x32_bf16 v[64:67], a[232:235], v[128:131], v[64:67]
    v_mfma_f32_16x16x32_bf16 v[68:71], a[236:239], v[128:131], v[68:71]
    v_mfma_f32_16x16x32_bf16 v[64:67], a[240:243], v[132:135], v[64:67]
    v_mfma_f32_16x16x32_bf16 v[68:71], a[244:247], v[132:135], v[68:71]
    v_mfma_f32_16x16x32_bf16 v[64:67], a[248:251], v[136:139], v[64:67]
    v_mfma_f32_16x16x32_bf16 v[68:71], a[252:255], v[136:139], v[68:71]
    v_and_b32 v28, 15, v0
    v_and_b32 v30, 48, v0
    v_lshl_add_u32 v30, v28, 13, v30
    v_cmp_gt_u32 vcc, 2, v28
    v_mov_b32 v28, 2147483648
    s_nop 0
    v_cndmask_b32 v30, v28, v30, vcc
    s_nop 0
    v_permlane32_swap_b32 v64, v68
    v_permlane32_swap_b32 v65, v69
    v_permlane32_swap_b32 v66, v70
    v_permlane32_swap_b32 v67, v71
    v_add_f32_dpp v64, v68, v64 quad_perm:[2,3,0,1] row_mask:0xf bank_mask:0xf
    v_add_f32_dpp v65, v69, v65 quad_perm:[2,3,0,1] row_mask:0xf bank_mask:0xf
    v_add_f32_dpp v66, v70, v66 quad_perm:[2,3,0,1] row_mask:0xf bank_mask:0xf
    v_add_f32_dpp v67, v71, v67 quad_perm:[2,3,0,1] row_mask:0xf bank_mask:0xf
    s_lshr_b32 s72, s72, 9
    s_add_u32 s72, s72, 92274688
    buffer_store_dwordx4 v[64:67], v30, s[4:7], s72 offen sc1
    s_branch L_y2_26
L_rg_25:
    v_pk_add_f32 v[108:109], v[108:109], v[110:111]
    v_pk_add_f32 v[108:109], v[108:109], v[112:113]
    v_pk_add_f32 v[108:109], v[108:109], v[114:115]
    v_pk_add_f32 v[108:109], v[108:109], v[116:117]
    v_pk_add_f32 v[108:109], v[108:109], v[118:119]
    v_pk_add_f32 v[108:109], v[108:109], v[120:121]
    v_pk_add_f32 v[108:109], v[108:109], v[122:123]
    v_pk_add_f32 v[108:109], v[108:109], v[124:125]
    v_pk_add_f32 v[108:109], v[108:109], v[126:127]
    v_pk_add_f32 v[108:109], v[108:109], v[128:129]
    v_pk_add_f32 v[108:109], v[108:109], v[130:131]
    v_pk_add_f32 v[108:109], v[108:109], v[132:133]
    v_pk_add_f32 v[108:109], v[108:109], v[134:135]
    v_add_f32 v108, v108, v109
    v_mov_b32 v109, v108
    s_nop 1
    v_permlane32_swap_b32 v108, v109
    v_add_f32 v108, v108, v109
    s_add_u32 s75, s75, 92798976
    buffer_store_dword v108, v38, s[4:7], s75 offen sc1
L_y2_26:
    s_mul_i32 s64, s14, 32768
    s_add_u32 m0, s64, 16384
    s_xor_b32 s65, s69, 524288
    buffer_load_dwordx4 v1, s[48:51], s65 offen  lds
    s_add_u32 m0, m0, 1024
    s_xor_b32 s65, s69, 557056
    buffer_load_dwordx4 v1, s[48:51], s65 offen  lds
    s_add_u32 m0, m0, 1024
    s_xor_b32 s65, s69, 589824
    buffer_load_dwordx4 v1, s[48:51], s65 offen  lds
    s_add_u32 m0, m0, 1024
    s_xor_b32 s65, s69, 622592
    buffer_load_dwordx4 v1, s[48:51], s65 offen  lds
    s_add_u32 m0, m0, 1024
    s_xor_b32 s65, s69, 655360
    buffer_load_dwordx4 v1, s[48:51], s65 offen  lds
    s_add_u32 m0, m0, 1024
    s_xor_b32 s65, s69, 688128
    buffer_load_dwordx4 v1, s[48:51], s65 offen  lds
    s_add_u32 m0, m0, 1024
    s_xor_b32 s65, s69, 720896
    buffer_load_dwordx4 v1, s[48:51], s65 offen  lds
    s_add_u32 m0, m0, 1024
    s_xor_b32 s65, s69, 753664
    buffer_load_dwordx4 v1, s[48:51], s65 offen  lds
    s_mul_i32 s64, s14, 32768
    s_add_u32 m0, s64, 24576
    s_xor_b32 s65, s69, 786432
    buffer_load_dwordx4 v1, s[48:51], s65 offen  lds
    s_add_u32 m0, m0, 1024
    s_xor_b32 s65, s69, 819200
    buffer_load_dwordx4 v1, s[48:51], s65 offen  lds
    s_add_u32 m0, m0, 1024
    s_xor_b32 s65, s69, 851968
    buffer_load_dwordx4 v1, s[48:51], s65 offen  lds
    s_add_u32 m0, m0, 1024
    s_xor_b32 s65, s69, 884736
    buffer_load_dwordx4 v1, s[48:51], s65 offen  lds
    s_add_u32 m0, m0, 1024
    s_xor_b32 s65, s69, 917504
    buffer_load_dwordx4 v1, s[48:51], s65 offen  lds
    s_add_u32 m0, m0, 1024
    s_xor_b32 s65, s69, 950272
    buffer_load_dwordx4 v1, s[48:51], s65 offen  lds
    s_add_u32 m0, m0, 1024
    s_xor_b32 s65, s69, 983040
    buffer_load_dwordx4 v1, s[48:51], s65 offen  lds
    s_add_u32 m0, m0, 1024
    s_xor_b32 s65, s69, 1015808
    buffer_load_dwordx4 v1, s[48:51], s65 offen  lds
    s_waitcnt vmcnt(24)
    ds_read_b64_tr_b16 a[0:1], v12 offset:0
    ds_read_b64_tr_b16 a[2:3], v12 offset:512
    ds_read_b64_tr_b16 a[4:5], v13 offset:0
    ds_read_b64_tr_b16 a[6:7], v13 offset:512
    ds_read_b64_tr_b16 a[8:9], v12 offset:2048
    ds_read_b64_tr_b16 a[10:11], v12 offset:2560
    ds_read_b64_tr_b16 a[12:13], v13 offset:2048
    ds_read_b64_tr_b16 a[14:15], v13 offset:2560
    ds_read_b64_tr_b16 a[16:17], v12 offset:4096
    ds_read_b64_tr_b16 a[18:19], v12 offset:4608
    ds_read_b64_tr_b16 a[20:21], v13 offset:4096
    ds_read_b64_tr_b16 a[22:23], v13 offset:4608
    ds_read_b64_tr_b16 a[24:25], v12 offset:6144
    ds_read_b64_tr_b16 a[26:27], v12 offset:6656
    ds_read_b64_tr_b16 a[28:29], v13 offset:6144
    ds_read_b64_tr_b16 a[30:31], v13 offset:6656
    s_waitcnt lgkmcnt(0)
    s_mul_i32 s64, s14, 32768
    s_add_u32 m0, s64, 0
    s_xor_b32 s65, s69, 1048576
    buffer_load_dwordx4 v1, s[48:51], s65 offen  lds
    s_add_u32 m0, m0, 1024
    s_xor_b32 s65, s69, 1081344
    buffer_load_dwordx4 v1, s[48:51], s65 offen  lds
    s_add_u32 m0, m0, 1024
    s_xor_b32 s65, s69, 1114112
    buffer_load_dwordx4 v1, s[48:51], s65 offen  lds
    s_add_u32 m0, m0, 1024
    s_xor_b32 s65, s69, 1146880
    buffer_load_dwordx4 v1, s[48:51], s65 offen  lds
    s_add_u32 m0, m0, 1024
    s_xor_b32 s65, s69, 1179648
    buffer_load_dwordx4 v1, s[48:51], s65 offen  lds
    s_add_u32 m0, m0, 1024
    s_xor_b32 s65, s69, 1212416
    buffer_load_dwordx4 v1, s[48:51], s65 offen  lds
    s_add_u32 m0, m0, 1024
    s_xor_b32 s65, s69, 1245184
    buffer_load_dwordx4 v1, s[48:51], s65 offen  lds
    s_add_u32 m0, m0, 1024
    s_xor_b32 s65, s69, 1277952
    buffer_load_dwordx4 v1, s[48:51], s65 offen  lds
    s_waitcnt vmcnt(24)
    ds_read_b64_tr_b16 a[32:33], v12 offset:8192
    ds_read_b64_tr_b16 a[34:35], v12 offset:8704
    ds_read_b64_tr_b16 a[36:37], v13 offset:8192
    ds_read_b64_tr_b16 a[38:39], v13 offset:8704
    ds_read_b64_tr_b16 a[40:41], v12 offset:10240
    ds_read_b64_tr_b16 a[42:43], v12 offset:10752
    ds_read_b64_tr_b16 a[44:45], v13 offset:10240
    ds_read_b64_tr_b16 a[46:47], v13 offset:10752
    ds_read_b64_tr_b16 a[48:49], v12 offset:12288
    ds_read_b64_tr_b16 a[50:51], v12 offset:12800
    ds_read_b64_tr_b16 a[52:53], v13 offset:12288
    ds_read_b64_tr_b16 a[54:55], v13 offset:12800
    ds_read_b64_tr_b16 a[56:57], v12 offset:14336
    ds_read_b64_tr_b16 a[58:59], v12 offset:14848
    ds_read_b64_tr_b16 a[60:61], v13 offset:14336
    ds_read_b64_tr_b16 a[62:63], v13 offset:14848
    s_waitcnt lgkmcnt(0)
    s_mul_i32 s64, s14, 32768
    s_add_u32 m0, s64, 8192
    s_xor_b32 s65, s69, 1310720
    buffer_load_dwordx4 v1, s[48:51], s65 offen  lds
    s_add_u32 m0, m0, 1024
    s_xor_b32 s65, s69, 1343488
    buffer_load_dwordx4 v1, s[48:51], s65 offen  lds
    s_add_u32 m0, m0, 1024
    s_xor_b32 s65, s69, 1376256
    buffer_load_dwordx4 v1, s[48:51], s65 offen  lds
    s_add_u32 m0, m0, 1024
    s_xor_b32 s65, s69, 1409024
    buffer_load_dwordx4 v1, s[48:51], s65 offen  lds
    s_add_u32 m0, m0, 1024
    s_xor_b32 s65, s69, 1441792
    buffer_load_dwordx4 v1, s[48:51], s65 offen  lds
    s_add_u32 m0, m0, 1024
    s_xor_b32 s65, s69, 1474560
    buffer_load_dwordx4 v1, s[48:51], s65 offen  lds
    s_add_u32 m0, m0, 1024
    s_xor_b32 s65, s69, 1507328
    buffer_load_dwordx4 v1, s[48:51], s65 offen  lds
    s_add_u32 m0, m0, 1024
    s_xor_b32 s65, s69, 1540096
    buffer_load_dwordx4 v1, s[48:51], s65 offen  lds
    s_waitcnt vmcnt(24)
    ds_read_b64_tr_b16 a[64:65], v12 offset:16384
    ds_read_b64_tr_b16 a[66:67], v12 offset:16896
    ds_read_b64_tr_b16 a[68:69], v13 offset:16384
    ds_read_b64_tr_b16 a[70:71], v13 offset:16896
    ds_read_b64_tr_b16 a[72:73], v12 offset:18432
    ds_read_b64_tr_b16 a[74:75], v12 offset:18944
    ds_read_b64_tr_b16 a[76:77], v13 offset:18432
    ds_read_b64_tr_b16 a[78:79], v13 offset:18944
    ds_read_b64_tr_b16 a[80:81], v12 offset:20480
    ds_read_b64_tr_b16 a[82:83], v12 offset:20992
    ds_read_b64_tr_b16 a[84:85], v13 offset:20480
    ds_read_b64_tr_b16 a[86:87], v13 offset:20992
    ds_read_b64_tr_b16 a[88:89], v12 offset:22528
    ds_read_b64_tr_b16 a[90:91], v12 offset:23040
    ds_read_b64_tr_b16 a[92:93], v13 offset:22528
    ds_read_b64_tr_b16 a[94:95], v13 offset:23040
    s_waitcnt lgkmcnt(0)
    s_barrier
    v_mov_b32 v28, 1
    buffer_store_dword v28, v33, s[4:7], 0 offen sc1
    s_mul_i32 s64, s14, 32768
    s_add_u32 m0, s64, 16384
    s_xor_b32 s65, s69, 1572864
    buffer_load_dwordx4 v1, s[48:51], s65 offen  lds
    s_add_u32 m0, m0, 1024
    s_xor_b32 s65, s69, 1605632
    buffer_load_dwordx4 v1, s[48:51], s65 offen  lds
    s_add_u32 m0, m0, 1024
    s_xor_b32 s65, s69, 1638400
    buffer_load_dwordx4 v1, s[48:51], s65 offen  lds
    s_add_u32 m0, m0, 1024
    s_xor_b32 s65, s69, 1671168
    buffer_load_dwordx4 v1, s[48:51], s65 offen  lds
    s_add_u32 m0, m0, 1024
    s_xor_b32 s65, s69, 1703936
    buffer_load_dwordx4 v1, s[48:51], s65 offen  lds
    s_add_u32 m0, m0, 1024
    s_xor_b32 s65, s69, 1736704
    buffer_load_dwordx4 v1, s[48:51], s65 offen  lds
    s_add_u32 m0, m0, 1024
    s_xor_b32 s65, s69, 1769472
    buffer_load_dwordx4 v1, s[48:51], s65 offen  lds
    s_add_u32 m0, m0, 1024
    s_xor_b32 s65, s69, 1802240
    buffer_load_dwordx4 v1, s[48:51], s65 offen  lds
    s_waitcnt vmcnt(24)
    ds_read_b64_tr_b16 a[96:97], v12 offset:24576
    ds_read_b64_tr_b16 a[98:99], v12 offset:25088
    ds_read_b64_tr_b16 a[100:101], v13 offset:24576
    ds_read_b64_tr_b16 a[102:103], v13 offset:25088
    ds_read_b64_tr_b16 a[104:105], v12 offset:26624
    ds_read_b64_tr_b16 a[106:107], v12 offset:27136
    ds_read_b64_tr_b16 a[108:109], v13 offset:26624
    ds_read_b64_tr_b16 a[110:111], v13 offset:27136
    ds_read_b64_tr_b16 a[112:113], v12 offset:28672
    ds_read_b64_tr_b16 a[114:115], v12 offset:29184
    ds_read_b64_tr_b16 a[116:117], v13 offset:28672
    ds_read_b64_tr_b16 a[118:119], v13 offset:29184
    ds_read_b64_tr_b16 a[120:121], v12 offset:30720
    ds_read_b64_tr_b16 a[122:123], v12 offset:31232
    ds_read_b64_tr_b16 a[124:125], v13 offset:30720
    ds_read_b64_tr_b16 a[126:127], v13 offset:31232
    s_waitcnt lgkmcnt(0)
    s_mul_i32 s64, s14, 32768
    s_add_u32 m0, s64, 24576
    s_xor_b32 s65, s69, 1835008
    buffer_load_dwordx4 v1, s[48:51], s65 offen  lds
    s_add_u32 m0, m0, 1024
    s_xor_b32 s65, s69, 1867776
    buffer_load_dwordx4 v1, s[48:51], s65 offen  lds
    s_add_u32 m0, m0, 1024
    s_xor_b32 s65, s69, 1900544
    buffer_load_dwordx4 v1, s[48:51], s65 offen  lds
    s_add_u32 m0, m0, 1024
    s_xor_b32 s65, s69, 1933312
    buffer_load_dwordx4 v1, s[48:51], s65 offen  lds
    s_add_u32 m0, m0, 1024
    s_xor_b32 s65, s69, 1966080
    buffer_load_dwordx4 v1, s[48:51], s65 offen  lds
    s_add_u32 m0, m0, 1024
    s_xor_b32 s65, s69, 1998848
    buffer_load_dwordx4 v1, s[48:51], s65 offen  lds
    s_add_u32 m0, m0, 1024
    s_xor_b32 s65, s69, 2031616
    buffer_load_dwordx4 v1, s[48:51], s65 offen  lds
    s_add_u32 m0, m0, 1024
    s_xor_b32 s65, s69, 2064384
    buffer_load_dwordx4 v1, s[48:51], s65 offen  lds
    s_waitcnt vmcnt(24)
    ds_read_b64_tr_b16 a[128:129], v12 offset:0
    ds_read_b64_tr_b16 a[130:131], v12 offset:512
    ds_read_b64_tr_b16 a[132:133], v13 offset:0
    ds_read_b64_tr_b16 a[134:135], v13 offset:512
    ds_read_b64_tr_b16 a[136:137], v12 offset:2048
    ds_read_b64_tr_b16 a[138:139], v12 offset:2560
    ds_read_b64_tr_b16 a[140:141], v13 offset:2048
    ds_read_b64_tr_b16 a[142:143], v13 offset:2560
    ds_read_b64_tr_b16 a[144:145], v12 offset:4096
    ds_read_b64_tr_b16 a[146:147], v12 offset:4608
    ds_read_b64_tr_b16 a[148:149], v13 offset:4096
    ds_read_b64_tr_b16 a[150:151], v13 offset:4608
    ds_read_b64_tr_b16 a[152:153], v12 offset:6144
    ds_read_b64_tr_b16 a[154:155], v12 offset:6656
    ds_read_b64_tr_b16 a[156:157], v13 offset:6144
    ds_read_b64_tr_b16 a[158:159], v13 offset:6656
    s_waitcnt lgkmcnt(0)
    s_waitcnt vmcnt(16)
    ds_read_b64_tr_b16 a[160:161], v12 offset:8192
    ds_read_b64_tr_b16 a[162:163], v12 offset:8704
    ds_read_b64_tr_b16 a[164:165], v13 offset:8192
    ds_read_b64_tr_b16 a[166:167], v13 offset:8704
    ds_read_b64_tr_b16 a[168:169], v12 offset:10240
    ds_read_b64_tr_b16 a[170:171], v12 offset:10752
    ds_read_b64_tr_b16 a[172:173], v13 offset:10240
    ds_read_b64_tr_b16 a[174:175], v13 offset:10752
    ds_read_b64_tr_b16 a[176:177], v12 offset:12288
    ds_read_b64_tr_b16 a[178:179], v12 offset:12800
    ds_read_b64_tr_b16 a[180:181], v13 offset:12288
    ds_read_b64_tr_b16 a[182:183], v13 offset:12800
    ds_read_b64_tr_b16 a[184:185], v12 offset:14336
    ds_read_b64_tr_b16 a[186:187], v12 offset:14848
    ds_read_b64_tr_b16 a[188:189], v13 offset:14336
    ds_read_b64_tr_b16 a[190:191], v13 offset:14848
    s_waitcnt lgkmcnt(0)
    s_waitcnt vmcnt(8)
    ds_read_b64_tr_b16 a[192:193], v12 offset:16384
    ds_read_b64_tr_b16 a[194:195], v12 offset:16896
    ds_read_b64_tr_b16 a[196:197], v13 offset:16384
    ds_read_b64_tr_b16 a[198:199], v13 offset:16896
    ds_read_b64_tr_b16 a[200:201], v12 offset:18432
    ds_read_b64_tr_b16 a[202:203], v12 offset:18944
    ds_read_b64_tr_b16 a[204:205], v13 offset:18432
    ds_read_b64_tr_b16 a[206:207], v13 offset:18944
    ds_read_b64_tr_b16 a[208:209], v12 offset:20480
    ds_read_b64_tr_b16 a[210:211], v12 offset:20992
    ds_read_b64_tr_b16 a[212:213], v13 offset:20480
    ds_read_b64_tr_b16 a[214:215], v13 offset:20992
    ds_read_b64_tr_b16 a[216:217], v12 offset:22528
    ds_read_b64_tr_b16 a[218:219], v12 offset:23040
    ds_read_b64_tr_b16 a[220:221], v13 offset:22528
    ds_read_b64_tr_b16 a[222:223], v13 offset:23040
    s_waitcnt lgkmcnt(0)
    s_waitcnt vmcnt(0)
    ds_read_b64_tr_b16 a[224:225], v12 offset:24576
    ds_read_b64_tr_b16 a[226:227], v12 offset:25088
    ds_read_b64_tr_b16 a[228:229], v13 offset:24576
    ds_read_b64_tr_b16 a[230:231], v13 offset:25088
    ds_read_b64_tr_b16 a[232:233], v12 offset:26624
    ds_read_b64_tr_b16 a[234:235], v12 offset:27136
    ds_read_b64_tr_b16 a[236:237], v13 offset:26624
    ds_read_b64_tr_b16 a[238:239], v13 offset:27136
    ds_read_b64_tr_b16 a[240:241], v12 offset:28672
    ds_read_b64_tr_b16 a[242:243], v12 offset:29184
    ds_read_b64_tr_b16 a[244:245], v13 offset:28672
    ds_read_b64_tr_b16 a[246:247], v13 offset:29184
    ds_read_b64_tr_b16 a[248:249], v12 offset:30720
    ds_read_b64_tr_b16 a[250:251], v12 offset:31232
    ds_read_b64_tr_b16 a[252:253], v13 offset:30720
    ds_read_b64_tr_b16 a[254:255], v13 offset:31232
    s_waitcnt lgkmcnt(0)
    s_xor_b32 s64, s13, 2
    s_or_b32 s64, s64, s14
    s_or_b32 s64, s64, s28
    s_cbranch_scc1 L_t8_27
    v_and_b32 v28, 31, v0
    v_lshlrev_b32 v28, 2, v28
    v_add_u32 v28, 85995520, v28
L_pl_28:
    buffer_load_dword v30, v28, s[4:7], 0 offen sc1
    s_waitcnt vmcnt(0)
    v_cmp_ge_u32 vcc, 0, v30
    s_cbranch_vccz L_pk_29
    s_sleep 2
    s_sub_u32 s15, s15, 1
    s_cbranch_scc0 L_pl_28
    s_branch L_abort
L_pk_29:
    v_lshlrev_b32 v28, 4, v0
    s_mov_b32 s72, 92274688
    s_mov_b32 s74, 92278784
    buffer_load_dwordx4 v[108:111], v28, s[4:7], s72 offen offset:0 sc1
    buffer_load_dwordx4 v[112:115], v28, s[4:7], s72 offen offset:1024 sc1
    buffer_load_dwordx4 v[116:119], v28, s[4:7], s72 offen offset:2048 sc1
    buffer_load_dwordx4 v[120:123], v28, s[4:7], s72 offen offset:3072 sc1
    buffer_load_dwordx4 v[124:127], v28, s[4:7], s74 offen offset:0 sc1
    buffer_load_dwordx4 v[128:131], v28, s[4:7], s74 offen offset:1024 sc1
    buffer_load_dwordx4 v[132:135], v28, s[4:7], s74 offen offset:2048 sc1
    buffer_load_dwordx4 v[136:139], v28, s[4:7], s74 offen offset:3072 sc1
    v_lshlrev_b32 v28, 2, v0
    v_sub_u32 v28, 0xfff, v28
    s_waitcnt vmcnt(0)
    v_cvt_pk_bf16_f32 v108, 0, v108
    v_ashrrev_i32 v30, 31, v108
    v_or_b32 v30, 0x80000000, v30
    v_xor_b32 v108, v108, v30
    v_and_b32 v108, 0xffff0000, v108
    v_subrev_u32 v30, 0, v28
    v_or_b32 v108, v108, v30
    v_cvt_pk_bf16_f32 v109, 0, v109
    v_ashrrev_i32 v30, 31, v109
    v_or_b32 v30, 0x80000000, v30
    v_xor_b32 v109, v109, v30
    v_and_b32 v109, 0xffff0000, v109
    v_subrev_u32 v30, 1, v28
    v_or_b32 v109, v109, v30
    v_cvt_pk_bf16_f32 v110, 0, v110
    v_ashrrev_i32 v30, 31, v110
    v_or_b32 v30, 0x80000000, v30
    v_xor_b32 v110, v110, v30
    v_and_b32 v110, 0xffff0000, v110
    v_subrev_u32 v30, 2, v28
    v_or_b32 v110, v110, v30
    v_cvt_pk_bf16_f32 v111, 0, v111
    v_ashrrev_i32 v30, 31, v111
    v_or_b32 v30, 0x80000000, v30
    v_xor_b32 v111, v111, v30
    v_and_b32 v111, 0xffff0000, v111
    v_subrev_u32 v30, 3, v28
    v_or_b32 v111, v111, v30
    v_cvt_pk_bf16_f32 v112, 0, v112
    v_ashrrev_i32 v30, 31, v112
    v_or_b32 v30, 0x80000000, v30
    v_xor_b32 v112, v112, v30
    v_and_b32 v112, 0xffff0000, v112
    v_subrev_u32 v30, 256, v28
    v_or_b32 v112, v112, v30
    v_cvt_pk_bf16_f32 v113, 0, v113
    v_ashrrev_i32 v30, 31, v113
    v_or_b32 v30, 0x80000000, v30
    v_xor_b32 v113, v113, v30
    v_and_b32 v113, 0xffff0000, v113
    v_subrev_u32 v30, 257, v28
    v_or_b32 v113, v113, v30
    v_cvt_pk_bf16_f32 v114, 0, v114
    v_ashrrev_i32 v30, 31, v114
    v_or_b32 v30, 0x80000000, v30
    v_xor_b32 v114, v114, v30
    v_and_b32 v114, 0xffff0000, v114
    v_subrev_u32 v30, 258, v28
    v_or_b32 v114, v114, v30
    v_cvt_pk_bf16_f32 v115, 0, v115
    v_ashrrev_i32 v30, 31, v115
    v_or_b32 v30, 0x80000000, v30
    v_xor_b32 v115, v115, v30
    v_and_b32 v115, 0xffff0000, v115
    v_subrev_u32 v30, 259, v28
    v_or_b32 v115, v115, v30
    v_cvt_pk_bf16_f32 v116, 0, v116
    v_ashrrev_i32 v30, 31, v116
    v_or_b32 v30, 0x80000000, v30
    v_xor_b32 v116, v116, v30
    v_and_b32 v116, 0xffff0000, v116
    v_subrev_u32 v30, 512, v28
    v_or_b32 v116, v116, v30
    v_cvt_pk_bf16_f32 v117, 0, v117
    v_ashrrev_i32 v30, 31, v117
    v_or_b32 v30, 0x80000000, v30
    v_xor_b32 v117, v117, v30
    v_and_b32 v117, 0xffff0000, v117
    v_subrev_u32 v30, 513, v28
    v_or_b32 v117, v117, v30
    v_cvt_pk_bf16_f32 v118, 0, v118
    v_ashrrev_i32 v30, 31, v118
    v_or_b32 v30, 0x80000000, v30
    v_xor_b32 v118, v118, v30
    v_and_b32 v118, 0xffff0000, v118
    v_subrev_u32 v30, 514, v28
    v_or_b32 v118, v118, v30
    v_cvt_pk_bf16_f32 v119, 0, v119
    v_ashrrev_i32 v30, 31, v119
    v_or_b32 v30, 0x80000000, v30
    v_xor_b32 v119, v119, v30
    v_and_b32 v119, 0xffff0000, v119
    v_subrev_u32 v30, 515, v28
    v_or_b32 v119, v119, v30
    v_cvt_pk_bf16_f32 v120, 0, v120
    v_ashrrev_i32 v30, 31, v120
    v_or_b32 v30, 0x80000000, v30
    v_xor_b32 v120, v120, v30
    v_and_b32 v120, 0xffff0000, v120
    v_subrev_u32 v30, 768, v28
    v_or_b32 v120, v120, v30
    v_cvt_pk_bf16_f32 v121, 0, v121
    v_ashrrev_i32 v30, 31, v121
    v_or_b32 v30, 0x80000000, v30
    v_xor_b32 v121, v121, v30
    v_and_b32 v121, 0xffff0000, v121
    v_subrev_u32 v30, 769, v28
    v_or_b32 v121, v121, v30
    v_cvt_pk_bf16_f32 v122, 0, v122
    v_ashrrev_i32 v30, 31, v122
    v_or_b32 v30, 0x80000000, v30
    v_xor_b32 v122, v122, v30
    v_and_b32 v122, 0xffff0000, v122
    v_subrev_u32 v30, 770, v28
    v_or_b32 v122, v122, v30
    v_cvt_pk_bf16_f32 v123, 0, v123
    v_ashrrev_i32 v30, 31, v123
    v_or_b32 v30, 0x80000000, v30
    v_xor_b32 v123, v123, v30
    v_and_b32 v123, 0xffff0000, v123
    v_subrev_u32 v30, 771, v28
    v_or_b32 v123, v123, v30
    v_cvt_pk_bf16_f32 v124, 0, v124
    v_ashrrev_i32 v30, 31, v124
    v_or_b32 v30, 0x80000000, v30
    v_xor_b32 v124, v124, v30
    v_and_b32 v124, 0xffff0000, v124
    v_subrev_u32 v30, 1024, v28
    v_or_b32 v124, v124, v30
    v_cvt_pk_bf16_f32 v125, 0, v125
    v_ashrrev_i32 v30, 31, v125
    v_or_b32 v30, 0x80000000, v30
    v_xor_b32 v125, v125, v30
    v_and_b32 v125, 0xffff0000, v125
    v_subrev_u32 v30, 1025, v28
    v_or_b32 v125, v125, v30
    v_cvt_pk_bf16_f32 v126, 0, v126
    v_ashrrev_i32 v30, 31, v126
    v_or_b32 v30, 0x80000000, v30
    v_xor_b32 v126, v126, v30
    v_and_b32 v126, 0xffff0000, v126
    v_subrev_u32 v30, 1026, v28
    v_or_b32 v126, v126, v30
    v_cvt_pk_bf16_f32 v127, 0, v127
    v_ashrrev_i32 v30, 31, v127
    v_or_b32 v30, 0x80000000, v30
    v_xor_b32 v127, v127, v30
    v_and_b32 v127, 0xffff0000, v127
    v_subrev_u32 v30, 1027, v28
    v_or_b32 v127, v127, v30
    v_cvt_pk_bf16_f32 v128, 0, v128
    v_ashrrev_i32 v30, 31, v128
    v_or_b32 v30, 0x80000000, v30
    v_xor_b32 v128, v128, v30
    v_and_b32 v128, 0xffff0000, v128
    v_subrev_u32 v30, 1280, v28
    v_or_b32 v128, v128, v30
    v_cvt_pk_bf16_f32 v129, 0, v129
    v_ashrrev_i32 v30, 31, v129
    v_or_b32 v30, 0x80000000, v30
    v_xor_b32 v129, v129, v30
    v_and_b32 v129, 0xffff0000, v129
    v_subrev_u32 v30, 1281, v28
    v_or_b32 v129, v129, v30
    v_cvt_pk_bf16_f32 v130, 0, v130
    v_ashrrev_i32 v30, 31, v130
    v_or_b32 v30, 0x80000000, v30
    v_xor_b32 v130, v130, v30
    v_and_b32 v130, 0xffff0000, v130
    v_subrev_u32 v30, 1282, v28
    v_or_b32 v130, v130, v30
    v_cvt_pk_bf16_f32 v131, 0, v131
    v_ashrrev_i32 v30, 31, v131
    v_or_b32 v30, 0x80000000, v30
    v_xor_b32 v131, v131, v30
    v_and_b32 v131, 0xffff0000, v131
    v_subrev_u32 v30, 1283, v28
    v_or_b32 v131, v131, v30
    v_cvt_pk_bf16_f32 v132, 0, v132
    v_ashrrev_i32 v30, 31, v132
    v_or_b32 v30, 0x80000000, v30
    v_xor_b32 v132, v132, v30
    v_and_b32 v132, 0xffff0000, v132
    v_subrev_u32 v30, 1536, v28
    v_or_b32 v132, v132, v30
    v_cvt_pk_bf16_f32 v133, 0, v133
    v_ashrrev_i32 v30, 31, v133
    v_or_b32 v30, 0x80000000, v30
    v_xor_b32 v133, v133, v30
    v_and_b32 v133, 0xffff0000, v133
    v_subrev_u32 v30, 1537, v28
    v_or_b32 v133, v133, v30
    v_cvt_pk_bf16_f32 v134, 0, v134
    v_ashrrev_i32 v30, 31, v134
    v_or_b32 v30, 0x80000000, v30
    v_xor_b32 v134, v134, v30
    v_and_b32 v134, 0xffff0000, v134
    v_subrev_u32 v30, 1538, v28
    v_or_b32 v134, v134, v30
    v_cvt_pk_bf16_f32 v135, 0, v135
    v_ashrrev_i32 v30, 31, v135
    v_or_b32 v30, 0x80000000, v30
    v_xor_b32 v135, v135, v30
    v_and_b32 v135, 0xffff0000, v135
    v_subrev_u32 v30, 1539, v28
    v_or_b32 v135, v135, v30
    v_cvt_pk_bf16_f32 v136, 0, v136
    v_ashrrev_i32 v30, 31, v136
    v_or_b32 v30, 0x80000000, v30
    v_xor_b32 v136, v136, v30
    v_and_b32 v136, 0xffff0000, v136
    v_subrev_u32 v30, 1792, v28
    v_or_b32 v136, v136, v30
    v_cvt_pk_bf16_f32 v137, 0, v137
    v_ashrrev_i32 v30, 31, v137
    v_or_b32 v30, 0x80000000, v30
    v_xor_b32 v137, v137, v30
    v_and_b32 v137, 0xffff0000, v137
    v_subrev_u32 v30, 1793, v28
    v_or_b32 v137, v137, v30
    v_cvt_pk_bf16_f32 v138, 0, v138
    v_ashrrev_i32 v30, 31, v138
    v_or_b32 v30, 0x80000000, v30
    v_xor_b32 v138, v138, v30
    v_and_b32 v138, 0xffff0000, v138
    v_subrev_u32 v30, 1794, v28
    v_or_b32 v138, v138, v30
    v_cvt_pk_bf16_f32 v139, 0, v139
    v_ashrrev_i32 v30, 31, v139
    v_or_b32 v30, 0x80000000, v30
    v_xor_b32 v139, v139, v30
    v_and_b32 v139, 0xffff0000, v139
    v_subrev_u32 v30, 1795, v28
    v_or_b32 v139, v139, v30
    s_mov_b32 s72, 0
    s_mov_b32 s74, 0
    v_mov_b32 v46, 0
L_tk_30:
    v_max3_u32 v30, v108, v109, v110
    v_max3_u32 v30, v30, v111, v112
    v_max3_u32 v30, v30, v113, v114
    v_max3_u32 v30, v30, v115, v116
    v_max3_u32 v30, v30, v117, v118
    v_max3_u32 v30, v30, v119, v120
    v_max3_u32 v30, v30, v121, v122
    v_max3_u32 v30, v30, v123, v124
    v_max3_u32 v30, v30, v125, v126
    v_max3_u32 v30, v30, v127, v128
    v_max3_u32 v30, v30, v129, v130
    v_max3_u32 v30, v30, v131, v132
    v_max3_u32 v30, v30, v133, v134
    v_max3_u32 v30, v30, v135, v136
    v_max3_u32 v30, v30, v137, v138
    v_max_u32 v30, v30, v139
    s_nop 1
    v_max_u32_dpp v30, v30, v30 row_ror:1 row_mask:0xf bank_mask:0xf
    s_nop 1
    v_max_u32_dpp v30, v30, v30 row_ror:2 row_mask:0xf bank_mask:0xf
    s_nop 1
    v_max_u32_dpp v30, v30, v30 row_ror:4 row_mask:0xf bank_mask:0xf
    s_nop 1
    v_max_u32_dpp v30, v30, v30 row_ror:8 row_mask:0xf bank_mask:0xf
    v_mov_b32 v28, v30
    s_nop 1
    v_permlane16_swap_b32 v30, v28
    v_max_u32 v30, v30, v28
    v_mov_b32 v28, v30
    s_nop 1
    v_permlane32_swap_b32 v30, v28
    v_max_u32 v30, v30, v28
    s_nop 0
    v_readfirstlane_b32 s75, v30
    v_sub_u32 v108, v108, v30
    v_sub_u32 v109, v109, v30
    v_sub_u32 v110, v110, v30
    v_sub_u32 v111, v111, v30
    v_sub_u32 v112, v112, v30
    v_sub_u32 v113, v113, v30
    v_sub_u32 v114, v114, v30
    v_sub_u32 v115, v115, v30
    v_sub_u32 v116, v116, v30
    v_sub_u32 v117, v117, v30
    v_sub_u32 v118, v118, v30
    v_sub_u32 v119, v119, v30
    v_sub_u32 v120, v120, v30
    v_sub_u32 v121, v121, v30
    v_sub_u32 v122, v122, v30
    v_sub_u32 v123, v123, v30
    v_sub_u32 v124, v124, v30
    v_sub_u32 v125, v125, v30
    v_sub_u32 v126, v126, v30
    v_sub_u32 v127, v127, v30
    v_sub_u32 v128, v128, v30
    v_sub_u32 v129, v129, v30
    v_sub_u32 v130, v130, v30
    v_sub_u32 v131, v131, v30
    v_sub_u32 v132, v132, v30
    v_sub_u32 v133, v133, v30
    v_sub_u32 v134, v134, v30
    v_sub_u32 v135, v135, v30
    v_sub_u32 v136, v136, v30
    v_sub_u32 v137, v137, v30
    v_sub_u32 v138, v138, v30
    v_sub_u32 v139, v139, v30
    s_add_u32 s74, s74, s75
    s_mov_b32 m0, s72
    v_writelane_b32 v46, s74, m0
    s_add_u32 s72, s72, 1
    s_cmp_lt_u32 s72, 8
    s_cbranch_scc1 L_tk_30
    s_mov_b64 exec, 0xff
    buffer_store_dword v46, v44, s[4:7], 0 offen sc1
    s_mov_b64 exec, -1
L_t8_27:
L_pl_31:
    buffer_load_dword v158, v44, s[4:7], 0 offen sc1
    s_waitcnt vmcnt(0)
    v_cmp_ge_u32 vcc, 0, v158
    s_cbranch_vccz L_pk_32
    s_sleep 2
    s_sub_u32 s15, s15, 1
    s_cbranch_scc0 L_pl_31
    s_branch L_abort
L_pk_32:
    v_not_b32 v159, v158
    v_and_b32 v159, 31, v159
    v_and_b32 v28, 3, v0
    v_lshlrev_b32 v28, 3, v28
    v_add_u32 v28, 85995648, v28
    buffer_load_dwordx2 v[42:43], v28, s[4:7], 0 offen sc1
    s_mov_b32 s52, s42
    s_and_b32 s53, s43, 0xffff
    s_mov_b32 s54, 4194304
    s_mov_b32 s55, 0x20000
    s_lshr_b32 s64, s84, 1
    s_lshl_b32 s64, s64, 4
    v_and_b32 v40, 15, v0
    v_add_u32 v40, s64, v40
    v_lshrrev_b32 v30, 4, v0
    v_lshlrev_b32 v38, 11, v40
    v_lshl_add_u32 v38, v30, 3, v38
    v_add_u32 v38, s88, v38
    v_lshlrev_b32 v39, 2, v40
    v_add_u32 v39, 92282880, v39
    s_lshl_b32 s64, s14, 10
    s_add_u32 s64, s64, 131072
    v_lshlrev_b32 v41, 4, v30
    v_add_u32 v41, s64, v41
    s_lshl_b32 s64, s84, 7
    s_add_u32 s64, s64, 85991424
    v_and_b32 v32, 31, v0
    v_lshlrev_b32 v32, 2, v32
    v_add_u32 v32, s64, v32
    s_lshl_b32 s64, s14, 2
    s_add_u32 s64, s64, 135168
    v_mov_b32 v156, s64
    v_mov_b32 v157, 135168
    s_mov_b32 s68, s28
    s_mov_b32 s87, 0
    s_mov_b32 s31, 0
    s_mov_b32 s93, 0
    s_mov_b32 s86, 0
    s_xor_b32 s70, s70, 0x10000
    s_barrier
    v_not_b32 v158, v158
    v_bfe_u32 v158, v158, 5, 6
L_o_fetch:
    buffer_load_dword v33, v32, s[4:7], 0 offen sc1
    s_waitcnt vmcnt(0)
    v_lshlrev_b32 v28, 2, v33
    v_and_or_b32 v28, v0, 3, v28
    v_subrev_u32 v28, s68, v28
    v_and_b32 v30, 3, v28
    v_cmp_gt_i32 vcc, 4, v28
    v_cmp_eq_u32 s[74:75], 0, v30
    s_nop 0
    s_and_b64 vcc, vcc, s[74:75]
    s_cbranch_scc0 L_of_33
    s_sleep 1
    s_sub_u32 s15, s15, 1
    s_cbranch_scc0 L_o_fetch
    s_branch L_abort
L_of_33:
    s_lshl_b32 s71, s68, 11
    s_and_b32 s71, s71, 0x2000
    s_xor_b32 s71, s71, s100
    s_xor_b32 s71, s71, 0x2000
    s_lshl_b32 s67, s68, 19
    s_or_b32 s71, s71, s67
    s_xor_b32 s70, s70, 0x10000
    s_mov_b32 m0, s70
    s_mov_b32 s72, s71
    buffer_load_dwordx4 v2, s[4:7], s72 offen offset:0 sc1 lds
    buffer_load_dwordx4 v2, s[4:7], s72 offen offset:1024 sc1 lds
    buffer_load_dwordx4 v2, s[4:7], s72 offen offset:2048 sc1 lds
    buffer_load_dwordx4 v2, s[4:7], s72 offen offset:3072 sc1 lds
    s_add_u32 m0, m0, 0x4000
    s_add_u32 s72, s72, 0x8000
    buffer_load_dwordx4 v2, s[4:7], s72 offen offset:0 sc1 lds
    buffer_load_dwordx4 v2, s[4:7], s72 offen offset:1024 sc1 lds
    buffer_load_dwordx4 v2, s[4:7], s72 offen offset:2048 sc1 lds
    buffer_load_dwordx4 v2, s[4:7], s72 offen offset:3072 sc1 lds
    s_add_u32 m0, m0, 0x4000
    s_add_u32 s72, s72, 0x8000
    buffer_load_dwordx4 v2, s[4:7], s72 offen offset:0 sc1 lds
    buffer_load_dwordx4 v2, s[4:7], s72 offen offset:1024 sc1 lds
    buffer_load_dwordx4 v2, s[4:7], s72 offen offset:2048 sc1 lds
    buffer_load_dwordx4 v2, s[4:7], s72 offen offset:3072 sc1 lds
    s_add_u32 m0, m0, 0x4000
    s_add_u32 s72, s72, 0x8000
    buffer_load_dwordx4 v2, s[4:7], s72 offen offset:0 sc1 lds
    buffer_load_dwordx4 v2, s[4:7], s72 offen offset:1024 sc1 lds
    buffer_load_dwordx4 v2, s[4:7], s72 offen offset:2048 sc1 lds
    buffer_load_dwordx4 v2, s[4:7], s72 offen offset:3072 sc1 lds
    buffer_load_dword v33, v32, s[4:7], 0 offen sc1
    s_xor_b32 s70, s70, 0x10000
    s_mov_b32 s90, 0
    s_mov_b32 s89, -1
    s_mov_b32 s30, 2147483648
    s_mov_b32 s69, 2147483648
    s_cmp_lt_u32 s68, 53
    s_cselect_b32 s64, 1, 3
    s_add_u32 s29, s68, s64
    s_lshl_b32 s91, s29, 11
    s_and_b32 s91, s91, 0x2000
    s_xor_b32 s91, s91, s100
    s_xor_b32 s91, s91, 0x2000
    s_lshl_b32 s67, s29, 19
    s_or_b32 s91, s91, s67
    s_waitcnt vmcnt(0)
    v_lshlrev_b32 v28, 2, v33
    v_and_or_b32 v28, v0, 3, v28
    v_subrev_u32 v28, s29, v28
    v_and_b32 v30, 3, v28
    v_cmp_gt_i32 vcc, 4, v28
    v_cmp_eq_u32 s[74:75], 0, v30
    s_nop 0
    s_and_b64 vcc, vcc, s[74:75]
    s_cselect_b32 s64, 2147483648, 0
    v_mov_b32 v28, s64
    ds_write_b32 v156, v28 offset:32
    s_waitcnt lgkmcnt(0)
    s_barrier
    ds_read_b32 v28, v157 offset:32
    ds_read_b128 v[76:79], v7 offset:0
    ds_read_b128 v[80:83], v8 offset:0
    ds_read_b128 v[84:87], v7 offset:2048
    ds_read_b128 v[88:91], v8 offset:2048
    ds_read_b128 v[92:95], v7 offset:4096
    ds_read_b128 v[96:99], v8 offset:4096
    s_waitcnt lgkmcnt(6)
    v_readfirstlane_b32 s85, v28
    s_nop 0
    s_or_b32 s91, s91, s85
L_o_loop:
    s_waitcnt lgkmcnt(4)
    v_mfma_f32_16x16x32_bf16 v[12:15], a[0:3], v[76:79], 0
    ds_read_b128 v[100:103], v7 offset:6144
    v_mfma_f32_16x16x32_bf16 v[16:19], a[4:7], v[76:79], 0
    v_mfma_f32_16x16x32_bf16 v[24:27], a[4:7], v[80:83], 0
    ds_read_b128 v[104:107], v8 offset:6144
    v_mfma_f32_16x16x32_bf16 v[20:23], a[0:3], v[80:83], 0
    v_and_or_b32 v144, v144, -2, s86
    buffer_store_dwordx4 v[144:147], v34, s[4:7], s69 offen offset:1024
    s_waitcnt lgkmcnt(4)
    v_mfma_f32_16x16x32_bf16 v[12:15], a[8:11], v[84:87], v[12:15]
    ds_read_b128 v[76:79], v7 offset:8192
    v_mfma_f32_16x16x32_bf16 v[16:19], a[12:15], v[84:87], v[16:19]
    v_mfma_f32_16x16x32_bf16 v[24:27], a[12:15], v[88:91], v[24:27]
    ds_read_b128 v[80:83], v8 offset:8192
    v_mfma_f32_16x16x32_bf16 v[20:23], a[8:11], v[88:91], v[20:23]
    s_waitcnt lgkmcnt(4)
    v_mfma_f32_16x16x32_bf16 v[12:15], a[16:19], v[92:95], v[12:15]
    ds_read_b128 v[84:87], v7 offset:10240
    v_mfma_f32_16x16x32_bf16 v[16:19], a[20:23], v[92:95], v[16:19]
    v_and_or_b32 v148, v148, -2, s86
    buffer_store_dwordx4 v[148:151], v34, s[4:7], s69 offen offset:2048
    v_mfma_f32_16x16x32_bf16 v[24:27], a[20:23], v[96:99], v[24:27]
    ds_read_b128 v[88:91], v8 offset:10240
    v_mfma_f32_16x16x32_bf16 v[20:23], a[16:19], v[96:99], v[20:23]
    s_waitcnt lgkmcnt(4)
    v_mfma_f32_16x16x32_bf16 v[12:15], a[24:27], v[100:103], v[12:15]
    ds_read_b128 v[92:95], v7 offset:12288
    v_mfma_f32_16x16x32_bf16 v[16:19], a[28:31], v[100:103], v[16:19]
    v_mfma_f32_16x16x32_bf16 v[24:27], a[28:31], v[104:107], v[24:27]
    ds_read_b128 v[96:99], v8 offset:12288
    v_mfma_f32_16x16x32_bf16 v[20:23], a[24:27], v[104:107], v[20:23]
    v_and_or_b32 v152, v152, -2, s86
    buffer_store_dwordx4 v[152:155], v34, s[4:7], s69 offen offset:3072
    s_waitcnt lgkmcnt(4)
    v_mfma_f32_16x16x32_bf16 v[12:15], a[32:35], v[76:79], v[12:15]
    ds_read_b128 v[100:103], v7 offset:14336
    v_mfma_f32_16x16x32_bf16 v[16:19], a[36:39], v[76:79], v[16:19]
    v_mfma_f32_16x16x32_bf16 v[24:27], a[36:39], v[80:83], v[24:27]
    ds_read_b128 v[104:107], v8 offset:14336
    v_mfma_f32_16x16x32_bf16 v[20:23], a[32:35], v[80:83], v[20:23]
    s_waitcnt lgkmcnt(4)
    v_mfma_f32_16x16x32_bf16 v[12:15], a[40:43], v[84:87], v[12:15]
    ds_read_b128 v[76:79], v7 offset:16384
    v_mfma_f32_16x16x32_bf16 v[16:19], a[44:47], v[84:87], v[16:19]
    s_mov_b32 m0, s70
    s_mov_b32 s72, s91
    v_mfma_f32_16x16x32_bf16 v[24:27], a[44:47], v[88:91], v[24:27]
    ds_read_b128 v[80:83], v8 offset:16384
    v_mfma_f32_16x16x32_bf16 v[20:23], a[40:43], v[88:91], v[20:23]
    buffer_load_dwordx4 v2, s[4:7], s72 offen offset:0 sc1 lds
    s_waitcnt lgkmcnt(4)
    v_mfma_f32_16x16x32_bf16 v[12:15], a[48:51], v[92:95], v[12:15]
    ds_read_b128 v[84:87], v7 offset:18432
    v_mfma_f32_16x16x32_bf16 v[16:19], a[52:55], v[92:95], v[16:19]
    v_mfma_f32_16x16x32_bf16 v[24:27], a[52:55], v[96:99], v[24:27]
    ds_read_b128 v[88:91], v8 offset:18432
    v_mfma_f32_16x16x32_bf16 v[20:23], a[48:51], v[96:99], v[20:23]
    buffer_load_dwordx4 v2, s[4:7], s72 offen offset:1024 sc1 lds
    s_waitcnt lgkmcnt(4)
    v_mfma_f32_16x16x32_bf16 v[12:15], a[56:59], v[100:103], v[12:15]
    ds_read_b128 v[92:95], v7 offset:20480
    v_mfma_f32_16x16x32_bf16 v[16:19], a[60:63], v[100:103], v[16:19]
    v_mfma_f32_16x16x32_bf16 v[24:27], a[60:63], v[104:107], v[24:27]
    ds_read_b128 v[96:99], v8 offset:20480
    v_mfma_f32_16x16x32_bf16 v[20:23], a[56:59], v[104:107], v[20:23]
    buffer_load_dwordx4 v2, s[4:7], s72 offen offset:2048 sc1 lds
    s_waitcnt lgkmcnt(4)
    v_mfma_f32_16x16x32_bf16 v[12:15], a[64:67], v[76:79], v[12:15]
    ds_read_b128 v[100:103], v7 offset:22528
    v_mfma_f32_16x16x32_bf16 v[16:19], a[68:71], v[76:79], v[16:19]
    s_waitcnt vmcnt(6)
    s_cmp_lt_u32 s29, 53
    s_cselect_b32 s64, 1, 3
    s_add_u32 s73, s29, s64
    v_mfma_f32_16x16x32_bf16 v[24:27], a[68:71], v[80:83], v[24:27]
    ds_read_b128 v[104:107], v8 offset:22528
    v_mfma_f32_16x16x32_bf16 v[20:23], a[64:67], v[80:83], v[20:23]
    buffer_load_dwordx4 v2, s[4:7], s72 offen offset:3072 sc1 lds
    s_waitcnt lgkmcnt(4)
    v_mfma_f32_16x16x32_bf16 v[12:15], a[72:75], v[84:87], v[12:15]
    ds_read_b128 v[76:79], v7 offset:24576
    v_mfma_f32_16x16x32_bf16 v[16:19], a[76:79], v[84:87], v[16:19]
    s_add_u32 m0, m0, 0x4000
    s_add_u32 s72, s72, 0x8000
    v_lshlrev_b32 v28, 2, v33
    v_and_or_b32 v28, v0, 3, v28
    v_mfma_f32_16x16x32_bf16 v[24:27], a[76:79], v[88:91], v[24:27]
    ds_read_b128 v[80:83], v8 offset:24576
    v_mfma_f32_16x16x32_bf16 v[20:23], a[72:75], v[88:91], v[20:23]
    buffer_load_dwordx4 v2, s[4:7], s72 offen offset:0 sc1 lds
    s_waitcnt lgkmcnt(4)
    v_mfma_f32_16x16x32_bf16 v[12:15], a[80:83], v[92:95], v[12:15]
    ds_read_b128 v[84:87], v7 offset:26624
    v_mfma_f32_16x16x32_bf16 v[16:19], a[84:87], v[92:95], v[16:19]
    v_subrev_u32 v28, s73, v28
    v_and_b32 v30, 3, v28
    v_mfma_f32_16x16x32_bf16 v[24:27], a[84:87], v[96:99], v[24:27]
    ds_read_b128 v[88:91], v8 offset:26624
    v_mfma_f32_16x16x32_bf16 v[20:23], a[80:83], v[96:99], v[20:23]
    buffer_load_dwordx4 v2, s[4:7], s72 offen offset:1024 sc1 lds
    s_waitcnt lgkmcnt(4)
    v_mfma_f32_16x16x32_bf16 v[12:15], a[88:91], v[100:103], v[12:15]
    ds_read_b128 v[92:95], v7 offset:28672
    v_mfma_f32_16x16x32_bf16 v[16:19], a[92:95], v[100:103], v[16:19]
    v_cmp_gt_i32 vcc, 4, v28
    v_cmp_eq_u32 s[74:75], 0, v30
    buffer_load_dwordx4 v[64:67], v35, s[4:7], s87 offen offset:1024 sc1
    v_mfma_f32_16x16x32_bf16 v[24:27], a[92:95], v[104:107], v[24:27]
    ds_read_b128 v[96:99], v8 offset:28672
    v_mfma_f32_16x16x32_bf16 v[20:23], a[88:91], v[104:107], v[20:23]
    buffer_load_dwordx4 v2, s[4:7], s72 offen offset:2048 sc1 lds
    s_waitcnt lgkmcnt(4)
    v_mfma_f32_16x16x32_bf16 v[12:15], a[96:99], v[76:79], v[12:15]
    ds_read_b128 v[100:103], v7 offset:30720
    v_mfma_f32_16x16x32_bf16 v[16:19], a[100:103], v[76:79], v[16:19]
    s_and_b64 vcc, vcc, s[74:75]
    s_cselect_b32 s64, 2147483648, 0
    buffer_load_dwordx4 v[68:71], v36, s[4:7], s87 offen offset:2048 sc1
    v_mfma_f32_16x16x32_bf16 v[24:27], a[100:103], v[80:83], v[24:27]
    ds_read_b128 v[104:107], v8 offset:30720
    v_mfma_f32_16x16x32_bf16 v[20:23], a[96:99], v[80:83], v[20:23]
    buffer_load_dwordx4 v2, s[4:7], s72 offen offset:3072 sc1 lds
    s_waitcnt lgkmcnt(4)
    v_mfma_f32_16x16x32_bf16 v[12:15], a[104:107], v[84:87], v[12:15]
    ds_read_b128 v[76:79], v7 offset:32768
    v_mfma_f32_16x16x32_bf16 v[16:19], a[108:111], v[84:87], v[16:19]
    s_add_u32 m0, m0, 0x4000
    s_add_u32 s72, s72, 0x8000
    v_mov_b32 v28, s64
    ds_write_b32 v156, v28 offset:0
    buffer_load_dwordx4 v[72:75], v37, s[4:7], s87 offen offset:3072 sc1
    v_mfma_f32_16x16x32_bf16 v[24:27], a[108:111], v[88:91], v[24:27]
    ds_read_b128 v[80:83], v8 offset:32768
    v_mfma_f32_16x16x32_bf16 v[20:23], a[104:107], v[88:91], v[20:23]
    buffer_load_dwordx4 v2, s[4:7], s72 offen offset:0 sc1 lds
    s_waitcnt lgkmcnt(5)
    v_mfma_f32_16x16x32_bf16 v[12:15], a[112:115], v[92:95], v[12:15]
    ds_read_b128 v[84:87], v7 offset:34816
    v_mfma_f32_16x16x32_bf16 v[16:19], a[116:119], v[92:95], v[16:19]
    s_lshl_b32 s66, s73, 11
    s_and_b32 s66, s66, 0x2000
    s_xor_b32 s66, s66, s100
    v_mfma_f32_16x16x32_bf16 v[24:27], a[116:119], v[96:99], v[24:27]
    ds_read_b128 v[88:91], v8 offset:34816
    v_mfma_f32_16x16x32_bf16 v[20:23], a[112:115], v[96:99], v[20:23]
    buffer_load_dwordx4 v2, s[4:7], s72 offen offset:1024 sc1 lds
    s_waitcnt lgkmcnt(5)
    v_mfma_f32_16x16x32_bf16 v[12:15], a[120:123], v[100:103], v[12:15]
    ds_read_b128 v[92:95], v7 offset:36864
    v_mfma_f32_16x16x32_bf16 v[16:19], a[124:127], v[100:103], v[16:19]
    s_xor_b32 s66, s66, 0x2000
    s_lshl_b32 s67, s73, 19
    s_or_b32 s66, s66, s67
    v_mfma_f32_16x16x32_bf16 v[24:27], a[124:127], v[104:107], v[24:27]
    ds_read_b128 v[96:99], v8 offset:36864
    v_mfma_f32_16x16x32_bf16 v[20:23], a[120:123], v[104:107], v[20:23]
    buffer_load_dwordx4 v2, s[4:7], s72 offen offset:2048 sc1 lds
    s_waitcnt lgkmcnt(4)
    v_mfma_f32_16x16x32_bf16 v[12:15], a[128:131], v[76:79], v[12:15]
    ds_read_b128 v[100:103], v7 offset:38912
    v_mfma_f32_16x16x32_bf16 v[16:19], a[132:135], v[76:79], v[16:19]
    s_or_b32 s66, s66, s64
    v_mul_f32 v56, 0xbfb8aa3b, v48
    v_exp_f32 v56, v56
    v_mfma_f32_16x16x32_bf16 v[24:27], a[132:135], v[80:83], v[24:27]
    ds_read_b128 v[104:107], v8 offset:38912
    v_mfma_f32_16x16x32_bf16 v[20:23], a[128:131], v[80:83], v[20:23]
    buffer_load_dwordx4 v2, s[4:7], s72 offen offset:3072 sc1 lds
    s_waitcnt lgkmcnt(4)
    v_mfma_f32_16x16x32_bf16 v[12:15], a[136:139], v[84:87], v[12:15]
    ds_read_b128 v[76:79], v7 offset:40960
    v_mfma_f32_16x16x32_bf16 v[16:19], a[140:143], v[84:87], v[16:19]
    s_add_u32 m0, m0, 0x4000
    s_add_u32 s72, s72, 0x8000
    v_lshlrev_b32 v52, 16, v46
    v_add_f32 v56, 1.0, v56
    v_rcp_f32 v56, v56
    v_mfma_f32_16x16x32_bf16 v[24:27], a[140:143], v[88:91], v[24:27]
    ds_read_b128 v[80:83], v8 offset:40960
    v_mfma_f32_16x16x32_bf16 v[20:23], a[136:139], v[88:91], v[20:23]
    buffer_load_dwordx4 v2, s[4:7], s72 offen offset:0 sc1 lds
    s_waitcnt lgkmcnt(4)
    v_mfma_f32_16x16x32_bf16 v[12:15], a[144:147], v[92:95], v[12:15]
    ds_read_b128 v[84:87], v7 offset:43008
    v_mfma_f32_16x16x32_bf16 v[16:19], a[148:151], v[92:95], v[16:19]
    v_and_b32 v53, 0xffff0000, v46
    v_lshlrev_b32 v54, 16, v47
    v_and_b32 v55, 0xffff0000, v47
    v_mfma_f32_16x16x32_bf16 v[24:27], a[148:151], v[96:99], v[24:27]
    ds_read_b128 v[88:91], v8 offset:43008
    v_mfma_f32_16x16x32_bf16 v[20:23], a[144:147], v[96:99], v[20:23]
    buffer_load_dwordx4 v2, s[4:7], s72 offen offset:1024 sc1 lds
    s_waitcnt lgkmcnt(4)
    v_mfma_f32_16x16x32_bf16 v[12:15], a[152:155], v[100:103], v[12:15]
    ds_read_b128 v[92:95], v7 offset:45056
    v_mfma_f32_16x16x32_bf16 v[16:19], a[156:159], v[100:103], v[16:19]
    v_pk_add_f32 v[60:61], v[140:141], v[52:53] neg_lo:[0,1] neg_hi:[0,1]
    v_pk_add_f32 v[62:63], v[142:143], v[54:55] neg_lo:[0,1] neg_hi:[0,1]
    v_mfma_f32_16x16x32_bf16 v[24:27], a[156:159], v[104:107], v[24:27]
    ds_read_b128 v[96:99], v8 offset:45056
    v_mfma_f32_16x16x32_bf16 v[20:23], a[152:155], v[104:107], v[20:23]
    buffer_load_dwordx4 v2, s[4:7], s72 offen offset:2048 sc1 lds
    s_waitcnt lgkmcnt(4)
    v_mfma_f32_16x16x32_bf16 v[12:15], a[160:163], v[76:79], v[12:15]
    ds_read_b128 v[100:103], v7 offset:47104
    v_mfma_f32_16x16x32_bf16 v[16:19], a[164:167], v[76:79], v[16:19]
    v_mfma_f32_16x16x32_bf16 v[24:27], a[164:167], v[80:83], v[24:27]
    ds_read_b128 v[104:107], v8 offset:47104
    v_mfma_f32_16x16x32_bf16 v[20:23], a[160:163], v[80:83], v[20:23]
    buffer_load_dwordx4 v2, s[4:7], s72 offen offset:3072 sc1 lds
    s_waitcnt lgkmcnt(4)
    v_mfma_f32_16x16x32_bf16 v[12:15], a[168:171], v[84:87], v[12:15]
    ds_read_b128 v[76:79], v7 offset:49152
    v_mfma_f32_16x16x32_bf16 v[16:19], a[172:175], v[84:87], v[16:19]
    v_mfma_f32_16x16x32_bf16 v[24:27], a[172:175], v[88:91], v[24:27]
    ds_read_b128 v[80:83], v8 offset:49152
    v_mfma_f32_16x16x32_bf16 v[20:23], a[168:171], v[88:91], v[20:23]
    s_mov_b32 s92, 0
    s_waitcnt vmcnt(8)
    s_waitcnt lgkmcnt(4)
    v_mfma_f32_16x16x32_bf16 v[12:15], a[176:179], v[92:95], v[12:15]
    ds_read_b128 v[84:87], v7 offset:51200
    v_mfma_f32_16x16x32_bf16 v[16:19], a[180:183], v[92:95], v[16:19]
    v_bitop3_b32 v28, v64, v68, s86 bitop3:0x7e
    v_bitop3_b32 v28, v28, v72, s86 bitop3:0xf6
    v_mfma_f32_16x16x32_bf16 v[24:27], a[180:183], v[96:99], v[24:27]
    ds_read_b128 v[88:91], v8 offset:51200
    v_mfma_f32_16x16x32_bf16 v[20:23], a[176:179], v[96:99], v[20:23]
    v_and_b32 v28, s90, v28
    v_cmp_ne_u32 vcc, 0, v28
    s_waitcnt lgkmcnt(4)
    v_mfma_f32_16x16x32_bf16 v[12:15], a[184:187], v[100:103], v[12:15]
    ds_read_b128 v[92:95], v7 offset:53248
    v_mfma_f32_16x16x32_bf16 v[16:19], a[188:191], v[100:103], v[16:19]
    s_lshl_b32 s65, s68, 16
    s_lshl_b32 s64, s68, 7
    v_mfma_f32_16x16x32_bf16 v[24:27], a[188:191], v[104:107], v[24:27]
    ds_read_b128 v[96:99], v8 offset:53248
    v_mfma_f32_16x16x32_bf16 v[20:23], a[184:187], v[104:107], v[20:23]
    s_cbranch_vccnz L_o_again
L_o_ok0:
    s_waitcnt lgkmcnt(4)
    v_mfma_f32_16x16x32_bf16 v[12:15], a[192:195], v[76:79], v[12:15]
    ds_read_b128 v[100:103], v7 offset:55296
    v_mfma_f32_16x16x32_bf16 v[16:19], a[196:199], v[76:79], v[16:19]
    buffer_load_dword v6, v5, s[4:7], s66 offen sc1
    v_pk_add_f32 v[64:65], v[60:61], v[64:65]
    v_pk_add_f32 v[68:69], v[68:69], v[72:73]
    v_mfma_f32_16x16x32_bf16 v[24:27], a[196:199], v[80:83], v[24:27]
    ds_read_b128 v[104:107], v8 offset:55296
    v_mfma_f32_16x16x32_bf16 v[20:23], a[192:195], v[80:83], v[20:23]
    buffer_load_dwordx2 v[46:47], v38, s[8:11], s65 offen
    v_pk_add_f32 v[66:67], v[62:63], v[66:67]
    v_pk_add_f32 v[70:71], v[70:71], v[74:75]
    s_waitcnt lgkmcnt(4)
    v_mfma_f32_16x16x32_bf16 v[12:15], a[200:203], v[84:87], v[12:15]
    ds_read_b128 v[76:79], v7 offset:57344
    v_mfma_f32_16x16x32_bf16 v[16:19], a[204:207], v[84:87], v[16:19]
    buffer_load_dword v48, v39, s[4:7], s64 offen sc1
    v_pk_add_f32 v[64:65], v[64:65], v[68:69]
    v_pk_fma_f32 v[64:65], v[64:65], v[56:57], v[52:53] op_sel_hi:[1,0,1]
    v_mfma_f32_16x16x32_bf16 v[24:27], a[204:207], v[88:91], v[24:27]
    ds_read_b128 v[80:83], v8 offset:57344
    v_mfma_f32_16x16x32_bf16 v[20:23], a[200:203], v[88:91], v[20:23]
    buffer_load_dword v33, v32, s[4:7], 0 offen sc1
    v_pk_add_f32 v[66:67], v[66:67], v[70:71]
    v_pk_fma_f32 v[66:67], v[66:67], v[56:57], v[54:55] op_sel_hi:[1,0,1]
    s_waitcnt lgkmcnt(4)
    v_mfma_f32_16x16x32_bf16 v[12:15], a[208:211], v[92:95], v[12:15]
    ds_read_b128 v[84:87], v7 offset:59392
    v_mfma_f32_16x16x32_bf16 v[16:19], a[212:215], v[92:95], v[16:19]
    v_cvt_pk_bf16_f32 v68, v64, v65
    v_cvt_pk_bf16_f32 v69, v66, v67
    v_mfma_f32_16x16x32_bf16 v[24:27], a[212:215], v[96:99], v[24:27]
    ds_read_b128 v[88:91], v8 offset:59392
    v_mfma_f32_16x16x32_bf16 v[20:23], a[208:211], v[96:99], v[20:23]
    buffer_store_dwordx2 v[68:69], v38, s[52:55], s30 offen
    v_cmp_eq_u32 vcc, s89, v158
    s_waitcnt lgkmcnt(4)
    v_mfma_f32_16x16x32_bf16 v[12:15], a[216:219], v[100:103], v[12:15]
    ds_read_b128 v[92:95], v7 offset:61440
    v_mfma_f32_16x16x32_bf16 v[16:19], a[220:223], v[100:103], v[16:19]
    v_mfma_f32_16x16x32_bf16 v[24:27], a[220:223], v[104:107], v[24:27]
    ds_read_b128 v[96:99], v8 offset:61440
    v_mfma_f32_16x16x32_bf16 v[20:23], a[216:219], v[104:107], v[20:23]
    s_cbranch_vccnz L_o_save
L_o_saved0:
    s_waitcnt lgkmcnt(4)
    v_mfma_f32_16x16x32_bf16 v[12:15], a[224:227], v[76:79], v[12:15]
    ds_read_b128 v[100:103], v7 offset:63488
    v_mfma_f32_16x16x32_bf16 v[16:19], a[228:231], v[76:79], v[16:19]
    s_mov_b32 s89, s68
    s_lshl_b32 s30, s68, 16
    v_mfma_f32_16x16x32_bf16 v[24:27], a[228:231], v[80:83], v[24:27]
    ds_read_b128 v[104:107], v8 offset:63488
    v_xor_b32 v7, 0x10000, v7
    v_xor_b32 v8, 0x10000, v8
    v_mfma_f32_16x16x32_bf16 v[20:23], a[224:227], v[80:83], v[20:23]
    s_mov_b32 s68, s29
    s_mov_b32 s29, s73
    s_waitcnt vmcnt(5)
    s_barrier
    s_waitcnt lgkmcnt(4)
    v_mfma_f32_16x16x32_bf16 v[12:15], a[232:235], v[84:87], v[12:15]
    ds_read_b128 v[76:79], v7 offset:0
    v_mfma_f32_16x16x32_bf16 v[16:19], a[236:239], v[84:87], v[16:19]
    ds_read_b32 v31, v157 offset:0
    s_mov_b32 s90, 1
    s_and_b32 s87, s31, 1
    v_mfma_f32_16x16x32_bf16 v[24:27], a[236:239], v[88:91], v[24:27]
    ds_read_b128 v[80:83], v8 offset:0
    v_mfma_f32_16x16x32_bf16 v[20:23], a[232:235], v[88:91], v[20:23]
    s_lshl_b32 s87, s87, 19
    s_mov_b32 s69, s87
    s_xor_b32 s70, s70, 0x10000
    s_add_u32 s71, s71, 0x10000
    s_waitcnt lgkmcnt(5)
    v_mfma_f32_16x16x32_bf16 v[12:15], a[240:243], v[92:95], v[12:15]
    ds_read_b128 v[84:87], v7 offset:2048
    v_mfma_f32_16x16x32_bf16 v[16:19], a[244:247], v[92:95], v[16:19]
    s_bfe_u32 s86, s31, 0x10001
    s_add_u32 s31, s31, 1
    v_mfma_f32_16x16x32_bf16 v[24:27], a[244:247], v[96:99], v[24:27]
    ds_read_b128 v[88:91], v8 offset:2048
    v_mfma_f32_16x16x32_bf16 v[20:23], a[240:243], v[96:99], v[20:23]
    s_lshl_b32 s91, s29, 11
    s_and_b32 s91, s91, 0x2000
    s_waitcnt lgkmcnt(5)
    v_mfma_f32_16x16x32_bf16 v[12:15], a[248:251], v[100:103], v[12:15]
    ds_read_b128 v[92:95], v7 offset:4096
    v_mfma_f32_16x16x32_bf16 v[16:19], a[252:255], v[100:103], v[16:19]
    s_xor_b32 s91, s91, s100
    s_xor_b32 s91, s91, 0x2000
    v_mfma_f32_16x16x32_bf16 v[24:27], a[252:255], v[104:107], v[24:27]
    ds_read_b128 v[96:99], v8 offset:4096
    v_mfma_f32_16x16x32_bf16 v[20:23], a[248:251], v[104:107], v[20:23]
    s_lshl_b32 s67, s29, 19
    s_or_b32 s91, s91, s67
    s_waitcnt lgkmcnt(5)
    v_readfirstlane_b32 s64, v31
    s_cmp_lg_u32 s85, 0
    s_cbranch_scc1 L_o_drain0
    s_mov_b32 s85, s64
    s_or_b32 s91, s91, s64
    s_waitcnt lgkmcnt(4)
    v_mfma_f32_16x16x32_bf16 v[140:143], a[0:3], v[76:79], 0
    ds_read_b128 v[100:103], v7 offset:6144
    v_mfma_f32_16x16x32_bf16 v[144:147], a[4:7], v[76:79], 0
    v_mfma_f32_16x16x32_bf16 v[152:155], a[4:7], v[80:83], 0
    ds_read_b128 v[104:107], v8 offset:6144
    v_mfma_f32_16x16x32_bf16 v[148:151], a[0:3], v[80:83], 0
    v_and_or_b32 v16, v16, -2, s86
    buffer_store_dwordx4 v[16:19], v34, s[4:7], s69 offen offset:1024
    s_waitcnt lgkmcnt(4)
    v_mfma_f32_16x16x32_bf16 v[140:143], a[8:11], v[84:87], v[140:143]
    ds_read_b128 v[76:79], v7 offset:8192
    v_mfma_f32_16x16x32_bf16 v[144:147], a[12:15], v[84:87], v[144:147]
    v_mfma_f32_16x16x32_bf16 v[152:155], a[12:15], v[88:91], v[152:155]
    ds_read_b128 v[80:83], v8 offset:8192
    v_mfma_f32_16x16x32_bf16 v[148:151], a[8:11], v[88:91], v[148:151]
    s_waitcnt lgkmcnt(4)
    v_mfma_f32_16x16x32_bf16 v[140:143], a[16:19], v[92:95], v[140:143]
    ds_read_b128 v[84:87], v7 offset:10240
    v_mfma_f32_16x16x32_bf16 v[144:147], a[20:23], v[92:95], v[144:147]
    v_and_or_b32 v20, v20, -2, s86
    buffer_store_dwordx4 v[20:23], v34, s[4:7], s69 offen offset:2048
    v_mfma_f32_16x16x32_bf16 v[152:155], a[20:23], v[96:99], v[152:155]
    ds_read_b128 v[88:91], v8 offset:10240
    v_mfma_f32_16x16x32_bf16 v[148:151], a[16:19], v[96:99], v[148:151]
    s_waitcnt lgkmcnt(4)
    v_mfma_f32_16x16x32_bf16 v[140:143], a[24:27], v[100:103], v[140:143]
    ds_read_b128 v[92:95], v7 offset:12288
    v_mfma_f32_16x16x32_bf16 v[144:147], a[28:31], v[100:103], v[144:147]
    v_mfma_f32_16x16x32_bf16 v[152:155], a[28:31], v[104:107], v[152:155]
    ds_read_b128 v[96:99], v8 offset:12288
    v_mfma_f32_16x16x32_bf16 v[148:151], a[24:27], v[104:107], v[148:151]
    v_and_or_b32 v24, v24, -2, s86
    buffer_store_dwordx4 v[24:27], v34, s[4:7], s69 offen offset:3072
    s_waitcnt lgkmcnt(4)
    v_mfma_f32_16x16x32_bf16 v[140:143], a[32:35], v[76:79], v[140:143]
    ds_read_b128 v[100:103], v7 offset:14336
    v_mfma_f32_16x16x32_bf16 v[144:147], a[36:39], v[76:79], v[144:147]
    v_mfma_f32_16x16x32_bf16 v[152:155], a[36:39], v[80:83], v[152:155]
    ds_read_b128 v[104:107], v8 offset:14336
    v_mfma_f32_16x16x32_bf16 v[148:151], a[32:35], v[80:83], v[148:151]
    s_waitcnt lgkmcnt(4)
    v_mfma_f32_16x16x32_bf16 v[140:143], a[40:43], v[84:87], v[140:143]
    ds_read_b128 v[76:79], v7 offset:16384
    v_mfma_f32_16x16x32_bf16 v[144:147], a[44:47], v[84:87], v[144:147]
    s_mov_b32 m0, s70
    s_mov_b32 s72, s91
    v_mfma_f32_16x16x32_bf16 v[152:155], a[44:47], v[88:91], v[152:155]
    ds_read_b128 v[80:83], v8 offset:16384
    v_mfma_f32_16x16x32_bf16 v[148:151], a[40:43], v[88:91], v[148:151]
    buffer_load_dwordx4 v2, s[4:7], s72 offen offset:0 sc1 lds
    s_waitcnt lgkmcnt(4)
    v_mfma_f32_16x16x32_bf16 v[140:143], a[48:51], v[92:95], v[140:143]
    ds_read_b128 v[84:87], v7 offset:18432
    v_mfma_f32_16x16x32_bf16 v[144:147], a[52:55], v[92:95], v[144:147]
    v_mfma_f32_16x16x32_bf16 v[152:155], a[52:55], v[96:99], v[152:155]
    ds_read_b128 v[88:91], v8 offset:18432
    v_mfma_f32_16x16x32_bf16 v[148:151], a[48:51], v[96:99], v[148:151]
    buffer_load_dwordx4 v2, s[4:7], s72 offen offset:1024 sc1 lds
    s_waitcnt lgkmcnt(4)
    v_mfma_f32_16x16x32_bf16 v[140:143], a[56:59], v[100:103], v[140:143]
    ds_read_b128 v[92:95], v7 offset:20480
    v_mfma_f32_16x16x32_bf16 v[144:147], a[60:63], v[100:103], v[144:147]
    v_mfma_f32_16x16x32_bf16 v[152:155], a[60:63], v[104:107], v[152:155]
    ds_read_b128 v[96:99], v8 offset:20480
    v_mfma_f32_16x16x32_bf16 v[148:151], a[56:59], v[104:107], v[148:151]
    buffer_load_dwordx4 v2, s[4:7], s72 offen offset:2048 sc1 lds
    s_waitcnt lgkmcnt(4)
    v_mfma_f32_16x16x32_bf16 v[140:143], a[64:67], v[76:79], v[140:143]
    ds_read_b128 v[100:103], v7 offset:22528
    v_mfma_f32_16x16x32_bf16 v[144:147], a[68:71], v[76:79], v[144:147]
    s_waitcnt vmcnt(6)
    s_cmp_lt_u32 s29, 53
    s_cselect_b32 s64, 1, 3
    s_add_u32 s73, s29, s64
    v_mfma_f32_16x16x32_bf16 v[152:155], a[68:71], v[80:83], v[152:155]
    ds_read_b128 v[104:107], v8 offset:22528
    v_mfma_f32_16x16x32_bf16 v[148:151], a[64:67], v[80:83], v[148:151]
    buffer_load_dwordx4 v2, s[4:7], s72 offen offset:3072 sc1 lds
    s_waitcnt lgkmcnt(4)
    v_mfma_f32_16x16x32_bf16 v[140:143], a[72:75], v[84:87], v[140:143]
    ds_read_b128 v[76:79], v7 offset:24576
    v_mfma_f32_16x16x32_bf16 v[144:147], a[76:79], v[84:87], v[144:147]
    s_add_u32 m0, m0, 0x4000
    s_add_u32 s72, s72, 0x8000
    v_lshlrev_b32 v28, 2, v33
    v_and_or_b32 v28, v0, 3, v28
    v_mfma_f32_16x16x32_bf16 v[152:155], a[76:79], v[88:91], v[152:155]
    ds_read_b128 v[80:83], v8 offset:24576
    v_mfma_f32_16x16x32_bf16 v[148:151], a[72:75], v[88:91], v[148:151]
    buffer_load_dwordx4 v2, s[4:7], s72 offen offset:0 sc1 lds
    s_waitcnt lgkmcnt(4)
    v_mfma_f32_16x16x32_bf16 v[140:143], a[80:83], v[92:95], v[140:143]
    ds_read_b128 v[84:87], v7 offset:26624
    v_mfma_f32_16x16x32_bf16 v[144:147], a[84:87], v[92:95], v[144:147]
    v_subrev_u32 v28, s73, v28
    v_and_b32 v30, 3, v28
    v_mfma_f32_16x16x32_bf16 v[152:155], a[84:87], v[96:99], v[152:155]
    ds_read_b128 v[88:91], v8 offset:26624
    v_mfma_f32_16x16x32_bf16 v[148:151], a[80:83], v[96:99], v[148:151]
    buffer_load_dwordx4 v2, s[4:7], s72 offen offset:1024 sc1 lds
    s_waitcnt lgkmcnt(4)
    v_mfma_f32_16x16x32_bf16 v[140:143], a[88:91], v[100:103], v[140:143]
    ds_read_b128 v[92:95], v7 offset:28672
    v_mfma_f32_16x16x32_bf16 v[144:147], a[92:95], v[100:103], v[144:147]
    v_cmp_gt_i32 vcc, 4, v28
    v_cmp_eq_u32 s[74:75], 0, v30
    buffer_load_dwordx4 v[64:67], v35, s[4:7], s87 offen offset:1024 sc1
    v_mfma_f32_16x16x32_bf16 v[152:155], a[92:95], v[104:107], v[152:155]
    ds_read_b128 v[96:99], v8 offset:28672
    v_mfma_f32_16x16x32_bf16 v[148:151], a[88:91], v[104:107], v[148:151]
    buffer_load_dwordx4 v2, s[4:7], s72 offen offset:2048 sc1 lds
    s_waitcnt lgkmcnt(4)
    v_mfma_f32_16x16x32_bf16 v[140:143], a[96:99], v[76:79], v[140:143]
    ds_read_b128 v[100:103], v7 offset:30720
    v_mfma_f32_16x16x32_bf16 v[144:147], a[100:103], v[76:79], v[144:147]
    s_and_b64 vcc, vcc, s[74:75]
    s_cselect_b32 s64, 2147483648, 0
    buffer_load_dwordx4 v[68:71], v36, s[4:7], s87 offen offset:2048 sc1
    v_mfma_f32_16x16x32_bf16 v[152:155], a[100:103], v[80:83], v[152:155]
    ds_read_b128 v[104:107], v8 offset:30720
    v_mfma_f32_16x16x32_bf16 v[148:151], a[96:99], v[80:83], v[148:151]
    buffer_load_dwordx4 v2, s[4:7], s72 offen offset:3072 sc1 lds
    s_waitcnt lgkmcnt(4)
    v_mfma_f32_16x16x32_bf16 v[140:143], a[104:107], v[84:87], v[140:143]
    ds_read_b128 v[76:79], v7 offset:32768
    v_mfma_f32_16x16x32_bf16 v[144:147], a[108:111], v[84:87], v[144:147]
    s_add_u32 m0, m0, 0x4000
    s_add_u32 s72, s72, 0x8000
    v_mov_b32 v28, s64
    ds_write_b32 v156, v28 offset:16
    buffer_load_dwordx4 v[72:75], v37, s[4:7], s87 offen offset:3072 sc1
    v_mfma_f32_16x16x32_bf16 v[152:155], a[108:111], v[88:91], v[152:155]
    ds_read_b128 v[80:83], v8 offset:32768
    v_mfma_f32_16x16x32_bf16 v[148:151], a[104:107], v[88:91], v[148:151]
    buffer_load_dwordx4 v2, s[4:7], s72 offen offset:0 sc1 lds
    s_waitcnt lgkmcnt(5)
    v_mfma_f32_16x16x32_bf16 v[140:143], a[112:115], v[92:95], v[140:143]
    ds_read_b128 v[84:87], v7 offset:34816
    v_mfma_f32_16x16x32_bf16 v[144:147], a[116:119], v[92:95], v[144:147]
    s_lshl_b32 s66, s73, 11
    s_and_b32 s66, s66, 0x2000
    s_xor_b32 s66, s66, s100
    v_mfma_f32_16x16x32_bf16 v[152:155], a[116:119], v[96:99], v[152:155]
    ds_read_b128 v[88:91], v8 offset:34816
    v_mfma_f32_16x16x32_bf16 v[148:151], a[112:115], v[96:99], v[148:151]
    buffer_load_dwordx4 v2, s[4:7], s72 offen offset:1024 sc1 lds
    s_waitcnt lgkmcnt(5)
    v_mfma_f32_16x16x32_bf16 v[140:143], a[120:123], v[100:103], v[140:143]
    ds_read_b128 v[92:95], v7 offset:36864
    v_mfma_f32_16x16x32_bf16 v[144:147], a[124:127], v[100:103], v[144:147]
    s_xor_b32 s66, s66, 0x2000
    s_lshl_b32 s67, s73, 19
    s_or_b32 s66, s66, s67
    v_mfma_f32_16x16x32_bf16 v[152:155], a[124:127], v[104:107], v[152:155]
    ds_read_b128 v[96:99], v8 offset:36864
    v_mfma_f32_16x16x32_bf16 v[148:151], a[120:123], v[104:107], v[148:151]
    buffer_load_dwordx4 v2, s[4:7], s72 offen offset:2048 sc1 lds
    s_waitcnt lgkmcnt(4)
    v_mfma_f32_16x16x32_bf16 v[140:143], a[128:131], v[76:79], v[140:143]
    ds_read_b128 v[100:103], v7 offset:38912
    v_mfma_f32_16x16x32_bf16 v[144:147], a[132:135], v[76:79], v[144:147]
    s_or_b32 s66, s66, s64
    v_mul_f32 v56, 0xbfb8aa3b, v48
    v_exp_f32 v56, v56
    v_mfma_f32_16x16x32_bf16 v[152:155], a[132:135], v[80:83], v[152:155]
    ds_read_b128 v[104:107], v8 offset:38912
    v_mfma_f32_16x16x32_bf16 v[148:151], a[128:131], v[80:83], v[148:151]
    buffer_load_dwordx4 v2, s[4:7], s72 offen offset:3072 sc1 lds
    s_waitcnt lgkmcnt(4)
    v_mfma_f32_16x16x32_bf16 v[140:143], a[136:139], v[84:87], v[140:143]
    ds_read_b128 v[76:79], v7 offset:40960
    v_mfma_f32_16x16x32_bf16 v[144:147], a[140:143], v[84:87], v[144:147]
    s_add_u32 m0, m0, 0x4000
    s_add_u32 s72, s72, 0x8000
    v_lshlrev_b32 v52, 16, v46
    v_add_f32 v56, 1.0, v56
    v_rcp_f32 v56, v56
    v_mfma_f32_16x16x32_bf16 v[152:155], a[140:143], v[88:91], v[152:155]
    ds_read_b128 v[80:83], v8 offset:40960
    v_mfma_f32_16x16x32_bf16 v[148:151], a[136:139], v[88:91], v[148:151]
    buffer_load_dwordx4 v2, s[4:7], s72 offen offset:0 sc1 lds
    s_waitcnt lgkmcnt(4)
    v_mfma_f32_16x16x32_bf16 v[140:143], a[144:147], v[92:95], v[140:143]
    ds_read_b128 v[84:87], v7 offset:43008
    v_mfma_f32_16x16x32_bf16 v[144:147], a[148:151], v[92:95], v[144:147]
    v_and_b32 v53, 0xffff0000, v46
    v_lshlrev_b32 v54, 16, v47
    v_and_b32 v55, 0xffff0000, v47
    v_mfma_f32_16x16x32_bf16 v[152:155], a[148:151], v[96:99], v[152:155]
    ds_read_b128 v[88:91], v8 offset:43008
    v_mfma_f32_16x16x32_bf16 v[148:151], a[144:147], v[96:99], v[148:151]
    buffer_load_dwordx4 v2, s[4:7], s72 offen offset:1024 sc1 lds
    s_waitcnt lgkmcnt(4)
    v_mfma_f32_16x16x32_bf16 v[140:143], a[152:155], v[100:103], v[140:143]
    ds_read_b128 v[92:95], v7 offset:45056
    v_mfma_f32_16x16x32_bf16 v[144:147], a[156:159], v[100:103], v[144:147]
    v_pk_add_f32 v[60:61], v[12:13], v[52:53] neg_lo:[0,1] neg_hi:[0,1]
    v_pk_add_f32 v[62:63], v[14:15], v[54:55] neg_lo:[0,1] neg_hi:[0,1]
    v_mfma_f32_16x16x32_bf16 v[152:155], a[156:159], v[104:107], v[152:155]
    ds_read_b128 v[96:99], v8 offset:45056
    v_mfma_f32_16x16x32_bf16 v[148:151], a[152:155], v[104:107], v[148:151]
    buffer_load_dwordx4 v2, s[4:7], s72 offen offset:2048 sc1 lds
    s_waitcnt lgkmcnt(4)
    v_mfma_f32_16x16x32_bf16 v[140:143], a[160:163], v[76:79], v[140:143]
    ds_read_b128 v[100:103], v7 offset:47104
    v_mfma_f32_16x16x32_bf16 v[144:147], a[164:167], v[76:79], v[144:147]
    v_mfma_f32_16x16x32_bf16 v[152:155], a[164:167], v[80:83], v[152:155]
    ds_read_b128 v[104:107], v8 offset:47104
    v_mfma_f32_16x16x32_bf16 v[148:151], a[160:163], v[80:83], v[148:151]
    buffer_load_dwordx4 v2, s[4:7], s72 offen offset:3072 sc1 lds
    s_waitcnt lgkmcnt(4)
    v_mfma_f32_16x16x32_bf16 v[140:143], a[168:171], v[84:87], v[140:143]
    ds_read_b128 v[76:79], v7 offset:49152
    v_mfma_f32_16x16x32_bf16 v[144:147], a[172:175], v[84:87], v[144:147]
    v_mfma_f32_16x16x32_bf16 v[152:155], a[172:175], v[88:91], v[152:155]
    ds_read_b128 v[80:83], v8 offset:49152
    v_mfma_f32_16x16x32_bf16 v[148:151], a[168:171], v[88:91], v[148:151]
    s_mov_b32 s92, 1
    s_waitcnt vmcnt(8)
    s_waitcnt lgkmcnt(4)
    v_mfma_f32_16x16x32_bf16 v[140:143], a[176:179], v[92:95], v[140:143]
    ds_read_b128 v[84:87], v7 offset:51200
    v_mfma_f32_16x16x32_bf16 v[144:147], a[180:183], v[92:95], v[144:147]
    v_bitop3_b32 v28, v64, v68, s86 bitop3:0x7e
    v_bitop3_b32 v28, v28, v72, s86 bitop3:0xf6
    v_mfma_f32_16x16x32_bf16 v[152:155], a[180:183], v[96:99], v[152:155]
    ds_read_b128 v[88:91], v8 offset:51200
    v_mfma_f32_16x16x32_bf16 v[148:151], a[176:179], v[96:99], v[148:151]
    v_and_b32 v28, s90, v28
    v_cmp_ne_u32 vcc, 0, v28
    s_waitcnt lgkmcnt(4)
    v_mfma_f32_16x16x32_bf16 v[140:143], a[184:187], v[100:103], v[140:143]
    ds_read_b128 v[92:95], v7 offset:53248
    v_mfma_f32_16x16x32_bf16 v[144:147], a[188:191], v[100:103], v[144:147]
    s_lshl_b32 s65, s68, 16
    s_lshl_b32 s64, s68, 7
    v_mfma_f32_16x16x32_bf16 v[152:155], a[188:191], v[104:107], v[152:155]
    ds_read_b128 v[96:99], v8 offset:53248
    v_mfma_f32_16x16x32_bf16 v[148:151], a[184:187], v[104:107], v[148:151]
    s_cbranch_vccnz L_o_again
L_o_ok1:
    s_waitcnt lgkmcnt(4)
    v_mfma_f32_16x16x32_bf16 v[140:143], a[192:195], v[76:79], v[140:143]
    ds_read_b128 v[100:103], v7 offset:55296
    v_mfma_f32_16x16x32_bf16 v[144:147], a[196:199], v[76:79], v[144:147]
    buffer_load_dword v6, v5, s[4:7], s66 offen sc1
    v_pk_add_f32 v[64:65], v[60:61], v[64:65]
    v_pk_add_f32 v[68:69], v[68:69], v[72:73]
    v_mfma_f32_16x16x32_bf16 v[152:155], a[196:199], v[80:83], v[152:155]
    ds_read_b128 v[104:107], v8 offset:55296
    v_mfma_f32_16x16x32_bf16 v[148:151], a[192:195], v[80:83], v[148:151]
    buffer_load_dwordx2 v[46:47], v38, s[8:11], s65 offen
    v_pk_add_f32 v[66:67], v[62:63], v[66:67]
    v_pk_add_f32 v[70:71], v[70:71], v[74:75]
    s_waitcnt lgkmcnt(4)
    v_mfma_f32_16x16x32_bf16 v[140:143], a[200:203], v[84:87], v[140:143]
    ds_read_b128 v[76:79], v7 offset:57344
    v_mfma_f32_16x16x32_bf16 v[144:147], a[204:207], v[84:87], v[144:147]
    buffer_load_dword v48, v39, s[4:7], s64 offen sc1
    v_pk_add_f32 v[64:65], v[64:65], v[68:69]
    v_pk_fma_f32 v[64:65], v[64:65], v[56:57], v[52:53] op_sel_hi:[1,0,1]
    v_mfma_f32_16x16x32_bf16 v[152:155], a[204:207], v[88:91], v[152:155]
    ds_read_b128 v[80:83], v8 offset:57344
    v_mfma_f32_16x16x32_bf16 v[148:151], a[200:203], v[88:91], v[148:151]
    buffer_load_dword v33, v32, s[4:7], 0 offen sc1
    v_pk_add_f32 v[66:67], v[66:67], v[70:71]
    v_pk_fma_f32 v[66:67], v[66:67], v[56:57], v[54:55] op_sel_hi:[1,0,1]
    s_waitcnt lgkmcnt(4)
    v_mfma_f32_16x16x32_bf16 v[140:143], a[208:211], v[92:95], v[140:143]
    ds_read_b128 v[84:87], v7 offset:59392
    v_mfma_f32_16x16x32_bf16 v[144:147], a[212:215], v[92:95], v[144:147]
    v_cvt_pk_bf16_f32 v68, v64, v65
    v_cvt_pk_bf16_f32 v69, v66, v67
    v_mfma_f32_16x16x32_bf16 v[152:155], a[212:215], v[96:99], v[152:155]
    ds_read_b128 v[88:91], v8 offset:59392
    v_mfma_f32_16x16x32_bf16 v[148:151], a[208:211], v[96:99], v[148:151]
    buffer_store_dwordx2 v[68:69], v38, s[52:55], s30 offen
    v_cmp_eq_u32 vcc, s89, v158
    s_waitcnt lgkmcnt(4)
    v_mfma_f32_16x16x32_bf16 v[140:143], a[216:219], v[100:103], v[140:143]
    ds_read_b128 v[92:95], v7 offset:61440
    v_mfma_f32_16x16x32_bf16 v[144:147], a[220:223], v[100:103], v[144:147]
    v_mfma_f32_16x16x32_bf16 v[152:155], a[220:223], v[104:107], v[152:155]
    ds_read_b128 v[96:99], v8 offset:61440
    v_mfma_f32_16x16x32_bf16 v[148:151], a[216:219], v[104:107], v[148:151]
    s_cbranch_vccnz L_o_save
L_o_saved1:
    s_waitcnt lgkmcnt(4)
    v_mfma_f32_16x16x32_bf16 v[140:143], a[224:227], v[76:79], v[140:143]
    ds_read_b128 v[100:103], v7 offset:63488
    v_mfma_f32_16x16x32_bf16 v[144:147], a[228:231], v[76:79], v[144:147]
    s_mov_b32 s89, s68
    s_lshl_b32 s30, s68, 16
    v_mfma_f32_16x16x32_bf16 v[152:155], a[228:231], v[80:83], v[152:155]
    ds_read_b128 v[104:107], v8 offset:63488
    v_xor_b32 v7, 0x10000, v7
    v_xor_b32 v8, 0x10000, v8
    v_mfma_f32_16x16x32_bf16 v[148:151], a[224:227], v[80:83], v[148:151]
    s_mov_b32 s68, s29
    s_mov_b32 s29, s73
    s_waitcnt vmcnt(5)
    s_barrier
    s_waitcnt lgkmcnt(4)
    v_mfma_f32_16x16x32_bf16 v[140:143], a[232:235], v[84:87], v[140:143]
    ds_read_b128 v[76:79], v7 offset:0
    v_mfma_f32_16x16x32_bf16 v[144:147], a[236:239], v[84:87], v[144:147]
    ds_read_b32 v31, v157 offset:16
    s_mov_b32 s90, 1
    s_and_b32 s87, s31, 1
    v_mfma_f32_16x16x32_bf16 v[152:155], a[236:239], v[88:91], v[152:155]
    ds_read_b128 v[80:83], v8 offset:0
    v_mfma_f32_16x16x32_bf16 v[148:151], a[232:235], v[88:91], v[148:151]
    s_lshl_b32 s87, s87, 19
    s_mov_b32 s69, s87
    s_xor_b32 s70, s70, 0x10000
    s_add_u32 s71, s71, 0x10000
    s_waitcnt lgkmcnt(5)
    v_mfma_f32_16x16x32_bf16 v[140:143], a[240:243], v[92:95], v[140:143]
    ds_read_b128 v[84:87], v7 offset:2048
    v_mfma_f32_16x16x32_bf16 v[144:147], a[244:247], v[92:95], v[144:147]
    s_bfe_u32 s86, s31, 0x10001
    s_add_u32 s31, s31, 1
    v_mfma_f32_16x16x32_bf16 v[152:155], a[244:247], v[96:99], v[152:155]
    ds_read_b128 v[88:91], v8 offset:2048
    v_mfma_f32_16x16x32_bf16 v[148:151], a[240:243], v[96:99], v[148:151]
    s_lshl_b32 s91, s29, 11
    s_and_b32 s91, s91, 0x2000
    s_waitcnt lgkmcnt(5)
    v_mfma_f32_16x16x32_bf16 v[140:143], a[248:251], v[100:103], v[140:143]
    ds_read_b128 v[92:95], v7 offset:4096
    v_mfma_f32_16x16x32_bf16 v[144:147], a[252:255], v[100:103], v[144:147]
    s_xor_b32 s91, s91, s100
    s_xor_b32 s91, s91, 0x2000
    v_mfma_f32_16x16x32_bf16 v[152:155], a[252:255], v[104:107], v[152:155]
    ds_read_b128 v[96:99], v8 offset:4096
    v_mfma_f32_16x16x32_bf16 v[148:151], a[248:251], v[104:107], v[148:151]
    s_lshl_b32 s67, s29, 19
    s_or_b32 s91, s91, s67
    s_waitcnt lgkmcnt(5)
    v_readfirstlane_b32 s64, v31
    s_cmp_lg_u32 s85, 0
    s_cbranch_scc1 L_o_drain1
    s_mov_b32 s85, s64
    s_or_b32 s91, s91, s64
    s_branch L_o_loop
L_o_drain0:
    s_nop 3
    v_and_or_b32 v16, v16, -2, s86
    buffer_store_dwordx4 v[16:19], v34, s[4:7], s69 offen offset:1024
    v_and_or_b32 v20, v20, -2, s86
    buffer_store_dwordx4 v[20:23], v34, s[4:7], s69 offen offset:2048
    v_and_or_b32 v24, v24, -2, s86
    buffer_store_dwordx4 v[24:27], v34, s[4:7], s69 offen offset:3072
    s_waitcnt vmcnt(3)
    v_mul_f32 v56, 0xbfb8aa3b, v48
    v_exp_f32 v56, v56
    v_lshlrev_b32 v52, 16, v46
    v_add_f32 v56, 1.0, v56
    v_rcp_f32 v56, v56
    v_and_b32 v53, 0xffff0000, v46
    v_lshlrev_b32 v54, 16, v47
    v_and_b32 v55, 0xffff0000, v47
    v_pk_add_f32 v[60:61], v[12:13], v[52:53] neg_lo:[0,1] neg_hi:[0,1]
    v_pk_add_f32 v[62:63], v[14:15], v[54:55] neg_lo:[0,1] neg_hi:[0,1]
    s_mov_b32 s92, 2
    s_branch L_o_again
L_o_drain1:
    s_nop 3
    v_and_or_b32 v144, v144, -2, s86
    buffer_store_dwordx4 v[144:147], v34, s[4:7], s69 offen offset:1024
    v_and_or_b32 v148, v148, -2, s86
    buffer_store_dwordx4 v[148:151], v34, s[4:7], s69 offen offset:2048
    v_and_or_b32 v152, v152, -2, s86
    buffer_store_dwordx4 v[152:155], v34, s[4:7], s69 offen offset:3072
    s_waitcnt vmcnt(3)
    v_mul_f32 v56, 0xbfb8aa3b, v48
    v_exp_f32 v56, v56
    v_lshlrev_b32 v52, 16, v46
    v_add_f32 v56, 1.0, v56
    v_rcp_f32 v56, v56
    v_and_b32 v53, 0xffff0000, v46
    v_lshlrev_b32 v54, 16, v47
    v_and_b32 v55, 0xffff0000, v47
    v_pk_add_f32 v[60:61], v[140:141], v[52:53] neg_lo:[0,1] neg_hi:[0,1]
    v_pk_add_f32 v[62:63], v[142:143], v[54:55] neg_lo:[0,1] neg_hi:[0,1]
    s_mov_b32 s92, 2
L_o_again:
    buffer_load_dwordx4 v[64:67], v35, s[4:7], s87 offen offset:1024 sc1
    buffer_load_dwordx4 v[68:71], v36, s[4:7], s87 offen offset:2048 sc1
    buffer_load_dwordx4 v[72:75], v37, s[4:7], s87 offen offset:3072 sc1
    s_sub_u32 s15, s15, 1
    s_cbranch_scc1 L_abort
    s_waitcnt vmcnt(0)
    v_bitop3_b32 v28, v64, v68, s86 bitop3:0x7e
    v_bitop3_b32 v28, v28, v72, s86 bitop3:0xf6
    v_and_b32 v28, s90, v28
    v_cmp_ne_u32 vcc, 0, v28
    s_cbranch_vccnz L_o_again
    s_cmp_eq_u32 s92, 0
    s_cbranch_scc1 L_o_ok0
    s_cmp_eq_u32 s92, 1
    s_cbranch_scc1 L_o_ok1
    v_pk_add_f32 v[64:65], v[60:61], v[64:65]
    v_pk_add_f32 v[68:69], v[68:69], v[72:73]
    v_pk_add_f32 v[66:67], v[62:63], v[66:67]
    v_pk_add_f32 v[70:71], v[70:71], v[74:75]
    v_pk_add_f32 v[64:65], v[64:65], v[68:69]
    v_pk_fma_f32 v[64:65], v[64:65], v[56:57], v[52:53] op_sel_hi:[1,0,1]
    v_pk_add_f32 v[66:67], v[66:67], v[70:71]
    v_pk_fma_f32 v[66:67], v[66:67], v[56:57], v[54:55] op_sel_hi:[1,0,1]
    v_cvt_pk_bf16_f32 v68, v64, v65
    v_cvt_pk_bf16_f32 v69, v66, v67
    buffer_store_dwordx2 v[68:69], v38, s[52:55], s30 offen
    v_cmp_eq_u32 vcc, s89, v158
    s_cbranch_vccnz L_o_save
L_o_saved2:
    s_cmp_lt_u32 s68, 64
    s_cbranch_scc1 L_o_fetch
    s_cmp_eq_u32 s93, 0
    s_cbranch_scc1 L_drain
    s_branch L_o_ysum
L_o_ydone:
    v_and_b32 v28, 3, v0
    v_lshlrev_b32 v28, 8, v28
    s_lshl_b32 s64, s14, 10
    s_add_u32 s64, s64, 131072
    v_add_u32 v28, s64, v28
    v_lshrrev_b32 v30, 2, v0
    ds_read2_b32 v[48:49], v28 offset0:16 offset1:48
    v_lshl_add_u32 v28, v30, 2, v28
    ds_read2_b32 v[46:47], v28 offset0:0 offset1:32
    s_not_b32 s93, s93
    v_and_b32 v68, 3, v0
    v_lshlrev_b32 v68, 1, v68
    v_lshrrev_b32 v68, v68, s93
    v_not_b32 v64, v42
    v_bfe_u32 v28, v68, 0, 1
    v_and_b32 v64, 0x7ff, v64
    v_lshlrev_b32 v64, 11, v64
    v_lshl_add_u32 v64, v30, 1, v64
    v_lshl_add_u32 v64, v28, 31, v64
    v_not_b32 v65, v43
    v_bfe_u32 v28, v68, 1, 1
    v_and_b32 v65, 0x7ff, v65
    v_lshlrev_b32 v65, 11, v65
    v_lshl_add_u32 v65, v30, 1, v65
    v_lshl_add_u32 v65, v28, 31, v65
    s_waitcnt lgkmcnt(0)
    v_sub_f32 v48, 1.0, v48
    v_fma_f32 v46, v48, v44, v46
    v_cvt_pk_bf16_f32 v46, v46, v46
    v_sub_f32 v49, 1.0, v49
    v_fma_f32 v47, v49, v45, v47
    v_cvt_pk_bf16_f32 v47, v47, v47
    s_waitcnt vmcnt(0)
    buffer_store_short v46, v64, s[52:55], s88 offen
    buffer_store_short v47, v65, s[52:55], s88 offen
    s_branch L_drain
L_o_save:
    s_and_b32 s76, vcc_lo, 0xff
L_o_save1:
    s_ff1_i32_b32 s77, s76
    v_readlane_b32 s78, v159, s77
    s_lshl_b32 s79, s77, 7
    v_add_u32 v28, s79, v41
    v_cmp_eq_u32 vcc, s78, v40
    s_bitset0_b32 s76, s77
    s_bfm_b32 s79, 1, s77
    s_and_b64 exec, vcc, -1
    s_cselect_b32 s79, s79, 0
    ds_write_b128 v28, v[64:67]
    ds_write_b32 v28, v56 offset:64
    s_mov_b64 exec, -1
    s_or_b32 s93, s93, s79
    s_cmp_lg_u32 s76, 0
    s_cbranch_scc1 L_o_save1
    s_cmp_eq_u32 s92, 0
    s_cbranch_scc1 L_o_saved0
    s_cmp_eq_u32 s92, 1
    s_cbranch_scc1 L_o_saved1
    s_branch L_o_saved2
L_o_ysum:
    s_lshr_b32 s64, s88, 1
    s_add_u32 s64, s64, 85996544
    v_and_b32 v28, 3, v0
    v_lshlrev_b32 v28, 2, v28
    v_add_u32 v28, s64, v28
L_pl_34:
    buffer_load_dword v30, v28, s[4:7], 0 offen sc1
    s_waitcnt vmcnt(0)
    v_cmp_ge_u32 vcc, 0, v30
    s_cbranch_vccz L_pk_35
    s_sleep 2
    s_sub_u32 s15, s15, 1
    s_cbranch_scc0 L_pl_34
    s_branch L_abort
L_pk_35:
    s_lshl_b32 s64, s88, 4
    s_add_u32 s64, s64, 92798976
    v_lshlrev_b32 v28, 3, v0
    buffer_load_dwordx2 v[108:109], v28, s[4:7], s64 offen sc1
    v_not_b32 v44, v42
    v_ashrrev_i32 v44, 31, v44
    v_or_b32 v44, 0x80000000, v44
    v_xor_b32 v44, v44, v42
    v_and_b32 v44, 0xffff0000, v44
    v_mul_f32 v44, 0xbfb8aa3b, v44
    v_exp_f32 v44, v44
    s_nop 0
    v_add_f32 v44, 1.0, v44
    v_rcp_f32 v44, v44
    v_not_b32 v45, v43
    v_ashrrev_i32 v45, 31, v45
    v_or_b32 v45, 0x80000000, v45
    v_xor_b32 v45, v45, v43
    v_and_b32 v45, 0xffff0000, v45
    v_mul_f32 v45, 0xbfb8aa3b, v45
    v_exp_f32 v45, v45
    s_nop 0
    v_add_f32 v45, 1.0, v45
    v_rcp_f32 v45, v45
    s_waitcnt vmcnt(0)
    v_pk_mul_f32 v[44:45], v[44:45], v[108:109]
    s_branch L_o_ydone
L_rec:
    s_lshr_b32 s81, s13, 2
    s_lshl_b32 s64, s12, 3
    s_add_u32 s81, s81, s64
    s_and_b32 s82, s13, 3
    s_and_b32 s101, s13, 3
    s_lshl_b32 s64, s14, 2
    s_xor_b32 s101, s101, s64
    s_mov_b32 s48, s20
    s_and_b32 s49, s21, 0xffff
    s_mov_b32 s50, 8388608
    s_mov_b32 s51, 0x20000
    s_mov_b32 s52, s22
    s_and_b32 s53, s23, 0xffff
    s_mov_b32 s54, 8388608
    s_mov_b32 s55, 0x20000
    s_mov_b32 s56, s24
    s_and_b32 s57, s25, 0xffff
    s_mov_b32 s58, 8388608
    s_mov_b32 s59, 0x20000
    s_mov_b32 s60, s26
    s_and_b32 s61, s27, 0xffff
    s_mov_b32 s62, 8388608
    s_mov_b32 s63, 0x20000
    v_lshrrev_b32 v7, 2, v0
    v_and_b32 v124, 3, v0
    v_lshlrev_b32 v124, 4, v124
    v_lshl_add_u32 v123, v7, 13, v124
    v_lshl_add_u32 v124, v7, 11, v124
    s_lshl_b32 s79, s101, 19
    s_lshl_b32 s64, s12, 11
    s_add_u32 s79, s79, s64
    s_lshl_b32 s64, s13, 6
    s_add_u32 s79, s79, s64
    s_lshl_b32 s80, s12, 21
    s_add_u32 s80, s80, s64
    s_lshl_b32 s64, s101, 17
    s_add_u32 s80, s80, s64
    s_mul_i32 s64, s14, 32768
    s_add_u32 m0, s64, 0
    s_xor_b32 s65, s79, 2097280
    buffer_load_dwordx4 v123, s[56:59], s65 offen  lds
    s_add_u32 m0, m0, 1024
    s_xor_b32 s65, s79, 2228352
    buffer_load_dwordx4 v123, s[56:59], s65 offen  lds
    s_add_u32 m0, m0, 1024
    s_xor_b32 s65, s79, 2359424
    buffer_load_dwordx4 v123, s[56:59], s65 offen  lds
    s_add_u32 m0, m0, 1024
    s_xor_b32 s65, s79, 2490496
    buffer_load_dwordx4 v123, s[56:59], s65 offen  lds
    s_add_u32 m0, m0, 1024
    s_xor_b32 s65, s79, 2621568
    buffer_load_dwordx4 v123, s[56:59], s65 offen  lds
    s_add_u32 m0, m0, 1024
    s_xor_b32 s65, s79, 2752640
    buffer_load_dwordx4 v123, s[56:59], s65 offen  lds
    s_add_u32 m0, m0, 1024
    s_xor_b32 s65, s79, 2883712
    buffer_load_dwordx4 v123, s[56:59], s65 offen  lds
    s_add_u32 m0, m0, 1024
    s_xor_b32 s65, s79, 3014784
    buffer_load_dwordx4 v123, s[56:59], s65 offen  lds
    v_and_b32 v4, 7, v0
    v_bfe_u32 v5, v0, 3, 1
    v_lshrrev_b32 v6, 4, v0
    v_lshlrev_b32 v3, 4, v0
    v_mov_b32 v84, -1
    v_mov_b32 v85, -1
    v_mov_b32 v86, -1
    v_mov_b32 v87, -1
    s_lshl_b32 s64, s12, 15
    s_add_u32 s64, s64, 83886080
    s_lshl_b32 s65, s13, 10
    s_add_u32 s65, s65, s64
    v_lshlrev_b32 v7, 8, v6
    v_add_u32 v7, s65, v7
    v_and_b32 v96, 15, v0
    v_lshl_add_u32 v96, v96, 3, v7
    v_lshl_add_u32 v97, v4, 4, v7
    v_lshl_add_u32 v97, v5, 31, v97
    s_lshl_b32 s66, s101, 11
    s_add_u32 s66, s66, s64
    v_lshrrev_b32 v7, 3, v0
    v_lshlrev_b32 v7, 8, v7
    v_lshl_add_u32 v7, v4, 4, v7
    v_add_u32 v2, s66, v7
    v_xor_b32 v120, 2048, v2
    v_xor_b32 v121, 4096, v2
    v_xor_b32 v122, 6144, v2
    v_add_u32 v116, s65, v3
    s_lshl_b32 s66, s81, 13
    s_add_u32 s66, s66, 84148224
    v_add_u32 v100, s66, v3
    s_lshl_b32 s67, s82, 10
    v_add_u32 v117, s67, v100
    v_lshl_add_u32 v98, v5, 31, v117
    v_lshlrev_b32 v7, 2, v0
    s_add_u32 s66, s66, 4096
    v_add_u32 v101, s66, v7
    s_lshl_b32 s67, s82, 8
    s_add_u32 s66, s66, s67
    v_and_b32 v7, 1, v6
    v_lshlrev_b32 v7, 4, v7
    v_lshl_add_u32 v7, v4, 5, v7
    v_add_u32 v99, s66, v7
    v_xor_b32 v7, 8, v0
    v_and_b32 v7, 40, v7
    v_min_u32 v7, 1, v7
    v_lshl_add_u32 v99, v7, 31, v99
    s_lshr_b32 s66, s13, 2
    s_lshl_b32 s66, s66, 14
    s_and_b32 s67, s13, 3
    s_lshl_b32 s67, s67, 11
    s_add_u32 s66, s66, s67
    s_lshl_b32 s67, s12, 9
    s_add_u32 s66, s66, s67
    s_add_u32 s66, s66, 167772160
    v_lshl_add_u32 v105, v0, 3, s66
    v_xor_b32 v102, 512, v105
    v_xor_b32 v103, 1024, v105
    v_xor_b32 v104, 1536, v105
    s_lshr_b32 s66, s13, 3
    s_lshl_b32 s66, s66, 14
    s_and_b32 s67, s13, 7
    s_lshl_b32 s67, s67, 10
    s_add_u32 s66, s66, s67
    s_lshl_b32 s67, s12, 8
    s_add_u32 s66, s66, s67
    s_add_u32 s28, s66, 85065728
    s_lshl_b32 s67, s81, 14
    s_lshl_b32 s66, s82, 11
    s_add_u32 s67, s67, s66
    v_lshl_add_u32 v7, v5, 4, v4
    v_lshlrev_b32 v7, 4, v7
    v_lshl_add_u32 v7, v6, 9, v7
    v_add_u32 v106, s67, v7
    v_bfe_u32 v7, v0, 2, 2
    v_and_b32 v112, 3, v0
    v_lshl_add_u32 v112, v7, 3, v112
    v_lshlrev_b32 v112, 4, v112
    v_lshl_add_u32 v7, v6, 9, v112
    s_xor_b32 s67, s67, 33558528
    v_add_u32 v107, s67, v7
    v_lshl_add_u32 v112, v6, 2, v112
    v_add_u32 v112, 148480, v112
    v_lshrrev_b32 v7, 3, v0
    v_lshlrev_b32 v7, 8, v7
    v_lshl_add_u32 v7, v4, 4, v7
    v_add_u32 v7, 147584, v7
    v_add_u32 v113, 147968, v3
    v_cmp_gt_u32 vcc, 32, v0
    s_nop 1
    v_cndmask_b32 v113, v113, v7, vcc
    s_lshr_b32 s67, s81, 1
    s_lshl_b32 s67, s67, 14
    s_and_b32 s66, s13, 7
    s_lshl_b32 s66, s66, 10
    s_add_u32 s67, s67, s66
    s_add_u32 s67, s67, 67108864
    v_add_u32 v114, s67, v3
    v_and_b32 v7, 32, v0
    v_lshlrev_b32 v7, 6, v7
    v_xor_b32 v114, v114, v7
    s_lshl_b32 s67, s81, 7
    s_add_u32 s67, s67, 85131264
    v_mov_b32 v110, s67
    s_lshl_b32 s66, s82, 3
    v_add_u32 v110, s66, v110
    v_mov_b32 v7, 2147483648
    s_lshl_b32 s66, s12, 11
    s_add_u32 s66, s66, 85999616
    s_lshl_b32 s67, s13, 2
    s_add_u32 s67, s67, s66
    v_lshlrev_b32 v132, 8, v0
    v_add_u32 v132, s67, v132
    v_cmp_gt_u32 vcc, 4, v0
    s_nop 1
    v_cndmask_b32 v132, v7, v132, vcc
    s_and_b32 s67, s13, 3
    s_lshl_b32 s67, s67, 8
    s_add_u32 s67, s67, s66
    v_and_b32 v133, 31, v0
    v_lshlrev_b32 v133, 2, v133
    v_add_u32 v133, s67, v133
    s_lshl_b32 s66, s81, 8
    s_add_u32 s66, s66, 86016000
    s_lshl_b32 s67, s82, 2
    s_add_u32 s67, s67, s66
    v_mov_b32 v134, s67
    v_cmp_eq_u32 vcc, 0, v0
    s_nop 1
    v_cndmask_b32 v134, v7, v134, vcc
    v_and_b32 v135, 3, v0
    v_lshlrev_b32 v135, 2, v135
    v_add_u32 v135, s66, v135
    s_lshr_b32 s66, s14, 1
    s_lshl_b32 s66, s66, 10
    s_and_b32 s67, s14, 1
    s_lshl_b32 s67, s67, 3
    s_add_u32 s66, s66, s67
    s_add_u32 s66, s66, 139264
    v_add_u32 v111, s66, v3
    v_add_u32 v3, 131072, v3
    v_mov_b32 v1, 0x4444
    v_mul_u32_u24 v7, 0xaaaa, v5
    v_add_u32 v1, v1, v7
    v_and_b32 v8, 15, v0
    v_and_b32 v9, 1, v6
    v_lshlrev_b32 v9, 2, v9
    v_sub_u32 v10, v8, v9
    v_mov_b32 v12, 0x3f80
    v_mov_b32 v13, 0x3f800000
    v_cmp_eq_u32 vcc, 0, v10
    s_nop 1
    v_cndmask_b32 v64, 0, v12, vcc
    v_cmp_eq_u32 vcc, 1, v10
    s_nop 1
    v_cndmask_b32 v64, v64, v13, vcc
    v_cmp_eq_u32 vcc, 2, v10
    s_nop 1
    v_cndmask_b32 v65, 0, v12, vcc
    v_cmp_eq_u32 vcc, 3, v10
    s_nop 1
    v_cndmask_b32 v65, v65, v13, vcc
    v_cmp_eq_u32 vcc, 8, v10
    s_nop 1
    v_cndmask_b32 v66, 0, v12, vcc
    v_cmp_eq_u32 vcc, 9, v10
    s_nop 1
    v_cndmask_b32 v66, v66, v13, vcc
    v_cmp_eq_u32 vcc, 10, v10
    s_nop 1
    v_cndmask_b32 v67, 0, v12, vcc
    v_cmp_eq_u32 vcc, 11, v10
    s_nop 1
    v_cndmask_b32 v67, v67, v13, vcc
    v_lshrrev_b32 v11, 2, v8
    v_and_b32 v14, 1, v8
    v_lshl_add_u32 v11, v11, 1, v14
    v_and_b32 v14, 2, v8
    v_lshl_add_u32 v11, v14, 5, v11
    v_sub_u32 v11, v11, v9
    v_cmp_eq_u32 vcc, 0, v11
    s_nop 1
    v_cndmask_b32 v68, 0, v12, vcc
    v_cmp_eq_u32 vcc, 1, v11
    s_nop 1
    v_cndmask_b32 v68, v68, v13, vcc
    v_cmp_eq_u32 vcc, 2, v11
    s_nop 1
    v_cndmask_b32 v69, 0, v12, vcc
    v_cmp_eq_u32 vcc, 3, v11
    s_nop 1
    v_cndmask_b32 v69, v69, v13, vcc
    v_cmp_eq_u32 vcc, 0, v11
    s_nop 1
    v_cndmask_b32 v70, 0, v12, vcc
    v_cmp_eq_u32 vcc, 1, v11
    s_nop 1
    v_cndmask_b32 v70, v70, v13, vcc
    v_cmp_eq_u32 vcc, 2, v11
    s_nop 1
    v_cndmask_b32 v71, 0, v12, vcc
    v_cmp_eq_u32 vcc, 3, v11
    s_nop 1
    v_cndmask_b32 v71, v71, v13, vcc
    v_sub_u32 v10, v10, v9
    v_cmp_eq_u32 vcc, 0, v10
    s_nop 1
    v_cndmask_b32 v76, 0, v12, vcc
    v_cmp_eq_u32 vcc, 2, v10
    s_nop 1
    v_cndmask_b32 v76, v76, v13, vcc
    v_cmp_eq_u32 vcc, 4, v10
    s_nop 1
    v_cndmask_b32 v77, 0, v12, vcc
    v_cmp_eq_u32 vcc, 6, v10
    s_nop 1
    v_cndmask_b32 v77, v77, v13, vcc
    v_cmp_eq_u32 vcc, 1, v10
    s_nop 1
    v_cndmask_b32 v78, 0, v12, vcc
    v_cmp_eq_u32 vcc, 3, v10
    s_nop 1
    v_cndmask_b32 v78, v78, v13, vcc
    v_cmp_eq_u32 vcc, 5, v10
    s_nop 1
    v_cndmask_b32 v79, 0, v12, vcc
    v_cmp_eq_u32 vcc, 7, v10
    s_nop 1
    v_cndmask_b32 v79, v79, v13, vcc
    v_mov_b32 v72, 0x3f803f80
    v_mov_b32 v73, 0x3f803f80
    v_mov_b32 v74, 0x3f803f80
    v_mov_b32 v75, 0x3f803f80
    s_mov_b32 s78, 0x3e0293ee
    s_lshl_b32 s64, s14, 19
    s_lshl_b32 s65, s14, 19
    buffer_store_dwordx4 v[84:87], v116, s[4:7], s64 offen
    buffer_store_dwordx4 v[84:87], v117, s[4:7], s65 offen
    buffer_store_dwordx4 v[84:87], v99, s[4:7], s65 offen
    s_and_b32 s64, s14, 1
    s_lshl_b32 s64, s64, 13
    s_add_u32 s64, s64, 16777216
    buffer_store_dwordx2 v[84:85], v105, s[4:7], s64 offen sc1
    s_cmp_lg_u32 s14, 0
    s_cbranch_scc1 L_m0_36
    v_mov_b32 v7, 0
    buffer_store_dword v7, v132, s[4:7], 0 offen
    buffer_store_dword v7, v134, s[4:7], 0 offen
    buffer_store_dword v7, v132, s[4:7], 0 offen offset:128
    s_mov_b32 s8, s18
    s_and_b32 s9, s19, 0xffff
    s_mov_b32 s10, 16384
    s_mov_b32 s11, 0x20000
    v_bfe_u32 v7, v0, 1, 3
    v_lshlrev_b32 v7, 11, v7
    v_lshl_add_u32 v7, v6, 4, v7
    v_and_b32 v80, 1, v0
    v_lshl_add_u32 v7, v80, 3, v7
    s_lshl_b32 s64, s13, 6
    s_xor_b32 s64, s64, 512
    buffer_load_dwordx2 v[80:81], v7, s[8:11], s64 offen
L_m0_36:
    v_lshrrev_b32 v8, 5, v0
    v_lshlrev_b32 v8, 4, v8
    v_lshl_add_u32 v8, v5, 3, v8
    v_and_b32 v9, 1, v6
    v_lshl_add_u32 v8, v9, 2, v8
    v_bfe_u32 v9, v0, 2, 1
    v_add_u32 v8, v8, v9
    v_lshlrev_b32 v8, 6, v8
    s_lshl_b32 s64, s14, 15
    v_add_u32 v8, s64, v8
    v_and_b32 v9, 3, v0
    v_lshl_add_u32 v126, v9, 4, v8
    v_and_b32 v9, 1, v0
    v_lshl_add_u32 v125, v9, 3, v8
    v_bfe_u32 v9, v0, 1, 1
    v_lshl_add_u32 v125, v9, 5, v125
    s_mul_i32 s64, s14, 32768
    s_add_u32 m0, s64, 8192
    s_xor_b32 s65, s79, 2097152
    buffer_load_dwordx4 v123, s[52:55], s65 offen  lds
    s_add_u32 m0, m0, 1024
    s_xor_b32 s65, s79, 2228224
    buffer_load_dwordx4 v123, s[52:55], s65 offen  lds
    s_add_u32 m0, m0, 1024
    s_xor_b32 s65, s79, 2359296
    buffer_load_dwordx4 v123, s[52:55], s65 offen  lds
    s_add_u32 m0, m0, 1024
    s_xor_b32 s65, s79, 2490368
    buffer_load_dwordx4 v123, s[52:55], s65 offen  lds
    s_add_u32 m0, m0, 1024
    s_xor_b32 s65, s79, 2621440
    buffer_load_dwordx4 v123, s[52:55], s65 offen  lds
    s_add_u32 m0, m0, 1024
    s_xor_b32 s65, s79, 2752512
    buffer_load_dwordx4 v123, s[52:55], s65 offen  lds
    s_add_u32 m0, m0, 1024
    s_xor_b32 s65, s79, 2883584
    buffer_load_dwordx4 v123, s[52:55], s65 offen  lds
    s_add_u32 m0, m0, 1024
    s_xor_b32 s65, s79, 3014656
    buffer_load_dwordx4 v123, s[52:55], s65 offen  lds
    s_waitcnt vmcnt(8)
    s_barrier
    s_cmp_lg_u32 s14, 3
    s_cbranch_scc1 L_arr_37
    s_mov_b32 s91, 0x100
    s_mov_b32 s84, -1
    s_mov_b32 s85, -1
    s_mov_b32 s86, 2
    s_add_u32 s67, s28, 0x2000
L_pl_38:
    s_memtime s[92:93]
    s_waitcnt lgkmcnt(0)
    s_load_dword s87, s[46:47], s28 glc
    s_waitcnt lgkmcnt(0)
    s_memtime s[94:95]
    s_waitcnt lgkmcnt(0)
    s_sub_u32 s92, s94, s92
    s_min_u32 s84, s84, s92
    s_memtime s[92:93]
    s_waitcnt lgkmcnt(0)
    s_load_dword s87, s[46:47], s67 glc
    s_waitcnt lgkmcnt(0)
    s_memtime s[94:95]
    s_waitcnt lgkmcnt(0)
    s_sub_u32 s92, s94, s92
    s_min_u32 s85, s85, s92
    s_sub_u32 s86, s86, 1
    s_cbranch_scc0 L_pl_38
    s_min_u32 s84, s84, s85
    s_mov_b32 s85, 0x20100
    s_cselect_b32 s85, s85, 0x2000100
    s_cmp_lt_u32 s84, 500
    s_cselect_b32 s91, s85, s91
    s_bfm_b32 s90, 1, s13
    s_lshl_b32 s92, s12, 3
    s_add_u32 s92, s92, s3
    s_atomic_add_x2 s[90:91], s[44:45], s92
L_arr_37:
    s_mul_i32 s64, s14, 32768
    s_add_u32 m0, s64, 16384
    s_xor_b32 s65, s79, 3145856
    buffer_load_dwordx4 v123, s[56:59], s65 offen  lds
    s_add_u32 m0, m0, 1024
    s_xor_b32 s65, s79, 3276928
    buffer_load_dwordx4 v123, s[56:59], s65 offen  lds
    s_add_u32 m0, m0, 1024
    s_xor_b32 s65, s79, 3408000
    buffer_load_dwordx4 v123, s[56:59], s65 offen  lds
    s_add_u32 m0, m0, 1024
    s_xor_b32 s65, s79, 3539072
    buffer_load_dwordx4 v123, s[56:59], s65 offen  lds
    s_add_u32 m0, m0, 1024
    s_xor_b32 s65, s79, 3670144
    buffer_load_dwordx4 v123, s[56:59], s65 offen  lds
    s_add_u32 m0, m0, 1024
    s_xor_b32 s65, s79, 3801216
    buffer_load_dwordx4 v123, s[56:59], s65 offen  lds
    s_add_u32 m0, m0, 1024
    s_xor_b32 s65, s79, 3932288
    buffer_load_dwordx4 v123, s[56:59], s65 offen  lds
    s_add_u32 m0, m0, 1024
    s_xor_b32 s65, s79, 4063360
    buffer_load_dwordx4 v123, s[56:59], s65 offen  lds
    s_mul_i32 s64, s14, 32768
    s_add_u32 m0, s64, 24576
    s_xor_b32 s65, s79, 3145728
    buffer_load_dwordx4 v123, s[52:55], s65 offen  lds
    s_add_u32 m0, m0, 1024
    s_xor_b32 s65, s79, 3276800
    buffer_load_dwordx4 v123, s[52:55], s65 offen  lds
    s_add_u32 m0, m0, 1024
    s_xor_b32 s65, s79, 3407872
    buffer_load_dwordx4 v123, s[52:55], s65 offen  lds
    s_add_u32 m0, m0, 1024
    s_xor_b32 s65, s79, 3538944
    buffer_load_dwordx4 v123, s[52:55], s65 offen  lds
    s_add_u32 m0, m0, 1024
    s_xor_b32 s65, s79, 3670016
    buffer_load_dwordx4 v123, s[52:55], s65 offen  lds
    s_add_u32 m0, m0, 1024
    s_xor_b32 s65, s79, 3801088
    buffer_load_dwordx4 v123, s[52:55], s65 offen  lds
    s_add_u32 m0, m0, 1024
    s_xor_b32 s65, s79, 3932160
    buffer_load_dwordx4 v123, s[52:55], s65 offen  lds
    s_add_u32 m0, m0, 1024
    s_xor_b32 s65, s79, 4063232
    buffer_load_dwordx4 v123, s[52:55], s65 offen  lds
    s_waitcnt vmcnt(24)
    ds_read_b64_tr_b16 a[128:129], v126 offset:0
    ds_read_b64_tr_b16 a[130:131], v126 offset:128
    ds_read_b64_tr_b16 a[132:133], v126 offset:2048
    ds_read_b64_tr_b16 a[134:135], v126 offset:2176
    ds_read_b64_tr_b16 a[136:137], v126 offset:8
    ds_read_b64_tr_b16 a[138:139], v126 offset:136
    ds_read_b64_tr_b16 a[140:141], v126 offset:2056
    ds_read_b64_tr_b16 a[142:143], v126 offset:2184
    ds_read_b64_tr_b16 a[144:145], v126 offset:4096
    ds_read_b64_tr_b16 a[146:147], v126 offset:4224
    ds_read_b64_tr_b16 a[148:149], v126 offset:6144
    ds_read_b64_tr_b16 a[150:151], v126 offset:6272
    ds_read_b64_tr_b16 a[152:153], v126 offset:4104
    ds_read_b64_tr_b16 a[154:155], v126 offset:4232
    ds_read_b64_tr_b16 a[156:157], v126 offset:6152
    ds_read_b64_tr_b16 a[158:159], v126 offset:6280
    s_waitcnt lgkmcnt(0)
    s_mul_i32 s64, s14, 32768
    s_add_u32 m0, s64, 0
    s_xor_b32 s65, s80, 131584
    buffer_load_dwordx4 v124, s[60:63], s65 offen  lds
    s_add_u32 m0, m0, 1024
    s_xor_b32 s65, s80, 164352
    buffer_load_dwordx4 v124, s[60:63], s65 offen  lds
    s_add_u32 m0, m0, 1024
    s_xor_b32 s65, s80, 197120
    buffer_load_dwordx4 v124, s[60:63], s65 offen  lds
    s_add_u32 m0, m0, 1024
    s_xor_b32 s65, s80, 229888
    buffer_load_dwordx4 v124, s[60:63], s65 offen  lds
    s_add_u32 m0, m0, 1024
    s_xor_b32 s65, s80, 512
    buffer_load_dwordx4 v124, s[60:63], s65 offen  lds
    s_add_u32 m0, m0, 1024
    s_xor_b32 s65, s80, 33280
    buffer_load_dwordx4 v124, s[60:63], s65 offen  lds
    s_add_u32 m0, m0, 1024
    s_xor_b32 s65, s80, 66048
    buffer_load_dwordx4 v124, s[60:63], s65 offen  lds
    s_add_u32 m0, m0, 1024
    s_xor_b32 s65, s80, 98816
    buffer_load_dwordx4 v124, s[60:63], s65 offen  lds
    s_waitcnt vmcnt(24)
    ds_read_b64_tr_b16 a[64:65], v125 offset:8192
    ds_read_b64_tr_b16 a[66:67], v125 offset:8320
    ds_read_b64_tr_b16 a[68:69], v125 offset:10240
    ds_read_b64_tr_b16 a[70:71], v125 offset:10368
    ds_read_b64_tr_b16 a[72:73], v125 offset:8208
    ds_read_b64_tr_b16 a[74:75], v125 offset:8336
    ds_read_b64_tr_b16 a[76:77], v125 offset:10256
    ds_read_b64_tr_b16 a[78:79], v125 offset:10384
    ds_read_b64_tr_b16 a[80:81], v125 offset:12288
    ds_read_b64_tr_b16 a[82:83], v125 offset:12416
    ds_read_b64_tr_b16 a[84:85], v125 offset:14336
    ds_read_b64_tr_b16 a[86:87], v125 offset:14464
    ds_read_b64_tr_b16 a[88:89], v125 offset:12304
    ds_read_b64_tr_b16 a[90:91], v125 offset:12432
    ds_read_b64_tr_b16 a[92:93], v125 offset:14352
    ds_read_b64_tr_b16 a[94:95], v125 offset:14480
    s_waitcnt lgkmcnt(0)
    s_mul_i32 s64, s14, 32768
    s_add_u32 m0, s64, 8192
    s_xor_b32 s65, s80, 393728
    buffer_load_dwordx4 v124, s[60:63], s65 offen  lds
    s_add_u32 m0, m0, 1024
    s_xor_b32 s65, s80, 426496
    buffer_load_dwordx4 v124, s[60:63], s65 offen  lds
    s_add_u32 m0, m0, 1024
    s_xor_b32 s65, s80, 459264
    buffer_load_dwordx4 v124, s[60:63], s65 offen  lds
    s_add_u32 m0, m0, 1024
    s_xor_b32 s65, s80, 492032
    buffer_load_dwordx4 v124, s[60:63], s65 offen  lds
    s_add_u32 m0, m0, 1024
    s_xor_b32 s65, s80, 262656
    buffer_load_dwordx4 v124, s[60:63], s65 offen  lds
    s_add_u32 m0, m0, 1024
    s_xor_b32 s65, s80, 295424
    buffer_load_dwordx4 v124, s[60:63], s65 offen  lds
    s_add_u32 m0, m0, 1024
    s_xor_b32 s65, s80, 328192
    buffer_load_dwordx4 v124, s[60:63], s65 offen  lds
    s_add_u32 m0, m0, 1024
    s_xor_b32 s65, s80, 360960
    buffer_load_dwordx4 v124, s[60:63], s65 offen  lds
    s_waitcnt vmcnt(24)
    ds_read_b64_tr_b16 a[160:161], v126 offset:16384
    ds_read_b64_tr_b16 a[162:163], v126 offset:16512
    ds_read_b64_tr_b16 a[164:165], v126 offset:18432
    ds_read_b64_tr_b16 a[166:167], v126 offset:18560
    ds_read_b64_tr_b16 a[168:169], v126 offset:16392
    ds_read_b64_tr_b16 a[170:171], v126 offset:16520
    ds_read_b64_tr_b16 a[172:173], v126 offset:18440
    ds_read_b64_tr_b16 a[174:175], v126 offset:18568
    ds_read_b64_tr_b16 a[176:177], v126 offset:20480
    ds_read_b64_tr_b16 a[178:179], v126 offset:20608
    ds_read_b64_tr_b16 a[180:181], v126 offset:22528
    ds_read_b64_tr_b16 a[182:183], v126 offset:22656
    ds_read_b64_tr_b16 a[184:185], v126 offset:20488
    ds_read_b64_tr_b16 a[186:187], v126 offset:20616
    ds_read_b64_tr_b16 a[188:189], v126 offset:22536
    ds_read_b64_tr_b16 a[190:191], v126 offset:22664
    s_waitcnt lgkmcnt(0)
    s_mul_i32 s64, s14, 32768
    s_add_u32 m0, s64, 16384
    s_xor_b32 s65, s79, 2097152
    buffer_load_dwordx4 v123, s[48:51], s65 offen  lds
    s_add_u32 m0, m0, 1024
    s_xor_b32 s65, s79, 2228224
    buffer_load_dwordx4 v123, s[48:51], s65 offen  lds
    s_add_u32 m0, m0, 1024
    s_xor_b32 s65, s79, 2359296
    buffer_load_dwordx4 v123, s[48:51], s65 offen  lds
    s_add_u32 m0, m0, 1024
    s_xor_b32 s65, s79, 2490368
    buffer_load_dwordx4 v123, s[48:51], s65 offen  lds
    s_add_u32 m0, m0, 1024
    s_xor_b32 s65, s79, 2621440
    buffer_load_dwordx4 v123, s[48:51], s65 offen  lds
    s_add_u32 m0, m0, 1024
    s_xor_b32 s65, s79, 2752512
    buffer_load_dwordx4 v123, s[48:51], s65 offen  lds
    s_add_u32 m0, m0, 1024
    s_xor_b32 s65, s79, 2883584
    buffer_load_dwordx4 v123, s[48:51], s65 offen  lds
    s_add_u32 m0, m0, 1024
    s_xor_b32 s65, s79, 3014656
    buffer_load_dwordx4 v123, s[48:51], s65 offen  lds
    s_waitcnt vmcnt(24)
    ds_read_b64_tr_b16 a[96:97], v125 offset:24576
    ds_read_b64_tr_b16 a[98:99], v125 offset:24704
    ds_read_b64_tr_b16 a[100:101], v125 offset:26624
    ds_read_b64_tr_b16 a[102:103], v125 offset:26752
    ds_read_b64_tr_b16 a[104:105], v125 offset:24592
    ds_read_b64_tr_b16 a[106:107], v125 offset:24720
    ds_read_b64_tr_b16 a[108:109], v125 offset:26640
    ds_read_b64_tr_b16 a[110:111], v125 offset:26768
    ds_read_b64_tr_b16 a[112:113], v125 offset:28672
    ds_read_b64_tr_b16 a[114:115], v125 offset:28800
    ds_read_b64_tr_b16 a[116:117], v125 offset:30720
    ds_read_b64_tr_b16 a[118:119], v125 offset:30848
    ds_read_b64_tr_b16 a[120:121], v125 offset:28688
    ds_read_b64_tr_b16 a[122:123], v125 offset:28816
    ds_read_b64_tr_b16 a[124:125], v125 offset:30736
    ds_read_b64_tr_b16 a[126:127], v125 offset:30864
    s_waitcnt lgkmcnt(0)
    s_mul_i32 s64, s14, 32768
    s_add_u32 m0, s64, 24576
    s_xor_b32 s65, s79, 3145728
    buffer_load_dwordx4 v123, s[48:51], s65 offen  lds
    s_add_u32 m0, m0, 1024
    s_xor_b32 s65, s79, 3276800
    buffer_load_dwordx4 v123, s[48:51], s65 offen  lds
    s_add_u32 m0, m0, 1024
    s_xor_b32 s65, s79, 3407872
    buffer_load_dwordx4 v123, s[48:51], s65 offen  lds
    s_add_u32 m0, m0, 1024
    s_xor_b32 s65, s79, 3538944
    buffer_load_dwordx4 v123, s[48:51], s65 offen  lds
    s_add_u32 m0, m0, 1024
    s_xor_b32 s65, s79, 3670016
    buffer_load_dwordx4 v123, s[48:51], s65 offen  lds
    s_add_u32 m0, m0, 1024
    s_xor_b32 s65, s79, 3801088
    buffer_load_dwordx4 v123, s[48:51], s65 offen  lds
    s_add_u32 m0, m0, 1024
    s_xor_b32 s65, s79, 3932160
    buffer_load_dwordx4 v123, s[48:51], s65 offen  lds
    s_add_u32 m0, m0, 1024
    s_xor_b32 s65, s79, 4063232
    buffer_load_dwordx4 v123, s[48:51], s65 offen  lds
    s_waitcnt vmcnt(24)
    ds_read_b64_tr_b16 a[192:193], v126 offset:0
    ds_read_b64_tr_b16 a[194:195], v126 offset:128
    ds_read_b64_tr_b16 a[196:197], v126 offset:2048
    ds_read_b64_tr_b16 a[198:199], v126 offset:2176
    ds_read_b64_tr_b16 a[200:201], v126 offset:8
    ds_read_b64_tr_b16 a[202:203], v126 offset:136
    ds_read_b64_tr_b16 a[204:205], v126 offset:2056
    ds_read_b64_tr_b16 a[206:207], v126 offset:2184
    ds_read_b64_tr_b16 a[208:209], v126 offset:4096
    ds_read_b64_tr_b16 a[210:211], v126 offset:4224
    ds_read_b64_tr_b16 a[212:213], v126 offset:6144
    ds_read_b64_tr_b16 a[214:215], v126 offset:6272
    ds_read_b64_tr_b16 a[216:217], v126 offset:4104
    ds_read_b64_tr_b16 a[218:219], v126 offset:4232
    ds_read_b64_tr_b16 a[220:221], v126 offset:6152
    ds_read_b64_tr_b16 a[222:223], v126 offset:6280
    s_waitcnt lgkmcnt(0)
    s_waitcnt vmcnt(16)
    ds_read_b64_tr_b16 a[224:225], v126 offset:8192
    ds_read_b64_tr_b16 a[226:227], v126 offset:8320
    ds_read_b64_tr_b16 a[228:229], v126 offset:10240
    ds_read_b64_tr_b16 a[230:231], v126 offset:10368
    ds_read_b64_tr_b16 a[232:233], v126 offset:8200
    ds_read_b64_tr_b16 a[234:235], v126 offset:8328
    ds_read_b64_tr_b16 a[236:237], v126 offset:10248
    ds_read_b64_tr_b16 a[238:239], v126 offset:10376
    ds_read_b64_tr_b16 a[240:241], v126 offset:12288
    ds_read_b64_tr_b16 a[242:243], v126 offset:12416
    ds_read_b64_tr_b16 a[244:245], v126 offset:14336
    ds_read_b64_tr_b16 a[246:247], v126 offset:14464
    ds_read_b64_tr_b16 a[248:249], v126 offset:12296
    ds_read_b64_tr_b16 a[250:251], v126 offset:12424
    ds_read_b64_tr_b16 a[252:253], v126 offset:14344
    ds_read_b64_tr_b16 a[254:255], v126 offset:14472
    s_waitcnt lgkmcnt(0)
    s_waitcnt vmcnt(8)
    ds_read_b64_tr_b16 a[0:1], v125 offset:16384
    ds_read_b64_tr_b16 a[2:3], v125 offset:16512
    ds_read_b64_tr_b16 a[4:5], v125 offset:18432
    ds_read_b64_tr_b16 a[6:7], v125 offset:18560
    ds_read_b64_tr_b16 a[8:9], v125 offset:16400
    ds_read_b64_tr_b16 a[10:11], v125 offset:16528
    ds_read_b64_tr_b16 a[12:13], v125 offset:18448
    ds_read_b64_tr_b16 a[14:15], v125 offset:18576
    ds_read_b64_tr_b16 a[16:17], v125 offset:20480
    ds_read_b64_tr_b16 a[18:19], v125 offset:20608
    ds_read_b64_tr_b16 a[20:21], v125 offset:22528
    ds_read_b64_tr_b16 a[22:23], v125 offset:22656
    ds_read_b64_tr_b16 a[24:25], v125 offset:20496
    ds_read_b64_tr_b16 a[26:27], v125 offset:20624
    ds_read_b64_tr_b16 a[28:29], v125 offset:22544
    ds_read_b64_tr_b16 a[30:31], v125 offset:22672
    s_waitcnt lgkmcnt(0)
    s_waitcnt vmcnt(0)
    ds_read_b64_tr_b16 a[32:33], v125 offset:24576
    ds_read_b64_tr_b16 a[34:35], v125 offset:24704
    ds_read_b64_tr_b16 a[36:37], v125 offset:26624
    ds_read_b64_tr_b16 a[38:39], v125 offset:26752
    ds_read_b64_tr_b16 a[40:41], v125 offset:24592
    ds_read_b64_tr_b16 a[42:43], v125 offset:24720
    ds_read_b64_tr_b16 a[44:45], v125 offset:26640
    ds_read_b64_tr_b16 a[46:47], v125 offset:26768
    ds_read_b64_tr_b16 a[48:49], v125 offset:28672
    ds_read_b64_tr_b16 a[50:51], v125 offset:28800
    ds_read_b64_tr_b16 a[52:53], v125 offset:30720
    ds_read_b64_tr_b16 a[54:55], v125 offset:30848
    ds_read_b64_tr_b16 a[56:57], v125 offset:28688
    ds_read_b64_tr_b16 a[58:59], v125 offset:28816
    ds_read_b64_tr_b16 a[60:61], v125 offset:30736
    ds_read_b64_tr_b16 a[62:63], v125 offset:30864
    s_waitcnt lgkmcnt(0)
    s_lshl_b32 s64, s14, 19
    s_lshl_b32 s65, s14, 19
    buffer_load_dword v8, v116, s[4:7], s64 offen sc1
    buffer_load_dword v8, v117, s[4:7], s65 offen sc1
    buffer_load_dword v8, v99, s[4:7], s65 offen sc1
    buffer_load_dword v8, v133, s[4:7], 0 offen sc1
    v_and_b32 v254, 7, v0
    v_lshl_add_u32 v254, v254, 3, s3
L_wall_39:
    global_load_dwordx2 v[250:251], v254, s[44:45] sc1
    s_waitcnt vmcnt(0)
    v_lshrrev_b32 v255, 8, v251
    s_nop 1
    v_add_u32_dpp v255, v255, v255 row_ror:1 row_mask:0xf bank_mask:0xf
    s_nop 1
    v_add_u32_dpp v255, v255, v255 row_ror:2 row_mask:0xf bank_mask:0xf
    s_nop 1
    v_add_u32_dpp v255, v255, v255 row_ror:4 row_mask:0xf bank_mask:0xf
    s_nop 0
    v_readfirstlane_b32 s100, v255
    s_nop 0
    s_and_b32 s64, s100, 0x1ff
    s_cmp_eq_u32 s64, 256
    s_cbranch_scc1 L_walld_40
    s_sleep 4
    s_sub_u32 s15, s15, 1
    s_cbranch_scc0 L_wall_39
    s_branch L_abort
L_walld_40:
    v_cmp_ne_u32 vcc, -1, v250
    s_cbranch_vccnz L_restart
    s_bfe_u32 s64, s100, 0x80009
    s_lshr_b32 s100, s100, 17
    s_cmp_gt_u32 s100, s64
    s_cselect_b32 s100, 0x2000, 0
    v_add_u32 v110, s100, v110
    s_mov_b32 s60, 0x3f80
    s_mov_b32 s61, 0x3f800000
    s_mov_b32 s48, 1
    s_mov_b32 s49, 0
    s_mov_b32 s50, 0
    s_mov_b32 s68, 0
    s_mov_b32 s75, 0
    s_mov_b32 s76, 0
    s_cmp_eq_u32 s14, 1
    s_cbranch_scc1 L_rec_w1
    s_cmp_eq_u32 s14, 2
    s_cbranch_scc1 L_rec_w2
    s_cmp_eq_u32 s14, 3
    s_cbranch_scc1 L_rec_w3
L_rec_w0:
    s_getpc_b64 s[56:57]
L_rec_Apc0:
    s_add_u32 s56, s56, L_rec_Afin0-L_rec_Apc0
    s_addc_u32 s57, s57, 0
    s_getpc_b64 s[58:59]
L_rec_Opc0:
    s_add_u32 s58, s58, L_rec_Ofin0-L_rec_Opc0
    s_addc_u32 s59, s59, 0
    v_min_u32 v80, -2, v80
    v_min_u32 v81, -2, v81
    buffer_store_dwordx2 v[80:81], v96, s[4:7], 0 offen
    v_mov_b32 v24, 0
    v_mov_b32 v25, 0
    v_mov_b32 v26, 0
    v_mov_b32 v27, 0
    v_mov_b32 v28, 0
    v_mov_b32 v29, 0
    v_mov_b32 v30, 0
    v_mov_b32 v31, 0
    v_mov_b32 v32, 0
    v_mov_b32 v33, 0
    v_mov_b32 v34, 0
    v_mov_b32 v35, 0
    v_mov_b32 v36, 0
    v_mov_b32 v37, 0
    v_mov_b32 v38, 0
    v_mov_b32 v39, 0
    v_mov_b32 v40, 0
    v_mov_b32 v41, 0
    v_mov_b32 v42, 0
    v_mov_b32 v43, 0
    v_mov_b32 v44, 0
    v_mov_b32 v45, 0
    v_mov_b32 v46, 0
    v_mov_b32 v47, 0
    v_mov_b32 v48, 0
    v_mov_b32 v49, 0
    v_mov_b32 v50, 0
    v_mov_b32 v51, 0
    v_mov_b32 v52, 0
    v_mov_b32 v53, 0
    v_mov_b32 v54, 0
    v_mov_b32 v55, 0
    v_mov_b32 v140, 0
    v_mov_b32 v141, 0
    v_mov_b32 v142, 0
    v_mov_b32 v143, 0
    v_mov_b32 v130, 0
    v_mov_b32 v131, 0
    ds_write_b32 v3, v84 offset:2048
    ds_write_b32 v3, v84 offset:3072
    ds_write_b32 v3, v84 offset:4096
    ds_write_b32 v3, v84 offset:5120
    ds_write_b32 v3, v84 offset:6144
    ds_write_b32 v3, v84 offset:7168
    ds_write_b32 v3, v84 offset:12288
    ds_write_b32 v3, v84 offset:14336
    ds_write_b32 v3, v84 offset:15360
    s_waitcnt lgkmcnt(0)
    s_and_b32 s64, s68, 3
    s_lshl_b32 s72, s64, 19
    s_xor_b32 s77, s72, 0x100000
    s_add_u32 s70, s72, 0x80000
    s_and_b32 s70, s70, 0x180000
    s_add_u32 s65, s72, 128
    s_add_u32 s64, s68, 1
    v_mov_b32 v136, s64
    s_mov_b32 s69, 0
.p2align 6
L_rec_loop0:
    s_barrier
    s_nop 15
    s_nop 3
    buffer_load_dwordx4 v[8:11], v2, s[4:7], s69 offen sc1
    s_nop 7
    buffer_load_dwordx4 v[12:15], v120, s[4:7], s69 offen sc1
    s_nop 7
    buffer_load_dwordx4 v[16:19], v121, s[4:7], s69 offen sc1
    s_nop 7
    buffer_load_dwordx4 v[20:23], v122, s[4:7], s69 offen sc1
    s_waitcnt vmcnt(3)
    v_cmp_eq_u32 vcc, -1, v8
    s_cbranch_vccnz L_rec_Af15_0
    v_smfmac_f32_16x16x64_bf16 v[24:27], v[8:11], a[0:7], v1
    v_smfmac_f32_16x16x64_bf16 v[32:35], v[8:11], a[64:71], v1
    s_waitcnt vmcnt(2)
    v_cmp_eq_u32 vcc, -1, v12
    v_smfmac_f32_16x16x64_bf16 v[28:31], v[8:11], a[8:15], v1
    v_smfmac_f32_16x16x64_bf16 v[36:39], v[8:11], a[72:79], v1
    s_cbranch_vccnz L_rec_Af14_1
    v_smfmac_f32_16x16x64_bf16 v[24:27], v[12:15], a[16:23], v1
    v_smfmac_f32_16x16x64_bf16 v[32:35], v[12:15], a[80:87], v1
    s_waitcnt vmcnt(1)
    v_cmp_eq_u32 vcc, -1, v16
    v_smfmac_f32_16x16x64_bf16 v[28:31], v[12:15], a[24:31], v1
    v_smfmac_f32_16x16x64_bf16 v[36:39], v[12:15], a[88:95], v1
    s_cbranch_vccnz L_rec_Af12_2
    v_smfmac_f32_16x16x64_bf16 v[24:27], v[16:19], a[32:39], v1
    v_smfmac_f32_16x16x64_bf16 v[32:35], v[16:19], a[96:103], v1
    s_waitcnt vmcnt(0)
    v_cmp_eq_u32 vcc, -1, v20
    v_smfmac_f32_16x16x64_bf16 v[28:31], v[16:19], a[40:47], v1
    v_smfmac_f32_16x16x64_bf16 v[36:39], v[16:19], a[104:111], v1
    s_cbranch_vccnz L_rec_Af8_3
    v_smfmac_f32_16x16x64_bf16 v[24:27], v[20:23], a[48:55], v1
    v_smfmac_f32_16x16x64_bf16 v[32:35], v[20:23], a[112:119], v1
    v_smfmac_f32_16x16x64_bf16 v[28:31], v[20:23], a[56:63], v1
    v_smfmac_f32_16x16x64_bf16 v[36:39], v[20:23], a[120:127], v1
L_rec_Afin0:
    v_cvt_pk_bf16_f32 v56, v24, v25
    v_cvt_pk_bf16_f32 v57, v26, v27
    v_cvt_pk_bf16_f32 v58, v32, v33
    v_cvt_pk_bf16_f32 v59, v34, v35
    v_smfmac_f32_16x16x64_bf16 v[40:43], v[8:11], a[128:135], v1
    v_cvt_pk_bf16_f32 v60, v28, v29
    v_cvt_pk_bf16_f32 v61, v30, v31
    s_nop 0
    v_cvt_pk_bf16_f32 v62, v36, v37
    v_cvt_pk_bf16_f32 v63, v38, v39
    v_mfma_f32_16x16x32_bf16 v[88:91], v[56:59], v[64:67], 0
    s_nop 0
    v_mfma_f32_16x16x32_bf16 v[92:95], v[60:63], v[64:67], 0
    s_barrier
    ds_read_b128 v[144:147], v3 offset:2048
    v_smfmac_f32_16x16x64_bf16 v[44:47], v[8:11], a[136:143], v1
    ds_read_b128 v[148:151], v3 offset:4096
    ds_read_b128 v[152:155], v3 offset:6144
    v_smfmac_f32_16x16x64_bf16 v[40:43], v[12:15], a[144:151], v1
    ds_read_b128 v[156:159], v3 offset:3072
    ds_read_b128 v[160:163], v3 offset:5120
    v_smfmac_f32_16x16x64_bf16 v[44:47], v[12:15], a[152:159], v1
    ds_read_b128 v[164:167], v3 offset:7168
L_fq_41:
    s_waitcnt lgkmcnt(5)
    v_mfma_f32_16x16x32_bf16 v[88:91], v[144:147], v[64:67], v[88:91]
    ds_read_b128 v[184:187], v3 offset:20480
    s_waitcnt lgkmcnt(5)
    v_mfma_f32_16x16x32_bf16 v[88:91], v[148:151], v[64:67], v[88:91]
    ds_read_b128 v[188:191], v3 offset:21504
    s_waitcnt lgkmcnt(5)
    v_mfma_f32_16x16x32_bf16 v[88:91], v[152:155], v[64:67], v[88:91]
    v_max3_u32 v4, v144, v148, v152
    s_waitcnt lgkmcnt(4)
    v_mfma_f32_16x16x32_bf16 v[92:95], v[156:159], v[64:67], v[92:95]
    s_waitcnt lgkmcnt(3)
    v_mfma_f32_16x16x32_bf16 v[92:95], v[160:163], v[64:67], v[92:95]
    v_max3_u32 v4, v4, v156, v160
    s_waitcnt lgkmcnt(2)
    v_mfma_f32_16x16x32_bf16 v[92:95], v[164:167], v[64:67], v[92:95]
    v_max_u32 v4, v4, v164
    v_cmp_eq_u32 vcc, -1, v4
    s_waitcnt lgkmcnt(0)
    v_cvt_pk_bf16_f32 v168, v88, v89
    v_cvt_pk_bf16_f32 v169, v90, v91
    s_nop 2
    v_cvt_pk_bf16_f32 v170, v92, v93
    v_cvt_pk_bf16_f32 v171, v94, v95
    s_nop 1
    v_mfma_f32_16x16x32_bf16 v[176:179], v[184:187], v[168:171], 0
    s_cbranch_vccnz L_fr_42
    v_mfma_f32_16x16x32_bf16 v[180:183], v[188:191], v[168:171], 0
    v_mfma_f32_16x16x32_bf16 v[172:175], v[168:171], v[168:171], 0
    buffer_store_dwordx4 v[176:179], v98, s[4:7], s72 offen
    v_smfmac_f32_16x16x64_bf16 v[40:43], v[16:19], a[160:167], v1
    buffer_store_dwordx4 v[180:183], v98, s[4:7], s72 offen offset:128
    v_smfmac_f32_16x16x64_bf16 v[44:47], v[16:19], a[168:175], v1
    buffer_store_dwordx4 v[172:175], v99, s[4:7], s72 offen
    v_smfmac_f32_16x16x64_bf16 v[40:43], v[20:23], a[176:183], v1
    s_barrier
    v_smfmac_f32_16x16x64_bf16 v[44:47], v[20:23], a[184:191], v1
    ds_write_b128 v3, v[168:171] offset:16384
    s_nop 2
    v_cvt_pk_bf16_f32 v80, v40, v41
    v_cvt_pk_bf16_f32 v81, v42, v43
    s_nop 1
    v_cvt_pk_bf16_f32 v82, v44, v45
    v_cvt_pk_bf16_f32 v83, v46, v47
    ds_write2st64_b64 v111, v[80:81], v[82:83] offset0:0 offset1:4
    s_waitcnt lgkmcnt(0)
    s_barrier
    s_cmp_eq_u32 s68, 63
    s_cbranch_scc1 L_rec_fin0
    ds_write_b32 v3, v84 offset:2048
    ds_write_b32 v3, v84 offset:3072
    ds_write_b32 v3, v84 offset:4096
    ds_write_b32 v3, v84 offset:5120
    ds_write_b32 v3, v84 offset:6144
    ds_write_b32 v3, v84 offset:7168
    ds_write_b32 v3, v84 offset:12288
    ds_write_b32 v3, v84 offset:14336
    ds_write_b32 v3, v84 offset:15360
    v_mov_b32 v24, 0
    v_mov_b32 v25, 0
    v_mov_b32 v26, 0
    v_mov_b32 v27, 0
    v_mov_b32 v28, 0
    v_mov_b32 v29, 0
    v_mov_b32 v30, 0
    v_mov_b32 v31, 0
    v_mov_b32 v32, 0
    v_mov_b32 v33, 0
    v_mov_b32 v34, 0
    v_mov_b32 v35, 0
    v_mov_b32 v36, 0
    v_mov_b32 v37, 0
    v_mov_b32 v38, 0
    v_mov_b32 v39, 0
    v_mov_b32 v40, 0
    v_mov_b32 v41, 0
    v_mov_b32 v42, 0
    v_mov_b32 v43, 0
    v_mov_b32 v44, 0
    v_mov_b32 v45, 0
    v_mov_b32 v46, 0
    v_mov_b32 v47, 0
    s_waitcnt lgkmcnt(0)
    s_barrier
    s_nop 15
    s_nop 3
    buffer_load_dwordx4 v[8:11], v2, s[4:7], s65 offen sc1
    s_nop 7
    buffer_load_dwordx4 v[12:15], v120, s[4:7], s65 offen sc1
    s_nop 7
    buffer_load_dwordx4 v[16:19], v121, s[4:7], s65 offen sc1
    s_nop 7
    buffer_load_dwordx4 v[20:23], v122, s[4:7], s65 offen sc1
    s_waitcnt vmcnt(3)
    v_cmp_eq_u32 vcc, -1, v8
    s_cbranch_vccnz L_rec_Of15_0
    v_smfmac_f32_16x16x64_bf16 v[48:51], v[8:11], a[192:199], v1
    s_waitcnt vmcnt(2)
    v_cmp_eq_u32 vcc, -1, v12
    v_smfmac_f32_16x16x64_bf16 v[52:55], v[8:11], a[200:207], v1
    s_cbranch_vccnz L_rec_Of14_1
    v_smfmac_f32_16x16x64_bf16 v[48:51], v[12:15], a[208:215], v1
    s_waitcnt vmcnt(1)
    v_cmp_eq_u32 vcc, -1, v16
    v_smfmac_f32_16x16x64_bf16 v[52:55], v[12:15], a[216:223], v1
    s_cbranch_vccnz L_rec_Of12_2
    v_smfmac_f32_16x16x64_bf16 v[48:51], v[16:19], a[224:231], v1
    s_waitcnt vmcnt(0)
    v_cmp_eq_u32 vcc, -1, v20
    v_smfmac_f32_16x16x64_bf16 v[52:55], v[16:19], a[232:239], v1
    s_cbranch_vccnz L_rec_Of8_3
    v_smfmac_f32_16x16x64_bf16 v[48:51], v[20:23], a[240:247], v1
    v_smfmac_f32_16x16x64_bf16 v[52:55], v[20:23], a[248:255], v1
L_rec_Ofin0:
    s_nop 3
    v_cvt_pk_bf16_f32 v56, v48, v49
    v_cvt_pk_bf16_f32 v57, v50, v51
    s_nop 1
    v_cvt_pk_bf16_f32 v58, v52, v53
    v_cvt_pk_bf16_f32 v59, v54, v55
    ds_write_b128 v3, v[56:59] offset:12288
    s_barrier
    v_mov_b32 v48, 0
    v_mov_b32 v49, 0
    v_mov_b32 v50, 0
    v_mov_b32 v51, 0
    v_mov_b32 v52, 0
    v_mov_b32 v53, 0
    v_mov_b32 v54, 0
    v_mov_b32 v55, 0
    s_mov_b32 s69, s70
    s_add_u32 s68, s68, 1
    s_and_b32 s64, s68, 3
    s_lshl_b32 s72, s64, 19
    s_xor_b32 s77, s72, 0x100000
    s_add_u32 s70, s72, 0x80000
    s_and_b32 s70, s70, 0x180000
    s_add_u32 s65, s72, 128
    s_add_u32 s64, s68, 1
    v_mov_b32 v136, s64
    s_branch L_rec_loop0
L_rec_fin0:
    s_branch L_drain
L_fr_42:
    ds_read_b128 v[144:147], v3 offset:2048
    ds_read_b128 v[148:151], v3 offset:4096
    ds_read_b128 v[152:155], v3 offset:6144
    ds_read_b128 v[156:159], v3 offset:3072
    ds_read_b128 v[160:163], v3 offset:5120
    ds_read_b128 v[164:167], v3 offset:7168
    v_mfma_f32_16x16x32_bf16 v[88:91], v[56:59], v[64:67], 0
    v_mfma_f32_16x16x32_bf16 v[92:95], v[60:63], v[64:67], 0
    s_sub_u32 s15, s15, 1
    s_cbranch_scc0 L_fq_41
    s_branch L_abort
L_rec_w1:
    s_getpc_b64 s[56:57]
L_rec_Apc1:
    s_add_u32 s56, s56, L_rec_Afin1-L_rec_Apc1
    s_addc_u32 s57, s57, 0
    s_getpc_b64 s[58:59]
L_rec_Opc1:
    s_add_u32 s58, s58, L_rec_Ofin1-L_rec_Opc1
    s_addc_u32 s59, s59, 0
    v_mov_b32 v24, 0
    v_mov_b32 v25, 0
    v_mov_b32 v26, 0
    v_mov_b32 v27, 0
    v_mov_b32 v28, 0
    v_mov_b32 v29, 0
    v_mov_b32 v30, 0
    v_mov_b32 v31, 0
    v_mov_b32 v32, 0
    v_mov_b32 v33, 0
    v_mov_b32 v34, 0
    v_mov_b32 v35, 0
    v_mov_b32 v36, 0
    v_mov_b32 v37, 0
    v_mov_b32 v38, 0
    v_mov_b32 v39, 0
    v_mov_b32 v40, 0
    v_mov_b32 v41, 0
    v_mov_b32 v42, 0
    v_mov_b32 v43, 0
    v_mov_b32 v44, 0
    v_mov_b32 v45, 0
    v_mov_b32 v46, 0
    v_mov_b32 v47, 0
    v_mov_b32 v48, 0
    v_mov_b32 v49, 0
    v_mov_b32 v50, 0
    v_mov_b32 v51, 0
    v_mov_b32 v52, 0
    v_mov_b32 v53, 0
    v_mov_b32 v54, 0
    v_mov_b32 v55, 0
    v_mov_b32 v140, 0
    v_mov_b32 v141, 0
    v_mov_b32 v142, 0
    v_mov_b32 v143, 0
    v_mov_b32 v130, 0
    v_mov_b32 v131, 0
    s_and_b32 s64, s68, 3
    s_lshl_b32 s72, s64, 19
    s_xor_b32 s77, s72, 0x100000
    s_add_u32 s70, s72, 0x80000
    s_and_b32 s70, s70, 0x180000
    s_add_u32 s65, s72, 128
    s_add_u32 s64, s68, 1
    v_mov_b32 v136, s64
    s_sub_u32 s64, s68, 1
    s_cselect_b32 s64, 64, s64
    s_lshl_b32 s73, s64, 10
    s_and_b32 s73, s73, 0x2000
    s_xor_b32 s73, s73, s100
    s_lshl_b32 s67, s64, 18
    s_or_b32 s73, s73, s67
    s_mov_b32 s69, 0
.p2align 6
L_rec_loop1:
    s_barrier
    s_nop 15
    s_nop 3
    buffer_load_dwordx4 v[8:11], v2, s[4:7], s69 offen sc1
    s_nop 7
    buffer_load_dwordx4 v[12:15], v120, s[4:7], s69 offen sc1
    s_nop 7
    buffer_load_dwordx4 v[16:19], v121, s[4:7], s69 offen sc1
    s_nop 7
    buffer_load_dwordx4 v[20:23], v122, s[4:7], s69 offen sc1
    s_waitcnt vmcnt(3)
    v_cmp_eq_u32 vcc, -1, v8
    s_cbranch_vccnz L_rec_Af15_0
    v_smfmac_f32_16x16x64_bf16 v[24:27], v[8:11], a[0:7], v1
    v_smfmac_f32_16x16x64_bf16 v[32:35], v[8:11], a[64:71], v1
    s_waitcnt vmcnt(2)
    v_cmp_eq_u32 vcc, -1, v12
    v_smfmac_f32_16x16x64_bf16 v[28:31], v[8:11], a[8:15], v1
    v_smfmac_f32_16x16x64_bf16 v[36:39], v[8:11], a[72:79], v1
    s_cbranch_vccnz L_rec_Af14_1
    v_smfmac_f32_16x16x64_bf16 v[24:27], v[12:15], a[16:23], v1
    v_smfmac_f32_16x16x64_bf16 v[32:35], v[12:15], a[80:87], v1
    s_waitcnt vmcnt(1)
    v_cmp_eq_u32 vcc, -1, v16
    v_smfmac_f32_16x16x64_bf16 v[28:31], v[12:15], a[24:31], v1
    v_smfmac_f32_16x16x64_bf16 v[36:39], v[12:15], a[88:95], v1
    s_cbranch_vccnz L_rec_Af12_2
    v_smfmac_f32_16x16x64_bf16 v[24:27], v[16:19], a[32:39], v1
    v_smfmac_f32_16x16x64_bf16 v[32:35], v[16:19], a[96:103], v1
    s_waitcnt vmcnt(0)
    v_cmp_eq_u32 vcc, -1, v20
    v_smfmac_f32_16x16x64_bf16 v[28:31], v[16:19], a[40:47], v1
    v_smfmac_f32_16x16x64_bf16 v[36:39], v[16:19], a[104:111], v1
    s_cbranch_vccnz L_rec_Af8_3
    v_smfmac_f32_16x16x64_bf16 v[24:27], v[20:23], a[48:55], v1
    v_smfmac_f32_16x16x64_bf16 v[32:35], v[20:23], a[112:119], v1
    v_smfmac_f32_16x16x64_bf16 v[28:31], v[20:23], a[56:63], v1
    v_smfmac_f32_16x16x64_bf16 v[36:39], v[20:23], a[120:127], v1
L_rec_Afin1:
    v_cvt_pk_bf16_f32 v56, v24, v25
    v_cvt_pk_bf16_f32 v57, v26, v27
    v_cvt_pk_bf16_f32 v58, v32, v33
    v_cvt_pk_bf16_f32 v59, v34, v35
    ds_write_b128 v3, v[56:59] offset:2048
    v_cvt_pk_bf16_f32 v60, v28, v29
    v_cvt_pk_bf16_f32 v61, v30, v31
    s_nop 0
    v_cvt_pk_bf16_f32 v62, v36, v37
    v_cvt_pk_bf16_f32 v63, v38, v39
    ds_write_b128 v3, v[60:63] offset:3072
    s_barrier
    v_smfmac_f32_16x16x64_bf16 v[40:43], v[8:11], a[128:135], v1
    v_smfmac_f32_16x16x64_bf16 v[44:47], v[8:11], a[136:143], v1
    v_smfmac_f32_16x16x64_bf16 v[40:43], v[12:15], a[144:151], v1
    v_smfmac_f32_16x16x64_bf16 v[44:47], v[12:15], a[152:159], v1
    v_smfmac_f32_16x16x64_bf16 v[40:43], v[16:19], a[160:167], v1
    v_smfmac_f32_16x16x64_bf16 v[44:47], v[16:19], a[168:175], v1
    v_smfmac_f32_16x16x64_bf16 v[40:43], v[20:23], a[176:183], v1
    v_smfmac_f32_16x16x64_bf16 v[44:47], v[20:23], a[184:191], v1
    s_nop 3
    v_cvt_pk_bf16_f32 v80, v40, v41
    v_cvt_pk_bf16_f32 v81, v42, v43
    s_nop 1
    v_cvt_pk_bf16_f32 v82, v44, v45
    v_cvt_pk_bf16_f32 v83, v46, v47
    ds_write2st64_b64 v111, v[80:81], v[82:83] offset0:0 offset1:4
    s_and_b32 s64, s68, 3
    s_lshl_b32 s72, s64, 19
    s_xor_b32 s77, s72, 0x100000
    s_add_u32 s70, s72, 0x80000
    s_and_b32 s70, s70, 0x180000
    s_add_u32 s65, s72, 128
    s_add_u32 s64, s68, 1
    v_mov_b32 v136, s64
    s_sub_u32 s64, s68, 1
    s_cselect_b32 s64, 64, s64
    s_lshl_b32 s73, s64, 10
    s_and_b32 s73, s73, 0x2000
    s_xor_b32 s73, s73, s100
    s_lshl_b32 s67, s64, 18
    s_or_b32 s73, s73, s67
    s_waitcnt lgkmcnt(0)
    s_barrier
    s_barrier
    s_cmp_eq_u32 s68, 63
    s_cbranch_scc1 L_rec_fin1
    v_mov_b32 v24, 0
    v_mov_b32 v25, 0
    v_mov_b32 v26, 0
    v_mov_b32 v27, 0
    v_mov_b32 v28, 0
    v_mov_b32 v29, 0
    v_mov_b32 v30, 0
    v_mov_b32 v31, 0
    v_mov_b32 v32, 0
    v_mov_b32 v33, 0
    v_mov_b32 v34, 0
    v_mov_b32 v35, 0
    v_mov_b32 v36, 0
    v_mov_b32 v37, 0
    v_mov_b32 v38, 0
    v_mov_b32 v39, 0
    v_mov_b32 v40, 0
    v_mov_b32 v41, 0
    v_mov_b32 v42, 0
    v_mov_b32 v43, 0
    v_mov_b32 v44, 0
    v_mov_b32 v45, 0
    v_mov_b32 v46, 0
    v_mov_b32 v47, 0
    v_mov_b32 v48, 0
    v_mov_b32 v49, 0
    v_mov_b32 v50, 0
    v_mov_b32 v51, 0
    v_mov_b32 v52, 0
    v_mov_b32 v53, 0
    v_mov_b32 v54, 0
    v_mov_b32 v55, 0
    s_waitcnt lgkmcnt(0)
    s_barrier
    s_nop 15
    s_nop 3
    buffer_load_dwordx4 v[8:11], v2, s[4:7], s65 offen sc1
    s_nop 7
    buffer_load_dwordx4 v[12:15], v120, s[4:7], s65 offen sc1
    s_nop 7
    buffer_load_dwordx4 v[16:19], v121, s[4:7], s65 offen sc1
    s_nop 7
    buffer_load_dwordx4 v[20:23], v122, s[4:7], s65 offen sc1
    s_waitcnt vmcnt(3)
    v_cmp_eq_u32 vcc, -1, v8
    s_cbranch_vccnz L_rec_Of15_0
    v_smfmac_f32_16x16x64_bf16 v[48:51], v[8:11], a[192:199], v1
    s_waitcnt vmcnt(2)
    v_cmp_eq_u32 vcc, -1, v12
    v_smfmac_f32_16x16x64_bf16 v[52:55], v[8:11], a[200:207], v1
    s_cbranch_vccnz L_rec_Of14_1
    v_smfmac_f32_16x16x64_bf16 v[48:51], v[12:15], a[208:215], v1
    s_waitcnt vmcnt(1)
    v_cmp_eq_u32 vcc, -1, v16
    v_smfmac_f32_16x16x64_bf16 v[52:55], v[12:15], a[216:223], v1
    s_cbranch_vccnz L_rec_Of12_2
    v_smfmac_f32_16x16x64_bf16 v[48:51], v[16:19], a[224:231], v1
    s_waitcnt vmcnt(0)
    v_cmp_eq_u32 vcc, -1, v20
    v_smfmac_f32_16x16x64_bf16 v[52:55], v[16:19], a[232:239], v1
    s_cbranch_vccnz L_rec_Of8_3
    v_smfmac_f32_16x16x64_bf16 v[48:51], v[20:23], a[240:247], v1
    v_smfmac_f32_16x16x64_bf16 v[52:55], v[20:23], a[248:255], v1
L_rec_Ofin1:
    s_nop 3
    v_cvt_pk_bf16_f32 v56, v48, v49
    v_cvt_pk_bf16_f32 v57, v50, v51
    s_nop 1
    v_cvt_pk_bf16_f32 v58, v52, v53
    v_cvt_pk_bf16_f32 v59, v54, v55
    s_nop 1
    v_mfma_f32_16x16x32_bf16 v[88:91], v[56:59], v[76:79], 0
    s_barrier
    ds_read_b128 v[144:147], v3 offset:12288
    ds_read_b128 v[148:151], v3 offset:14336
    ds_read_b128 v[152:155], v3 offset:15360
L_wq_43:
    s_waitcnt lgkmcnt(2)
    v_mfma_f32_16x16x32_bf16 v[88:91], v[144:147], v[76:79], v[88:91]
    s_waitcnt lgkmcnt(0)
    v_mfma_f32_16x16x32_bf16 v[88:91], v[148:151], v[76:79], v[88:91]
    v_max3_u32 v4, v144, v148, v152
    v_cmp_eq_u32 vcc, -1, v4
    v_mfma_f32_16x16x32_bf16 v[88:91], v[152:155], v[76:79], v[88:91]
    s_nop 2
    s_cbranch_vccnz L_wr_44
    s_nop 3
    v_cvt_pk_bf16_f32 v92, v88, v89
    v_cvt_pk_bf16_f32 v93, v90, v91
    buffer_store_dwordx2 v[92:93], v105, s[4:7], s73 offen sc1
    s_mov_b32 s69, s70
    s_add_u32 s68, s68, 1
    v_lshlrev_b32 v88, 16, v92
    v_and_b32 v89, 0xffff0000, v92
    v_lshlrev_b32 v90, 16, v93
    v_and_b32 v91, 0xffff0000, v93
    s_nop 15
    s_nop 15
    s_nop 15
    s_nop 15
    s_nop 13
    buffer_load_dwordx2 v[156:157], v102, s[4:7], s73 offen sc1
    buffer_load_dwordx2 v[158:159], v103, s[4:7], s73 offen sc1
    buffer_load_dwordx2 v[160:161], v104, s[4:7], s73 offen sc1
    s_nop 15
    s_nop 15
    s_nop 3
    buffer_load_dwordx2 v[162:163], v102, s[4:7], s73 offen sc1
    buffer_load_dwordx2 v[164:165], v103, s[4:7], s73 offen sc1
    buffer_load_dwordx2 v[166:167], v104, s[4:7], s73 offen sc1
    s_nop 15
    s_nop 15
    s_nop 15
    buffer_load_dwordx2 v[168:169], v102, s[4:7], s73 offen sc1
    buffer_load_dwordx2 v[170:171], v103, s[4:7], s73 offen sc1
    buffer_load_dwordx2 v[172:173], v104, s[4:7], s73 offen sc1
    s_waitcnt vmcnt(8)
    v_dot2_f32_bf16 v60, v156, s60, v88
    v_dot2_f32_bf16 v61, v156, s61, v89
    v_dot2_f32_bf16 v62, v157, s60, v90
    v_dot2_f32_bf16 v63, v157, s61, v91
    s_waitcnt vmcnt(7)
    v_dot2_f32_bf16 v60, v158, s60, v60
    v_dot2_f32_bf16 v61, v158, s61, v61
    v_dot2_f32_bf16 v62, v159, s60, v62
    v_dot2_f32_bf16 v63, v159, s61, v63
    s_waitcnt vmcnt(6)
    v_max3_u32 v4, v156, v158, v160
    v_cmp_eq_u32 vcc, -1, v4
    v_dot2_f32_bf16 v60, v160, s60, v60
    v_dot2_f32_bf16 v61, v160, s61, v61
    v_dot2_f32_bf16 v62, v161, s60, v62
    v_dot2_f32_bf16 v63, v161, s61, v63
    s_nop 0
    v_cvt_pk_bf16_f32 v80, v60, v61
    s_nop 0
    v_cvt_pk_bf16_f32 v81, v62, v63
    s_cbranch_vccnz L_cf_47
    buffer_store_dwordx2 v[80:81], v96, s[4:7], s69 offen
    s_branch L_rec_loop1
L_cf_47:
    buffer_load_dwordx2 v[156:157], v102, s[4:7], s73 offen sc1
    buffer_load_dwordx2 v[158:159], v103, s[4:7], s73 offen sc1
    buffer_load_dwordx2 v[160:161], v104, s[4:7], s73 offen sc1
    s_waitcnt vmcnt(8)
    v_dot2_f32_bf16 v60, v162, s60, v88
    v_dot2_f32_bf16 v61, v162, s61, v89
    v_dot2_f32_bf16 v62, v163, s60, v90
    v_dot2_f32_bf16 v63, v163, s61, v91
    s_waitcnt vmcnt(7)
    v_dot2_f32_bf16 v60, v164, s60, v60
    v_dot2_f32_bf16 v61, v164, s61, v61
    v_dot2_f32_bf16 v62, v165, s60, v62
    v_dot2_f32_bf16 v63, v165, s61, v63
    s_waitcnt vmcnt(6)
    v_max3_u32 v4, v162, v164, v166
    v_cmp_eq_u32 vcc, -1, v4
    v_dot2_f32_bf16 v60, v166, s60, v60
    v_dot2_f32_bf16 v61, v166, s61, v61
    v_dot2_f32_bf16 v62, v167, s60, v62
    v_dot2_f32_bf16 v63, v167, s61, v63
    s_nop 0
    v_cvt_pk_bf16_f32 v80, v60, v61
    s_nop 0
    v_cvt_pk_bf16_f32 v81, v62, v63
    s_cbranch_vccnz L_cf_48
    buffer_store_dwordx2 v[80:81], v96, s[4:7], s69 offen
    s_branch L_rec_loop1
L_cf_48:
    buffer_load_dwordx2 v[162:163], v102, s[4:7], s73 offen sc1
    buffer_load_dwordx2 v[164:165], v103, s[4:7], s73 offen sc1
    buffer_load_dwordx2 v[166:167], v104, s[4:7], s73 offen sc1
    s_waitcnt vmcnt(8)
    v_dot2_f32_bf16 v60, v168, s60, v88
    v_dot2_f32_bf16 v61, v168, s61, v89
    v_dot2_f32_bf16 v62, v169, s60, v90
    v_dot2_f32_bf16 v63, v169, s61, v91
    s_waitcnt vmcnt(7)
    v_dot2_f32_bf16 v60, v170, s60, v60
    v_dot2_f32_bf16 v61, v170, s61, v61
    v_dot2_f32_bf16 v62, v171, s60, v62
    v_dot2_f32_bf16 v63, v171, s61, v63
    s_waitcnt vmcnt(6)
    v_max3_u32 v4, v168, v170, v172
    v_cmp_eq_u32 vcc, -1, v4
    v_dot2_f32_bf16 v60, v172, s60, v60
    v_dot2_f32_bf16 v61, v172, s61, v61
    v_dot2_f32_bf16 v62, v173, s60, v62
    v_dot2_f32_bf16 v63, v173, s61, v63
    s_nop 0
    v_cvt_pk_bf16_f32 v80, v60, v61
    s_nop 0
    v_cvt_pk_bf16_f32 v81, v62, v63
    s_cbranch_vccnz L_cf_49
    buffer_store_dwordx2 v[80:81], v96, s[4:7], s69 offen
    s_branch L_rec_loop1
L_cf_49:
    buffer_load_dwordx2 v[168:169], v102, s[4:7], s73 offen sc1
    buffer_load_dwordx2 v[170:171], v103, s[4:7], s73 offen sc1
    buffer_load_dwordx2 v[172:173], v104, s[4:7], s73 offen sc1
L_cp_45:
    s_waitcnt vmcnt(8)
    v_dot2_f32_bf16 v60, v156, s60, v88
    v_dot2_f32_bf16 v61, v156, s61, v89
    v_dot2_f32_bf16 v62, v157, s60, v90
    v_dot2_f32_bf16 v63, v157, s61, v91
    s_waitcnt vmcnt(7)
    v_dot2_f32_bf16 v60, v158, s60, v60
    v_dot2_f32_bf16 v61, v158, s61, v61
    v_dot2_f32_bf16 v62, v159, s60, v62
    v_dot2_f32_bf16 v63, v159, s61, v63
    s_waitcnt vmcnt(6)
    v_max3_u32 v4, v156, v158, v160
    v_cmp_eq_u32 vcc, -1, v4
    v_dot2_f32_bf16 v60, v160, s60, v60
    v_dot2_f32_bf16 v61, v160, s61, v61
    v_dot2_f32_bf16 v62, v161, s60, v62
    v_dot2_f32_bf16 v63, v161, s61, v63
    s_nop 0
    v_cvt_pk_bf16_f32 v80, v60, v61
    s_nop 0
    v_cvt_pk_bf16_f32 v81, v62, v63
    s_cbranch_vccnz L_cf_50
    buffer_store_dwordx2 v[80:81], v96, s[4:7], s69 offen
    s_branch L_rec_loop1
L_cf_50:
    buffer_load_dwordx2 v[156:157], v102, s[4:7], s73 offen sc1
    buffer_load_dwordx2 v[158:159], v103, s[4:7], s73 offen sc1
    buffer_load_dwordx2 v[160:161], v104, s[4:7], s73 offen sc1
    s_waitcnt vmcnt(8)
    v_dot2_f32_bf16 v60, v162, s60, v88
    v_dot2_f32_bf16 v61, v162, s61, v89
    v_dot2_f32_bf16 v62, v163, s60, v90
    v_dot2_f32_bf16 v63, v163, s61, v91
    s_waitcnt vmcnt(7)
    v_dot2_f32_bf16 v60, v164, s60, v60
    v_dot2_f32_bf16 v61, v164, s61, v61
    v_dot2_f32_bf16 v62, v165, s60, v62
    v_dot2_f32_bf16 v63, v165, s61, v63
    s_waitcnt vmcnt(6)
    v_max3_u32 v4, v162, v164, v166
    v_cmp_eq_u32 vcc, -1, v4
    v_dot2_f32_bf16 v60, v166, s60, v60
    v_dot2_f32_bf16 v61, v166, s61, v61
    v_dot2_f32_bf16 v62, v167, s60, v62
    v_dot2_f32_bf16 v63, v167, s61, v63
    s_nop 0
    v_cvt_pk_bf16_f32 v80, v60, v61
    s_nop 0
    v_cvt_pk_bf16_f32 v81, v62, v63
    s_cbranch_vccnz L_cf_51
    buffer_store_dwordx2 v[80:81], v96, s[4:7], s69 offen
    s_branch L_rec_loop1
L_cf_51:
    buffer_load_dwordx2 v[162:163], v102, s[4:7], s73 offen sc1
    buffer_load_dwordx2 v[164:165], v103, s[4:7], s73 offen sc1
    buffer_load_dwordx2 v[166:167], v104, s[4:7], s73 offen sc1
    s_waitcnt vmcnt(8)
    v_dot2_f32_bf16 v60, v168, s60, v88
    v_dot2_f32_bf16 v61, v168, s61, v89
    v_dot2_f32_bf16 v62, v169, s60, v90
    v_dot2_f32_bf16 v63, v169, s61, v91
    s_waitcnt vmcnt(7)
    v_dot2_f32_bf16 v60, v170, s60, v60
    v_dot2_f32_bf16 v61, v170, s61, v61
    v_dot2_f32_bf16 v62, v171, s60, v62
    v_dot2_f32_bf16 v63, v171, s61, v63
    s_waitcnt vmcnt(6)
    v_max3_u32 v4, v168, v170, v172
    v_cmp_eq_u32 vcc, -1, v4
    v_dot2_f32_bf16 v60, v172, s60, v60
    v_dot2_f32_bf16 v61, v172, s61, v61
    v_dot2_f32_bf16 v62, v173, s60, v62
    v_dot2_f32_bf16 v63, v173, s61, v63
    s_nop 0
    v_cvt_pk_bf16_f32 v80, v60, v61
    s_nop 0
    v_cvt_pk_bf16_f32 v81, v62, v63
    s_cbranch_vccnz L_cf_52
    buffer_store_dwordx2 v[80:81], v96, s[4:7], s69 offen
    s_branch L_rec_loop1
L_cf_52:
    buffer_load_dwordx2 v[168:169], v102, s[4:7], s73 offen sc1
    buffer_load_dwordx2 v[170:171], v103, s[4:7], s73 offen sc1
    buffer_load_dwordx2 v[172:173], v104, s[4:7], s73 offen sc1
    s_sub_u32 s15, s15, 1
    s_cbranch_scc0 L_cp_45
    s_branch L_abort
L_rec_fin1:
    s_branch L_drain
L_wr_44:
    ds_read_b128 v[144:147], v3 offset:12288
    ds_read_b128 v[148:151], v3 offset:14336
    ds_read_b128 v[152:155], v3 offset:15360
    s_nop 3
    v_mfma_f32_16x16x32_bf16 v[88:91], v[56:59], v[76:79], 0
    s_sub_u32 s15, s15, 1
    s_cbranch_scc0 L_wq_43
    s_branch L_abort
L_rec_w2:
    s_getpc_b64 s[56:57]
L_rec_Apc2:
    s_add_u32 s56, s56, L_rec_Afin2-L_rec_Apc2
    s_addc_u32 s57, s57, 0
    s_getpc_b64 s[58:59]
L_rec_Opc2:
    s_add_u32 s58, s58, L_rec_Ofin2-L_rec_Opc2
    s_addc_u32 s59, s59, 0
    v_mov_b32 v220, 0
    v_mov_b32 v221, 0
    v_mov_b32 v222, 0
    v_mov_b32 v223, 0
    v_mov_b32 v224, 0
    v_mov_b32 v225, 0
    v_mov_b32 v226, 0
    v_mov_b32 v227, 0
    v_mov_b32 v232, 0
    v_mov_b32 v233, 0
    v_mov_b32 v234, 0
    v_mov_b32 v235, 0
    v_mov_b32 v128, s78
    v_mov_b32 v129, s78
    v_mov_b32 v24, 0
    v_mov_b32 v25, 0
    v_mov_b32 v26, 0
    v_mov_b32 v27, 0
    v_mov_b32 v28, 0
    v_mov_b32 v29, 0
    v_mov_b32 v30, 0
    v_mov_b32 v31, 0
    v_mov_b32 v32, 0
    v_mov_b32 v33, 0
    v_mov_b32 v34, 0
    v_mov_b32 v35, 0
    v_mov_b32 v36, 0
    v_mov_b32 v37, 0
    v_mov_b32 v38, 0
    v_mov_b32 v39, 0
    v_mov_b32 v40, 0
    v_mov_b32 v41, 0
    v_mov_b32 v42, 0
    v_mov_b32 v43, 0
    v_mov_b32 v44, 0
    v_mov_b32 v45, 0
    v_mov_b32 v46, 0
    v_mov_b32 v47, 0
    v_mov_b32 v48, 0
    v_mov_b32 v49, 0
    v_mov_b32 v50, 0
    v_mov_b32 v51, 0
    v_mov_b32 v52, 0
    v_mov_b32 v53, 0
    v_mov_b32 v54, 0
    v_mov_b32 v55, 0
    v_mov_b32 v140, 0
    v_mov_b32 v141, 0
    v_mov_b32 v142, 0
    v_mov_b32 v143, 0
    v_mov_b32 v130, 0
    v_mov_b32 v131, 0
    s_and_b32 s64, s68, 3
    s_lshl_b32 s72, s64, 19
    s_xor_b32 s77, s72, 0x100000
    s_add_u32 s70, s72, 0x80000
    s_and_b32 s70, s70, 0x180000
    s_add_u32 s65, s72, 128
    s_add_u32 s64, s68, 1
    v_mov_b32 v136, s64
    s_mov_b32 s69, 0
.p2align 6
L_rec_loop2:
    s_barrier
    s_nop 15
    s_nop 3
    buffer_load_dwordx4 v[8:11], v2, s[4:7], s69 offen sc1
    s_nop 7
    buffer_load_dwordx4 v[12:15], v120, s[4:7], s69 offen sc1
    s_nop 7
    buffer_load_dwordx4 v[16:19], v121, s[4:7], s69 offen sc1
    s_nop 7
    buffer_load_dwordx4 v[20:23], v122, s[4:7], s69 offen sc1
    s_waitcnt vmcnt(3)
    v_cmp_eq_u32 vcc, -1, v8
    s_cbranch_vccnz L_rec_Af15_0
    v_smfmac_f32_16x16x64_bf16 v[24:27], v[8:11], a[0:7], v1
    v_smfmac_f32_16x16x64_bf16 v[32:35], v[8:11], a[64:71], v1
    s_waitcnt vmcnt(2)
    v_cmp_eq_u32 vcc, -1, v12
    v_smfmac_f32_16x16x64_bf16 v[28:31], v[8:11], a[8:15], v1
    v_smfmac_f32_16x16x64_bf16 v[36:39], v[8:11], a[72:79], v1
    s_cbranch_vccnz L_rec_Af14_1
    v_smfmac_f32_16x16x64_bf16 v[24:27], v[12:15], a[16:23], v1
    v_smfmac_f32_16x16x64_bf16 v[32:35], v[12:15], a[80:87], v1
    s_waitcnt vmcnt(1)
    v_cmp_eq_u32 vcc, -1, v16
    v_smfmac_f32_16x16x64_bf16 v[28:31], v[12:15], a[24:31], v1
    v_smfmac_f32_16x16x64_bf16 v[36:39], v[12:15], a[88:95], v1
    s_cbranch_vccnz L_rec_Af12_2
    v_smfmac_f32_16x16x64_bf16 v[24:27], v[16:19], a[32:39], v1
    v_smfmac_f32_16x16x64_bf16 v[32:35], v[16:19], a[96:103], v1
    s_waitcnt vmcnt(0)
    v_cmp_eq_u32 vcc, -1, v20
    v_smfmac_f32_16x16x64_bf16 v[28:31], v[16:19], a[40:47], v1
    v_smfmac_f32_16x16x64_bf16 v[36:39], v[16:19], a[104:111], v1
    s_cbranch_vccnz L_rec_Af8_3
    v_smfmac_f32_16x16x64_bf16 v[24:27], v[20:23], a[48:55], v1
    v_smfmac_f32_16x16x64_bf16 v[32:35], v[20:23], a[112:119], v1
    v_smfmac_f32_16x16x64_bf16 v[28:31], v[20:23], a[56:63], v1
    v_smfmac_f32_16x16x64_bf16 v[36:39], v[20:23], a[120:127], v1
L_rec_Afin2:
    v_cvt_pk_bf16_f32 v56, v24, v25
    v_cvt_pk_bf16_f32 v57, v26, v27
    v_cvt_pk_bf16_f32 v58, v32, v33
    v_cvt_pk_bf16_f32 v59, v34, v35
    ds_write_b128 v3, v[56:59] offset:4096
    v_cvt_pk_bf16_f32 v60, v28, v29
    v_cvt_pk_bf16_f32 v61, v30, v31
    s_nop 0
    v_cvt_pk_bf16_f32 v62, v36, v37
    v_cvt_pk_bf16_f32 v63, v38, v39
    ds_write_b128 v3, v[60:63] offset:5120
    s_barrier
    v_smfmac_f32_16x16x64_bf16 v[40:43], v[8:11], a[128:135], v1
    v_smfmac_f32_16x16x64_bf16 v[44:47], v[8:11], a[136:143], v1
    buffer_load_dword v140, v135, s[4:7], 0 offen sc1
    v_smfmac_f32_16x16x64_bf16 v[40:43], v[12:15], a[144:151], v1
    v_smfmac_f32_16x16x64_bf16 v[44:47], v[12:15], a[152:159], v1
    v_smfmac_f32_16x16x64_bf16 v[40:43], v[16:19], a[160:167], v1
    buffer_load_dword v140, v135, s[4:7], 0 offen sc1
    v_smfmac_f32_16x16x64_bf16 v[44:47], v[16:19], a[168:175], v1
    v_smfmac_f32_16x16x64_bf16 v[40:43], v[20:23], a[176:183], v1
    ds_read_b128 v[184:187], v3 offset:18432
    ds_read_b128 v[188:191], v3 offset:19456
    v_smfmac_f32_16x16x64_bf16 v[44:47], v[20:23], a[184:191], v1
    buffer_load_dword v140, v135, s[4:7], 0 offen sc1
    s_nop 2
    v_cvt_pk_bf16_f32 v80, v40, v41
    v_cvt_pk_bf16_f32 v81, v42, v43
    s_nop 1
    v_cvt_pk_bf16_f32 v82, v44, v45
    v_cvt_pk_bf16_f32 v83, v46, v47
    ds_write2st64_b64 v111, v[80:81], v[82:83] offset0:0 offset1:4
L_ep_53:
    v_cmp_ge_u32 vcc, s68, v140
    buffer_load_dword v140, v135, s[4:7], 0 offen offset:0 sc1
    s_waitcnt vmcnt(12)
    s_cbranch_vccz L_eo_54
    v_cmp_ge_u32 vcc, s68, v140
    buffer_load_dword v140, v135, s[4:7], 0 offen offset:0 sc1
    s_waitcnt vmcnt(12)
    s_cbranch_vccz L_eo_54
    v_cmp_ge_u32 vcc, s68, v140
    buffer_load_dword v140, v135, s[4:7], 0 offen offset:0 sc1
    s_waitcnt vmcnt(12)
    s_cbranch_vccz L_eo_54
    v_cmp_ge_u32 vcc, s68, v140
    buffer_load_dword v140, v135, s[4:7], 0 offen offset:0 sc1
    s_waitcnt vmcnt(12)
    s_cbranch_vccz L_eo_54
    v_cmp_ge_u32 vcc, s68, v140
    buffer_load_dword v140, v135, s[4:7], 0 offen offset:0 sc1
    s_waitcnt vmcnt(12)
    s_cbranch_vccz L_eo_54
    v_cmp_ge_u32 vcc, s68, v140
    buffer_load_dword v140, v135, s[4:7], 0 offen offset:0 sc1
    s_waitcnt vmcnt(12)
    s_cbranch_vccz L_eo_54
    v_cmp_ge_u32 vcc, s68, v140
    buffer_load_dword v140, v135, s[4:7], 0 offen offset:0 sc1
    s_waitcnt vmcnt(12)
    s_cbranch_vccz L_eo_54
    v_cmp_ge_u32 vcc, s68, v140
    buffer_load_dword v140, v135, s[4:7], 0 offen offset:0 sc1
    s_waitcnt vmcnt(12)
    s_cbranch_vccz L_eo_54
    s_sub_u32 s15, s15, 1
    s_cbranch_scc0 L_ep_53
    s_branch L_abort
L_eo_54:
    s_waitcnt lgkmcnt(0)
    s_barrier
    s_nop 15
    s_nop 5
    buffer_load_dwordx4 v[192:195], v100, s[4:7], s72 offen offset:0 sc1
    buffer_load_dwordx4 v[196:199], v100, s[4:7], s72 offen offset:1024 sc1
    buffer_load_dword v208, v101, s[4:7], s72 offen offset:0 sc1
    buffer_load_dword v209, v101, s[4:7], s72 offen offset:256 sc1
    buffer_load_dword v210, v101, s[4:7], s72 offen offset:512 sc1
    buffer_load_dword v211, v101, s[4:7], s72 offen offset:768 sc1
    buffer_load_dwordx4 v[200:203], v100, s[4:7], s72 offen offset:2048 sc1
    buffer_load_dwordx4 v[204:207], v100, s[4:7], s72 offen offset:3072 sc1
    s_cmp_eq_u32 s68, 63
    s_cbranch_scc1 L_rec_fin2
    s_barrier
    ds_read_b128 v[144:147], v3 offset:8192
    ds_read_b128 v[148:151], v3 offset:9216
    ds_read_b128 v[152:155], v3 offset:10240
    ds_read_b128 v[156:159], v3 offset:11264
    s_waitcnt lgkmcnt(3)
    v_mfma_f32_16x16x32_bf16 v[212:215], v[68:71], v[144:147], 0
    s_waitcnt lgkmcnt(2)
    v_mfma_f32_16x16x32_bf16 v[212:215], v[68:71], v[148:151], v[212:215]
    s_waitcnt lgkmcnt(1)
    v_mfma_f32_16x16x32_bf16 v[216:219], v[68:71], v[152:155], 0
    s_waitcnt lgkmcnt(0)
    v_mfma_f32_16x16x32_bf16 v[216:219], v[68:71], v[156:159], v[216:219]
L_sw_55:
    s_waitcnt vmcnt(6)
    v_pk_add_f32 v[176:177], v[192:193], v[196:197]
    v_pk_add_f32 v[178:179], v[194:195], v[198:199]
    v_pk_mul_f32 v[176:177], v[176:177], v[128:129]
    v_pk_mul_f32 v[178:179], v[178:179], v[128:129]
    s_waitcnt vmcnt(2)
    v_pk_add_f32 v[172:173], v[208:209], v[210:211]
    v_add_f32 v172, v172, v173
    v_mul_f32 v172, s78, v172
    s_waitcnt vmcnt(1)
    v_pk_fma_f32 v[176:177], v[200:201], v[128:129], v[176:177]
    v_pk_fma_f32 v[178:179], v[202:203], v[128:129], v[178:179]
    s_waitcnt vmcnt(0)
    v_pk_fma_f32 v[176:177], v[204:205], v[128:129], v[176:177]
    v_pk_fma_f32 v[178:179], v[206:207], v[128:129], v[178:179]
    v_maximum3_f32 v236, v176, v177, v172
    v_maximum3_f32 v236, v236, v178, v179
    v_cmp_u_f32 vcc, v236, v236
    s_nop 0
    v_max_f32_dpp v236, v236, v236 row_ror:8 row_mask:0xf bank_mask:0xf
    v_mov_b32 v5, v236
    v_cvt_pk_bf16_f32 v220, v212, v213
    v_cvt_pk_bf16_f32 v224, v216, v217
    v_permlane16_swap_b32 v236, v5
    v_max_f32 v236, v236, v5
    v_mov_b32 v5, v236
    s_cbranch_vccnz L_srt_56
L_sok_57:
    s_nop 0
    v_permlane32_swap_b32 v236, v5
    v_max_f32 v236, v236, v5
    v_sub_f32 v172, v172, v236
    v_exp_f32 v172, v172
    v_pk_add_f32 v[176:177], v[176:177], v[236:237] op_sel_hi:[1,0] neg_lo:[0,1] neg_hi:[0,1]
    v_pk_add_f32 v[178:179], v[178:179], v[236:237] op_sel_hi:[1,0] neg_lo:[0,1] neg_hi:[0,1]
    v_mov_b32_dpp v5, v172 row_ror:8 row_mask:0xf bank_mask:0xf
    v_cvt_pk_bf16_f32 v232, v172, v5
    v_exp_f32 v176, v176
    v_exp_f32 v177, v177
    v_mfma_f32_16x16x32_bf16 v[236:239], v[72:75], v[232:235], 0
    v_exp_f32 v178, v178
    v_cvt_pk_bf16_f32 v228, v176, v177
    v_mfma_f32_16x16x32_bf16 v[88:91], v[220:223], v[232:235], 0
    v_exp_f32 v179, v179
    v_mov_b32_dpp v230, v228 row_ror:8 row_mask:0xf bank_mask:0xf
    v_cvt_pk_bf16_f32 v229, v178, v179
    v_mfma_f32_16x16x32_bf16 v[92:95], v[224:227], v[232:235], 0
    s_nop 0
    v_mov_b32_dpp v231, v229 row_ror:8 row_mask:0xf bank_mask:0xf
    s_nop 1
    v_mfma_f32_16x16x32_bf16 v[236:239], v[72:75], v[228:231], v[236:239]
    v_mfma_f32_16x16x32_bf16 v[88:91], v[184:187], v[228:231], v[88:91]
    v_mfma_f32_16x16x32_bf16 v[92:95], v[188:191], v[228:231], v[92:95]
    v_rcp_f32 v236, v236
    s_nop 2
    v_pk_mul_f32 v[88:89], v[88:89], v[236:237] op_sel_hi:[1,0]
    v_pk_mul_f32 v[90:91], v[90:91], v[236:237] op_sel_hi:[1,0]
    v_cvt_pk_bf16_f32 v80, v88, v89
    v_cvt_pk_bf16_f32 v81, v90, v91
    v_pk_mul_f32 v[92:93], v[92:93], v[236:237] op_sel_hi:[1,0]
    v_pk_mul_f32 v[94:95], v[94:95], v[236:237] op_sel_hi:[1,0]
    v_cvt_pk_bf16_f32 v82, v92, v93
    v_cvt_pk_bf16_f32 v83, v94, v95
    buffer_store_dwordx4 v[80:83], v97, s[4:7], s65 offen
    s_barrier
    s_nop 15
    s_nop 3
    buffer_load_dwordx4 v[8:11], v2, s[4:7], s65 offen sc1
    s_nop 7
    buffer_load_dwordx4 v[12:15], v120, s[4:7], s65 offen sc1
    s_nop 7
    buffer_load_dwordx4 v[16:19], v121, s[4:7], s65 offen sc1
    s_nop 7
    buffer_load_dwordx4 v[20:23], v122, s[4:7], s65 offen sc1
    s_waitcnt vmcnt(3)
    v_cmp_eq_u32 vcc, -1, v8
    s_cbranch_vccnz L_rec_Of15_0
    v_smfmac_f32_16x16x64_bf16 v[48:51], v[8:11], a[192:199], v1
    s_waitcnt vmcnt(2)
    v_cmp_eq_u32 vcc, -1, v12
    v_smfmac_f32_16x16x64_bf16 v[52:55], v[8:11], a[200:207], v1
    s_cbranch_vccnz L_rec_Of14_1
    v_smfmac_f32_16x16x64_bf16 v[48:51], v[12:15], a[208:215], v1
    s_waitcnt vmcnt(1)
    v_cmp_eq_u32 vcc, -1, v16
    v_smfmac_f32_16x16x64_bf16 v[52:55], v[12:15], a[216:223], v1
    s_cbranch_vccnz L_rec_Of12_2
    v_smfmac_f32_16x16x64_bf16 v[48:51], v[16:19], a[224:231], v1
    s_waitcnt vmcnt(0)
    v_cmp_eq_u32 vcc, -1, v20
    v_smfmac_f32_16x16x64_bf16 v[52:55], v[16:19], a[232:239], v1
    s_cbranch_vccnz L_rec_Of8_3
    v_smfmac_f32_16x16x64_bf16 v[48:51], v[20:23], a[240:247], v1
    v_smfmac_f32_16x16x64_bf16 v[52:55], v[20:23], a[248:255], v1
L_rec_Ofin2:
    s_nop 3
    v_cvt_pk_bf16_f32 v56, v48, v49
    v_cvt_pk_bf16_f32 v57, v50, v51
    s_nop 1
    v_cvt_pk_bf16_f32 v58, v52, v53
    v_cvt_pk_bf16_f32 v59, v54, v55
    ds_write_b128 v3, v[56:59] offset:14336
    s_barrier
    v_mov_b32 v48, 0
    v_mov_b32 v49, 0
    v_mov_b32 v50, 0
    v_mov_b32 v51, 0
    v_mov_b32 v52, 0
    v_mov_b32 v53, 0
    v_mov_b32 v54, 0
    v_mov_b32 v55, 0
    v_mov_b32 v24, 0
    v_mov_b32 v25, 0
    v_mov_b32 v26, 0
    v_mov_b32 v27, 0
    v_mov_b32 v28, 0
    v_mov_b32 v29, 0
    v_mov_b32 v30, 0
    v_mov_b32 v31, 0
    v_mov_b32 v32, 0
    v_mov_b32 v33, 0
    v_mov_b32 v34, 0
    v_mov_b32 v35, 0
    v_mov_b32 v36, 0
    v_mov_b32 v37, 0
    v_mov_b32 v38, 0
    v_mov_b32 v39, 0
    v_mov_b32 v40, 0
    v_mov_b32 v41, 0
    v_mov_b32 v42, 0
    v_mov_b32 v43, 0
    v_mov_b32 v44, 0
    v_mov_b32 v45, 0
    v_mov_b32 v46, 0
    v_mov_b32 v47, 0
    s_mov_b32 s69, s70
    s_add_u32 s68, s68, 1
    s_and_b32 s64, s68, 3
    s_lshl_b32 s72, s64, 19
    s_xor_b32 s77, s72, 0x100000
    s_add_u32 s70, s72, 0x80000
    s_and_b32 s70, s70, 0x180000
    s_add_u32 s65, s72, 128
    s_add_u32 s64, s68, 1
    v_mov_b32 v136, s64
    s_branch L_rec_loop2
L_rec_fin2:
    s_barrier
    s_branch L_drain
L_srt_56:
    buffer_load_dwordx4 v[192:195], v100, s[4:7], s72 offen offset:0 sc1
    buffer_load_dwordx4 v[196:199], v100, s[4:7], s72 offen offset:1024 sc1
    buffer_load_dword v208, v101, s[4:7], s72 offen offset:0 sc1
    buffer_load_dword v209, v101, s[4:7], s72 offen offset:256 sc1
    buffer_load_dword v210, v101, s[4:7], s72 offen offset:512 sc1
    buffer_load_dword v211, v101, s[4:7], s72 offen offset:768 sc1
    buffer_load_dwordx4 v[200:203], v100, s[4:7], s72 offen offset:2048 sc1
    buffer_load_dwordx4 v[204:207], v100, s[4:7], s72 offen offset:3072 sc1
    s_sub_u32 s15, s15, 1
    s_cbranch_scc0 L_sw_55
    s_branch L_abort
L_rec_w3:
    s_getpc_b64 s[56:57]
L_rec_Apc3:
    s_add_u32 s56, s56, L_rec_Afin3-L_rec_Apc3
    s_addc_u32 s57, s57, 0
    s_getpc_b64 s[58:59]
L_rec_Opc3:
    s_add_u32 s58, s58, L_rec_Ofin3-L_rec_Opc3
    s_addc_u32 s59, s59, 0
    v_mov_b32 v108, 0
    v_mov_b32 v109, 0
    v_min_u32 v108, v108, v109
    s_nop 0
    v_readfirstlane_b32 s75, v108
    s_lshl_b32 s54, s76, 11
    s_and_b32 s54, s54, 0x2000
    s_xor_b32 s54, s54, s100
    s_lshl_b32 s67, s76, 19
    s_or_b32 s54, s54, s67
    s_mov_b32 m0, 149504
    s_cmp_le_u32 s75, s76
    s_cbranch_scc1 L_kvp_58
L_kvo_59:
    buffer_load_dwordx4 v107, s[4:7], s54 offen offset:0 sc1 lds
    s_mov_b32 m0, 150464
    s_nop 0
    buffer_load_dwordx4 v107, s[4:7], s54 offen offset:64 sc1 lds
    s_mov_b32 m0, 151552
    s_nop 0
    buffer_load_dwordx4 v106, s[4:7], s54 offen offset:0 sc1 lds
    s_mov_b32 m0, 152448
    s_nop 0
    buffer_load_dwordx4 v106, s[4:7], s54 offen offset:128 sc1 lds
    s_add_u32 s54, s76, 3
    s_add_u32 s76, s76, 1
    s_cmp_gt_u32 s75, s54
    s_cbranch_scc1 L_kvn_60
    buffer_load_dwordx2 v[108:109], v110, s[4:7], 0 offen sc1
L_kvn_60:
    v_mov_b32 v24, 0
    v_mov_b32 v25, 0
    v_mov_b32 v26, 0
    v_mov_b32 v27, 0
    v_mov_b32 v28, 0
    v_mov_b32 v29, 0
    v_mov_b32 v30, 0
    v_mov_b32 v31, 0
    v_mov_b32 v32, 0
    v_mov_b32 v33, 0
    v_mov_b32 v34, 0
    v_mov_b32 v35, 0
    v_mov_b32 v36, 0
    v_mov_b32 v37, 0
    v_mov_b32 v38, 0
    v_mov_b32 v39, 0
    v_mov_b32 v40, 0
    v_mov_b32 v41, 0
    v_mov_b32 v42, 0
    v_mov_b32 v43, 0
    v_mov_b32 v44, 0
    v_mov_b32 v45, 0
    v_mov_b32 v46, 0
    v_mov_b32 v47, 0
    v_mov_b32 v48, 0
    v_mov_b32 v49, 0
    v_mov_b32 v50, 0
    v_mov_b32 v51, 0
    v_mov_b32 v52, 0
    v_mov_b32 v53, 0
    v_mov_b32 v54, 0
    v_mov_b32 v55, 0
    v_mov_b32 v140, 0
    v_mov_b32 v141, 0
    v_mov_b32 v142, 0
    v_mov_b32 v143, 0
    v_mov_b32 v130, 0
    v_mov_b32 v131, 0
    s_and_b32 s64, s68, 3
    s_lshl_b32 s72, s64, 19
    s_xor_b32 s77, s72, 0x100000
    s_add_u32 s70, s72, 0x80000
    s_and_b32 s70, s70, 0x180000
    s_add_u32 s65, s72, 128
    s_add_u32 s64, s68, 1
    v_mov_b32 v136, s64
    s_mov_b32 s69, 0
.p2align 6
L_rec_loop3:
    s_barrier
    s_nop 15
    s_nop 3
    buffer_load_dwordx4 v[8:11], v2, s[4:7], s69 offen sc1
    s_nop 7
    buffer_load_dwordx4 v[12:15], v120, s[4:7], s69 offen sc1
    s_nop 7
    buffer_load_dwordx4 v[16:19], v121, s[4:7], s69 offen sc1
    s_nop 7
    buffer_load_dwordx4 v[20:23], v122, s[4:7], s69 offen sc1
    s_waitcnt vmcnt(3)
    v_cmp_eq_u32 vcc, -1, v8
    s_cbranch_vccnz L_rec_Af15_0
    v_smfmac_f32_16x16x64_bf16 v[24:27], v[8:11], a[0:7], v1
    v_smfmac_f32_16x16x64_bf16 v[32:35], v[8:11], a[64:71], v1
    s_waitcnt vmcnt(2)
    v_cmp_eq_u32 vcc, -1, v12
    v_smfmac_f32_16x16x64_bf16 v[28:31], v[8:11], a[8:15], v1
    v_smfmac_f32_16x16x64_bf16 v[36:39], v[8:11], a[72:79], v1
    s_cbranch_vccnz L_rec_Af14_1
    v_smfmac_f32_16x16x64_bf16 v[24:27], v[12:15], a[16:23], v1
    v_smfmac_f32_16x16x64_bf16 v[32:35], v[12:15], a[80:87], v1
    s_waitcnt vmcnt(1)
    v_cmp_eq_u32 vcc, -1, v16
    v_smfmac_f32_16x16x64_bf16 v[28:31], v[12:15], a[24:31], v1
    v_smfmac_f32_16x16x64_bf16 v[36:39], v[12:15], a[88:95], v1
    s_cbranch_vccnz L_rec_Af12_2
    v_smfmac_f32_16x16x64_bf16 v[24:27], v[16:19], a[32:39], v1
    v_smfmac_f32_16x16x64_bf16 v[32:35], v[16:19], a[96:103], v1
    s_waitcnt vmcnt(0)
    v_cmp_eq_u32 vcc, -1, v20
    v_smfmac_f32_16x16x64_bf16 v[28:31], v[16:19], a[40:47], v1
    v_smfmac_f32_16x16x64_bf16 v[36:39], v[16:19], a[104:111], v1
    s_cbranch_vccnz L_rec_Af8_3
    v_smfmac_f32_16x16x64_bf16 v[24:27], v[20:23], a[48:55], v1
    v_smfmac_f32_16x16x64_bf16 v[32:35], v[20:23], a[112:119], v1
    v_smfmac_f32_16x16x64_bf16 v[28:31], v[20:23], a[56:63], v1
    v_smfmac_f32_16x16x64_bf16 v[36:39], v[20:23], a[120:127], v1
L_rec_Afin3:
    v_cvt_pk_bf16_f32 v56, v24, v25
    v_cvt_pk_bf16_f32 v57, v26, v27
    v_cvt_pk_bf16_f32 v58, v32, v33
    v_cvt_pk_bf16_f32 v59, v34, v35
    ds_write_b128 v3, v[56:59] offset:6144
    v_cvt_pk_bf16_f32 v60, v28, v29
    v_cvt_pk_bf16_f32 v61, v30, v31
    s_nop 0
    v_cvt_pk_bf16_f32 v62, v36, v37
    v_cvt_pk_bf16_f32 v63, v38, v39
    ds_write_b128 v3, v[60:63] offset:7168
    s_barrier
    buffer_store_dword v136, v134, s[4:7], 0 offen
    v_smfmac_f32_16x16x64_bf16 v[40:43], v[8:11], a[128:135], v1
    v_smfmac_f32_16x16x64_bf16 v[44:47], v[8:11], a[136:143], v1
    v_smfmac_f32_16x16x64_bf16 v[40:43], v[12:15], a[144:151], v1
    v_smfmac_f32_16x16x64_bf16 v[44:47], v[12:15], a[152:159], v1
    v_smfmac_f32_16x16x64_bf16 v[40:43], v[16:19], a[160:167], v1
    v_smfmac_f32_16x16x64_bf16 v[44:47], v[16:19], a[168:175], v1
    v_smfmac_f32_16x16x64_bf16 v[40:43], v[20:23], a[176:183], v1
    v_smfmac_f32_16x16x64_bf16 v[44:47], v[20:23], a[184:191], v1
    s_nop 3
    v_cvt_pk_bf16_f32 v80, v40, v41
    v_cvt_pk_bf16_f32 v81, v42, v43
    s_nop 1
    v_cvt_pk_bf16_f32 v82, v44, v45
    v_cvt_pk_bf16_f32 v83, v46, v47
    ds_write2st64_b64 v111, v[80:81], v[82:83] offset0:0 offset1:4
    s_waitcnt lgkmcnt(0)
    s_barrier
    v_min_u32 v108, v108, v109
    s_nop 0
    v_readfirstlane_b32 s75, v108
    s_lshl_b32 s54, s76, 11
    s_and_b32 s54, s54, 0x2000
    s_xor_b32 s54, s54, s100
    s_lshl_b32 s67, s76, 19
    s_or_b32 s54, s54, s67
    s_mov_b32 m0, 149504
    v_mov_b32 v24, 0
    v_mov_b32 v25, 0
    v_mov_b32 v26, 0
    v_mov_b32 v27, 0
    v_mov_b32 v28, 0
    v_mov_b32 v29, 0
    v_mov_b32 v30, 0
    v_mov_b32 v31, 0
    v_mov_b32 v32, 0
    v_mov_b32 v33, 0
    v_mov_b32 v34, 0
    v_mov_b32 v35, 0
    v_mov_b32 v36, 0
    v_mov_b32 v37, 0
    v_mov_b32 v38, 0
    v_mov_b32 v39, 0
    v_mov_b32 v40, 0
    v_mov_b32 v41, 0
    v_mov_b32 v42, 0
    v_mov_b32 v43, 0
    v_mov_b32 v44, 0
    v_mov_b32 v45, 0
    v_mov_b32 v46, 0
    v_mov_b32 v47, 0
    s_barrier
    s_cmp_le_u32 s75, s76
    s_cbranch_scc1 L_kvp_61
L_kvo_62:
    buffer_load_dwordx4 v107, s[4:7], s54 offen offset:0 sc1 lds
    s_mov_b32 m0, 150464
    s_nop 0
    buffer_load_dwordx4 v107, s[4:7], s54 offen offset:64 sc1 lds
    s_mov_b32 m0, 151552
    s_nop 0
    buffer_load_dwordx4 v106, s[4:7], s54 offen offset:0 sc1 lds
    s_mov_b32 m0, 152448
    s_nop 0
    buffer_load_dwordx4 v106, s[4:7], s54 offen offset:128 sc1 lds
    s_add_u32 s54, s76, 3
    s_add_u32 s76, s76, 1
    s_cmp_gt_u32 s75, s54
    s_cbranch_scc1 L_kvn_63
L_kvp_61:
    buffer_load_dwordx2 v[108:109], v110, s[4:7], 0 offen sc1
L_kvn_63:
    ds_read_b128 v[144:147], v3 offset:8192
    ds_read_b128 v[148:151], v3 offset:9216
    ds_read_b128 v[152:155], v3 offset:10240
    ds_read_b128 v[156:159], v3 offset:11264
    s_waitcnt lgkmcnt(3)
    v_mfma_f32_16x16x32_bf16 v[212:215], v[68:71], v[144:147], 0
    s_waitcnt lgkmcnt(2)
    v_mfma_f32_16x16x32_bf16 v[212:215], v[68:71], v[148:151], v[212:215]
    s_waitcnt lgkmcnt(1)
    v_mfma_f32_16x16x32_bf16 v[216:219], v[68:71], v[152:155], 0
    s_waitcnt lgkmcnt(0)
    v_mfma_f32_16x16x32_bf16 v[216:219], v[68:71], v[156:159], v[216:219]
    v_cvt_pk_bf16_f32 v220, v212, v213
    ds_write_b32 v112, v220 offset:0
    s_nop 5
    v_cvt_pk_bf16_f32 v224, v216, v217
    ds_write_b32 v112, v224 offset:64
    ds_read_b128 v[80:83], v113
    s_lshl_b32 s64, s68, 10
    s_and_b32 s64, s64, 0x2000
    s_xor_b32 s64, s64, s100
    s_lshl_b32 s67, s68, 18
    s_or_b32 s64, s64, s67
    s_cmp_eq_u32 s68, 63
    s_cbranch_scc1 L_rec_fin3
    s_waitcnt lgkmcnt(0)
    s_barrier
    s_nop 15
    s_nop 3
    buffer_load_dwordx4 v[8:11], v2, s[4:7], s65 offen sc1
    s_nop 7
    buffer_load_dwordx4 v[12:15], v120, s[4:7], s65 offen sc1
    s_nop 7
    buffer_load_dwordx4 v[16:19], v121, s[4:7], s65 offen sc1
    s_nop 7
    buffer_load_dwordx4 v[20:23], v122, s[4:7], s65 offen sc1
    s_waitcnt vmcnt(3)
    v_cmp_eq_u32 vcc, -1, v8
    s_cbranch_vccnz L_rec_Of15_0
    v_smfmac_f32_16x16x64_bf16 v[48:51], v[8:11], a[192:199], v1
    s_waitcnt vmcnt(2)
    v_cmp_eq_u32 vcc, -1, v12
    v_smfmac_f32_16x16x64_bf16 v[52:55], v[8:11], a[200:207], v1
    s_cbranch_vccnz L_rec_Of14_1
    v_smfmac_f32_16x16x64_bf16 v[48:51], v[12:15], a[208:215], v1
    s_waitcnt vmcnt(1)
    v_cmp_eq_u32 vcc, -1, v16
    v_smfmac_f32_16x16x64_bf16 v[52:55], v[12:15], a[216:223], v1
    s_cbranch_vccnz L_rec_Of12_2
    v_smfmac_f32_16x16x64_bf16 v[48:51], v[16:19], a[224:231], v1
    s_waitcnt vmcnt(0)
    v_cmp_eq_u32 vcc, -1, v20
    v_smfmac_f32_16x16x64_bf16 v[52:55], v[16:19], a[232:239], v1
    s_cbranch_vccnz L_rec_Of8_3
    v_smfmac_f32_16x16x64_bf16 v[48:51], v[20:23], a[240:247], v1
    v_smfmac_f32_16x16x64_bf16 v[52:55], v[20:23], a[248:255], v1
L_rec_Ofin3:
    s_nop 3
    v_cvt_pk_bf16_f32 v56, v48, v49
    v_cvt_pk_bf16_f32 v57, v50, v51
    s_nop 1
    v_cvt_pk_bf16_f32 v58, v52, v53
    v_cvt_pk_bf16_f32 v59, v54, v55
    ds_write_b128 v3, v[56:59] offset:15360
    s_barrier
    buffer_store_dwordx4 v[80:83], v114, s[4:7], s64 offen sc1
    v_mov_b32 v48, 0
    v_mov_b32 v49, 0
    v_mov_b32 v50, 0
    v_mov_b32 v51, 0
    v_mov_b32 v52, 0
    v_mov_b32 v53, 0
    v_mov_b32 v54, 0
    v_mov_b32 v55, 0
    buffer_store_dwordx4 v[84:87], v116, s[4:7], s77 offen
    buffer_store_dwordx4 v[84:87], v117, s[4:7], s77 offen
    buffer_store_dwordx4 v[84:87], v99, s[4:7], s77 offen
    s_add_u32 s64, s68, 2
    s_cmp_eq_u32 s64, s76
    s_cbranch_scc1 L_kvl_64
    v_min_u32 v108, v108, v109
    s_nop 0
    v_readfirstlane_b32 s75, v108
    s_lshl_b32 s54, s76, 11
    s_and_b32 s54, s54, 0x2000
    s_xor_b32 s54, s54, s100
    s_lshl_b32 s67, s76, 19
    s_or_b32 s54, s54, s67
    s_mov_b32 m0, 149504
    s_cmp_le_u32 s75, s76
    s_cbranch_scc1 L_kvp_65
L_kvo_66:
    buffer_load_dwordx4 v107, s[4:7], s54 offen offset:0 sc1 lds
    s_mov_b32 m0, 150464
    s_nop 0
    buffer_load_dwordx4 v107, s[4:7], s54 offen offset:64 sc1 lds
    s_mov_b32 m0, 151552
    s_nop 0
    buffer_load_dwordx4 v106, s[4:7], s54 offen offset:0 sc1 lds
    s_mov_b32 m0, 152448
    s_nop 0
    buffer_load_dwordx4 v106, s[4:7], s54 offen offset:128 sc1 lds
    s_add_u32 s54, s76, 3
    s_add_u32 s76, s76, 1
    s_cmp_gt_u32 s75, s54
    s_cbranch_scc1 L_kvn_67
    buffer_load_dwordx2 v[108:109], v110, s[4:7], 0 offen sc1
L_kvn_67:
L_kvl_64:
    s_mov_b32 s69, s70
    s_add_u32 s68, s68, 1
    s_and_b32 s64, s68, 3
    s_lshl_b32 s72, s64, 19
    s_xor_b32 s77, s72, 0x100000
    s_add_u32 s70, s72, 0x80000
    s_and_b32 s70, s70, 0x180000
    s_add_u32 s65, s72, 128
    s_add_u32 s64, s68, 1
    v_mov_b32 v136, s64
    s_branch L_rec_loop3
L_rec_fin3:
    s_waitcnt lgkmcnt(0)
    buffer_store_dwordx4 v[80:83], v114, s[4:7], s64 offen sc1
    s_branch L_drain
L_kvp_58:
    buffer_load_dwordx2 v[108:109], v110, s[4:7], 0 offen sc1
    s_sub_u32 s15, s15, 1
    s_cbranch_scc1 L_abort
    s_waitcnt vmcnt(0)
    v_min_u32 v108, v108, v109
    s_nop 0
    v_readfirstlane_b32 s75, v108
    s_nop 0
    s_cmp_le_u32 s75, s76
    s_cbranch_scc1 L_kvp_58
    s_branch L_kvo_59
L_rec_Af15_0:
    s_mov_b64 exec, vcc
    buffer_load_dwordx4 v[8:11], v2, s[4:7], s69 offen sc1
    s_mov_b64 exec, -1
    s_waitcnt vmcnt(3)
    v_cmp_eq_u32 vcc, -1, v12
L_rec_As15_1:
    s_cbranch_vccnz L_rec_Af15_1
    v_smfmac_f32_16x16x64_bf16 v[24:27], v[12:15], a[16:23], v1
    v_smfmac_f32_16x16x64_bf16 v[32:35], v[12:15], a[80:87], v1
    s_waitcnt vmcnt(2)
    v_cmp_eq_u32 vcc, -1, v16
    v_smfmac_f32_16x16x64_bf16 v[28:31], v[12:15], a[24:31], v1
    v_smfmac_f32_16x16x64_bf16 v[36:39], v[12:15], a[88:95], v1
L_rec_As13_2:
    s_cbranch_vccnz L_rec_Af13_2
    v_smfmac_f32_16x16x64_bf16 v[24:27], v[16:19], a[32:39], v1
    v_smfmac_f32_16x16x64_bf16 v[32:35], v[16:19], a[96:103], v1
    s_waitcnt vmcnt(1)
    v_cmp_eq_u32 vcc, -1, v20
    v_smfmac_f32_16x16x64_bf16 v[28:31], v[16:19], a[40:47], v1
    v_smfmac_f32_16x16x64_bf16 v[36:39], v[16:19], a[104:111], v1
L_rec_As9_3:
    s_cbranch_vccnz L_rec_Af9_3
    v_smfmac_f32_16x16x64_bf16 v[24:27], v[20:23], a[48:55], v1
    v_smfmac_f32_16x16x64_bf16 v[32:35], v[20:23], a[112:119], v1
    s_waitcnt vmcnt(0)
    v_cmp_eq_u32 vcc, -1, v8
    v_smfmac_f32_16x16x64_bf16 v[28:31], v[20:23], a[56:63], v1
    v_smfmac_f32_16x16x64_bf16 v[36:39], v[20:23], a[120:127], v1
L_rec_As1_0:
    s_cbranch_vccnz L_rec_Af1_0
    v_smfmac_f32_16x16x64_bf16 v[24:27], v[8:11], a[0:7], v1
    v_smfmac_f32_16x16x64_bf16 v[32:35], v[8:11], a[64:71], v1
    v_smfmac_f32_16x16x64_bf16 v[28:31], v[8:11], a[8:15], v1
    v_smfmac_f32_16x16x64_bf16 v[36:39], v[8:11], a[72:79], v1
    s_setpc_b64 s[56:57]
L_rec_Af15_1:
    s_mov_b64 exec, vcc
    buffer_load_dwordx4 v[12:15], v120, s[4:7], s69 offen sc1
    s_mov_b64 exec, -1
    s_waitcnt vmcnt(3)
    v_cmp_eq_u32 vcc, -1, v16
L_rec_As15_2:
    s_cbranch_vccnz L_rec_Af15_2
    v_smfmac_f32_16x16x64_bf16 v[24:27], v[16:19], a[32:39], v1
    v_smfmac_f32_16x16x64_bf16 v[32:35], v[16:19], a[96:103], v1
    s_waitcnt vmcnt(2)
    v_cmp_eq_u32 vcc, -1, v20
    v_smfmac_f32_16x16x64_bf16 v[28:31], v[16:19], a[40:47], v1
    v_smfmac_f32_16x16x64_bf16 v[36:39], v[16:19], a[104:111], v1
L_rec_As11_3:
    s_cbranch_vccnz L_rec_Af11_3
    v_smfmac_f32_16x16x64_bf16 v[24:27], v[20:23], a[48:55], v1
    v_smfmac_f32_16x16x64_bf16 v[32:35], v[20:23], a[112:119], v1
    s_waitcnt vmcnt(1)
    v_cmp_eq_u32 vcc, -1, v8
    v_smfmac_f32_16x16x64_bf16 v[28:31], v[20:23], a[56:63], v1
    v_smfmac_f32_16x16x64_bf16 v[36:39], v[20:23], a[120:127], v1
L_rec_As3_0:
    s_cbranch_vccnz L_rec_Af3_0
    v_smfmac_f32_16x16x64_bf16 v[24:27], v[8:11], a[0:7], v1
    v_smfmac_f32_16x16x64_bf16 v[32:35], v[8:11], a[64:71], v1
    s_waitcnt vmcnt(0)
    v_cmp_eq_u32 vcc, -1, v12
    v_smfmac_f32_16x16x64_bf16 v[28:31], v[8:11], a[8:15], v1
    v_smfmac_f32_16x16x64_bf16 v[36:39], v[8:11], a[72:79], v1
L_rec_As2_1:
    s_cbranch_vccnz L_rec_Af2_1
    v_smfmac_f32_16x16x64_bf16 v[24:27], v[12:15], a[16:23], v1
    v_smfmac_f32_16x16x64_bf16 v[32:35], v[12:15], a[80:87], v1
    v_smfmac_f32_16x16x64_bf16 v[28:31], v[12:15], a[24:31], v1
    v_smfmac_f32_16x16x64_bf16 v[36:39], v[12:15], a[88:95], v1
    s_setpc_b64 s[56:57]
L_rec_Af15_2:
    s_mov_b64 exec, vcc
    buffer_load_dwordx4 v[16:19], v121, s[4:7], s69 offen sc1
    s_mov_b64 exec, -1
    s_waitcnt vmcnt(3)
    v_cmp_eq_u32 vcc, -1, v20
L_rec_As15_3:
    s_cbranch_vccnz L_rec_Af15_3
    v_smfmac_f32_16x16x64_bf16 v[24:27], v[20:23], a[48:55], v1
    v_smfmac_f32_16x16x64_bf16 v[32:35], v[20:23], a[112:119], v1
    s_waitcnt vmcnt(2)
    v_cmp_eq_u32 vcc, -1, v8
    v_smfmac_f32_16x16x64_bf16 v[28:31], v[20:23], a[56:63], v1
    v_smfmac_f32_16x16x64_bf16 v[36:39], v[20:23], a[120:127], v1
L_rec_As7_0:
    s_cbranch_vccnz L_rec_Af7_0
    v_smfmac_f32_16x16x64_bf16 v[24:27], v[8:11], a[0:7], v1
    v_smfmac_f32_16x16x64_bf16 v[32:35], v[8:11], a[64:71], v1
    s_waitcnt vmcnt(1)
    v_cmp_eq_u32 vcc, -1, v12
    v_smfmac_f32_16x16x64_bf16 v[28:31], v[8:11], a[8:15], v1
    v_smfmac_f32_16x16x64_bf16 v[36:39], v[8:11], a[72:79], v1
L_rec_As6_1:
    s_cbranch_vccnz L_rec_Af6_1
    v_smfmac_f32_16x16x64_bf16 v[24:27], v[12:15], a[16:23], v1
    v_smfmac_f32_16x16x64_bf16 v[32:35], v[12:15], a[80:87], v1
    s_waitcnt vmcnt(0)
    v_cmp_eq_u32 vcc, -1, v16
    v_smfmac_f32_16x16x64_bf16 v[28:31], v[12:15], a[24:31], v1
    v_smfmac_f32_16x16x64_bf16 v[36:39], v[12:15], a[88:95], v1
L_rec_As4_2:
    s_cbranch_vccnz L_rec_Af4_2
    v_smfmac_f32_16x16x64_bf16 v[24:27], v[16:19], a[32:39], v1
    v_smfmac_f32_16x16x64_bf16 v[32:35], v[16:19], a[96:103], v1
    v_smfmac_f32_16x16x64_bf16 v[28:31], v[16:19], a[40:47], v1
    v_smfmac_f32_16x16x64_bf16 v[36:39], v[16:19], a[104:111], v1
    s_setpc_b64 s[56:57]
L_rec_Af15_3:
    s_mov_b64 exec, vcc
    buffer_load_dwordx4 v[20:23], v122, s[4:7], s69 offen sc1
    s_mov_b64 exec, -1
    s_sub_u32 s15, s15, 1
    s_cbranch_scc1 L_abort
    s_waitcnt vmcnt(3)
    v_cmp_eq_u32 vcc, -1, v8
L_rec_As15_0:
    s_cbranch_vccnz L_rec_Af15_0
    v_smfmac_f32_16x16x64_bf16 v[24:27], v[8:11], a[0:7], v1
    v_smfmac_f32_16x16x64_bf16 v[32:35], v[8:11], a[64:71], v1
    s_waitcnt vmcnt(2)
    v_cmp_eq_u32 vcc, -1, v12
    v_smfmac_f32_16x16x64_bf16 v[28:31], v[8:11], a[8:15], v1
    v_smfmac_f32_16x16x64_bf16 v[36:39], v[8:11], a[72:79], v1
L_rec_As14_1:
    s_cbranch_vccnz L_rec_Af14_1
    v_smfmac_f32_16x16x64_bf16 v[24:27], v[12:15], a[16:23], v1
    v_smfmac_f32_16x16x64_bf16 v[32:35], v[12:15], a[80:87], v1
    s_waitcnt vmcnt(1)
    v_cmp_eq_u32 vcc, -1, v16
    v_smfmac_f32_16x16x64_bf16 v[28:31], v[12:15], a[24:31], v1
    v_smfmac_f32_16x16x64_bf16 v[36:39], v[12:15], a[88:95], v1
L_rec_As12_2:
    s_cbranch_vccnz L_rec_Af12_2
    v_smfmac_f32_16x16x64_bf16 v[24:27], v[16:19], a[32:39], v1
    v_smfmac_f32_16x16x64_bf16 v[32:35], v[16:19], a[96:103], v1
    s_waitcnt vmcnt(0)
    v_cmp_eq_u32 vcc, -1, v20
    v_smfmac_f32_16x16x64_bf16 v[28:31], v[16:19], a[40:47], v1
    v_smfmac_f32_16x16x64_bf16 v[36:39], v[16:19], a[104:111], v1
L_rec_As8_3:
    s_cbranch_vccnz L_rec_Af8_3
    v_smfmac_f32_16x16x64_bf16 v[24:27], v[20:23], a[48:55], v1
    v_smfmac_f32_16x16x64_bf16 v[32:35], v[20:23], a[112:119], v1
    v_smfmac_f32_16x16x64_bf16 v[28:31], v[20:23], a[56:63], v1
    v_smfmac_f32_16x16x64_bf16 v[36:39], v[20:23], a[120:127], v1
    s_setpc_b64 s[56:57]
L_rec_Af7_0:
    s_mov_b64 exec, vcc
    buffer_load_dwordx4 v[8:11], v2, s[4:7], s69 offen sc1
    s_mov_b64 exec, -1
    s_waitcnt vmcnt(2)
    v_cmp_eq_u32 vcc, -1, v12
L_rec_As7_1:
    s_cbranch_vccnz L_rec_Af7_1
    v_smfmac_f32_16x16x64_bf16 v[24:27], v[12:15], a[16:23], v1
    v_smfmac_f32_16x16x64_bf16 v[32:35], v[12:15], a[80:87], v1
    s_waitcnt vmcnt(1)
    v_cmp_eq_u32 vcc, -1, v16
    v_smfmac_f32_16x16x64_bf16 v[28:31], v[12:15], a[24:31], v1
    v_smfmac_f32_16x16x64_bf16 v[36:39], v[12:15], a[88:95], v1
L_rec_As5_2:
    s_cbranch_vccnz L_rec_Af5_2
    v_smfmac_f32_16x16x64_bf16 v[24:27], v[16:19], a[32:39], v1
    v_smfmac_f32_16x16x64_bf16 v[32:35], v[16:19], a[96:103], v1
    s_waitcnt vmcnt(0)
    v_cmp_eq_u32 vcc, -1, v8
    v_smfmac_f32_16x16x64_bf16 v[28:31], v[16:19], a[40:47], v1
    v_smfmac_f32_16x16x64_bf16 v[36:39], v[16:19], a[104:111], v1
    s_branch L_rec_As1_0
L_rec_Af7_1:
    s_mov_b64 exec, vcc
    buffer_load_dwordx4 v[12:15], v120, s[4:7], s69 offen sc1
    s_mov_b64 exec, -1
    s_waitcnt vmcnt(2)
    v_cmp_eq_u32 vcc, -1, v16
L_rec_As7_2:
    s_cbranch_vccnz L_rec_Af7_2
    v_smfmac_f32_16x16x64_bf16 v[24:27], v[16:19], a[32:39], v1
    v_smfmac_f32_16x16x64_bf16 v[32:35], v[16:19], a[96:103], v1
    s_waitcnt vmcnt(1)
    v_cmp_eq_u32 vcc, -1, v8
    v_smfmac_f32_16x16x64_bf16 v[28:31], v[16:19], a[40:47], v1
    v_smfmac_f32_16x16x64_bf16 v[36:39], v[16:19], a[104:111], v1
    s_branch L_rec_As3_0
L_rec_Af7_2:
    s_mov_b64 exec, vcc
    buffer_load_dwordx4 v[16:19], v121, s[4:7], s69 offen sc1
    s_mov_b64 exec, -1
    s_sub_u32 s15, s15, 1
    s_cbranch_scc1 L_abort
    s_waitcnt vmcnt(2)
    v_cmp_eq_u32 vcc, -1, v8
    s_branch L_rec_As7_0
L_rec_Af11_0:
    s_mov_b64 exec, vcc
    buffer_load_dwordx4 v[8:11], v2, s[4:7], s69 offen sc1
    s_mov_b64 exec, -1
    s_waitcnt vmcnt(2)
    v_cmp_eq_u32 vcc, -1, v12
L_rec_As11_1:
    s_cbranch_vccnz L_rec_Af11_1
    v_smfmac_f32_16x16x64_bf16 v[24:27], v[12:15], a[16:23], v1
    v_smfmac_f32_16x16x64_bf16 v[32:35], v[12:15], a[80:87], v1
    s_waitcnt vmcnt(1)
    v_cmp_eq_u32 vcc, -1, v20
    v_smfmac_f32_16x16x64_bf16 v[28:31], v[12:15], a[24:31], v1
    v_smfmac_f32_16x16x64_bf16 v[36:39], v[12:15], a[88:95], v1
    s_branch L_rec_As9_3
L_rec_Af11_1:
    s_mov_b64 exec, vcc
    buffer_load_dwordx4 v[12:15], v120, s[4:7], s69 offen sc1
    s_mov_b64 exec, -1
    s_waitcnt vmcnt(2)
    v_cmp_eq_u32 vcc, -1, v20
    s_branch L_rec_As11_3
L_rec_Af11_3:
    s_mov_b64 exec, vcc
    buffer_load_dwordx4 v[20:23], v122, s[4:7], s69 offen sc1
    s_mov_b64 exec, -1
    s_sub_u32 s15, s15, 1
    s_cbranch_scc1 L_abort
    s_waitcnt vmcnt(2)
    v_cmp_eq_u32 vcc, -1, v8
L_rec_As11_0:
    s_cbranch_vccnz L_rec_Af11_0
    v_smfmac_f32_16x16x64_bf16 v[24:27], v[8:11], a[0:7], v1
    v_smfmac_f32_16x16x64_bf16 v[32:35], v[8:11], a[64:71], v1
    s_waitcnt vmcnt(1)
    v_cmp_eq_u32 vcc, -1, v12
    v_smfmac_f32_16x16x64_bf16 v[28:31], v[8:11], a[8:15], v1
    v_smfmac_f32_16x16x64_bf16 v[36:39], v[8:11], a[72:79], v1
L_rec_As10_1:
    s_cbranch_vccnz L_rec_Af10_1
    v_smfmac_f32_16x16x64_bf16 v[24:27], v[12:15], a[16:23], v1
    v_smfmac_f32_16x16x64_bf16 v[32:35], v[12:15], a[80:87], v1
    s_waitcnt vmcnt(0)
    v_cmp_eq_u32 vcc, -1, v20
    v_smfmac_f32_16x16x64_bf16 v[28:31], v[12:15], a[24:31], v1
    v_smfmac_f32_16x16x64_bf16 v[36:39], v[12:15], a[88:95], v1
    s_branch L_rec_As8_3
L_rec_Af13_0:
    s_mov_b64 exec, vcc
    buffer_load_dwordx4 v[8:11], v2, s[4:7], s69 offen sc1
    s_mov_b64 exec, -1
    s_waitcnt vmcnt(2)
    v_cmp_eq_u32 vcc, -1, v16
    s_branch L_rec_As13_2
L_rec_Af13_2:
    s_mov_b64 exec, vcc
    buffer_load_dwordx4 v[16:19], v121, s[4:7], s69 offen sc1
    s_mov_b64 exec, -1
    s_waitcnt vmcnt(2)
    v_cmp_eq_u32 vcc, -1, v20
L_rec_As13_3:
    s_cbranch_vccnz L_rec_Af13_3
    v_smfmac_f32_16x16x64_bf16 v[24:27], v[20:23], a[48:55], v1
    v_smfmac_f32_16x16x64_bf16 v[32:35], v[20:23], a[112:119], v1
    s_waitcnt vmcnt(1)
    v_cmp_eq_u32 vcc, -1, v8
    v_smfmac_f32_16x16x64_bf16 v[28:31], v[20:23], a[56:63], v1
    v_smfmac_f32_16x16x64_bf16 v[36:39], v[20:23], a[120:127], v1
L_rec_As5_0:
    s_cbranch_vccnz L_rec_Af5_0
    v_smfmac_f32_16x16x64_bf16 v[24:27], v[8:11], a[0:7], v1
    v_smfmac_f32_16x16x64_bf16 v[32:35], v[8:11], a[64:71], v1
    s_waitcnt vmcnt(0)
    v_cmp_eq_u32 vcc, -1, v16
    v_smfmac_f32_16x16x64_bf16 v[28:31], v[8:11], a[8:15], v1
    v_smfmac_f32_16x16x64_bf16 v[36:39], v[8:11], a[72:79], v1
    s_branch L_rec_As4_2
L_rec_Af13_3:
    s_mov_b64 exec, vcc
    buffer_load_dwordx4 v[20:23], v122, s[4:7], s69 offen sc1
    s_mov_b64 exec, -1
    s_sub_u32 s15, s15, 1
    s_cbranch_scc1 L_abort
    s_waitcnt vmcnt(2)
    v_cmp_eq_u32 vcc, -1, v8
L_rec_As13_0:
    s_cbranch_vccnz L_rec_Af13_0
    v_smfmac_f32_16x16x64_bf16 v[24:27], v[8:11], a[0:7], v1
    v_smfmac_f32_16x16x64_bf16 v[32:35], v[8:11], a[64:71], v1
    s_waitcnt vmcnt(1)
    v_cmp_eq_u32 vcc, -1, v16
    v_smfmac_f32_16x16x64_bf16 v[28:31], v[8:11], a[8:15], v1
    v_smfmac_f32_16x16x64_bf16 v[36:39], v[8:11], a[72:79], v1
    s_branch L_rec_As12_2
L_rec_Af14_1:
    s_mov_b64 exec, vcc
    buffer_load_dwordx4 v[12:15], v120, s[4:7], s69 offen sc1
    s_mov_b64 exec, -1
    s_waitcnt vmcnt(2)
    v_cmp_eq_u32 vcc, -1, v16
L_rec_As14_2:
    s_cbranch_vccnz L_rec_Af14_2
    v_smfmac_f32_16x16x64_bf16 v[24:27], v[16:19], a[32:39], v1
    v_smfmac_f32_16x16x64_bf16 v[32:35], v[16:19], a[96:103], v1
    s_waitcnt vmcnt(1)
    v_cmp_eq_u32 vcc, -1, v20
    v_smfmac_f32_16x16x64_bf16 v[28:31], v[16:19], a[40:47], v1
    v_smfmac_f32_16x16x64_bf16 v[36:39], v[16:19], a[104:111], v1
L_rec_As10_3:
    s_cbranch_vccnz L_rec_Af10_3
    v_smfmac_f32_16x16x64_bf16 v[24:27], v[20:23], a[48:55], v1
    v_smfmac_f32_16x16x64_bf16 v[32:35], v[20:23], a[112:119], v1
    s_waitcnt vmcnt(0)
    v_cmp_eq_u32 vcc, -1, v12
    v_smfmac_f32_16x16x64_bf16 v[28:31], v[20:23], a[56:63], v1
    v_smfmac_f32_16x16x64_bf16 v[36:39], v[20:23], a[120:127], v1
    s_branch L_rec_As2_1
L_rec_Af14_2:
    s_mov_b64 exec, vcc
    buffer_load_dwordx4 v[16:19], v121, s[4:7], s69 offen sc1
    s_mov_b64 exec, -1
    s_waitcnt vmcnt(2)
    v_cmp_eq_u32 vcc, -1, v20
L_rec_As14_3:
    s_cbranch_vccnz L_rec_Af14_3
    v_smfmac_f32_16x16x64_bf16 v[24:27], v[20:23], a[48:55], v1
    v_smfmac_f32_16x16x64_bf16 v[32:35], v[20:23], a[112:119], v1
    s_waitcnt vmcnt(1)
    v_cmp_eq_u32 vcc, -1, v12
    v_smfmac_f32_16x16x64_bf16 v[28:31], v[20:23], a[56:63], v1
    v_smfmac_f32_16x16x64_bf16 v[36:39], v[20:23], a[120:127], v1
    s_branch L_rec_As6_1
L_rec_Af14_3:
    s_mov_b64 exec, vcc
    buffer_load_dwordx4 v[20:23], v122, s[4:7], s69 offen sc1
    s_mov_b64 exec, -1
    s_sub_u32 s15, s15, 1
    s_cbranch_scc1 L_abort
    s_waitcnt vmcnt(2)
    v_cmp_eq_u32 vcc, -1, v12
    s_branch L_rec_As14_1
L_rec_Af3_0:
    s_mov_b64 exec, vcc
    buffer_load_dwordx4 v[8:11], v2, s[4:7], s69 offen sc1
    s_mov_b64 exec, -1
    s_waitcnt vmcnt(1)
    v_cmp_eq_u32 vcc, -1, v12
L_rec_As3_1:
    s_cbranch_vccnz L_rec_Af3_1
    v_smfmac_f32_16x16x64_bf16 v[24:27], v[12:15], a[16:23], v1
    v_smfmac_f32_16x16x64_bf16 v[32:35], v[12:15], a[80:87], v1
    s_waitcnt vmcnt(0)
    v_cmp_eq_u32 vcc, -1, v8
    v_smfmac_f32_16x16x64_bf16 v[28:31], v[12:15], a[24:31], v1
    v_smfmac_f32_16x16x64_bf16 v[36:39], v[12:15], a[88:95], v1
    s_branch L_rec_As1_0
L_rec_Af3_1:
    s_mov_b64 exec, vcc
    buffer_load_dwordx4 v[12:15], v120, s[4:7], s69 offen sc1
    s_mov_b64 exec, -1
    s_sub_u32 s15, s15, 1
    s_cbranch_scc1 L_abort
    s_waitcnt vmcnt(1)
    v_cmp_eq_u32 vcc, -1, v8
    s_branch L_rec_As3_0
L_rec_Af5_0:
    s_mov_b64 exec, vcc
    buffer_load_dwordx4 v[8:11], v2, s[4:7], s69 offen sc1
    s_mov_b64 exec, -1
    s_waitcnt vmcnt(1)
    v_cmp_eq_u32 vcc, -1, v16
    s_branch L_rec_As5_2
L_rec_Af5_2:
    s_mov_b64 exec, vcc
    buffer_load_dwordx4 v[16:19], v121, s[4:7], s69 offen sc1
    s_mov_b64 exec, -1
    s_sub_u32 s15, s15, 1
    s_cbranch_scc1 L_abort
    s_waitcnt vmcnt(1)
    v_cmp_eq_u32 vcc, -1, v8
    s_branch L_rec_As5_0
L_rec_Af6_1:
    s_mov_b64 exec, vcc
    buffer_load_dwordx4 v[12:15], v120, s[4:7], s69 offen sc1
    s_mov_b64 exec, -1
    s_waitcnt vmcnt(1)
    v_cmp_eq_u32 vcc, -1, v16
L_rec_As6_2:
    s_cbranch_vccnz L_rec_Af6_2
    v_smfmac_f32_16x16x64_bf16 v[24:27], v[16:19], a[32:39], v1
    v_smfmac_f32_16x16x64_bf16 v[32:35], v[16:19], a[96:103], v1
    s_waitcnt vmcnt(0)
    v_cmp_eq_u32 vcc, -1, v12
    v_smfmac_f32_16x16x64_bf16 v[28:31], v[16:19], a[40:47], v1
    v_smfmac_f32_16x16x64_bf16 v[36:39], v[16:19], a[104:111], v1
    s_branch L_rec_As2_1
L_rec_Af6_2:
    s_mov_b64 exec, vcc
    buffer_load_dwordx4 v[16:19], v121, s[4:7], s69 offen sc1
    s_mov_b64 exec, -1
    s_sub_u32 s15, s15, 1
    s_cbranch_scc1 L_abort
    s_waitcnt vmcnt(1)
    v_cmp_eq_u32 vcc, -1, v12
    s_branch L_rec_As6_1
L_rec_Af9_0:
    s_mov_b64 exec, vcc
    buffer_load_dwordx4 v[8:11], v2, s[4:7], s69 offen sc1
    s_mov_b64 exec, -1
    s_waitcnt vmcnt(1)
    v_cmp_eq_u32 vcc, -1, v20
    s_branch L_rec_As9_3
L_rec_Af9_3:
    s_mov_b64 exec, vcc
    buffer_load_dwordx4 v[20:23], v122, s[4:7], s69 offen sc1
    s_mov_b64 exec, -1
    s_sub_u32 s15, s15, 1
    s_cbranch_scc1 L_abort
    s_waitcnt vmcnt(1)
    v_cmp_eq_u32 vcc, -1, v8
L_rec_As9_0:
    s_cbranch_vccnz L_rec_Af9_0
    v_smfmac_f32_16x16x64_bf16 v[24:27], v[8:11], a[0:7], v1
    v_smfmac_f32_16x16x64_bf16 v[32:35], v[8:11], a[64:71], v1
    s_waitcnt vmcnt(0)
    v_cmp_eq_u32 vcc, -1, v20
    v_smfmac_f32_16x16x64_bf16 v[28:31], v[8:11], a[8:15], v1
    v_smfmac_f32_16x16x64_bf16 v[36:39], v[8:11], a[72:79], v1
    s_branch L_rec_As8_3
L_rec_Af10_1:
    s_mov_b64 exec, vcc
    buffer_load_dwordx4 v[12:15], v120, s[4:7], s69 offen sc1
    s_mov_b64 exec, -1
    s_waitcnt vmcnt(1)
    v_cmp_eq_u32 vcc, -1, v20
    s_branch L_rec_As10_3
L_rec_Af10_3:
    s_mov_b64 exec, vcc
    buffer_load_dwordx4 v[20:23], v122, s[4:7], s69 offen sc1
    s_mov_b64 exec, -1
    s_sub_u32 s15, s15, 1
    s_cbranch_scc1 L_abort
    s_waitcnt vmcnt(1)
    v_cmp_eq_u32 vcc, -1, v12
    s_branch L_rec_As10_1
L_rec_Af12_2:
    s_mov_b64 exec, vcc
    buffer_load_dwordx4 v[16:19], v121, s[4:7], s69 offen sc1
    s_mov_b64 exec, -1
    s_waitcnt vmcnt(1)
    v_cmp_eq_u32 vcc, -1, v20
L_rec_As12_3:
    s_cbranch_vccnz L_rec_Af12_3
    v_smfmac_f32_16x16x64_bf16 v[24:27], v[20:23], a[48:55], v1
    v_smfmac_f32_16x16x64_bf16 v[32:35], v[20:23], a[112:119], v1
    s_waitcnt vmcnt(0)
    v_cmp_eq_u32 vcc, -1, v16
    v_smfmac_f32_16x16x64_bf16 v[28:31], v[20:23], a[56:63], v1
    v_smfmac_f32_16x16x64_bf16 v[36:39], v[20:23], a[120:127], v1
    s_branch L_rec_As4_2
L_rec_Af12_3:
    s_mov_b64 exec, vcc
    buffer_load_dwordx4 v[20:23], v122, s[4:7], s69 offen sc1
    s_mov_b64 exec, -1
    s_sub_u32 s15, s15, 1
    s_cbranch_scc1 L_abort
    s_waitcnt vmcnt(1)
    v_cmp_eq_u32 vcc, -1, v16
    s_branch L_rec_As12_2
L_rec_Af1_0:
    s_mov_b64 exec, vcc
    buffer_load_dwordx4 v[8:11], v2, s[4:7], s69 offen sc1
    s_mov_b64 exec, -1
    s_sub_u32 s15, s15, 1
    s_cbranch_scc1 L_abort
    s_waitcnt vmcnt(0)
    v_cmp_eq_u32 vcc, -1, v8
    s_branch L_rec_As1_0
L_rec_Af2_1:
    s_mov_b64 exec, vcc
    buffer_load_dwordx4 v[12:15], v120, s[4:7], s69 offen sc1
    s_mov_b64 exec, -1
    s_sub_u32 s15, s15, 1
    s_cbranch_scc1 L_abort
    s_waitcnt vmcnt(0)
    v_cmp_eq_u32 vcc, -1, v12
    s_branch L_rec_As2_1
L_rec_Af4_2:
    s_mov_b64 exec, vcc
    buffer_load_dwordx4 v[16:19], v121, s[4:7], s69 offen sc1
    s_mov_b64 exec, -1
    s_sub_u32 s15, s15, 1
    s_cbranch_scc1 L_abort
    s_waitcnt vmcnt(0)
    v_cmp_eq_u32 vcc, -1, v16
    s_branch L_rec_As4_2
L_rec_Af8_3:
    s_mov_b64 exec, vcc
    buffer_load_dwordx4 v[20:23], v122, s[4:7], s69 offen sc1
    s_mov_b64 exec, -1
    s_sub_u32 s15, s15, 1
    s_cbranch_scc1 L_abort
    s_waitcnt vmcnt(0)
    v_cmp_eq_u32 vcc, -1, v20
    s_branch L_rec_As8_3
L_rec_Of15_0:
    s_mov_b64 exec, vcc
    buffer_load_dwordx4 v[8:11], v2, s[4:7], s65 offen sc1
    s_mov_b64 exec, -1
    s_waitcnt vmcnt(3)
    v_cmp_eq_u32 vcc, -1, v12
L_rec_Os15_1:
    s_cbranch_vccnz L_rec_Of15_1
    v_smfmac_f32_16x16x64_bf16 v[48:51], v[12:15], a[208:215], v1
    s_waitcnt vmcnt(2)
    v_cmp_eq_u32 vcc, -1, v16
    v_smfmac_f32_16x16x64_bf16 v[52:55], v[12:15], a[216:223], v1
L_rec_Os13_2:
    s_cbranch_vccnz L_rec_Of13_2
    v_smfmac_f32_16x16x64_bf16 v[48:51], v[16:19], a[224:231], v1
    s_waitcnt vmcnt(1)
    v_cmp_eq_u32 vcc, -1, v20
    v_smfmac_f32_16x16x64_bf16 v[52:55], v[16:19], a[232:239], v1
L_rec_Os9_3:
    s_cbranch_vccnz L_rec_Of9_3
    v_smfmac_f32_16x16x64_bf16 v[48:51], v[20:23], a[240:247], v1
    s_waitcnt vmcnt(0)
    v_cmp_eq_u32 vcc, -1, v8
    v_smfmac_f32_16x16x64_bf16 v[52:55], v[20:23], a[248:255], v1
L_rec_Os1_0:
    s_cbranch_vccnz L_rec_Of1_0
    v_smfmac_f32_16x16x64_bf16 v[48:51], v[8:11], a[192:199], v1
    v_smfmac_f32_16x16x64_bf16 v[52:55], v[8:11], a[200:207], v1
    s_setpc_b64 s[58:59]
L_rec_Of15_1:
    s_mov_b64 exec, vcc
    buffer_load_dwordx4 v[12:15], v120, s[4:7], s65 offen sc1
    s_mov_b64 exec, -1
    s_waitcnt vmcnt(3)
    v_cmp_eq_u32 vcc, -1, v16
L_rec_Os15_2:
    s_cbranch_vccnz L_rec_Of15_2
    v_smfmac_f32_16x16x64_bf16 v[48:51], v[16:19], a[224:231], v1
    s_waitcnt vmcnt(2)
    v_cmp_eq_u32 vcc, -1, v20
    v_smfmac_f32_16x16x64_bf16 v[52:55], v[16:19], a[232:239], v1
L_rec_Os11_3:
    s_cbranch_vccnz L_rec_Of11_3
    v_smfmac_f32_16x16x64_bf16 v[48:51], v[20:23], a[240:247], v1
    s_waitcnt vmcnt(1)
    v_cmp_eq_u32 vcc, -1, v8
    v_smfmac_f32_16x16x64_bf16 v[52:55], v[20:23], a[248:255], v1
L_rec_Os3_0:
    s_cbranch_vccnz L_rec_Of3_0
    v_smfmac_f32_16x16x64_bf16 v[48:51], v[8:11], a[192:199], v1
    s_waitcnt vmcnt(0)
    v_cmp_eq_u32 vcc, -1, v12
    v_smfmac_f32_16x16x64_bf16 v[52:55], v[8:11], a[200:207], v1
L_rec_Os2_1:
    s_cbranch_vccnz L_rec_Of2_1
    v_smfmac_f32_16x16x64_bf16 v[48:51], v[12:15], a[208:215], v1
    v_smfmac_f32_16x16x64_bf16 v[52:55], v[12:15], a[216:223], v1
    s_setpc_b64 s[58:59]
L_rec_Of15_2:
    s_mov_b64 exec, vcc
    buffer_load_dwordx4 v[16:19], v121, s[4:7], s65 offen sc1
    s_mov_b64 exec, -1
    s_waitcnt vmcnt(3)
    v_cmp_eq_u32 vcc, -1, v20
L_rec_Os15_3:
    s_cbranch_vccnz L_rec_Of15_3
    v_smfmac_f32_16x16x64_bf16 v[48:51], v[20:23], a[240:247], v1
    s_waitcnt vmcnt(2)
    v_cmp_eq_u32 vcc, -1, v8
    v_smfmac_f32_16x16x64_bf16 v[52:55], v[20:23], a[248:255], v1
L_rec_Os7_0:
    s_cbranch_vccnz L_rec_Of7_0
    v_smfmac_f32_16x16x64_bf16 v[48:51], v[8:11], a[192:199], v1
    s_waitcnt vmcnt(1)
    v_cmp_eq_u32 vcc, -1, v12
    v_smfmac_f32_16x16x64_bf16 v[52:55], v[8:11], a[200:207], v1
L_rec_Os6_1:
    s_cbranch_vccnz L_rec_Of6_1
    v_smfmac_f32_16x16x64_bf16 v[48:51], v[12:15], a[208:215], v1
    s_waitcnt vmcnt(0)
    v_cmp_eq_u32 vcc, -1, v16
    v_smfmac_f32_16x16x64_bf16 v[52:55], v[12:15], a[216:223], v1
L_rec_Os4_2:
    s_cbranch_vccnz L_rec_Of4_2
    v_smfmac_f32_16x16x64_bf16 v[48:51], v[16:19], a[224:231], v1
    v_smfmac_f32_16x16x64_bf16 v[52:55], v[16:19], a[232:239], v1
    s_setpc_b64 s[58:59]
L_rec_Of15_3:
    s_mov_b64 exec, vcc
    buffer_load_dwordx4 v[20:23], v122, s[4:7], s65 offen sc1
    s_mov_b64 exec, -1
    s_sub_u32 s15, s15, 1
    s_cbranch_scc1 L_abort
    s_waitcnt vmcnt(3)
    v_cmp_eq_u32 vcc, -1, v8
L_rec_Os15_0:
    s_cbranch_vccnz L_rec_Of15_0
    v_smfmac_f32_16x16x64_bf16 v[48:51], v[8:11], a[192:199], v1
    s_waitcnt vmcnt(2)
    v_cmp_eq_u32 vcc, -1, v12
    v_smfmac_f32_16x16x64_bf16 v[52:55], v[8:11], a[200:207], v1
L_rec_Os14_1:
    s_cbranch_vccnz L_rec_Of14_1
    v_smfmac_f32_16x16x64_bf16 v[48:51], v[12:15], a[208:215], v1
    s_waitcnt vmcnt(1)
    v_cmp_eq_u32 vcc, -1, v16
    v_smfmac_f32_16x16x64_bf16 v[52:55], v[12:15], a[216:223], v1
L_rec_Os12_2:
    s_cbranch_vccnz L_rec_Of12_2
    v_smfmac_f32_16x16x64_bf16 v[48:51], v[16:19], a[224:231], v1
    s_waitcnt vmcnt(0)
    v_cmp_eq_u32 vcc, -1, v20
    v_smfmac_f32_16x16x64_bf16 v[52:55], v[16:19], a[232:239], v1
L_rec_Os8_3:
    s_cbranch_vccnz L_rec_Of8_3
    v_smfmac_f32_16x16x64_bf16 v[48:51], v[20:23], a[240:247], v1
    v_smfmac_f32_16x16x64_bf16 v[52:55], v[20:23], a[248:255], v1
    s_setpc_b64 s[58:59]
L_rec_Of7_0:
    s_mov_b64 exec, vcc
    buffer_load_dwordx4 v[8:11], v2, s[4:7], s65 offen sc1
    s_mov_b64 exec, -1
    s_waitcnt vmcnt(2)
    v_cmp_eq_u32 vcc, -1, v12
L_rec_Os7_1:
    s_cbranch_vccnz L_rec_Of7_1
    v_smfmac_f32_16x16x64_bf16 v[48:51], v[12:15], a[208:215], v1
    s_waitcnt vmcnt(1)
    v_cmp_eq_u32 vcc, -1, v16
    v_smfmac_f32_16x16x64_bf16 v[52:55], v[12:15], a[216:223], v1
L_rec_Os5_2:
    s_cbranch_vccnz L_rec_Of5_2
    v_smfmac_f32_16x16x64_bf16 v[48:51], v[16:19], a[224:231], v1
    s_waitcnt vmcnt(0)
    v_cmp_eq_u32 vcc, -1, v8
    v_smfmac_f32_16x16x64_bf16 v[52:55], v[16:19], a[232:239], v1
    s_branch L_rec_Os1_0
L_rec_Of7_1:
    s_mov_b64 exec, vcc
    buffer_load_dwordx4 v[12:15], v120, s[4:7], s65 offen sc1
    s_mov_b64 exec, -1
    s_waitcnt vmcnt(2)
    v_cmp_eq_u32 vcc, -1, v16
L_rec_Os7_2:
    s_cbranch_vccnz L_rec_Of7_2
    v_smfmac_f32_16x16x64_bf16 v[48:51], v[16:19], a[224:231], v1
    s_waitcnt vmcnt(1)
    v_cmp_eq_u32 vcc, -1, v8
    v_smfmac_f32_16x16x64_bf16 v[52:55], v[16:19], a[232:239], v1
    s_branch L_rec_Os3_0
L_rec_Of7_2:
    s_mov_b64 exec, vcc
    buffer_load_dwordx4 v[16:19], v121, s[4:7], s65 offen sc1
    s_mov_b64 exec, -1
    s_sub_u32 s15, s15, 1
    s_cbranch_scc1 L_abort
    s_waitcnt vmcnt(2)
    v_cmp_eq_u32 vcc, -1, v8
    s_branch L_rec_Os7_0
L_rec_Of11_0:
    s_mov_b64 exec, vcc
    buffer_load_dwordx4 v[8:11], v2, s[4:7], s65 offen sc1
    s_mov_b64 exec, -1
    s_waitcnt vmcnt(2)
    v_cmp_eq_u32 vcc, -1, v12
L_rec_Os11_1:
    s_cbranch_vccnz L_rec_Of11_1
    v_smfmac_f32_16x16x64_bf16 v[48:51], v[12:15], a[208:215], v1
    s_waitcnt vmcnt(1)
    v_cmp_eq_u32 vcc, -1, v20
    v_smfmac_f32_16x16x64_bf16 v[52:55], v[12:15], a[216:223], v1
    s_branch L_rec_Os9_3
L_rec_Of11_1:
    s_mov_b64 exec, vcc
    buffer_load_dwordx4 v[12:15], v120, s[4:7], s65 offen sc1
    s_mov_b64 exec, -1
    s_waitcnt vmcnt(2)
    v_cmp_eq_u32 vcc, -1, v20
    s_branch L_rec_Os11_3
L_rec_Of11_3:
    s_mov_b64 exec, vcc
    buffer_load_dwordx4 v[20:23], v122, s[4:7], s65 offen sc1
    s_mov_b64 exec, -1
    s_sub_u32 s15, s15, 1
    s_cbranch_scc1 L_abort
    s_waitcnt vmcnt(2)
    v_cmp_eq_u32 vcc, -1, v8
L_rec_Os11_0:
    s_cbranch_vccnz L_rec_Of11_0
    v_smfmac_f32_16x16x64_bf16 v[48:51], v[8:11], a[192:199], v1
    s_waitcnt vmcnt(1)
    v_cmp_eq_u32 vcc, -1, v12
    v_smfmac_f32_16x16x64_bf16 v[52:55], v[8:11], a[200:207], v1
L_rec_Os10_1:
    s_cbranch_vccnz L_rec_Of10_1
    v_smfmac_f32_16x16x64_bf16 v[48:51], v[12:15], a[208:215], v1
    s_waitcnt vmcnt(0)
    v_cmp_eq_u32 vcc, -1, v20
    v_smfmac_f32_16x16x64_bf16 v[52:55], v[12:15], a[216:223], v1
    s_branch L_rec_Os8_3
L_rec_Of13_0:
    s_mov_b64 exec, vcc
    buffer_load_dwordx4 v[8:11], v2, s[4:7], s65 offen sc1
    s_mov_b64 exec, -1
    s_waitcnt vmcnt(2)
    v_cmp_eq_u32 vcc, -1, v16
    s_branch L_rec_Os13_2
L_rec_Of13_2:
    s_mov_b64 exec, vcc
    buffer_load_dwordx4 v[16:19], v121, s[4:7], s65 offen sc1
    s_mov_b64 exec, -1
    s_waitcnt vmcnt(2)
    v_cmp_eq_u32 vcc, -1, v20
L_rec_Os13_3:
    s_cbranch_vccnz L_rec_Of13_3
    v_smfmac_f32_16x16x64_bf16 v[48:51], v[20:23], a[240:247], v1
    s_waitcnt vmcnt(1)
    v_cmp_eq_u32 vcc, -1, v8
    v_smfmac_f32_16x16x64_bf16 v[52:55], v[20:23], a[248:255], v1
L_rec_Os5_0:
    s_cbranch_vccnz L_rec_Of5_0
    v_smfmac_f32_16x16x64_bf16 v[48:51], v[8:11], a[192:199], v1
    s_waitcnt vmcnt(0)
    v_cmp_eq_u32 vcc, -1, v16
    v_smfmac_f32_16x16x64_bf16 v[52:55], v[8:11], a[200:207], v1
    s_branch L_rec_Os4_2
L_rec_Of13_3:
    s_mov_b64 exec, vcc
    buffer_load_dwordx4 v[20:23], v122, s[4:7], s65 offen sc1
    s_mov_b64 exec, -1
    s_sub_u32 s15, s15, 1
    s_cbranch_scc1 L_abort
    s_waitcnt vmcnt(2)
    v_cmp_eq_u32 vcc, -1, v8
L_rec_Os13_0:
    s_cbranch_vccnz L_rec_Of13_0
    v_smfmac_f32_16x16x64_bf16 v[48:51], v[8:11], a[192:199], v1
    s_waitcnt vmcnt(1)
    v_cmp_eq_u32 vcc, -1, v16
    v_smfmac_f32_16x16x64_bf16 v[52:55], v[8:11], a[200:207], v1
    s_branch L_rec_Os12_2
L_rec_Of14_1:
    s_mov_b64 exec, vcc
    buffer_load_dwordx4 v[12:15], v120, s[4:7], s65 offen sc1
    s_mov_b64 exec, -1
    s_waitcnt vmcnt(2)
    v_cmp_eq_u32 vcc, -1, v16
L_rec_Os14_2:
    s_cbranch_vccnz L_rec_Of14_2
    v_smfmac_f32_16x16x64_bf16 v[48:51], v[16:19], a[224:231], v1
    s_waitcnt vmcnt(1)
    v_cmp_eq_u32 vcc, -1, v20
    v_smfmac_f32_16x16x64_bf16 v[52:55], v[16:19], a[232:239], v1
L_rec_Os10_3:
    s_cbranch_vccnz L_rec_Of10_3
    v_smfmac_f32_16x16x64_bf16 v[48:51], v[20:23], a[240:247], v1
    s_waitcnt vmcnt(0)
    v_cmp_eq_u32 vcc, -1, v12
    v_smfmac_f32_16x16x64_bf16 v[52:55], v[20:23], a[248:255], v1
    s_branch L_rec_Os2_1
L_rec_Of14_2:
    s_mov_b64 exec, vcc
    buffer_load_dwordx4 v[16:19], v121, s[4:7], s65 offen sc1
    s_mov_b64 exec, -1
    s_waitcnt vmcnt(2)
    v_cmp_eq_u32 vcc, -1, v20
L_rec_Os14_3:
    s_cbranch_vccnz L_rec_Of14_3
    v_smfmac_f32_16x16x64_bf16 v[48:51], v[20:23], a[240:247], v1
    s_waitcnt vmcnt(1)
    v_cmp_eq_u32 vcc, -1, v12
    v_smfmac_f32_16x16x64_bf16 v[52:55], v[20:23], a[248:255], v1
    s_branch L_rec_Os6_1
L_rec_Of14_3:
    s_mov_b64 exec, vcc
    buffer_load_dwordx4 v[20:23], v122, s[4:7], s65 offen sc1
    s_mov_b64 exec, -1
    s_sub_u32 s15, s15, 1
    s_cbranch_scc1 L_abort
    s_waitcnt vmcnt(2)
    v_cmp_eq_u32 vcc, -1, v12
    s_branch L_rec_Os14_1
L_rec_Of3_0:
    s_mov_b64 exec, vcc
    buffer_load_dwordx4 v[8:11], v2, s[4:7], s65 offen sc1
    s_mov_b64 exec, -1
    s_waitcnt vmcnt(1)
    v_cmp_eq_u32 vcc, -1, v12
L_rec_Os3_1:
    s_cbranch_vccnz L_rec_Of3_1
    v_smfmac_f32_16x16x64_bf16 v[48:51], v[12:15], a[208:215], v1
    s_waitcnt vmcnt(0)
    v_cmp_eq_u32 vcc, -1, v8
    v_smfmac_f32_16x16x64_bf16 v[52:55], v[12:15], a[216:223], v1
    s_branch L_rec_Os1_0
L_rec_Of3_1:
    s_mov_b64 exec, vcc
    buffer_load_dwordx4 v[12:15], v120, s[4:7], s65 offen sc1
    s_mov_b64 exec, -1
    s_sub_u32 s15, s15, 1
    s_cbranch_scc1 L_abort
    s_waitcnt vmcnt(1)
    v_cmp_eq_u32 vcc, -1, v8
    s_branch L_rec_Os3_0
L_rec_Of5_0:
    s_mov_b64 exec, vcc
    buffer_load_dwordx4 v[8:11], v2, s[4:7], s65 offen sc1
    s_mov_b64 exec, -1
    s_waitcnt vmcnt(1)
    v_cmp_eq_u32 vcc, -1, v16
    s_branch L_rec_Os5_2
L_rec_Of5_2:
    s_mov_b64 exec, vcc
    buffer_load_dwordx4 v[16:19], v121, s[4:7], s65 offen sc1
    s_mov_b64 exec, -1
    s_sub_u32 s15, s15, 1
    s_cbranch_scc1 L_abort
    s_waitcnt vmcnt(1)
    v_cmp_eq_u32 vcc, -1, v8
    s_branch L_rec_Os5_0
L_rec_Of6_1:
    s_mov_b64 exec, vcc
    buffer_load_dwordx4 v[12:15], v120, s[4:7], s65 offen sc1
    s_mov_b64 exec, -1
    s_waitcnt vmcnt(1)
    v_cmp_eq_u32 vcc, -1, v16
L_rec_Os6_2:
    s_cbranch_vccnz L_rec_Of6_2
    v_smfmac_f32_16x16x64_bf16 v[48:51], v[16:19], a[224:231], v1
    s_waitcnt vmcnt(0)
    v_cmp_eq_u32 vcc, -1, v12
    v_smfmac_f32_16x16x64_bf16 v[52:55], v[16:19], a[232:239], v1
    s_branch L_rec_Os2_1
L_rec_Of6_2:
    s_mov_b64 exec, vcc
    buffer_load_dwordx4 v[16:19], v121, s[4:7], s65 offen sc1
    s_mov_b64 exec, -1
    s_sub_u32 s15, s15, 1
    s_cbranch_scc1 L_abort
    s_waitcnt vmcnt(1)
    v_cmp_eq_u32 vcc, -1, v12
    s_branch L_rec_Os6_1
L_rec_Of9_0:
    s_mov_b64 exec, vcc
    buffer_load_dwordx4 v[8:11], v2, s[4:7], s65 offen sc1
    s_mov_b64 exec, -1
    s_waitcnt vmcnt(1)
    v_cmp_eq_u32 vcc, -1, v20
    s_branch L_rec_Os9_3
L_rec_Of9_3:
    s_mov_b64 exec, vcc
    buffer_load_dwordx4 v[20:23], v122, s[4:7], s65 offen sc1
    s_mov_b64 exec, -1
    s_sub_u32 s15, s15, 1
    s_cbranch_scc1 L_abort
    s_waitcnt vmcnt(1)
    v_cmp_eq_u32 vcc, -1, v8
L_rec_Os9_0:
    s_cbranch_vccnz L_rec_Of9_0
    v_smfmac_f32_16x16x64_bf16 v[48:51], v[8:11], a[192:199], v1
    s_waitcnt vmcnt(0)
    v_cmp_eq_u32 vcc, -1, v20
    v_smfmac_f32_16x16x64_bf16 v[52:55], v[8:11], a[200:207], v1
    s_branch L_rec_Os8_3
L_rec_Of10_1:
    s_mov_b64 exec, vcc
    buffer_load_dwordx4 v[12:15], v120, s[4:7], s65 offen sc1
    s_mov_b64 exec, -1
    s_waitcnt vmcnt(1)
    v_cmp_eq_u32 vcc, -1, v20
    s_branch L_rec_Os10_3
L_rec_Of10_3:
    s_mov_b64 exec, vcc
    buffer_load_dwordx4 v[20:23], v122, s[4:7], s65 offen sc1
    s_mov_b64 exec, -1
    s_sub_u32 s15, s15, 1
    s_cbranch_scc1 L_abort
    s_waitcnt vmcnt(1)
    v_cmp_eq_u32 vcc, -1, v12
    s_branch L_rec_Os10_1
L_rec_Of12_2:
    s_mov_b64 exec, vcc
    buffer_load_dwordx4 v[16:19], v121, s[4:7], s65 offen sc1
    s_mov_b64 exec, -1
    s_waitcnt vmcnt(1)
    v_cmp_eq_u32 vcc, -1, v20
L_rec_Os12_3:
    s_cbranch_vccnz L_rec_Of12_3
    v_smfmac_f32_16x16x64_bf16 v[48:51], v[20:23], a[240:247], v1
    s_waitcnt vmcnt(0)
    v_cmp_eq_u32 vcc, -1, v16
    v_smfmac_f32_16x16x64_bf16 v[52:55], v[20:23], a[248:255], v1
    s_branch L_rec_Os4_2
L_rec_Of12_3:
    s_mov_b64 exec, vcc
    buffer_load_dwordx4 v[20:23], v122, s[4:7], s65 offen sc1
    s_mov_b64 exec, -1
    s_sub_u32 s15, s15, 1
    s_cbranch_scc1 L_abort
    s_waitcnt vmcnt(1)
    v_cmp_eq_u32 vcc, -1, v16
    s_branch L_rec_Os12_2
L_rec_Of1_0:
    s_mov_b64 exec, vcc
    buffer_load_dwordx4 v[8:11], v2, s[4:7], s65 offen sc1
    s_mov_b64 exec, -1
    s_sub_u32 s15, s15, 1
    s_cbranch_scc1 L_abort
    s_waitcnt vmcnt(0)
    v_cmp_eq_u32 vcc, -1, v8
    s_branch L_rec_Os1_0
L_rec_Of2_1:
    s_mov_b64 exec, vcc
    buffer_load_dwordx4 v[12:15], v120, s[4:7], s65 offen sc1
    s_mov_b64 exec, -1
    s_sub_u32 s15, s15, 1
    s_cbranch_scc1 L_abort
    s_waitcnt vmcnt(0)
    v_cmp_eq_u32 vcc, -1, v12
    s_branch L_rec_Os2_1
L_rec_Of4_2:
    s_mov_b64 exec, vcc
    buffer_load_dwordx4 v[16:19], v121, s[4:7], s65 offen sc1
    s_mov_b64 exec, -1
    s_sub_u32 s15, s15, 1
    s_cbranch_scc1 L_abort
    s_waitcnt vmcnt(0)
    v_cmp_eq_u32 vcc, -1, v16
    s_branch L_rec_Os4_2
L_rec_Of8_3:
    s_mov_b64 exec, vcc
    buffer_load_dwordx4 v[20:23], v122, s[4:7], s65 offen sc1
    s_mov_b64 exec, -1
    s_sub_u32 s15, s15, 1
    s_cbranch_scc1 L_abort
    s_waitcnt vmcnt(0)
    v_cmp_eq_u32 vcc, -1, v20
    s_branch L_rec_Os8_3
L_kvp_65:
    buffer_load_dwordx2 v[108:109], v110, s[4:7], 0 offen sc1
    s_sub_u32 s15, s15, 1
    s_cbranch_scc1 L_abort
    s_waitcnt vmcnt(0)
    v_min_u32 v108, v108, v109
    s_nop 0
    v_readfirstlane_b32 s75, v108
    s_nop 0
    s_cmp_le_u32 s75, s76
    s_cbranch_scc1 L_kvp_65
    s_branch L_kvo_66
L_restart:
    s_waitcnt vmcnt(0) lgkmcnt(0)
    s_cmp_lg_u32 s3, 64
    s_cbranch_scc1 L_abort
    s_mov_b32 s3, 128
    s_barrier
    v_mov_b32 v3, 163824
    s_cmp_lg_u32 s14, 0
    s_cbranch_scc1 L_tk_68
    s_lshl_b32 s64, s12, 2
    v_mov_b32 v1, s64
    v_mov_b32 v2, 1
    s_mov_b64 exec, 1
    global_atomic_add v2, v1, v2, s[44:45] offset:192 sc0
    s_waitcnt vmcnt(0)
    ds_write_b32 v3, v2
    s_mov_b64 exec, -1
    s_waitcnt lgkmcnt(0)
L_tk_68:
    s_barrier
    ds_read_b32 v2, v3
    s_waitcnt lgkmcnt(0)
    v_readfirstlane_b32 s13, v2
    s_nop 0
    s_cmp_lt_u32 s13, 32
    s_cbranch_scc1 L_roles
L_abort:
    v_mov_b32 v1, 240
    v_mov_b32 v2, 1
    s_mov_b64 exec, 1
    global_atomic_add v1, v2, s[44:45]
L_drain:
    s_waitcnt vmcnt(0) lgkmcnt(0)
L_exit:
    s_endpgm
.section .rodata,"a"
.p2align 6
.amdhsa_kernel gated_mix__memory_aug_recurrent_mem_tr__moe_arch_mod__prompt_kernel
  .amdhsa_next_free_vgpr 512
  .amdhsa_next_free_sgpr 102
  .amdhsa_accum_offset 256
  .amdhsa_group_segment_fixed_size 0
  .amdhsa_kernarg_size 128
  .amdhsa_user_sgpr_count 2
  .amdhsa_user_sgpr_kernarg_segment_ptr 1
  .amdhsa_system_sgpr_workgroup_id_x 1
  .amdhsa_float_denorm_mode_32 3
.end_amdhsa_kernel
```
